```python
import torch

def _softmax(x, axis=-1):
    return torch.softmax(x, dim=axis)

def _gelu(x):
    return torch.nn.functional.gelu(x, approximate='tanh')

def _silu(x):
    return torch.nn.functional.silu(x)

def _sigmoid(x):
    return torch.sigmoid(x)

def _layernorm(x, axis=-1, eps=1e-05):
    m = x.mean(dim=axis, keepdim=True)
    v = x.var(dim=axis, keepdim=True, unbiased=False)
    return (x - m) / torch.sqrt(v + eps)

def _scatter_add(tgt, idx, src, axis=0):
    return tgt.clone().index_add_(axis, idx, src)

def _segment_sum(src, seg, n):
    out = torch.zeros((n,) + src.shape[1:], dtype=src.dtype)
    return out.index_add_(0, seg, src)

def _pad(x, pw):
    flat = tuple((v for pair in reversed(pw) for v in pair))
    return torch.nn.functional.pad(x, flat)
kernel_name = 'parallel_sum__memory_aug_recurrent_mem_tr__moe_arch_mod__prompt'

def setup_inputs():

    _w = lambda a: (lambda t: t.to(torch.bfloat16) if t.is_floating_point() else t)(torch.as_tensor(a))

    def _A_setup():
        B, S, Dm = (1, 2048, 448)
        H, Dh = (16, 256)
        M, seg = (8, 32)
        seg = min(seg, S)
        S = S // seg * seg
        return {'x': _w((lambda *s: torch.randn(*s, dtype=torch.bfloat16) * 0.05)(B, S, Dm)), 'mem0': _w((lambda *s: torch.randn(*s, dtype=torch.bfloat16) * 1.6)(B, M, Dm)), 'Wq': _w((lambda *s: torch.randn(*s, dtype=torch.bfloat16) * 0.8)(Dm, H, Dh) * Dm ** (-0.5)), 'Wk': _w((lambda *s: torch.randn(*s, dtype=torch.bfloat16) * 0.8)(Dm, H, Dh) * Dm ** (-0.5)), 'Wv': _w((lambda *s: torch.randn(*s, dtype=torch.bfloat16) * 1.6)(Dm, H, Dh) * Dm ** (-0.5)), 'Wo': _w((lambda *s: torch.randn(*s, dtype=torch.bfloat16) * 1.6)(H, Dh, Dm) * (H * Dh) ** (-0.5)), 'seg_len': seg}
    _A_in = _A_setup()

    def _B_setup():
        B, S, D, F, C = (1, 2048, 448, 1792, 8)
        return {'x': _w((lambda *s: torch.randn(*s, dtype=torch.bfloat16) * 0.05)(B, S, D)), 'w_r': _w((lambda *s: torch.randn(*s, dtype=torch.bfloat16) * 0.05)(D)), 'w_gate': _w((lambda *s: torch.randn(*s, dtype=torch.bfloat16) * 0.05)(D, F)), 'w_up': _w((lambda *s: torch.randn(*s, dtype=torch.bfloat16) * 0.05)(D, F)), 'w_down': _w((lambda *s: torch.randn(*s, dtype=torch.bfloat16) * 0.05)(F, D))}
    _B_in = _B_setup()
    return {'A_x': _A_in['x'], 'A_mem0': _A_in['mem0'], 'A_Wq': _A_in['Wq'], 'A_Wk': _A_in['Wk'], 'A_Wv': _A_in['Wv'], 'A_Wo': _A_in['Wo'], 'A_seg_len': _A_in['seg_len'], 'B_x': _B_in['x'], 'B_w_r': _B_in['w_r'], 'B_w_gate': _B_in['w_gate'], 'B_w_up': _B_in['w_up'], 'B_w_down': _B_in['w_down']}

def reference(A_x, A_mem0, A_Wq, A_Wk, A_Wv, A_Wo, A_seg_len, B_x, B_w_r, B_w_gate, B_w_up, B_w_down):

    def _A_ref(x, mem0, Wq, Wk, Wv, Wo, seg_len):
        B, S, Dm = x.shape
        H, Dh = (Wq.shape[1], Wq.shape[2])
        M = mem0.shape[1]
        scale = Dh ** (-0.5)
        n_seg = S // seg_len
        L = M + seg_len
        idx = torch.arange(L)
        mask = (idx[:, None] < M) | (idx[:, None] >= idx[None, :])
        mem = mem0
        outs = []
        for s in range(n_seg):
            xs = x[:, s * seg_len:(s + 1) * seg_len, :].clone()
            h = torch.concatenate([mem, xs], axis=1)
            q = torch.einsum('btd,dhe->bhte', h, Wq)
            k = torch.einsum('btd,dhe->bhte', h, Wk)
            v = torch.einsum('btd,dhe->bhte', h, Wv)
            scores = torch.einsum('bhqe,bhke->bhqk', q, k) * scale
            scores = torch.where(mask[None, None], scores, -1000000000.0)
            p = _softmax(scores, axis=-1)
            o = torch.einsum('bhqk,bhke->bhqe', p, v)
            o = torch.einsum('bhte,hed->btd', o, Wo)
            mem = o[:, :M, :].clone()
            outs.append(o[:, M:, :])
        return torch.concatenate(outs, axis=1)

    def _B_ref(x, w_r, w_gate, w_up, w_down):
        B, S, D = x.shape
        C = 8
        r = x @ w_r
        idx = torch.argsort(-r, axis=-1)[:, :C]
        idx_e = (lambda x, n, axis: torch.repeat_interleave(x, n, dim=axis))(idx.reshape(B, C, 1), D, axis=2)
        x_sel = (lambda x, i, axis: torch.take_along_dim(x, i, dim=axis))(x, idx_e, axis=1)
        g = _silu(x_sel @ w_gate)
        u = x_sel @ w_up
        y = g * u @ w_down
        r_sel = _sigmoid((lambda x, i, axis: torch.take_along_dim(x, i, dim=axis))(r, idx, axis=1))
        y = y * r_sel.reshape(B, C, 1)
        b_off = (torch.arange(B) * S).reshape(B, 1)
        flat_idx = (idx + b_off).reshape(B * C)
        zero = (x * 0.0).reshape(B * S, D)
        upd = _scatter_add(zero, flat_idx, y.reshape(B * C, D), axis=0)
        return x + upd.reshape(B, S, D)
    x = A_x
    xn = _layernorm(x, axis=-1)
    return x + _A_ref(xn, A_mem0, A_Wq, A_Wk, A_Wv, A_Wo, A_seg_len) + _B_ref(xn, B_w_r, B_w_gate, B_w_up, B_w_down)
```

```asm
; @launch grid=(256,1,1) block=(256,1,1) lds=163840
.amdgcn_target "amdgcn-amd-amdhsa--gfx950"
.text
.globl parallel_sum__memory_aug_recurrent_mem_tr__moe_arch_mod__prompt_kernel
.p2align 8
.type parallel_sum__memory_aug_recurrent_mem_tr__moe_arch_mod__prompt_kernel,@function
parallel_sum__memory_aug_recurrent_mem_tr__moe_arch_mod__prompt_kernel:
    s_cmp_ge_u32 s2, 256
    s_cbranch_scc1 K3_end
    s_load_dwordx4 s[16:19], s[0:1], 104
    s_load_dwordx2 s[4:5], s[0:1], 0
    s_load_dwordx2 s[6:7], s[0:1], 96
    s_load_dwordx4 s[8:11], s[0:1], 72
    s_load_dwordx2 s[12:13], s[0:1], 88
    v_and_b32 v1, 63, v0
    v_lshrrev_b32 v3, 6, v0
    v_and_b32 v2, 15, v0
    v_readfirstlane_b32 s3, v3
    v_bfe_u32 v3, v0, 4, 2
    v_lshlrev_b32 v4, 4, v1
    s_and_b32 s20, s2, 7
    s_lshr_b32 s21, s2, 3
    s_waitcnt lgkmcnt(0)
    s_add_u32 s14, s18, 0x5d8c000
    s_addc_u32 s15, s19, 0
    s_load_dword s96, s[14:15], 0
    s_cmp_lg_u32 s20, 0
    s_cbranch_scc1 KM_worker
    s_load_dwordx2 s[76:77], s[0:1], 8
    s_load_dwordx2 s[78:79], s[0:1], 64
    s_waitcnt lgkmcnt(0)
    s_add_u32 s96, s96, 1
    s_lshl_b32 s95, s96, 3
    s_getreg_b32 s35, hwreg(HW_REG_XCC_ID, 0, 4)
    s_lshl_b32 s28, s96, 4
    s_or_b32 s35, s35, s28
    s_add_u32 s40, s18, 0x500000
    s_addc_u32 s41, s19, 0
    s_mov_b32 s42, 0x80000
    s_mov_b32 s43, 0x20000
    s_add_u32 s44, s18, 0x600000
    s_addc_u32 s45, s19, 0
    s_mov_b32 s46, 0xa0000
    s_mov_b32 s47, 0x20000
    s_lshl_b32 s23, s21, 2
    s_add_u32 s23, s23, s3
    s_mov_b32 s36, s4
    s_mov_b32 s37, s5
    s_mov_b32 s38, 0x1c0000
    s_mov_b32 s39, 0x20000
    s_mov_b32 s68, s78
    s_mov_b32 s69, s79
    s_mov_b32 s70, 0x380
    s_mov_b32 s71, 0x20000
    s_add_u32 s48, s18, 0x200000
    s_addc_u32 s49, s19, 0
    s_mov_b32 s50, 0x1c0000
    s_mov_b32 s51, 0x20000
    s_add_u32 s52, s18, 0x400000
    s_addc_u32 s53, s19, 0
    s_mov_b32 s54, 0x2000
    s_mov_b32 s55, 0x20000
    s_mov_b32 s64, s76
    s_mov_b32 s65, s77
    s_mov_b32 s66, 0x1c00
    s_mov_b32 s67, 0x20000
    v_mul_u32_u24 v7, 896, v2
    v_lshl_add_u32 v7, v3, 4, v7
    v_lshlrev_b32 v5, 4, v3
    s_mul_i32 s24, s23, 14336
    buffer_load_dwordx4 v[8:11], v7, s[36:39], s24 offen offset:0
    buffer_load_dwordx4 v[12:15], v7, s[36:39], s24 offen offset:64
    buffer_load_dwordx4 v[16:19], v7, s[36:39], s24 offen offset:128
    buffer_load_dwordx4 v[20:23], v7, s[36:39], s24 offen offset:192
    buffer_load_dwordx4 v[24:27], v7, s[36:39], s24 offen offset:256
    buffer_load_dwordx4 v[28:31], v7, s[36:39], s24 offen offset:320
    buffer_load_dwordx4 v[32:35], v7, s[36:39], s24 offen offset:384
    buffer_load_dwordx4 v[36:39], v7, s[36:39], s24 offen offset:448
    buffer_load_dwordx4 v[40:43], v7, s[36:39], s24 offen offset:512
    buffer_load_dwordx4 v[44:47], v7, s[36:39], s24 offen offset:576
    buffer_load_dwordx4 v[48:51], v7, s[36:39], s24 offen offset:640
    buffer_load_dwordx4 v[52:55], v7, s[36:39], s24 offen offset:704
    buffer_load_dwordx4 v[56:59], v7, s[36:39], s24 offen offset:768
    buffer_load_dwordx4 v[60:63], v7, s[36:39], s24 offen offset:832
    s_mov_b64 exec, 0
    s_cmp_eq_u32 s3, 0
    s_cbranch_scc1 KL_wm_p0
    s_cmp_eq_u32 s3, 1
    s_cbranch_scc1 KL_wm_p11
    s_cmp_eq_u32 s3, 2
    s_cbranch_scc1 KL_wm_p22
    s_branch KL_wm_p33
KL_wm_ret:
    s_mov_b64 exec, -1
    buffer_load_dwordx4 v[64:67], v5, s[68:71], 0 offen offset:0
    buffer_load_dwordx4 v[68:71], v5, s[68:71], 0 offen offset:64
    buffer_load_dwordx4 v[72:75], v5, s[68:71], 0 offen offset:128
    buffer_load_dwordx4 v[76:79], v5, s[68:71], 0 offen offset:192
    buffer_load_dwordx4 v[80:83], v5, s[68:71], 0 offen offset:256
    buffer_load_dwordx4 v[84:87], v5, s[68:71], 0 offen offset:320
    buffer_load_dwordx4 v[88:91], v5, s[68:71], 0 offen offset:384
    buffer_load_dwordx4 v[92:95], v5, s[68:71], 0 offen offset:448
    buffer_load_dwordx4 v[96:99], v5, s[68:71], 0 offen offset:512
    buffer_load_dwordx4 v[100:103], v5, s[68:71], 0 offen offset:576
    buffer_load_dwordx4 v[104:107], v5, s[68:71], 0 offen offset:640
    buffer_load_dwordx4 v[108:111], v5, s[68:71], 0 offen offset:704
    buffer_load_dwordx4 v[112:115], v5, s[68:71], 0 offen offset:768
    buffer_load_dwordx4 v[116:119], v5, s[68:71], 0 offen offset:832
    s_cmp_lg_u32 s23, 120
    s_cbranch_scc1 KL_nomem
    v_lshrrev_b32 v6, 1, v2
    v_mul_u32_u24 v6, 896, v6
    v_lshl_add_u32 v6, v3, 5, v6
    v_and_b32 v5, 1, v2
    v_cmp_eq_u32 vcc, 1, v5
    buffer_load_dwordx4 v[120:123], v6, s[64:67], 0 offen offset:0
    buffer_load_dwordx4 v[124:127], v6, s[64:67], 0 offen offset:16
    buffer_load_dwordx4 v[128:131], v6, s[64:67], 0 offen offset:128
    buffer_load_dwordx4 v[132:135], v6, s[64:67], 0 offen offset:144
    buffer_load_dwordx4 v[136:139], v6, s[64:67], 0 offen offset:256
    buffer_load_dwordx4 v[140:143], v6, s[64:67], 0 offen offset:272
    buffer_load_dwordx4 v[144:147], v6, s[64:67], 0 offen offset:384
    buffer_load_dwordx4 v[148:151], v6, s[64:67], 0 offen offset:400
    buffer_load_dwordx4 v[152:155], v6, s[64:67], 0 offen offset:512
    buffer_load_dwordx4 v[156:159], v6, s[64:67], 0 offen offset:528
    buffer_load_dwordx4 v[160:163], v6, s[64:67], 0 offen offset:640
    buffer_load_dwordx4 v[164:167], v6, s[64:67], 0 offen offset:656
    buffer_load_dwordx4 v[168:171], v6, s[64:67], 0 offen offset:768
    buffer_load_dwordx4 v[172:175], v6, s[64:67], 0 offen offset:784
    s_waitcnt vmcnt(0)
    s_mov_b32 s27, 0xfffefffe
    v_cndmask_b32 v176, v120, v121, vcc
    v_pk_min_u16 v176, v176, s27
    v_cndmask_b32 v177, v122, v123, vcc
    v_pk_min_u16 v177, v177, s27
    v_cndmask_b32 v178, v124, v125, vcc
    v_pk_min_u16 v178, v178, s27
    v_cndmask_b32 v179, v126, v127, vcc
    v_pk_min_u16 v179, v179, s27
    s_mov_b32 s25, 0
    buffer_store_dwordx4 v[176:179], v4, s[40:43], s25 offen sc1
    v_cndmask_b32 v180, v128, v129, vcc
    v_pk_min_u16 v180, v180, s27
    v_cndmask_b32 v181, v130, v131, vcc
    v_pk_min_u16 v181, v181, s27
    v_cndmask_b32 v182, v132, v133, vcc
    v_pk_min_u16 v182, v182, s27
    v_cndmask_b32 v183, v134, v135, vcc
    v_pk_min_u16 v183, v183, s27
    s_mov_b32 s25, 1024
    buffer_store_dwordx4 v[180:183], v4, s[40:43], s25 offen sc1
    v_cndmask_b32 v184, v136, v137, vcc
    v_pk_min_u16 v184, v184, s27
    v_cndmask_b32 v185, v138, v139, vcc
    v_pk_min_u16 v185, v185, s27
    v_cndmask_b32 v186, v140, v141, vcc
    v_pk_min_u16 v186, v186, s27
    v_cndmask_b32 v187, v142, v143, vcc
    v_pk_min_u16 v187, v187, s27
    s_mov_b32 s25, 2048
    buffer_store_dwordx4 v[184:187], v4, s[40:43], s25 offen sc1
    v_cndmask_b32 v188, v144, v145, vcc
    v_pk_min_u16 v188, v188, s27
    v_cndmask_b32 v189, v146, v147, vcc
    v_pk_min_u16 v189, v189, s27
    v_cndmask_b32 v190, v148, v149, vcc
    v_pk_min_u16 v190, v190, s27
    v_cndmask_b32 v191, v150, v151, vcc
    v_pk_min_u16 v191, v191, s27
    s_mov_b32 s25, 3072
    buffer_store_dwordx4 v[188:191], v4, s[40:43], s25 offen sc1
    v_cndmask_b32 v192, v152, v153, vcc
    v_pk_min_u16 v192, v192, s27
    v_cndmask_b32 v193, v154, v155, vcc
    v_pk_min_u16 v193, v193, s27
    v_cndmask_b32 v194, v156, v157, vcc
    v_pk_min_u16 v194, v194, s27
    v_cndmask_b32 v195, v158, v159, vcc
    v_pk_min_u16 v195, v195, s27
    s_mov_b32 s25, 4096
    buffer_store_dwordx4 v[192:195], v4, s[40:43], s25 offen sc1
    v_cndmask_b32 v196, v160, v161, vcc
    v_pk_min_u16 v196, v196, s27
    v_cndmask_b32 v197, v162, v163, vcc
    v_pk_min_u16 v197, v197, s27
    v_cndmask_b32 v198, v164, v165, vcc
    v_pk_min_u16 v198, v198, s27
    v_cndmask_b32 v199, v166, v167, vcc
    v_pk_min_u16 v199, v199, s27
    s_mov_b32 s25, 5120
    buffer_store_dwordx4 v[196:199], v4, s[40:43], s25 offen sc1
    v_cndmask_b32 v200, v168, v169, vcc
    v_pk_min_u16 v200, v200, s27
    v_cndmask_b32 v201, v170, v171, vcc
    v_pk_min_u16 v201, v201, s27
    v_cndmask_b32 v202, v172, v173, vcc
    v_pk_min_u16 v202, v202, s27
    v_cndmask_b32 v203, v174, v175, vcc
    v_pk_min_u16 v203, v203, s27
    s_mov_b32 s25, 6144
    buffer_store_dwordx4 v[200:203], v4, s[40:43], s25 offen sc1
    s_waitcnt vmcnt(0)
KL_nomem:
KL_wm_p0:
    s_cbranch_execz KL_wm_p1
    s_waitcnt vmcnt(14)
    s_mov_b32 s26, 0xffff0000
    s_mov_b32 s27, 0x3f803f80
    v_mov_b32 v236, 0
    v_mov_b32 v237, 0
    v_dot2_f32_bf16 v236, v8, s27, v236
    v_lshlrev_b32 v120, 16, v8
    v_and_b32 v121, s26, v8
    v_dot2_f32_bf16 v237, v9, s27, v237
    v_lshlrev_b32 v122, 16, v9
    v_and_b32 v123, s26, v9
    v_dot2_f32_bf16 v236, v10, s27, v236
    v_lshlrev_b32 v124, 16, v10
    v_and_b32 v125, s26, v10
    v_dot2_f32_bf16 v237, v11, s27, v237
    v_lshlrev_b32 v126, 16, v11
    v_and_b32 v127, s26, v11
    v_dot2_f32_bf16 v236, v12, s27, v236
    v_lshlrev_b32 v128, 16, v12
    v_and_b32 v129, s26, v12
KL_wm_p1:
    s_cbranch_execz KL_wm_p2
    v_dot2_f32_bf16 v237, v13, s27, v237
    v_lshlrev_b32 v130, 16, v13
    v_and_b32 v131, s26, v13
    v_dot2_f32_bf16 v236, v14, s27, v236
    v_lshlrev_b32 v132, 16, v14
    v_and_b32 v133, s26, v14
    v_dot2_f32_bf16 v237, v15, s27, v237
    v_lshlrev_b32 v134, 16, v15
    v_and_b32 v135, s26, v15
    v_dot2_f32_bf16 v236, v16, s27, v236
    v_lshlrev_b32 v136, 16, v16
    v_and_b32 v137, s26, v16
    v_dot2_f32_bf16 v237, v17, s27, v237
    v_lshlrev_b32 v138, 16, v17
    v_and_b32 v139, s26, v17
    v_dot2_f32_bf16 v236, v18, s27, v236
    v_lshlrev_b32 v140, 16, v18
    v_and_b32 v141, s26, v18
    v_dot2_f32_bf16 v237, v19, s27, v237
    v_lshlrev_b32 v142, 16, v19
KL_wm_p2:
    s_cbranch_execz KL_wm_p3
    v_and_b32 v143, s26, v19
    v_dot2_f32_bf16 v236, v20, s27, v236
    v_lshlrev_b32 v144, 16, v20
    v_and_b32 v145, s26, v20
    v_dot2_f32_bf16 v237, v21, s27, v237
    v_lshlrev_b32 v146, 16, v21
    v_and_b32 v147, s26, v21
    v_dot2_f32_bf16 v236, v22, s27, v236
    v_lshlrev_b32 v148, 16, v22
    v_and_b32 v149, s26, v22
    v_dot2_f32_bf16 v237, v23, s27, v237
    v_lshlrev_b32 v150, 16, v23
    v_and_b32 v151, s26, v23
    v_dot2_f32_bf16 v236, v24, s27, v236
    v_lshlrev_b32 v152, 16, v24
    v_and_b32 v153, s26, v24
    v_dot2_f32_bf16 v237, v25, s27, v237
    v_lshlrev_b32 v154, 16, v25
    v_and_b32 v155, s26, v25
    v_dot2_f32_bf16 v236, v26, s27, v236
KL_wm_p3:
    s_cbranch_execz KL_wm_p4
    v_lshlrev_b32 v156, 16, v26
    v_and_b32 v157, s26, v26
    v_dot2_f32_bf16 v237, v27, s27, v237
    v_lshlrev_b32 v158, 16, v27
    v_and_b32 v159, s26, v27
    v_dot2_f32_bf16 v236, v28, s27, v236
    v_lshlrev_b32 v160, 16, v28
    v_and_b32 v161, s26, v28
    v_dot2_f32_bf16 v237, v29, s27, v237
    v_lshlrev_b32 v162, 16, v29
    v_and_b32 v163, s26, v29
    v_dot2_f32_bf16 v236, v30, s27, v236
    v_lshlrev_b32 v164, 16, v30
    v_and_b32 v165, s26, v30
    v_dot2_f32_bf16 v237, v31, s27, v237
    v_lshlrev_b32 v166, 16, v31
    v_and_b32 v167, s26, v31
    v_dot2_f32_bf16 v236, v32, s27, v236
    v_lshlrev_b32 v168, 16, v32
    v_and_b32 v169, s26, v32
    v_dot2_f32_bf16 v237, v33, s27, v237
KL_wm_p4:
    s_cbranch_execz KL_wm_p5
    v_lshlrev_b32 v170, 16, v33
    v_and_b32 v171, s26, v33
    v_dot2_f32_bf16 v236, v34, s27, v236
    v_lshlrev_b32 v172, 16, v34
    v_and_b32 v173, s26, v34
    v_dot2_f32_bf16 v237, v35, s27, v237
    v_lshlrev_b32 v174, 16, v35
    v_and_b32 v175, s26, v35
    v_dot2_f32_bf16 v236, v36, s27, v236
    v_lshlrev_b32 v176, 16, v36
    v_and_b32 v177, s26, v36
    v_dot2_f32_bf16 v237, v37, s27, v237
    v_lshlrev_b32 v178, 16, v37
    v_and_b32 v179, s26, v37
    v_dot2_f32_bf16 v236, v38, s27, v236
    v_lshlrev_b32 v180, 16, v38
    v_and_b32 v181, s26, v38
    v_dot2_f32_bf16 v237, v39, s27, v237
    v_lshlrev_b32 v182, 16, v39
    v_and_b32 v183, s26, v39
    v_dot2_f32_bf16 v236, v40, s27, v236
KL_wm_p5:
    s_cbranch_execz KL_wm_p6
    v_lshlrev_b32 v184, 16, v40
    v_and_b32 v185, s26, v40
    v_dot2_f32_bf16 v237, v41, s27, v237
    v_lshlrev_b32 v186, 16, v41
    v_and_b32 v187, s26, v41
    v_dot2_f32_bf16 v236, v42, s27, v236
    v_lshlrev_b32 v188, 16, v42
    v_and_b32 v189, s26, v42
    v_dot2_f32_bf16 v237, v43, s27, v237
    v_lshlrev_b32 v190, 16, v43
    v_and_b32 v191, s26, v43
    v_dot2_f32_bf16 v236, v44, s27, v236
    v_lshlrev_b32 v192, 16, v44
    v_and_b32 v193, s26, v44
    v_dot2_f32_bf16 v237, v45, s27, v237
    v_lshlrev_b32 v194, 16, v45
    v_and_b32 v195, s26, v45
    v_dot2_f32_bf16 v236, v46, s27, v236
    v_lshlrev_b32 v196, 16, v46
    v_and_b32 v197, s26, v46
    v_dot2_f32_bf16 v237, v47, s27, v237
KL_wm_p6:
    s_cbranch_execz KL_wm_p7
    v_lshlrev_b32 v198, 16, v47
    v_and_b32 v199, s26, v47
    v_dot2_f32_bf16 v236, v48, s27, v236
    v_lshlrev_b32 v200, 16, v48
    v_and_b32 v201, s26, v48
    v_dot2_f32_bf16 v237, v49, s27, v237
    v_lshlrev_b32 v202, 16, v49
    v_and_b32 v203, s26, v49
    v_dot2_f32_bf16 v236, v50, s27, v236
    v_lshlrev_b32 v204, 16, v50
    v_and_b32 v205, s26, v50
    v_dot2_f32_bf16 v237, v51, s27, v237
    v_lshlrev_b32 v206, 16, v51
    v_and_b32 v207, s26, v51
    v_dot2_f32_bf16 v236, v52, s27, v236
    v_lshlrev_b32 v208, 16, v52
    v_and_b32 v209, s26, v52
    v_dot2_f32_bf16 v237, v53, s27, v237
    v_lshlrev_b32 v210, 16, v53
    v_and_b32 v211, s26, v53
    v_dot2_f32_bf16 v236, v54, s27, v236
KL_wm_p7:
    s_cbranch_execz KL_wm_p8
    v_lshlrev_b32 v212, 16, v54
    v_and_b32 v213, s26, v54
    v_dot2_f32_bf16 v237, v55, s27, v237
    v_lshlrev_b32 v214, 16, v55
    v_and_b32 v215, s26, v55
    v_dot2_f32_bf16 v236, v56, s27, v236
    v_lshlrev_b32 v216, 16, v56
    v_and_b32 v217, s26, v56
    v_dot2_f32_bf16 v237, v57, s27, v237
    v_lshlrev_b32 v218, 16, v57
    v_and_b32 v219, s26, v57
    v_dot2_f32_bf16 v236, v58, s27, v236
    v_lshlrev_b32 v220, 16, v58
    v_and_b32 v221, s26, v58
    v_dot2_f32_bf16 v237, v59, s27, v237
    v_lshlrev_b32 v222, 16, v59
    v_and_b32 v223, s26, v59
    v_dot2_f32_bf16 v236, v60, s27, v236
    v_lshlrev_b32 v224, 16, v60
    v_and_b32 v225, s26, v60
    v_dot2_f32_bf16 v237, v61, s27, v237
KL_wm_p8:
    s_cbranch_execz KL_wm_p9
    v_lshlrev_b32 v226, 16, v61
    v_and_b32 v227, s26, v61
    v_dot2_f32_bf16 v236, v62, s27, v236
    v_lshlrev_b32 v228, 16, v62
    v_and_b32 v229, s26, v62
    v_dot2_f32_bf16 v237, v63, s27, v237
    v_lshlrev_b32 v230, 16, v63
    v_and_b32 v231, s26, v63
    s_nop 0
    v_add_f32 v236, v236, v237
    v_mov_b32 v237, v236
    s_nop 1
    v_permlane16_swap_b32 v236, v237
    v_add_f32 v236, v236, v237
    v_mov_b32 v237, v236
    s_nop 1
    v_permlane32_swap_b32 v236, v237
    v_add_f32 v236, v236, v237
    v_mul_f32 v236, 0x3b124925, v236
    v_mov_b32 v237, v236
    v_mov_b32 v240, 0
    v_mov_b32 v241, 0
    v_mov_b32 v242, 0
    v_mov_b32 v243, 0
    v_pk_add_f32 v[244:245], v[120:121], v[236:237] neg_lo:[0,1] neg_hi:[0,1]
    v_pk_add_f32 v[246:247], v[122:123], v[236:237] neg_lo:[0,1] neg_hi:[0,1]
KL_wm_p9:
    s_cbranch_execz KL_wm_p10
    v_pk_fma_f32 v[240:241], v[244:245], v[244:245], v[240:241]
    v_pk_fma_f32 v[242:243], v[246:247], v[246:247], v[242:243]
    v_pk_add_f32 v[244:245], v[124:125], v[236:237] neg_lo:[0,1] neg_hi:[0,1]
    v_pk_add_f32 v[246:247], v[126:127], v[236:237] neg_lo:[0,1] neg_hi:[0,1]
    v_pk_fma_f32 v[240:241], v[244:245], v[244:245], v[240:241]
    v_pk_fma_f32 v[242:243], v[246:247], v[246:247], v[242:243]
    v_pk_add_f32 v[244:245], v[128:129], v[236:237] neg_lo:[0,1] neg_hi:[0,1]
    v_pk_add_f32 v[246:247], v[130:131], v[236:237] neg_lo:[0,1] neg_hi:[0,1]
    v_pk_fma_f32 v[240:241], v[244:245], v[244:245], v[240:241]
    v_pk_fma_f32 v[242:243], v[246:247], v[246:247], v[242:243]
    v_pk_add_f32 v[244:245], v[132:133], v[236:237] neg_lo:[0,1] neg_hi:[0,1]
    v_pk_add_f32 v[246:247], v[134:135], v[236:237] neg_lo:[0,1] neg_hi:[0,1]
    v_pk_fma_f32 v[240:241], v[244:245], v[244:245], v[240:241]
    v_pk_fma_f32 v[242:243], v[246:247], v[246:247], v[242:243]
KL_wm_p10:
    s_cbranch_execz KL_wm_ret
    v_pk_add_f32 v[244:245], v[136:137], v[236:237] neg_lo:[0,1] neg_hi:[0,1]
    v_pk_add_f32 v[246:247], v[138:139], v[236:237] neg_lo:[0,1] neg_hi:[0,1]
    v_pk_fma_f32 v[240:241], v[244:245], v[244:245], v[240:241]
    v_pk_fma_f32 v[242:243], v[246:247], v[246:247], v[242:243]
    v_pk_add_f32 v[244:245], v[140:141], v[236:237] neg_lo:[0,1] neg_hi:[0,1]
    v_pk_add_f32 v[246:247], v[142:143], v[236:237] neg_lo:[0,1] neg_hi:[0,1]
    v_pk_fma_f32 v[240:241], v[244:245], v[244:245], v[240:241]
    v_pk_fma_f32 v[242:243], v[246:247], v[246:247], v[242:243]
    v_pk_add_f32 v[244:245], v[144:145], v[236:237] neg_lo:[0,1] neg_hi:[0,1]
    v_pk_add_f32 v[246:247], v[146:147], v[236:237] neg_lo:[0,1] neg_hi:[0,1]
    v_pk_fma_f32 v[240:241], v[244:245], v[244:245], v[240:241]
    v_pk_fma_f32 v[242:243], v[246:247], v[246:247], v[242:243]
    v_pk_add_f32 v[244:245], v[148:149], v[236:237] neg_lo:[0,1] neg_hi:[0,1]
    v_pk_add_f32 v[246:247], v[150:151], v[236:237] neg_lo:[0,1] neg_hi:[0,1]
KL_wm_p11:
    s_cbranch_execz KL_wm_p12
    v_pk_fma_f32 v[240:241], v[244:245], v[244:245], v[240:241]
    v_pk_fma_f32 v[242:243], v[246:247], v[246:247], v[242:243]
    v_pk_add_f32 v[244:245], v[152:153], v[236:237] neg_lo:[0,1] neg_hi:[0,1]
    v_pk_add_f32 v[246:247], v[154:155], v[236:237] neg_lo:[0,1] neg_hi:[0,1]
    v_pk_fma_f32 v[240:241], v[244:245], v[244:245], v[240:241]
    v_pk_fma_f32 v[242:243], v[246:247], v[246:247], v[242:243]
    v_pk_add_f32 v[244:245], v[156:157], v[236:237] neg_lo:[0,1] neg_hi:[0,1]
    v_pk_add_f32 v[246:247], v[158:159], v[236:237] neg_lo:[0,1] neg_hi:[0,1]
    v_pk_fma_f32 v[240:241], v[244:245], v[244:245], v[240:241]
    v_pk_fma_f32 v[242:243], v[246:247], v[246:247], v[242:243]
    v_pk_add_f32 v[244:245], v[160:161], v[236:237] neg_lo:[0,1] neg_hi:[0,1]
    v_pk_add_f32 v[246:247], v[162:163], v[236:237] neg_lo:[0,1] neg_hi:[0,1]
    v_pk_fma_f32 v[240:241], v[244:245], v[244:245], v[240:241]
    v_pk_fma_f32 v[242:243], v[246:247], v[246:247], v[242:243]
KL_wm_p12:
    s_cbranch_execz KL_wm_p13
    v_pk_add_f32 v[244:245], v[164:165], v[236:237] neg_lo:[0,1] neg_hi:[0,1]
    v_pk_add_f32 v[246:247], v[166:167], v[236:237] neg_lo:[0,1] neg_hi:[0,1]
    v_pk_fma_f32 v[240:241], v[244:245], v[244:245], v[240:241]
    v_pk_fma_f32 v[242:243], v[246:247], v[246:247], v[242:243]
    v_pk_add_f32 v[244:245], v[168:169], v[236:237] neg_lo:[0,1] neg_hi:[0,1]
    v_pk_add_f32 v[246:247], v[170:171], v[236:237] neg_lo:[0,1] neg_hi:[0,1]
    v_pk_fma_f32 v[240:241], v[244:245], v[244:245], v[240:241]
    v_pk_fma_f32 v[242:243], v[246:247], v[246:247], v[242:243]
    v_pk_add_f32 v[244:245], v[172:173], v[236:237] neg_lo:[0,1] neg_hi:[0,1]
    v_pk_add_f32 v[246:247], v[174:175], v[236:237] neg_lo:[0,1] neg_hi:[0,1]
    v_pk_fma_f32 v[240:241], v[244:245], v[244:245], v[240:241]
    v_pk_fma_f32 v[242:243], v[246:247], v[246:247], v[242:243]
    v_pk_add_f32 v[244:245], v[176:177], v[236:237] neg_lo:[0,1] neg_hi:[0,1]
    v_pk_add_f32 v[246:247], v[178:179], v[236:237] neg_lo:[0,1] neg_hi:[0,1]
KL_wm_p13:
    s_cbranch_execz KL_wm_p14
    v_pk_fma_f32 v[240:241], v[244:245], v[244:245], v[240:241]
    v_pk_fma_f32 v[242:243], v[246:247], v[246:247], v[242:243]
    v_pk_add_f32 v[244:245], v[180:181], v[236:237] neg_lo:[0,1] neg_hi:[0,1]
    v_pk_add_f32 v[246:247], v[182:183], v[236:237] neg_lo:[0,1] neg_hi:[0,1]
    v_pk_fma_f32 v[240:241], v[244:245], v[244:245], v[240:241]
    v_pk_fma_f32 v[242:243], v[246:247], v[246:247], v[242:243]
    v_pk_add_f32 v[244:245], v[184:185], v[236:237] neg_lo:[0,1] neg_hi:[0,1]
    v_pk_add_f32 v[246:247], v[186:187], v[236:237] neg_lo:[0,1] neg_hi:[0,1]
    v_pk_fma_f32 v[240:241], v[244:245], v[244:245], v[240:241]
    v_pk_fma_f32 v[242:243], v[246:247], v[246:247], v[242:243]
    v_pk_add_f32 v[244:245], v[188:189], v[236:237] neg_lo:[0,1] neg_hi:[0,1]
    v_pk_add_f32 v[246:247], v[190:191], v[236:237] neg_lo:[0,1] neg_hi:[0,1]
    v_pk_fma_f32 v[240:241], v[244:245], v[244:245], v[240:241]
    v_pk_fma_f32 v[242:243], v[246:247], v[246:247], v[242:243]
KL_wm_p14:
    s_cbranch_execz KL_wm_p15
    v_pk_add_f32 v[244:245], v[192:193], v[236:237] neg_lo:[0,1] neg_hi:[0,1]
    v_pk_add_f32 v[246:247], v[194:195], v[236:237] neg_lo:[0,1] neg_hi:[0,1]
    v_pk_fma_f32 v[240:241], v[244:245], v[244:245], v[240:241]
    v_pk_fma_f32 v[242:243], v[246:247], v[246:247], v[242:243]
    v_pk_add_f32 v[244:245], v[196:197], v[236:237] neg_lo:[0,1] neg_hi:[0,1]
    v_pk_add_f32 v[246:247], v[198:199], v[236:237] neg_lo:[0,1] neg_hi:[0,1]
    v_pk_fma_f32 v[240:241], v[244:245], v[244:245], v[240:241]
    v_pk_fma_f32 v[242:243], v[246:247], v[246:247], v[242:243]
    v_pk_add_f32 v[244:245], v[200:201], v[236:237] neg_lo:[0,1] neg_hi:[0,1]
    v_pk_add_f32 v[246:247], v[202:203], v[236:237] neg_lo:[0,1] neg_hi:[0,1]
    v_pk_fma_f32 v[240:241], v[244:245], v[244:245], v[240:241]
    v_pk_fma_f32 v[242:243], v[246:247], v[246:247], v[242:243]
    v_pk_add_f32 v[244:245], v[204:205], v[236:237] neg_lo:[0,1] neg_hi:[0,1]
    v_pk_add_f32 v[246:247], v[206:207], v[236:237] neg_lo:[0,1] neg_hi:[0,1]
KL_wm_p15:
    s_cbranch_execz KL_wm_p16
    v_pk_fma_f32 v[240:241], v[244:245], v[244:245], v[240:241]
    v_pk_fma_f32 v[242:243], v[246:247], v[246:247], v[242:243]
    v_pk_add_f32 v[244:245], v[208:209], v[236:237] neg_lo:[0,1] neg_hi:[0,1]
    v_pk_add_f32 v[246:247], v[210:211], v[236:237] neg_lo:[0,1] neg_hi:[0,1]
    v_pk_fma_f32 v[240:241], v[244:245], v[244:245], v[240:241]
    v_pk_fma_f32 v[242:243], v[246:247], v[246:247], v[242:243]
    v_pk_add_f32 v[244:245], v[212:213], v[236:237] neg_lo:[0,1] neg_hi:[0,1]
    v_pk_add_f32 v[246:247], v[214:215], v[236:237] neg_lo:[0,1] neg_hi:[0,1]
    v_pk_fma_f32 v[240:241], v[244:245], v[244:245], v[240:241]
    v_pk_fma_f32 v[242:243], v[246:247], v[246:247], v[242:243]
    v_pk_add_f32 v[244:245], v[216:217], v[236:237] neg_lo:[0,1] neg_hi:[0,1]
    v_pk_add_f32 v[246:247], v[218:219], v[236:237] neg_lo:[0,1] neg_hi:[0,1]
    v_pk_fma_f32 v[240:241], v[244:245], v[244:245], v[240:241]
    v_pk_fma_f32 v[242:243], v[246:247], v[246:247], v[242:243]
KL_wm_p16:
    s_cbranch_execz KL_wm_p17
    v_pk_add_f32 v[244:245], v[220:221], v[236:237] neg_lo:[0,1] neg_hi:[0,1]
    v_pk_add_f32 v[246:247], v[222:223], v[236:237] neg_lo:[0,1] neg_hi:[0,1]
    v_pk_fma_f32 v[240:241], v[244:245], v[244:245], v[240:241]
    v_pk_fma_f32 v[242:243], v[246:247], v[246:247], v[242:243]
    v_pk_add_f32 v[244:245], v[224:225], v[236:237] neg_lo:[0,1] neg_hi:[0,1]
    v_pk_add_f32 v[246:247], v[226:227], v[236:237] neg_lo:[0,1] neg_hi:[0,1]
    v_pk_fma_f32 v[240:241], v[244:245], v[244:245], v[240:241]
    v_pk_fma_f32 v[242:243], v[246:247], v[246:247], v[242:243]
    v_pk_add_f32 v[244:245], v[228:229], v[236:237] neg_lo:[0,1] neg_hi:[0,1]
    v_pk_add_f32 v[246:247], v[230:231], v[236:237] neg_lo:[0,1] neg_hi:[0,1]
    v_pk_fma_f32 v[240:241], v[244:245], v[244:245], v[240:241]
    v_pk_fma_f32 v[242:243], v[246:247], v[246:247], v[242:243]
    v_pk_add_f32 v[240:241], v[240:241], v[242:243]
    v_add_f32 v240, v240, v241
KL_wm_p17:
    s_cbranch_execz KL_wm_p18
    v_mov_b32 v241, v240
    s_nop 1
    v_permlane16_swap_b32 v240, v241
    v_add_f32 v240, v240, v241
    v_mov_b32 v241, v240
    s_nop 1
    v_permlane32_swap_b32 v240, v241
    v_add_f32 v240, v240, v241
    v_mul_f32 v240, 0x3b124925, v240
    v_cvt_pk_bf16_f32 v236, v236, v240
    v_and_b32 v240, s26, v236
    v_lshlrev_b32 v236, 16, v236
    v_add_f32 v240, 0x3727c5ac, v240
    v_cvt_pk_bf16_f32 v240, v240, v240
    v_and_b32 v240, s26, v240
    v_sqrt_f32 v240, v240
    v_mov_b32 v237, v236
    v_cvt_pk_bf16_f32 v240, v240, v240
    v_and_b32 v240, s26, v240
    v_rcp_f32 v240, v240
    s_nop 0
    v_mov_b32 v241, v240
    s_mul_i32 s25, s23, 14336
KL_wm_p18:
    s_cbranch_execz KL_wm_p19
    v_pk_add_f32 v[120:121], v[120:121], v[236:237] neg_lo:[0,1] neg_hi:[0,1]
    v_cvt_pk_bf16_f32 v8, v120, v121
    v_lshlrev_b32 v120, 16, v8
    v_and_b32 v121, s26, v8
    v_pk_mul_f32 v[120:121], v[120:121], v[240:241]
    v_cvt_pk_bf16_f32 v8, v120, v121
    v_pk_add_f32 v[122:123], v[122:123], v[236:237] neg_lo:[0,1] neg_hi:[0,1]
    v_cvt_pk_bf16_f32 v9, v122, v123
    v_lshlrev_b32 v122, 16, v9
    v_and_b32 v123, s26, v9
    v_pk_mul_f32 v[122:123], v[122:123], v[240:241]
    v_cvt_pk_bf16_f32 v9, v122, v123
    v_pk_add_f32 v[124:125], v[124:125], v[236:237] neg_lo:[0,1] neg_hi:[0,1]
    v_cvt_pk_bf16_f32 v10, v124, v125
    v_lshlrev_b32 v124, 16, v10
    v_and_b32 v125, s26, v10
    v_pk_mul_f32 v[124:125], v[124:125], v[240:241]
KL_wm_p19:
    s_cbranch_execz KL_wm_p20
    v_cvt_pk_bf16_f32 v10, v124, v125
    v_pk_add_f32 v[126:127], v[126:127], v[236:237] neg_lo:[0,1] neg_hi:[0,1]
    v_cvt_pk_bf16_f32 v11, v126, v127
    v_lshlrev_b32 v126, 16, v11
    v_and_b32 v127, s26, v11
    v_pk_mul_f32 v[126:127], v[126:127], v[240:241]
    v_cvt_pk_bf16_f32 v11, v126, v127
    buffer_store_dwordx4 v[8:11], v4, s[48:51], s25 offen offset:0 sc1
    v_pk_add_f32 v[128:129], v[128:129], v[236:237] neg_lo:[0,1] neg_hi:[0,1]
    v_cvt_pk_bf16_f32 v12, v128, v129
    v_lshlrev_b32 v128, 16, v12
    v_and_b32 v129, s26, v12
    v_pk_mul_f32 v[128:129], v[128:129], v[240:241]
    v_cvt_pk_bf16_f32 v12, v128, v129
    v_pk_add_f32 v[130:131], v[130:131], v[236:237] neg_lo:[0,1] neg_hi:[0,1]
    v_cvt_pk_bf16_f32 v13, v130, v131
KL_wm_p20:
    s_cbranch_execz KL_wm_p21
    v_lshlrev_b32 v130, 16, v13
    v_and_b32 v131, s26, v13
    v_pk_mul_f32 v[130:131], v[130:131], v[240:241]
    v_cvt_pk_bf16_f32 v13, v130, v131
    v_pk_add_f32 v[132:133], v[132:133], v[236:237] neg_lo:[0,1] neg_hi:[0,1]
    v_cvt_pk_bf16_f32 v14, v132, v133
    v_lshlrev_b32 v132, 16, v14
    v_and_b32 v133, s26, v14
    v_pk_mul_f32 v[132:133], v[132:133], v[240:241]
    v_cvt_pk_bf16_f32 v14, v132, v133
    v_pk_add_f32 v[134:135], v[134:135], v[236:237] neg_lo:[0,1] neg_hi:[0,1]
    v_cvt_pk_bf16_f32 v15, v134, v135
    v_lshlrev_b32 v134, 16, v15
    v_and_b32 v135, s26, v15
    v_pk_mul_f32 v[134:135], v[134:135], v[240:241]
    v_cvt_pk_bf16_f32 v15, v134, v135
    buffer_store_dwordx4 v[12:15], v4, s[48:51], s25 offen offset:1024 sc1
KL_wm_p21:
    s_cbranch_execz KL_wm_ret
    v_pk_add_f32 v[136:137], v[136:137], v[236:237] neg_lo:[0,1] neg_hi:[0,1]
    v_cvt_pk_bf16_f32 v16, v136, v137
    v_lshlrev_b32 v136, 16, v16
    v_and_b32 v137, s26, v16
    v_pk_mul_f32 v[136:137], v[136:137], v[240:241]
    v_cvt_pk_bf16_f32 v16, v136, v137
    v_pk_add_f32 v[138:139], v[138:139], v[236:237] neg_lo:[0,1] neg_hi:[0,1]
    v_cvt_pk_bf16_f32 v17, v138, v139
    v_lshlrev_b32 v138, 16, v17
    v_and_b32 v139, s26, v17
    v_pk_mul_f32 v[138:139], v[138:139], v[240:241]
    v_cvt_pk_bf16_f32 v17, v138, v139
    v_pk_add_f32 v[140:141], v[140:141], v[236:237] neg_lo:[0,1] neg_hi:[0,1]
    v_cvt_pk_bf16_f32 v18, v140, v141
    v_lshlrev_b32 v140, 16, v18
    v_and_b32 v141, s26, v18
    v_pk_mul_f32 v[140:141], v[140:141], v[240:241]
KL_wm_p22:
    s_cbranch_execz KL_wm_p23
    v_cvt_pk_bf16_f32 v18, v140, v141
    v_pk_add_f32 v[142:143], v[142:143], v[236:237] neg_lo:[0,1] neg_hi:[0,1]
    v_cvt_pk_bf16_f32 v19, v142, v143
    v_lshlrev_b32 v142, 16, v19
    v_and_b32 v143, s26, v19
    v_pk_mul_f32 v[142:143], v[142:143], v[240:241]
    v_cvt_pk_bf16_f32 v19, v142, v143
    buffer_store_dwordx4 v[16:19], v4, s[48:51], s25 offen offset:2048 sc1
    v_pk_add_f32 v[144:145], v[144:145], v[236:237] neg_lo:[0,1] neg_hi:[0,1]
    v_cvt_pk_bf16_f32 v20, v144, v145
    v_lshlrev_b32 v144, 16, v20
    v_and_b32 v145, s26, v20
    v_pk_mul_f32 v[144:145], v[144:145], v[240:241]
    v_cvt_pk_bf16_f32 v20, v144, v145
    v_pk_add_f32 v[146:147], v[146:147], v[236:237] neg_lo:[0,1] neg_hi:[0,1]
    v_cvt_pk_bf16_f32 v21, v146, v147
KL_wm_p23:
    s_cbranch_execz KL_wm_p24
    v_lshlrev_b32 v146, 16, v21
    v_and_b32 v147, s26, v21
    v_pk_mul_f32 v[146:147], v[146:147], v[240:241]
    v_cvt_pk_bf16_f32 v21, v146, v147
    v_pk_add_f32 v[148:149], v[148:149], v[236:237] neg_lo:[0,1] neg_hi:[0,1]
    v_cvt_pk_bf16_f32 v22, v148, v149
    v_lshlrev_b32 v148, 16, v22
    v_and_b32 v149, s26, v22
    v_pk_mul_f32 v[148:149], v[148:149], v[240:241]
    v_cvt_pk_bf16_f32 v22, v148, v149
    v_pk_add_f32 v[150:151], v[150:151], v[236:237] neg_lo:[0,1] neg_hi:[0,1]
    v_cvt_pk_bf16_f32 v23, v150, v151
    v_lshlrev_b32 v150, 16, v23
    v_and_b32 v151, s26, v23
    v_pk_mul_f32 v[150:151], v[150:151], v[240:241]
    v_cvt_pk_bf16_f32 v23, v150, v151
    buffer_store_dwordx4 v[20:23], v4, s[48:51], s25 offen offset:3072 sc1
KL_wm_p24:
    s_cbranch_execz KL_wm_p25
    s_add_u32 s25, s25, 4096
    v_pk_add_f32 v[152:153], v[152:153], v[236:237] neg_lo:[0,1] neg_hi:[0,1]
    v_cvt_pk_bf16_f32 v24, v152, v153
    v_lshlrev_b32 v152, 16, v24
    v_and_b32 v153, s26, v24
    v_pk_mul_f32 v[152:153], v[152:153], v[240:241]
    v_cvt_pk_bf16_f32 v24, v152, v153
    v_pk_add_f32 v[154:155], v[154:155], v[236:237] neg_lo:[0,1] neg_hi:[0,1]
    v_cvt_pk_bf16_f32 v25, v154, v155
    v_lshlrev_b32 v154, 16, v25
    v_and_b32 v155, s26, v25
    v_pk_mul_f32 v[154:155], v[154:155], v[240:241]
    v_cvt_pk_bf16_f32 v25, v154, v155
    v_pk_add_f32 v[156:157], v[156:157], v[236:237] neg_lo:[0,1] neg_hi:[0,1]
    v_cvt_pk_bf16_f32 v26, v156, v157
    v_lshlrev_b32 v156, 16, v26
KL_wm_p25:
    s_cbranch_execz KL_wm_p26
    v_and_b32 v157, s26, v26
    v_pk_mul_f32 v[156:157], v[156:157], v[240:241]
    v_cvt_pk_bf16_f32 v26, v156, v157
    v_pk_add_f32 v[158:159], v[158:159], v[236:237] neg_lo:[0,1] neg_hi:[0,1]
    v_cvt_pk_bf16_f32 v27, v158, v159
    v_lshlrev_b32 v158, 16, v27
    v_and_b32 v159, s26, v27
    v_pk_mul_f32 v[158:159], v[158:159], v[240:241]
    v_cvt_pk_bf16_f32 v27, v158, v159
    buffer_store_dwordx4 v[24:27], v4, s[48:51], s25 offen offset:0 sc1
    v_pk_add_f32 v[160:161], v[160:161], v[236:237] neg_lo:[0,1] neg_hi:[0,1]
    v_cvt_pk_bf16_f32 v28, v160, v161
    v_lshlrev_b32 v160, 16, v28
    v_and_b32 v161, s26, v28
    v_pk_mul_f32 v[160:161], v[160:161], v[240:241]
    v_cvt_pk_bf16_f32 v28, v160, v161
KL_wm_p26:
    s_cbranch_execz KL_wm_p27
    v_pk_add_f32 v[162:163], v[162:163], v[236:237] neg_lo:[0,1] neg_hi:[0,1]
    v_cvt_pk_bf16_f32 v29, v162, v163
    v_lshlrev_b32 v162, 16, v29
    v_and_b32 v163, s26, v29
    v_pk_mul_f32 v[162:163], v[162:163], v[240:241]
    v_cvt_pk_bf16_f32 v29, v162, v163
    v_pk_add_f32 v[164:165], v[164:165], v[236:237] neg_lo:[0,1] neg_hi:[0,1]
    v_cvt_pk_bf16_f32 v30, v164, v165
    v_lshlrev_b32 v164, 16, v30
    v_and_b32 v165, s26, v30
    v_pk_mul_f32 v[164:165], v[164:165], v[240:241]
    v_cvt_pk_bf16_f32 v30, v164, v165
    v_pk_add_f32 v[166:167], v[166:167], v[236:237] neg_lo:[0,1] neg_hi:[0,1]
    v_cvt_pk_bf16_f32 v31, v166, v167
    v_lshlrev_b32 v166, 16, v31
    v_and_b32 v167, s26, v31
    v_pk_mul_f32 v[166:167], v[166:167], v[240:241]
KL_wm_p27:
    s_cbranch_execz KL_wm_p28
    v_cvt_pk_bf16_f32 v31, v166, v167
    buffer_store_dwordx4 v[28:31], v4, s[48:51], s25 offen offset:1024 sc1
    v_pk_add_f32 v[168:169], v[168:169], v[236:237] neg_lo:[0,1] neg_hi:[0,1]
    v_cvt_pk_bf16_f32 v32, v168, v169
    v_lshlrev_b32 v168, 16, v32
    v_and_b32 v169, s26, v32
    v_pk_mul_f32 v[168:169], v[168:169], v[240:241]
    v_cvt_pk_bf16_f32 v32, v168, v169
    v_pk_add_f32 v[170:171], v[170:171], v[236:237] neg_lo:[0,1] neg_hi:[0,1]
    v_cvt_pk_bf16_f32 v33, v170, v171
    v_lshlrev_b32 v170, 16, v33
    v_and_b32 v171, s26, v33
    v_pk_mul_f32 v[170:171], v[170:171], v[240:241]
    v_cvt_pk_bf16_f32 v33, v170, v171
    v_pk_add_f32 v[172:173], v[172:173], v[236:237] neg_lo:[0,1] neg_hi:[0,1]
    v_cvt_pk_bf16_f32 v34, v172, v173
KL_wm_p28:
    s_cbranch_execz KL_wm_p29
    v_lshlrev_b32 v172, 16, v34
    v_and_b32 v173, s26, v34
    v_pk_mul_f32 v[172:173], v[172:173], v[240:241]
    v_cvt_pk_bf16_f32 v34, v172, v173
    v_pk_add_f32 v[174:175], v[174:175], v[236:237] neg_lo:[0,1] neg_hi:[0,1]
    v_cvt_pk_bf16_f32 v35, v174, v175
    v_lshlrev_b32 v174, 16, v35
    v_and_b32 v175, s26, v35
    v_pk_mul_f32 v[174:175], v[174:175], v[240:241]
    v_cvt_pk_bf16_f32 v35, v174, v175
    buffer_store_dwordx4 v[32:35], v4, s[48:51], s25 offen offset:2048 sc1
    v_pk_add_f32 v[176:177], v[176:177], v[236:237] neg_lo:[0,1] neg_hi:[0,1]
    v_cvt_pk_bf16_f32 v36, v176, v177
    v_lshlrev_b32 v176, 16, v36
    v_and_b32 v177, s26, v36
    v_pk_mul_f32 v[176:177], v[176:177], v[240:241]
    v_cvt_pk_bf16_f32 v36, v176, v177
KL_wm_p29:
    s_cbranch_execz KL_wm_p30
    v_pk_add_f32 v[178:179], v[178:179], v[236:237] neg_lo:[0,1] neg_hi:[0,1]
    v_cvt_pk_bf16_f32 v37, v178, v179
    v_lshlrev_b32 v178, 16, v37
    v_and_b32 v179, s26, v37
    v_pk_mul_f32 v[178:179], v[178:179], v[240:241]
    v_cvt_pk_bf16_f32 v37, v178, v179
    v_pk_add_f32 v[180:181], v[180:181], v[236:237] neg_lo:[0,1] neg_hi:[0,1]
    v_cvt_pk_bf16_f32 v38, v180, v181
    v_lshlrev_b32 v180, 16, v38
    v_and_b32 v181, s26, v38
    v_pk_mul_f32 v[180:181], v[180:181], v[240:241]
    v_cvt_pk_bf16_f32 v38, v180, v181
    v_pk_add_f32 v[182:183], v[182:183], v[236:237] neg_lo:[0,1] neg_hi:[0,1]
    v_cvt_pk_bf16_f32 v39, v182, v183
    v_lshlrev_b32 v182, 16, v39
    v_and_b32 v183, s26, v39
    v_pk_mul_f32 v[182:183], v[182:183], v[240:241]
KL_wm_p30:
    s_cbranch_execz KL_wm_p31
    v_cvt_pk_bf16_f32 v39, v182, v183
    buffer_store_dwordx4 v[36:39], v4, s[48:51], s25 offen offset:3072 sc1
    s_add_u32 s25, s25, 4096
    v_pk_add_f32 v[184:185], v[184:185], v[236:237] neg_lo:[0,1] neg_hi:[0,1]
    v_cvt_pk_bf16_f32 v40, v184, v185
    v_lshlrev_b32 v184, 16, v40
    v_and_b32 v185, s26, v40
    v_pk_mul_f32 v[184:185], v[184:185], v[240:241]
    v_cvt_pk_bf16_f32 v40, v184, v185
    v_pk_add_f32 v[186:187], v[186:187], v[236:237] neg_lo:[0,1] neg_hi:[0,1]
    v_cvt_pk_bf16_f32 v41, v186, v187
    v_lshlrev_b32 v186, 16, v41
    v_and_b32 v187, s26, v41
    v_pk_mul_f32 v[186:187], v[186:187], v[240:241]
    v_cvt_pk_bf16_f32 v41, v186, v187
    v_pk_add_f32 v[188:189], v[188:189], v[236:237] neg_lo:[0,1] neg_hi:[0,1]
KL_wm_p31:
    s_cbranch_execz KL_wm_p32
    v_cvt_pk_bf16_f32 v42, v188, v189
    v_lshlrev_b32 v188, 16, v42
    v_and_b32 v189, s26, v42
    v_pk_mul_f32 v[188:189], v[188:189], v[240:241]
    v_cvt_pk_bf16_f32 v42, v188, v189
    v_pk_add_f32 v[190:191], v[190:191], v[236:237] neg_lo:[0,1] neg_hi:[0,1]
    v_cvt_pk_bf16_f32 v43, v190, v191
    v_lshlrev_b32 v190, 16, v43
    v_and_b32 v191, s26, v43
    v_pk_mul_f32 v[190:191], v[190:191], v[240:241]
    v_cvt_pk_bf16_f32 v43, v190, v191
    buffer_store_dwordx4 v[40:43], v4, s[48:51], s25 offen offset:0 sc1
    v_pk_add_f32 v[192:193], v[192:193], v[236:237] neg_lo:[0,1] neg_hi:[0,1]
    v_cvt_pk_bf16_f32 v44, v192, v193
    v_lshlrev_b32 v192, 16, v44
    v_and_b32 v193, s26, v44
    v_pk_mul_f32 v[192:193], v[192:193], v[240:241]
KL_wm_p32:
    s_cbranch_execz KL_wm_ret
    v_cvt_pk_bf16_f32 v44, v192, v193
    v_pk_add_f32 v[194:195], v[194:195], v[236:237] neg_lo:[0,1] neg_hi:[0,1]
    v_cvt_pk_bf16_f32 v45, v194, v195
    v_lshlrev_b32 v194, 16, v45
    v_and_b32 v195, s26, v45
    v_pk_mul_f32 v[194:195], v[194:195], v[240:241]
    v_cvt_pk_bf16_f32 v45, v194, v195
    v_pk_add_f32 v[196:197], v[196:197], v[236:237] neg_lo:[0,1] neg_hi:[0,1]
    v_cvt_pk_bf16_f32 v46, v196, v197
    v_lshlrev_b32 v196, 16, v46
    v_and_b32 v197, s26, v46
    v_pk_mul_f32 v[196:197], v[196:197], v[240:241]
    v_cvt_pk_bf16_f32 v46, v196, v197
    v_pk_add_f32 v[198:199], v[198:199], v[236:237] neg_lo:[0,1] neg_hi:[0,1]
    v_cvt_pk_bf16_f32 v47, v198, v199
    v_lshlrev_b32 v198, 16, v47
KL_wm_p33:
    s_cbranch_execz KL_wm_p34
    v_and_b32 v199, s26, v47
    v_pk_mul_f32 v[198:199], v[198:199], v[240:241]
    v_cvt_pk_bf16_f32 v47, v198, v199
    buffer_store_dwordx4 v[44:47], v4, s[48:51], s25 offen offset:1024 sc1
    v_pk_add_f32 v[200:201], v[200:201], v[236:237] neg_lo:[0,1] neg_hi:[0,1]
    v_cvt_pk_bf16_f32 v48, v200, v201
    v_lshlrev_b32 v200, 16, v48
    v_and_b32 v201, s26, v48
    v_pk_mul_f32 v[200:201], v[200:201], v[240:241]
    v_cvt_pk_bf16_f32 v48, v200, v201
    v_pk_add_f32 v[202:203], v[202:203], v[236:237] neg_lo:[0,1] neg_hi:[0,1]
    v_cvt_pk_bf16_f32 v49, v202, v203
    v_lshlrev_b32 v202, 16, v49
    v_and_b32 v203, s26, v49
    v_pk_mul_f32 v[202:203], v[202:203], v[240:241]
    v_cvt_pk_bf16_f32 v49, v202, v203
KL_wm_p34:
    s_cbranch_execz KL_wm_p35
    v_pk_add_f32 v[204:205], v[204:205], v[236:237] neg_lo:[0,1] neg_hi:[0,1]
    v_cvt_pk_bf16_f32 v50, v204, v205
    v_lshlrev_b32 v204, 16, v50
    v_and_b32 v205, s26, v50
    v_pk_mul_f32 v[204:205], v[204:205], v[240:241]
    v_cvt_pk_bf16_f32 v50, v204, v205
    v_pk_add_f32 v[206:207], v[206:207], v[236:237] neg_lo:[0,1] neg_hi:[0,1]
    v_cvt_pk_bf16_f32 v51, v206, v207
    v_lshlrev_b32 v206, 16, v51
    v_and_b32 v207, s26, v51
    v_pk_mul_f32 v[206:207], v[206:207], v[240:241]
    v_cvt_pk_bf16_f32 v51, v206, v207
    buffer_store_dwordx4 v[48:51], v4, s[48:51], s25 offen offset:2048 sc1
    v_pk_add_f32 v[208:209], v[208:209], v[236:237] neg_lo:[0,1] neg_hi:[0,1]
    v_cvt_pk_bf16_f32 v52, v208, v209
    v_lshlrev_b32 v208, 16, v52
KL_wm_p35:
    s_cbranch_execz KL_wm_p36
    v_and_b32 v209, s26, v52
    v_pk_mul_f32 v[208:209], v[208:209], v[240:241]
    v_cvt_pk_bf16_f32 v52, v208, v209
    v_pk_add_f32 v[210:211], v[210:211], v[236:237] neg_lo:[0,1] neg_hi:[0,1]
    v_cvt_pk_bf16_f32 v53, v210, v211
    v_lshlrev_b32 v210, 16, v53
    v_and_b32 v211, s26, v53
    v_pk_mul_f32 v[210:211], v[210:211], v[240:241]
    v_cvt_pk_bf16_f32 v53, v210, v211
    v_pk_add_f32 v[212:213], v[212:213], v[236:237] neg_lo:[0,1] neg_hi:[0,1]
    v_cvt_pk_bf16_f32 v54, v212, v213
    v_lshlrev_b32 v212, 16, v54
    v_and_b32 v213, s26, v54
    v_pk_mul_f32 v[212:213], v[212:213], v[240:241]
    v_cvt_pk_bf16_f32 v54, v212, v213
    v_pk_add_f32 v[214:215], v[214:215], v[236:237] neg_lo:[0,1] neg_hi:[0,1]
KL_wm_p36:
    s_cbranch_execz KL_wm_p37
    v_cvt_pk_bf16_f32 v55, v214, v215
    v_lshlrev_b32 v214, 16, v55
    v_and_b32 v215, s26, v55
    v_pk_mul_f32 v[214:215], v[214:215], v[240:241]
    v_cvt_pk_bf16_f32 v55, v214, v215
    buffer_store_dwordx4 v[52:55], v4, s[48:51], s25 offen offset:3072 sc1
    s_add_u32 s25, s25, 4096
    v_pk_add_f32 v[216:217], v[216:217], v[236:237] neg_lo:[0,1] neg_hi:[0,1]
    v_cvt_pk_bf16_f32 v56, v216, v217
    v_lshlrev_b32 v216, 16, v56
    v_and_b32 v217, s26, v56
    v_pk_mul_f32 v[216:217], v[216:217], v[240:241]
    v_cvt_pk_bf16_f32 v56, v216, v217
    v_pk_add_f32 v[218:219], v[218:219], v[236:237] neg_lo:[0,1] neg_hi:[0,1]
    v_cvt_pk_bf16_f32 v57, v218, v219
    v_lshlrev_b32 v218, 16, v57
KL_wm_p37:
    s_cbranch_execz KL_wm_p38
    v_and_b32 v219, s26, v57
    v_pk_mul_f32 v[218:219], v[218:219], v[240:241]
    v_cvt_pk_bf16_f32 v57, v218, v219
    v_pk_add_f32 v[220:221], v[220:221], v[236:237] neg_lo:[0,1] neg_hi:[0,1]
    v_cvt_pk_bf16_f32 v58, v220, v221
    v_lshlrev_b32 v220, 16, v58
    v_and_b32 v221, s26, v58
    v_pk_mul_f32 v[220:221], v[220:221], v[240:241]
    v_cvt_pk_bf16_f32 v58, v220, v221
    v_pk_add_f32 v[222:223], v[222:223], v[236:237] neg_lo:[0,1] neg_hi:[0,1]
    v_cvt_pk_bf16_f32 v59, v222, v223
    v_lshlrev_b32 v222, 16, v59
    v_and_b32 v223, s26, v59
    v_pk_mul_f32 v[222:223], v[222:223], v[240:241]
    v_cvt_pk_bf16_f32 v59, v222, v223
    buffer_store_dwordx4 v[56:59], v4, s[48:51], s25 offen offset:0 sc1
KL_wm_p38:
    s_cbranch_execz KL_wm_p39
    v_pk_add_f32 v[224:225], v[224:225], v[236:237] neg_lo:[0,1] neg_hi:[0,1]
    v_cvt_pk_bf16_f32 v60, v224, v225
    v_lshlrev_b32 v224, 16, v60
    v_and_b32 v225, s26, v60
    v_pk_mul_f32 v[224:225], v[224:225], v[240:241]
    v_cvt_pk_bf16_f32 v60, v224, v225
    v_pk_add_f32 v[226:227], v[226:227], v[236:237] neg_lo:[0,1] neg_hi:[0,1]
    v_cvt_pk_bf16_f32 v61, v226, v227
    v_lshlrev_b32 v226, 16, v61
    v_and_b32 v227, s26, v61
    v_pk_mul_f32 v[226:227], v[226:227], v[240:241]
    v_cvt_pk_bf16_f32 v61, v226, v227
    v_pk_add_f32 v[228:229], v[228:229], v[236:237] neg_lo:[0,1] neg_hi:[0,1]
    v_cvt_pk_bf16_f32 v62, v228, v229
    v_lshlrev_b32 v228, 16, v62
    v_and_b32 v229, s26, v62
    v_pk_mul_f32 v[228:229], v[228:229], v[240:241]
KL_wm_p39:
    s_cbranch_execz KL_wm_p40
    v_cvt_pk_bf16_f32 v62, v228, v229
    v_pk_add_f32 v[230:231], v[230:231], v[236:237] neg_lo:[0,1] neg_hi:[0,1]
    v_cvt_pk_bf16_f32 v63, v230, v231
    v_lshlrev_b32 v230, 16, v63
    v_and_b32 v231, s26, v63
    v_pk_mul_f32 v[230:231], v[230:231], v[240:241]
    v_cvt_pk_bf16_f32 v63, v230, v231
    buffer_store_dwordx4 v[60:63], v4, s[48:51], s25 offen offset:1024 sc1
    s_waitcnt vmcnt(14)
    v_mov_b32 v240, 0
    v_mov_b32 v241, 0
    v_dot2_f32_bf16 v240, v8, v64, v240
    v_dot2_f32_bf16 v241, v9, v65, v241
    v_dot2_f32_bf16 v240, v10, v66, v240
    v_dot2_f32_bf16 v241, v11, v67, v241
    v_dot2_f32_bf16 v240, v12, v68, v240
KL_wm_p40:
    s_cbranch_execz KL_wm_p41
    v_dot2_f32_bf16 v241, v13, v69, v241
    v_dot2_f32_bf16 v240, v14, v70, v240
    v_dot2_f32_bf16 v241, v15, v71, v241
    v_dot2_f32_bf16 v240, v16, v72, v240
    v_dot2_f32_bf16 v241, v17, v73, v241
    v_dot2_f32_bf16 v240, v18, v74, v240
    v_dot2_f32_bf16 v241, v19, v75, v241
    v_dot2_f32_bf16 v240, v20, v76, v240
    v_dot2_f32_bf16 v241, v21, v77, v241
    v_dot2_f32_bf16 v240, v22, v78, v240
    v_dot2_f32_bf16 v241, v23, v79, v241
    v_dot2_f32_bf16 v240, v24, v80, v240
    v_dot2_f32_bf16 v241, v25, v81, v241
    v_dot2_f32_bf16 v240, v26, v82, v240
KL_wm_p41:
    s_cbranch_execz KL_wm_p42
    v_dot2_f32_bf16 v241, v27, v83, v241
    v_dot2_f32_bf16 v240, v28, v84, v240
    v_dot2_f32_bf16 v241, v29, v85, v241
    v_dot2_f32_bf16 v240, v30, v86, v240
    v_dot2_f32_bf16 v241, v31, v87, v241
    v_dot2_f32_bf16 v240, v32, v88, v240
    v_dot2_f32_bf16 v241, v33, v89, v241
    v_dot2_f32_bf16 v240, v34, v90, v240
    v_dot2_f32_bf16 v241, v35, v91, v241
    v_dot2_f32_bf16 v240, v36, v92, v240
    v_dot2_f32_bf16 v241, v37, v93, v241
    v_dot2_f32_bf16 v240, v38, v94, v240
    v_dot2_f32_bf16 v241, v39, v95, v241
    v_dot2_f32_bf16 v240, v40, v96, v240
KL_wm_p42:
    s_cbranch_execz KL_wm_p43
    v_dot2_f32_bf16 v241, v41, v97, v241
    v_dot2_f32_bf16 v240, v42, v98, v240
    v_dot2_f32_bf16 v241, v43, v99, v241
    v_dot2_f32_bf16 v240, v44, v100, v240
    v_dot2_f32_bf16 v241, v45, v101, v241
    v_dot2_f32_bf16 v240, v46, v102, v240
    v_dot2_f32_bf16 v241, v47, v103, v241
    v_dot2_f32_bf16 v240, v48, v104, v240
    v_dot2_f32_bf16 v241, v49, v105, v241
    v_dot2_f32_bf16 v240, v50, v106, v240
    v_dot2_f32_bf16 v241, v51, v107, v241
    v_dot2_f32_bf16 v240, v52, v108, v240
    v_dot2_f32_bf16 v241, v53, v109, v241
    v_dot2_f32_bf16 v240, v54, v110, v240
KL_wm_p43:
    s_cbranch_execz KL_wm_p44
    v_dot2_f32_bf16 v241, v55, v111, v241
    v_dot2_f32_bf16 v240, v56, v112, v240
    v_dot2_f32_bf16 v241, v57, v113, v241
    v_dot2_f32_bf16 v240, v58, v114, v240
    v_dot2_f32_bf16 v241, v59, v115, v241
    v_dot2_f32_bf16 v240, v60, v116, v240
    v_dot2_f32_bf16 v241, v61, v117, v241
    v_dot2_f32_bf16 v240, v62, v118, v240
    v_dot2_f32_bf16 v241, v63, v119, v241
    s_nop 2
    v_add_f32 v240, v240, v241
    v_mov_b32 v241, v240
    s_nop 1
    v_permlane16_swap_b32 v240, v241
    v_add_f32 v240, v240, v241
    v_mov_b32 v241, v240
    s_nop 1
    v_permlane32_swap_b32 v240, v241
    v_add_f32 v240, v240, v241
    v_cvt_pk_bf16_f32 v240, v240, v240
KL_wm_p44:
    s_cbranch_execz KL_wm_ret
    v_and_b32 v240, s26, v240
    v_lshlrev_b32 v241, 2, v2
    s_lshl_b32 s25, s23, 6
    s_mov_b64 exec, 0xffff
    buffer_store_dword v240, v241, s[52:55], s25 offen sc1
    s_mov_b64 exec, -1
    s_add_u32 s56, s18, 0x5d00000
    s_addc_u32 s57, s19, 0
    s_mov_b32 s58, 0xb8000
    s_mov_b32 s59, 0x20000
    s_waitcnt vmcnt(0)
    s_lshl_b32 s28, s21, 7
    s_add_u32 s28, s28, 565248
    v_mov_b32 v8, s96
    v_mov_b32 v9, s28
    s_barrier
    s_mov_b64 exec, 1
    buffer_store_dword v8, v9, s[56:59], 0 offen sc1
    s_mov_b64 exec, -1
    s_cmp_lg_u32 s21, 31
    s_cbranch_scc1 K3_nofill
    v_min_u32 v8, 55, v1
    v_lshlrev_b32 v8, 7, v8
    s_mov_b32 s28, 720896
    s_mov_b32 s29, 728064
    s_mov_b32 s27, 0
K3_fw0:
    buffer_load_dword v9, v8, s[56:59], s28 offen sc1
    s_add_u32 s27, s27, 1
    s_cmp_gt_u32 s27, 65536
    s_cbranch_scc1 K3_bail
    s_waitcnt vmcnt(0)
    v_cmp_ne_u32 vcc, s96, v9
    s_cbranch_vccz K3_fw0_ok
    s_sleep 8
    s_branch K3_fw0
K3_fw0_ok:
    s_mov_b32 s27, 0
K3_fw1:
    buffer_load_dword v9, v8, s[56:59], s29 offen sc1
    s_add_u32 s27, s27, 1
    s_cmp_gt_u32 s27, 65536
    s_cbranch_scc1 K3_bail
    s_waitcnt vmcnt(0)
    v_cmp_ne_u32 vcc, s96, v9
    s_cbranch_vccz K3_fw1_ok
    s_sleep 8
    s_branch K3_fw1
K3_fw1_ok:
K3_nofill:
    s_lshl_b32 s28, s21, 7
    s_add_u32 s28, s28, 737280
    v_mov_b32 v8, s35
    v_mov_b32 v9, s28
    s_barrier
    s_mov_b64 exec, 1
    buffer_store_dword v8, v9, s[56:59], 0 offen sc1
    s_mov_b64 exec, -1
    s_cmp_eq_u32 s21, 31
    s_cbranch_scc1 K3_w
    s_cmp_eq_u32 s21, 30
    s_cbranch_scc1 K3_f
    s_cmp_ge_u32 s21, 16
    s_cbranch_scc1 K3_b
    s_mov_b32 s22, s21
    s_mul_i32 s26, s22, 401408
    s_add_u32 s26, s26, 0x800000
    s_add_u32 s36, s18, s26
    s_addc_u32 s37, s19, 0
    s_mov_b32 s38, 0x62000
    s_mov_b32 s39, 0x20000
    s_add_u32 s48, s18, 0x3400000
    s_addc_u32 s49, s19, 0
    s_mov_b32 s50, 0x1c00000
    s_mov_b32 s51, 0x20000
    s_add_u32 s52, s18, 0x200000
    s_addc_u32 s53, s19, 0
    s_mov_b32 s54, 0x1c0000
    s_mov_b32 s55, 0x20000
    s_add_u32 s56, s18, 0x5d00000
    s_addc_u32 s57, s19, 0
    s_mov_b32 s58, 0xb8000
    s_mov_b32 s59, 0x20000
    v_min_u32 v5, 27, v1
    v_lshlrev_b32 v5, 7, v5
    s_mul_i32 s29, s22, 3584
    s_add_u32 s29, s29, 589824
    s_mov_b32 s27, 0
K3a_wp0:
    buffer_load_dword v6, v5, s[56:59], s29 offen sc1
    s_add_u32 s27, s27, 1
    s_cmp_gt_u32 s27, 65536
    s_cbranch_scc1 K3_bail
K3a_wp0_chk:
    s_waitcnt vmcnt(0)
    v_subrev_u32 v6, s95, v6
    v_subrev_u32 v6, 1, v6
    v_cmp_lt_u32 vcc, 4, v6
    s_cbranch_vccz K3a_wp0_ok
    s_sleep 6
    s_branch K3a_wp0
K3a_wp0_ok:
    s_mul_i32 s28, s3, 100352
    s_add_u32 s28, s28, 0
    buffer_load_dwordx4 a[0:3], v4, s[36:39], s28 offen offset:0 sc1
    buffer_load_dwordx4 a[4:7], v4, s[36:39], s28 offen offset:1024 sc1
    buffer_load_dwordx4 a[8:11], v4, s[36:39], s28 offen offset:2048 sc1
    buffer_load_dwordx4 a[12:15], v4, s[36:39], s28 offen offset:3072 sc1
    s_add_u32 s28, s28, 14336
    buffer_load_dwordx4 a[56:59], v4, s[36:39], s28 offen offset:0 sc1
    buffer_load_dwordx4 a[60:63], v4, s[36:39], s28 offen offset:1024 sc1
    buffer_load_dwordx4 a[64:67], v4, s[36:39], s28 offen offset:2048 sc1
    buffer_load_dwordx4 a[68:71], v4, s[36:39], s28 offen offset:3072 sc1
    s_add_u32 s28, s28, 14336
    buffer_load_dwordx4 a[112:115], v4, s[36:39], s28 offen offset:0 sc1
    buffer_load_dwordx4 a[116:119], v4, s[36:39], s28 offen offset:1024 sc1
    buffer_load_dwordx4 a[120:123], v4, s[36:39], s28 offen offset:2048 sc1
    buffer_load_dwordx4 a[124:127], v4, s[36:39], s28 offen offset:3072 sc1
    s_add_u32 s28, s28, 14336
    buffer_load_dwordx4 a[168:171], v4, s[36:39], s28 offen offset:0 sc1
    buffer_load_dwordx4 a[172:175], v4, s[36:39], s28 offen offset:1024 sc1
    buffer_load_dwordx4 a[176:179], v4, s[36:39], s28 offen offset:2048 sc1
    buffer_load_dwordx4 a[180:183], v4, s[36:39], s28 offen offset:3072 sc1
    s_add_u32 s28, s28, 14336
    buffer_load_dwordx4 a[224:227], v4, s[36:39], s28 offen offset:0 sc1
    buffer_load_dwordx4 a[228:231], v4, s[36:39], s28 offen offset:1024 sc1
    buffer_load_dwordx4 a[232:235], v4, s[36:39], s28 offen offset:2048 sc1
    buffer_load_dwordx4 a[236:239], v4, s[36:39], s28 offen offset:3072 sc1
    s_add_u32 s28, s28, 14336
    buffer_load_dwordx4 v[144:147], v4, s[36:39], s28 offen offset:0 sc1
    buffer_load_dwordx4 v[148:151], v4, s[36:39], s28 offen offset:1024 sc1
    buffer_load_dwordx4 v[152:155], v4, s[36:39], s28 offen offset:2048 sc1
    buffer_load_dwordx4 v[156:159], v4, s[36:39], s28 offen offset:3072 sc1
    s_add_u32 s28, s28, 14336
    buffer_load_dwordx4 v[200:203], v4, s[36:39], s28 offen offset:0 sc1
    buffer_load_dwordx4 v[204:207], v4, s[36:39], s28 offen offset:1024 sc1
    buffer_load_dwordx4 v[208:211], v4, s[36:39], s28 offen offset:2048 sc1
    buffer_load_dwordx4 v[212:215], v4, s[36:39], s28 offen offset:3072 sc1
    s_add_u32 s28, s28, 14336
    buffer_load_dword v6, v5, s[56:59], s29 offen sc1
    s_mov_b32 s27, 0
    s_branch K3a_wp1_chk
K3a_wp1:
    buffer_load_dword v6, v5, s[56:59], s29 offen sc1
    s_add_u32 s27, s27, 1
    s_cmp_gt_u32 s27, 65536
    s_cbranch_scc1 K3_bail
K3a_wp1_chk:
    s_waitcnt vmcnt(0)
    v_subrev_u32 v6, s95, v6
    v_subrev_u32 v6, 2, v6
    v_cmp_lt_u32 vcc, 3, v6
    s_cbranch_vccz K3a_wp1_ok
    s_sleep 6
    s_branch K3a_wp1
K3a_wp1_ok:
    s_mul_i32 s28, s3, 100352
    s_add_u32 s28, s28, 4096
    buffer_load_dwordx4 a[16:19], v4, s[36:39], s28 offen offset:0 sc1
    buffer_load_dwordx4 a[20:23], v4, s[36:39], s28 offen offset:1024 sc1
    buffer_load_dwordx4 a[24:27], v4, s[36:39], s28 offen offset:2048 sc1
    buffer_load_dwordx4 a[28:31], v4, s[36:39], s28 offen offset:3072 sc1
    s_add_u32 s28, s28, 14336
    buffer_load_dwordx4 a[72:75], v4, s[36:39], s28 offen offset:0 sc1
    buffer_load_dwordx4 a[76:79], v4, s[36:39], s28 offen offset:1024 sc1
    buffer_load_dwordx4 a[80:83], v4, s[36:39], s28 offen offset:2048 sc1
    buffer_load_dwordx4 a[84:87], v4, s[36:39], s28 offen offset:3072 sc1
    s_add_u32 s28, s28, 14336
    buffer_load_dwordx4 a[128:131], v4, s[36:39], s28 offen offset:0 sc1
    buffer_load_dwordx4 a[132:135], v4, s[36:39], s28 offen offset:1024 sc1
    buffer_load_dwordx4 a[136:139], v4, s[36:39], s28 offen offset:2048 sc1
    buffer_load_dwordx4 a[140:143], v4, s[36:39], s28 offen offset:3072 sc1
    s_add_u32 s28, s28, 14336
    buffer_load_dwordx4 a[184:187], v4, s[36:39], s28 offen offset:0 sc1
    buffer_load_dwordx4 a[188:191], v4, s[36:39], s28 offen offset:1024 sc1
    buffer_load_dwordx4 a[192:195], v4, s[36:39], s28 offen offset:2048 sc1
    buffer_load_dwordx4 a[196:199], v4, s[36:39], s28 offen offset:3072 sc1
    s_add_u32 s28, s28, 14336
    buffer_load_dwordx4 a[240:243], v4, s[36:39], s28 offen offset:0 sc1
    buffer_load_dwordx4 a[244:247], v4, s[36:39], s28 offen offset:1024 sc1
    buffer_load_dwordx4 a[248:251], v4, s[36:39], s28 offen offset:2048 sc1
    buffer_load_dwordx4 a[252:255], v4, s[36:39], s28 offen offset:3072 sc1
    s_add_u32 s28, s28, 14336
    buffer_load_dwordx4 v[160:163], v4, s[36:39], s28 offen offset:0 sc1
    buffer_load_dwordx4 v[164:167], v4, s[36:39], s28 offen offset:1024 sc1
    buffer_load_dwordx4 v[168:171], v4, s[36:39], s28 offen offset:2048 sc1
    buffer_load_dwordx4 v[172:175], v4, s[36:39], s28 offen offset:3072 sc1
    s_add_u32 s28, s28, 14336
    buffer_load_dwordx4 v[216:219], v4, s[36:39], s28 offen offset:0 sc1
    buffer_load_dwordx4 v[220:223], v4, s[36:39], s28 offen offset:1024 sc1
    buffer_load_dwordx4 v[224:227], v4, s[36:39], s28 offen offset:2048 sc1
    buffer_load_dwordx4 v[228:231], v4, s[36:39], s28 offen offset:3072 sc1
    s_add_u32 s28, s28, 14336
    buffer_load_dword v6, v5, s[56:59], s29 offen sc1
    s_mov_b32 s27, 0
    s_branch K3a_wp2_chk
K3a_wp2:
    buffer_load_dword v6, v5, s[56:59], s29 offen sc1
    s_add_u32 s27, s27, 1
    s_cmp_gt_u32 s27, 65536
    s_cbranch_scc1 K3_bail
K3a_wp2_chk:
    s_waitcnt vmcnt(0)
    v_subrev_u32 v6, s95, v6
    v_subrev_u32 v6, 3, v6
    v_cmp_lt_u32 vcc, 2, v6
    s_cbranch_vccz K3a_wp2_ok
    s_sleep 6
    s_branch K3a_wp2
K3a_wp2_ok:
    s_mul_i32 s28, s3, 100352
    s_add_u32 s28, s28, 8192
    buffer_load_dwordx4 a[32:35], v4, s[36:39], s28 offen offset:0 sc1
    buffer_load_dwordx4 a[36:39], v4, s[36:39], s28 offen offset:1024 sc1
    buffer_load_dwordx4 a[40:43], v4, s[36:39], s28 offen offset:2048 sc1
    buffer_load_dwordx4 a[44:47], v4, s[36:39], s28 offen offset:3072 sc1
    s_add_u32 s28, s28, 14336
    buffer_load_dwordx4 a[88:91], v4, s[36:39], s28 offen offset:0 sc1
    buffer_load_dwordx4 a[92:95], v4, s[36:39], s28 offen offset:1024 sc1
    buffer_load_dwordx4 a[96:99], v4, s[36:39], s28 offen offset:2048 sc1
    buffer_load_dwordx4 a[100:103], v4, s[36:39], s28 offen offset:3072 sc1
    s_add_u32 s28, s28, 14336
    buffer_load_dwordx4 a[144:147], v4, s[36:39], s28 offen offset:0 sc1
    buffer_load_dwordx4 a[148:151], v4, s[36:39], s28 offen offset:1024 sc1
    buffer_load_dwordx4 a[152:155], v4, s[36:39], s28 offen offset:2048 sc1
    buffer_load_dwordx4 a[156:159], v4, s[36:39], s28 offen offset:3072 sc1
    s_add_u32 s28, s28, 14336
    buffer_load_dwordx4 a[200:203], v4, s[36:39], s28 offen offset:0 sc1
    buffer_load_dwordx4 a[204:207], v4, s[36:39], s28 offen offset:1024 sc1
    buffer_load_dwordx4 a[208:211], v4, s[36:39], s28 offen offset:2048 sc1
    buffer_load_dwordx4 a[212:215], v4, s[36:39], s28 offen offset:3072 sc1
    s_add_u32 s28, s28, 14336
    buffer_load_dwordx4 v[120:123], v4, s[36:39], s28 offen offset:0 sc1
    buffer_load_dwordx4 v[124:127], v4, s[36:39], s28 offen offset:1024 sc1
    buffer_load_dwordx4 v[128:131], v4, s[36:39], s28 offen offset:2048 sc1
    buffer_load_dwordx4 v[132:135], v4, s[36:39], s28 offen offset:3072 sc1
    s_add_u32 s28, s28, 14336
    buffer_load_dwordx4 v[176:179], v4, s[36:39], s28 offen offset:0 sc1
    buffer_load_dwordx4 v[180:183], v4, s[36:39], s28 offen offset:1024 sc1
    buffer_load_dwordx4 v[184:187], v4, s[36:39], s28 offen offset:2048 sc1
    buffer_load_dwordx4 v[188:191], v4, s[36:39], s28 offen offset:3072 sc1
    s_add_u32 s28, s28, 14336
    buffer_load_dwordx4 v[232:235], v4, s[36:39], s28 offen offset:0 sc1
    buffer_load_dwordx4 v[236:239], v4, s[36:39], s28 offen offset:1024 sc1
    buffer_load_dwordx4 v[240:243], v4, s[36:39], s28 offen offset:2048 sc1
    buffer_load_dwordx4 v[244:247], v4, s[36:39], s28 offen offset:3072 sc1
    s_add_u32 s28, s28, 14336
    buffer_load_dword v6, v5, s[56:59], s29 offen sc1
    s_mov_b32 s27, 0
    s_branch K3a_wp3_chk
K3a_wp3:
    buffer_load_dword v6, v5, s[56:59], s29 offen sc1
    s_add_u32 s27, s27, 1
    s_cmp_gt_u32 s27, 65536
    s_cbranch_scc1 K3_bail
K3a_wp3_chk:
    s_waitcnt vmcnt(0)
    v_subrev_u32 v6, s95, v6
    v_subrev_u32 v6, 4, v6
    v_cmp_lt_u32 vcc, 1, v6
    s_cbranch_vccz K3a_wp3_ok
    s_sleep 6
    s_branch K3a_wp3
K3a_wp3_ok:
    s_mul_i32 s28, s3, 100352
    s_add_u32 s28, s28, 12288
    buffer_load_dwordx4 a[48:51], v4, s[36:39], s28 offen offset:0 sc1
    buffer_load_dwordx4 a[52:55], v4, s[36:39], s28 offen offset:1024 sc1
    s_add_u32 s28, s28, 14336
    buffer_load_dwordx4 a[104:107], v4, s[36:39], s28 offen offset:0 sc1
    buffer_load_dwordx4 a[108:111], v4, s[36:39], s28 offen offset:1024 sc1
    s_add_u32 s28, s28, 14336
    buffer_load_dwordx4 a[160:163], v4, s[36:39], s28 offen offset:0 sc1
    buffer_load_dwordx4 a[164:167], v4, s[36:39], s28 offen offset:1024 sc1
    s_add_u32 s28, s28, 14336
    buffer_load_dwordx4 a[216:219], v4, s[36:39], s28 offen offset:0 sc1
    buffer_load_dwordx4 a[220:223], v4, s[36:39], s28 offen offset:1024 sc1
    s_add_u32 s28, s28, 14336
    buffer_load_dwordx4 v[136:139], v4, s[36:39], s28 offen offset:0 sc1
    buffer_load_dwordx4 v[140:143], v4, s[36:39], s28 offen offset:1024 sc1
    s_add_u32 s28, s28, 14336
    buffer_load_dwordx4 v[192:195], v4, s[36:39], s28 offen offset:0 sc1
    buffer_load_dwordx4 v[196:199], v4, s[36:39], s28 offen offset:1024 sc1
    s_add_u32 s28, s28, 14336
    buffer_load_dwordx4 v[248:251], v4, s[36:39], s28 offen offset:0 sc1
    buffer_load_dwordx4 v[252:255], v4, s[36:39], s28 offen offset:1024 sc1
    s_add_u32 s28, s28, 14336
    s_or_b32 s28, s21, s3
    s_cmp_lg_u32 s28, 0
    s_cbranch_scc1 K3a_nt
    s_mov_b32 s28, 741376
    v_mov_b32 v8, s96
    v_mov_b32 v9, 0
    s_mov_b64 exec, 1
    buffer_store_dword v8, v9, s[56:59], s28 offen sc1
    s_mov_b64 exec, -1
K3a_nt:
    v_min_u32 v20, 31, v1
    v_lshlrev_b32 v20, 7, v20
    s_mov_b32 s27, 0
    s_mov_b32 s28, 737280
    buffer_load_dword v21, v20, s[56:59], s28 offen sc1
    s_mul_i32 s28, s3, 7
    s_add_u32 s30, s28, 6
    v_lshrrev_b32 v8, 1, v3
    v_and_b32 v9, 1, v3
    v_lshlrev_b32 v7, 7, v8
    v_lshl_add_u32 v7, v2, 3, v7
    v_lshl_add_u32 v7, v9, 2, v7
    s_lshl_b32 s28, s28, 8
    v_add_u32 v5, s28, v7
    s_lshl_b32 s30, s30, 8
    v_add_u32 v6, s30, v7
    s_mov_b32 s64, 0
    s_mov_b32 s26, 0xffff0000
    v_lshrrev_b32 v10, 2, v2
    v_and_b32 v11, 3, v2
    v_lshrrev_b32 v12, 1, v10
    v_lshl_add_u32 v12, v8, 1, v12
    v_lshlrev_b32 v0, 8, v12
    v_and_b32 v12, 1, v11
    v_lshl_add_u32 v0, v12, 7, v0
    v_lshlrev_b32 v12, 3, v9
    v_and_b32 v13, 2, v11
    v_add_u32 v12, v12, v13
    v_and_b32 v13, 1, v10
    v_add_u32 v12, v12, v13
    v_lshl_add_u32 v0, v12, 3, v0
    s_sub_u32 s28, s3, 1
    s_and_b32 s28, s28, 1
    s_mul_i32 s94, s28, 14336
    s_lshl_b32 s28, s28, 3
    s_add_u32 s28, s28, 7168
    v_lshl_add_u32 v7, v9, 2, v8
    v_mul_u32_u24 v7, 144, v7
    v_lshrrev_b32 v12, 1, v2
    v_lshl_add_u32 v7, v12, 4, v7
    v_and_b32 v12, 1, v2
    v_lshl_add_u32 v7, v12, 2, v7
    v_add_u32 v7, s28, v7
    v_lshlrev_b32 v118, 6, v1
    s_mul_i32 s28, s22, 28672
    s_cmp_eq_u32 s3, 0
    s_cselect_b32 s94, s28, s94
    v_mul_u32_u24 v106, 144, v2
    v_lshl_add_u32 v106, v3, 3, v106
    v_add_u32 v106, 8320, v106
    v_lshrrev_b32 v12, 3, v1
    v_and_b32 v13, 7, v1
    v_mul_u32_u24 v14, 144, v12
    v_lshl_add_u32 v105, v13, 2, v14
    v_add_u32 v105, 8320, v105
    v_lshl_add_u32 v14, v13, 4, v14
    v_add_u32 v14, 7168, v14
    s_cmp_eq_u32 s3, 0
    s_cselect_b64 vcc, -1, 0
    v_cndmask_b32 v7, v7, v14, vcc
    v_lshlrev_b32 v15, 5, v12
    v_lshrrev_b32 v14, 2, v13
    v_lshl_add_u32 v15, v14, 8, v15
    v_bfe_u32 v14, v13, 1, 1
    v_lshl_add_u32 v15, v14, 3, v15
    v_and_b32 v14, 1, v13
    v_lshl_add_u32 v116, v14, 4, v15
    s_lshl_b32 s28, s22, 9
    v_add_u32 v116, s28, v116
    v_lshl_add_u32 v117, v14, 1, v15
    s_lshr_b32 s28, s22, 2
    s_lshl_b32 s28, s28, 9
    s_and_b32 s29, s22, 1
    s_lshl_b32 s29, s29, 4
    s_add_u32 s28, s28, s29
    s_bfe_u32 s29, s22, 0x10001
    s_lshl_b32 s29, s29, 2
    s_add_u32 s28, s28, s29
    s_add_u32 s28, s28, 8192
    v_add_u32 v117, s28, v117
    v_mov_b32 v14, 0x7ffffff0
    v_min_u32 v114, 15, v1
    v_lshlrev_b32 v114, 7, v114
    v_add_u32 v114, 2048, v114
    v_min_u32 v111, 27, v1
    v_lshlrev_b32 v111, 2, v111
    s_and_b32 s28, s22, 0
    s_lshl_b32 s28, s28, 7
    s_add_u32 s28, s28, 7168
    v_add_u32 v111, s28, v111
    v_mov_b32 v112, 0
    s_mov_b32 s28, 8192
    buffer_load_dword v115, v114, s[56:59], s28 offen sc1
    s_lshl_b32 s29, s22, 2
    s_add_u32 s29, s29, 15872
    v_lshlrev_b32 v110, 7, v1
    v_add_u32 v110, s29, v110
    v_cmp_gt_u32 vcc, 1, v1
    s_nop 1
    v_cndmask_b32 v110, v14, v110, vcc
    v_mov_b32 v12, 0x4444
    v_mov_b32 v14, 0xeeee
    v_cmp_lt_u32 vcc, 7, v2
    s_nop 1
    v_cndmask_b32 v3, v12, v14, vcc
    v_and_b32 v2, 1, v2
    v_cmp_eq_u32 vcc, 1, v2
    s_nop 1
    v_cndmask_b32 v2, v12, v14, vcc
    v_add_u32 v1, 12288, v4
    s_sub_u32 s88, s3, 1
    s_mul_i32 s88, s88, 9216
    s_add_u32 s87, s88, 32768
    s_mov_b32 s33, 0
    s_cmp_ge_u32 s88, 10000
    s_cbranch_scc1 K3a_nx
    s_mul_i32 s28, s33, 28672
    s_add_u32 s28, s28, s94
    buffer_load_dwordx4 v[64:67], v4, s[52:55], s28 offen offset:0
    buffer_load_dwordx4 v[68:71], v4, s[52:55], s28 offen offset:1024
    buffer_load_dwordx4 v[72:75], v4, s[52:55], s28 offen offset:2048
    buffer_load_dwordx4 v[76:79], v4, s[52:55], s28 offen offset:3072
    s_add_u32 s28, s28, 4096
    buffer_load_dwordx4 v[80:83], v4, s[52:55], s28 offen offset:0
    buffer_load_dwordx4 v[84:87], v4, s[52:55], s28 offen offset:1024
    buffer_load_dwordx4 v[88:91], v4, s[52:55], s28 offen offset:2048
    buffer_load_dwordx4 v[92:95], v4, s[52:55], s28 offen offset:3072
    s_add_u32 s28, s28, 4096
    buffer_load_dwordx4 v[96:99], v4, s[52:55], s28 offen offset:0
    buffer_load_dwordx4 v[100:103], v4, s[52:55], s28 offen offset:1024
    buffer_load_dwordx4 v[104:107], v4, s[52:55], s28 offen offset:2048
    buffer_load_dwordx4 v[108:111], v4, s[52:55], s28 offen offset:3072
    s_add_u32 s28, s28, 4096
    buffer_load_dwordx4 v[112:115], v4, s[52:55], s28 offen offset:0
    buffer_load_dwordx4 v[116:119], v4, s[52:55], s28 offen offset:1024
K3a_nx:
    s_mov_b32 s27, 0
    s_mov_b32 s28, 737280
    s_branch K3_end_fl1429_chk
K3_end_fl1429:
    buffer_load_dword v21, v20, s[56:59], s28 offen sc1
    s_add_u32 s27, s27, 1
    s_cmp_gt_u32 s27, 65536
    s_cbranch_scc1 K3_bail
K3_end_fl1429_chk:
    s_waitcnt vmcnt(0)
    v_xor_b32 v21, s35, v21
    v_cmp_lt_u32 vcc, 15, v21
    s_cbranch_vccnz K3_end_fl1429
    v_cmp_ne_u32 vcc, 0, v21
    s_nop 0
    s_cmp_lg_u64 vcc, 0
    s_cselect_b32 s65, 1, 0
    s_cmp_lg_u32 s65, 0
    s_cbranch_scc1 K3a_fl1
    s_cmp_eq_u32 s3, 0
    s_cbranch_scc1 K3a_r0f0
    s_cmp_eq_u32 s3, 3
    s_cbranch_scc1 K3a_r3f0
K3a1f0_loop:
    s_lshl_b32 s32, s64, 13
    s_add_u32 s34, s32, 4096
    s_add_u32 s33, s64, 1
    s_min_u32 s33, s33, 63
    s_mov_b32 s27, 0
    v_mov_b32 v36, 0
    v_mov_b32 v37, 0
    v_mov_b32 v38, 0
    v_mov_b32 v39, 0
    v_mov_b32 v40, 0
    v_mov_b32 v41, 0
    v_mov_b32 v42, 0
    v_mov_b32 v43, 0
    v_mov_b32 v44, 0
    v_mov_b32 v45, 0
    v_mov_b32 v46, 0
    v_mov_b32 v47, 0
    v_mov_b32 v48, 0
    v_mov_b32 v49, 0
    v_mov_b32 v50, 0
    v_mov_b32 v51, 0
    v_mov_b32 v52, 0
    v_mov_b32 v53, 0
    v_mov_b32 v54, 0
    v_mov_b32 v55, 0
    v_mov_b32 v56, 0
    v_mov_b32 v57, 0
    v_mov_b32 v58, 0
    v_mov_b32 v59, 0
    v_mov_b32 v60, 0
    v_mov_b32 v61, 0
    v_mov_b32 v62, 0
    v_mov_b32 v63, 0
K3a1f0_go:
    s_barrier
    ds_read_b128 v[8:11], v1 offset:0
    ds_read_b128 v[12:15], v1 offset:1024
    s_waitcnt lgkmcnt(1)
    v_smfmac_f32_16x16x64_bf16 v[36:39], v[8:11], a[0:7], v2
    v_smfmac_f32_16x16x64_bf16 v[40:43], v[8:11], a[56:63], v2
    v_smfmac_f32_16x16x64_bf16 v[44:47], v[8:11], a[112:119], v2
    v_smfmac_f32_16x16x64_bf16 v[48:51], v[8:11], a[168:175], v2
    s_barrier
    ds_read_b128 v[16:19], v1 offset:2048
    ds_read_b128 v[20:23], v1 offset:3072
    ds_read_b128 v[24:27], v1 offset:4096
    ds_read_b128 v[28:31], v1 offset:5120
    ds_read_b128 v[32:35], v1 offset:6144
    v_smfmac_f32_16x16x64_bf16 v[52:55], v[8:11], a[224:231], v2
    v_smfmac_f32_16x16x64_bf16 v[56:59], v[8:11], v[144:151], v2
    v_smfmac_f32_16x16x64_bf16 v[60:63], v[8:11], v[200:207], v2
    s_waitcnt lgkmcnt(5)
    v_smfmac_f32_16x16x64_bf16 v[36:39], v[12:15], a[8:15], v2
    v_smfmac_f32_16x16x64_bf16 v[40:43], v[12:15], a[64:71], v2
    v_smfmac_f32_16x16x64_bf16 v[44:47], v[12:15], a[120:127], v2
    v_smfmac_f32_16x16x64_bf16 v[48:51], v[12:15], a[176:183], v2
    v_smfmac_f32_16x16x64_bf16 v[52:55], v[12:15], a[232:239], v2
    v_smfmac_f32_16x16x64_bf16 v[56:59], v[12:15], v[152:159], v2
    v_smfmac_f32_16x16x64_bf16 v[60:63], v[12:15], v[208:215], v2
    s_waitcnt lgkmcnt(4)
    v_smfmac_f32_16x16x64_bf16 v[36:39], v[16:19], a[16:23], v2
    v_smfmac_f32_16x16x64_bf16 v[40:43], v[16:19], a[72:79], v2
    s_waitcnt lgkmcnt(3)
    v_smfmac_f32_16x16x64_bf16 v[36:39], v[20:23], a[24:31], v2
    v_smfmac_f32_16x16x64_bf16 v[40:43], v[20:23], a[80:87], v2
    s_waitcnt lgkmcnt(2)
    v_smfmac_f32_16x16x64_bf16 v[36:39], v[24:27], a[32:39], v2
    v_smfmac_f32_16x16x64_bf16 v[40:43], v[24:27], a[88:95], v2
    s_waitcnt lgkmcnt(1)
    v_smfmac_f32_16x16x64_bf16 v[36:39], v[28:31], a[40:47], v2
    v_smfmac_f32_16x16x64_bf16 v[40:43], v[28:31], a[96:103], v2
    s_waitcnt lgkmcnt(0)
    v_smfmac_f32_16x16x64_bf16 v[36:39], v[32:35], a[48:55], v2
    v_smfmac_f32_16x16x64_bf16 v[40:43], v[32:35], a[104:111], v2
    v_smfmac_f32_16x16x64_bf16 v[44:47], v[16:19], a[128:135], v2
    v_smfmac_f32_16x16x64_bf16 v[48:51], v[16:19], a[184:191], v2
    v_smfmac_f32_16x16x64_bf16 v[44:47], v[20:23], a[136:143], v2
    v_smfmac_f32_16x16x64_bf16 v[48:51], v[20:23], a[192:199], v2
    s_nop 2
    v_add_f32 v36, v36, v37
    v_smfmac_f32_16x16x64_bf16 v[44:47], v[24:27], a[144:151], v2
    v_add_f32 v38, v38, v39
    v_smfmac_f32_16x16x64_bf16 v[48:51], v[24:27], a[200:207], v2
    v_cmp_u_f32 vcc, v36, v38
    v_smfmac_f32_16x16x64_bf16 v[44:47], v[28:31], a[152:159], v2
    s_cbranch_vccnz K3a1f0_slow
K3a1f0_back:
    v_smfmac_f32_16x16x64_bf16 v[48:51], v[28:31], a[208:215], v2
    v_cvt_pk_bf16_f32 v36, v36, v38
    v_smfmac_f32_16x16x64_bf16 v[44:47], v[32:35], a[160:167], v2
    v_add_f32 v40, v40, v41
    v_smfmac_f32_16x16x64_bf16 v[48:51], v[32:35], a[216:223], v2
    v_add_f32 v42, v42, v43
    v_smfmac_f32_16x16x64_bf16 v[52:55], v[16:19], a[240:247], v2
    v_cvt_pk_bf16_f32 v40, v40, v42
    v_smfmac_f32_16x16x64_bf16 v[56:59], v[16:19], v[160:167], v2
    ds_write2st64_b32 v5, v36, v40 offset0:0 offset1:1
    v_smfmac_f32_16x16x64_bf16 v[52:55], v[20:23], a[248:255], v2
    v_smfmac_f32_16x16x64_bf16 v[56:59], v[20:23], v[168:175], v2
    v_add_f32 v44, v44, v45
    v_smfmac_f32_16x16x64_bf16 v[52:55], v[24:27], v[120:127], v2
    v_add_f32 v46, v46, v47
    v_smfmac_f32_16x16x64_bf16 v[56:59], v[24:27], v[176:183], v2
    v_cvt_pk_bf16_f32 v44, v44, v46
    v_smfmac_f32_16x16x64_bf16 v[52:55], v[28:31], v[128:135], v2
    v_add_f32 v48, v48, v49
    v_smfmac_f32_16x16x64_bf16 v[56:59], v[28:31], v[184:191], v2
    v_add_f32 v50, v50, v51
    v_smfmac_f32_16x16x64_bf16 v[52:55], v[32:35], v[136:143], v2
    v_cvt_pk_bf16_f32 v48, v48, v50
    v_smfmac_f32_16x16x64_bf16 v[56:59], v[32:35], v[192:199], v2
    ds_write2st64_b32 v5, v44, v48 offset0:2 offset1:3
    v_smfmac_f32_16x16x64_bf16 v[60:63], v[16:19], v[216:223], v2
    v_mov_b32 v36, 0
    v_smfmac_f32_16x16x64_bf16 v[60:63], v[20:23], v[224:231], v2
    v_smfmac_f32_16x16x64_bf16 v[60:63], v[24:27], v[232:239], v2
    v_mov_b32 v37, 0
    v_mov_b32 v38, 0
    v_smfmac_f32_16x16x64_bf16 v[60:63], v[28:31], v[240:247], v2
    v_mov_b32 v39, 0
    v_add_f32 v52, v52, v53
    v_smfmac_f32_16x16x64_bf16 v[60:63], v[32:35], v[248:255], v2
    v_add_f32 v54, v54, v55
    v_cvt_pk_bf16_f32 v52, v52, v54
    v_add_f32 v56, v56, v57
    v_add_f32 v58, v58, v59
    v_cvt_pk_bf16_f32 v56, v56, v58
    ds_write2st64_b32 v5, v52, v56 offset0:4 offset1:5
    s_nop 1
    v_add_f32 v60, v60, v61
    v_add_f32 v62, v62, v63
    v_cvt_pk_bf16_f32 v60, v60, v62
    ds_write_b32 v6, v60
    s_waitcnt lgkmcnt(0)
    s_barrier
    ds_read_b64_tr_b16 v[8:9], v0 offset:0
    ds_read_b64_tr_b16 v[10:11], v0 offset:32
    ds_read_b64_tr_b16 v[40:41], v0 offset:1024
    ds_read_b64_tr_b16 v[42:43], v0 offset:1056
    ds_read_b64_tr_b16 v[44:45], v0 offset:2048
    ds_read_b64_tr_b16 v[46:47], v0 offset:2080
    ds_read_b64_tr_b16 v[48:49], v0 offset:3072
    ds_read_b64_tr_b16 v[50:51], v0 offset:3104
    ds_read_b64_tr_b16 v[52:53], v0 offset:4096
    ds_read_b64_tr_b16 v[54:55], v0 offset:4128
    ds_read_b64_tr_b16 v[56:57], v0 offset:5120
    ds_read_b64_tr_b16 v[58:59], v0 offset:5152
    ds_read_b64_tr_b16 v[60:61], v0 offset:6144
    ds_read_b64_tr_b16 v[62:63], v0 offset:6176
    s_waitcnt lgkmcnt(12) vmcnt(0)
    v_smfmac_f32_16x16x64_bf16 v[36:39], v[8:11], v[64:71], v3
    s_waitcnt lgkmcnt(10)
    v_smfmac_f32_16x16x64_bf16 v[36:39], v[40:43], v[72:79], v3
    s_waitcnt lgkmcnt(8)
    v_smfmac_f32_16x16x64_bf16 v[36:39], v[44:47], v[80:87], v3
    s_waitcnt lgkmcnt(6)
    v_smfmac_f32_16x16x64_bf16 v[36:39], v[48:51], v[88:95], v3
    s_waitcnt lgkmcnt(4)
    v_smfmac_f32_16x16x64_bf16 v[36:39], v[52:55], v[96:103], v3
    s_waitcnt lgkmcnt(2)
    v_smfmac_f32_16x16x64_bf16 v[36:39], v[56:59], v[104:111], v3
    s_waitcnt lgkmcnt(0)
    v_smfmac_f32_16x16x64_bf16 v[36:39], v[60:63], v[112:119], v3
    s_nop 7
    v_permlane32_swap_b32 v36, v37
    v_permlane32_swap_b32 v38, v39
    v_add_f32 v36, v36, v37
    v_add_f32 v38, v38, v39
    ds_write2_b32 v7, v36, v38 offset0:0 offset1:72
    s_waitcnt lgkmcnt(0)
    s_barrier
    s_mul_i32 s28, s33, 28672
    s_add_u32 s28, s28, s94
    s_barrier
    buffer_load_dwordx4 v[64:67], v4, s[52:55], s28 offen offset:0
    buffer_load_dwordx4 v[68:71], v4, s[52:55], s28 offen offset:1024
    buffer_load_dwordx4 v[72:75], v4, s[52:55], s28 offen offset:2048
    buffer_load_dwordx4 v[76:79], v4, s[52:55], s28 offen offset:3072
    s_add_u32 s28, s28, 4096
    buffer_load_dwordx4 v[80:83], v4, s[52:55], s28 offen offset:0
    buffer_load_dwordx4 v[84:87], v4, s[52:55], s28 offen offset:1024
    buffer_load_dwordx4 v[88:91], v4, s[52:55], s28 offen offset:2048
    buffer_load_dwordx4 v[92:95], v4, s[52:55], s28 offen offset:3072
    s_add_u32 s28, s28, 4096
    buffer_load_dwordx4 v[96:99], v4, s[52:55], s28 offen offset:0
    buffer_load_dwordx4 v[100:103], v4, s[52:55], s28 offen offset:1024
    buffer_load_dwordx4 v[104:107], v4, s[52:55], s28 offen offset:2048
    buffer_load_dwordx4 v[108:111], v4, s[52:55], s28 offen offset:3072
    s_add_u32 s28, s28, 4096
    buffer_load_dwordx4 v[112:115], v4, s[52:55], s28 offen offset:0
    buffer_load_dwordx4 v[116:119], v4, s[52:55], s28 offen offset:1024
    s_add_u32 s64, s64, 1
    s_cmp_lt_u32 s64, 63
    s_cbranch_scc1 K3a1f0_loop
    s_branch K3_end
K3a1f0_slow:
    s_waitcnt vmcnt(0)
    v_pk_max_u16 v37, v8, v9
    v_pk_max_u16 v37, v37, v10
    v_pk_max_u16 v37, v37, v11
    v_pk_max_u16 v37, v37, v12
    v_pk_max_u16 v37, v37, v13
    v_pk_max_u16 v37, v37, v14
    v_pk_max_u16 v37, v37, v15
    v_pk_max_u16 v37, v37, v16
    v_pk_max_u16 v37, v37, v17
    v_pk_max_u16 v37, v37, v18
    v_pk_max_u16 v37, v37, v19
    v_pk_max_u16 v37, v37, v20
    v_pk_max_u16 v37, v37, v21
    v_pk_max_u16 v37, v37, v22
    v_pk_max_u16 v37, v37, v23
    v_pk_max_u16 v37, v37, v24
    v_pk_max_u16 v37, v37, v25
    v_pk_max_u16 v37, v37, v26
    v_pk_max_u16 v37, v37, v27
    v_pk_max_u16 v37, v37, v28
    v_pk_max_u16 v37, v37, v29
    v_pk_max_u16 v37, v37, v30
    v_pk_max_u16 v37, v37, v31
    v_pk_max_u16 v37, v37, v32
    v_pk_max_u16 v37, v37, v33
    v_pk_max_u16 v37, v37, v34
    v_pk_max_u16 v37, v37, v35
    v_lshlrev_b32 v39, 16, v37
    v_max_u32 v37, v37, v39
    v_cmp_le_u32 vcc, s26, v37
    s_cbranch_vccz K3a1f0_back
    s_add_u32 s27, s27, 1
    s_cmp_gt_u32 s27, 65536
    s_cbranch_scc1 K3_bail
    s_branch K3a1f0_retry
K3a1f0_retry:
    v_mov_b32 v36, 0
    v_mov_b32 v37, 0
    v_mov_b32 v38, 0
    v_mov_b32 v39, 0
    v_mov_b32 v40, 0
    v_mov_b32 v41, 0
    v_mov_b32 v42, 0
    v_mov_b32 v43, 0
    v_mov_b32 v44, 0
    v_mov_b32 v45, 0
    v_mov_b32 v46, 0
    v_mov_b32 v47, 0
    v_mov_b32 v48, 0
    v_mov_b32 v49, 0
    v_mov_b32 v50, 0
    v_mov_b32 v51, 0
    v_mov_b32 v52, 0
    v_mov_b32 v53, 0
    v_mov_b32 v54, 0
    v_mov_b32 v55, 0
    v_mov_b32 v56, 0
    v_mov_b32 v57, 0
    v_mov_b32 v58, 0
    v_mov_b32 v59, 0
    v_mov_b32 v60, 0
    v_mov_b32 v61, 0
    v_mov_b32 v62, 0
    v_mov_b32 v63, 0
    s_mov_b32 m0, 12288
    s_barrier
    s_branch K3a1f0_go
K3a_r0f0:
K3a0f0_loop:
    s_lshl_b32 s32, s64, 13
    s_add_u32 s34, s32, 4096
    s_add_u32 s33, s64, 1
    s_min_u32 s33, s33, 63
    s_mov_b32 s27, 0
    v_mov_b32 v36, 0
    v_mov_b32 v37, 0
    v_mov_b32 v38, 0
    v_mov_b32 v39, 0
    v_mov_b32 v40, 0
    v_mov_b32 v41, 0
    v_mov_b32 v42, 0
    v_mov_b32 v43, 0
    v_mov_b32 v44, 0
    v_mov_b32 v45, 0
    v_mov_b32 v46, 0
    v_mov_b32 v47, 0
    v_mov_b32 v48, 0
    v_mov_b32 v49, 0
    v_mov_b32 v50, 0
    v_mov_b32 v51, 0
    v_mov_b32 v52, 0
    v_mov_b32 v53, 0
    v_mov_b32 v54, 0
    v_mov_b32 v55, 0
    v_mov_b32 v56, 0
    v_mov_b32 v57, 0
    v_mov_b32 v58, 0
    v_mov_b32 v59, 0
    v_mov_b32 v60, 0
    v_mov_b32 v61, 0
    v_mov_b32 v62, 0
    v_mov_b32 v63, 0
    s_mul_i32 s30, s33, 458752
    s_lshl_b32 s29, s33, 13
    s_add_u32 s29, s29, 8192
    s_waitcnt vmcnt(0)
    v_cmp_ne_u32 vcc, s96, v115
    s_cmp_eq_u64 vcc, 0
    s_cselect_b32 s93, s94, 0x40000000
    s_add_u32 s30, s30, s93
    s_mul_i32 s31, s64, 10240
    s_mov_b32 m0, 12288
    s_cmp_eq_u32 s64, 0
    s_cbranch_scc1 K3a0f0_hu_ok
    s_mov_b32 s23, 0
    buffer_load_dword v108, v111, s[40:43], s32 offen sc1
    buffer_load_dword v109, v111, s[40:43], s32 offen sc1
    buffer_load_dword v107, v111, s[40:43], s32 offen sc1
    buffer_load_dword v104, v111, s[40:43], s32 offen sc1
K3a0f0_hu:
    buffer_load_dword v103, v111, s[40:43], s32 offen sc1
    s_waitcnt vmcnt(4)
    v_cmp_eq_u32 vcc, -1, v108
    s_cbranch_vccz K3a0f0_hu_ok
    buffer_load_dword v108, v111, s[40:43], s32 offen sc1
    s_waitcnt vmcnt(4)
    v_cmp_eq_u32 vcc, -1, v109
    s_cbranch_vccz K3a0f0_hu_ok
    buffer_load_dword v109, v111, s[40:43], s32 offen sc1
    s_waitcnt vmcnt(4)
    v_cmp_eq_u32 vcc, -1, v107
    s_cbranch_vccz K3a0f0_hu_ok
    buffer_load_dword v107, v111, s[40:43], s32 offen sc1
    s_waitcnt vmcnt(4)
    v_cmp_eq_u32 vcc, -1, v104
    s_cbranch_vccz K3a0f0_hu_ok
    buffer_load_dword v104, v111, s[40:43], s32 offen sc1
    s_waitcnt vmcnt(4)
    v_cmp_eq_u32 vcc, -1, v103
    s_cbranch_vccz K3a0f0_hu_ok
    s_add_u32 s23, s23, 1
    s_cmp_gt_u32 s23, 65536
    s_cbranch_scc0 K3a0f0_hu
    s_branch K3_bail
K3a0f0_hu_ok:
K3a0f0_go:
    buffer_load_dwordx4 v4, s[40:43], s32 offen offset:0 sc1 lds
    buffer_load_dwordx4 v4, s[40:43], s32 offen offset:1024 sc1 lds
    buffer_load_dwordx4 v4, s[40:43], s32 offen offset:2048 sc1 lds
    buffer_load_dwordx4 v4, s[40:43], s32 offen offset:3072 sc1 lds
    s_add_u32 m0, m0, 4096
    s_nop 0
    buffer_load_dwordx4 v4, s[40:43], s34 offen offset:0 sc1 lds
    buffer_load_dwordx4 v4, s[40:43], s34 offen offset:1024 sc1 lds
    buffer_load_dwordx4 v4, s[40:43], s34 offen offset:2048 sc1 lds
    buffer_load_dword v119, v118, s[48:51], s30 offen sc1
    s_add_u32 s30, s30, 4096
    buffer_load_dword v119, v118, s[48:51], s30 offen sc1
    s_add_u32 s30, s30, 4096
    buffer_load_dword v119, v118, s[48:51], s30 offen sc1
    s_add_u32 s30, s30, 4096
    buffer_load_dword v119, v118, s[48:51], s30 offen sc1
    s_add_u32 s30, s30, 4096
    buffer_load_dword v119, v118, s[48:51], s30 offen sc1
    s_add_u32 s30, s30, 4096
    buffer_load_dword v119, v118, s[48:51], s30 offen sc1
    s_add_u32 s30, s30, 4096
    buffer_load_dword v119, v118, s[48:51], s30 offen sc1
    s_add_u32 s30, s30, 4096
    buffer_load_dword v115, v114, s[56:59], s29 offen sc1
    s_waitcnt vmcnt(13)
    s_barrier
    ds_read_b128 v[8:11], v1 offset:0
    ds_read_b128 v[12:15], v1 offset:1024
    s_waitcnt lgkmcnt(1)
    v_smfmac_f32_16x16x64_bf16 v[36:39], v[8:11], a[0:7], v2
    v_smfmac_f32_16x16x64_bf16 v[40:43], v[8:11], a[56:63], v2
    v_smfmac_f32_16x16x64_bf16 v[44:47], v[8:11], a[112:119], v2
    v_smfmac_f32_16x16x64_bf16 v[48:51], v[8:11], a[168:175], v2
    s_waitcnt vmcnt(8)
    s_barrier
    ds_read_b128 v[16:19], v1 offset:2048
    ds_read_b128 v[20:23], v1 offset:3072
    ds_read_b128 v[24:27], v1 offset:4096
    ds_read_b128 v[28:31], v1 offset:5120
    ds_read_b128 v[32:35], v1 offset:6144
    v_smfmac_f32_16x16x64_bf16 v[52:55], v[8:11], a[224:231], v2
    v_smfmac_f32_16x16x64_bf16 v[56:59], v[8:11], v[144:151], v2
    v_smfmac_f32_16x16x64_bf16 v[60:63], v[8:11], v[200:207], v2
    s_waitcnt lgkmcnt(5)
    v_smfmac_f32_16x16x64_bf16 v[36:39], v[12:15], a[8:15], v2
    v_smfmac_f32_16x16x64_bf16 v[40:43], v[12:15], a[64:71], v2
    v_smfmac_f32_16x16x64_bf16 v[44:47], v[12:15], a[120:127], v2
    v_smfmac_f32_16x16x64_bf16 v[48:51], v[12:15], a[176:183], v2
    v_smfmac_f32_16x16x64_bf16 v[52:55], v[12:15], a[232:239], v2
    v_smfmac_f32_16x16x64_bf16 v[56:59], v[12:15], v[152:159], v2
    v_smfmac_f32_16x16x64_bf16 v[60:63], v[12:15], v[208:215], v2
    s_waitcnt lgkmcnt(4)
    v_smfmac_f32_16x16x64_bf16 v[36:39], v[16:19], a[16:23], v2
    v_smfmac_f32_16x16x64_bf16 v[40:43], v[16:19], a[72:79], v2
    s_waitcnt lgkmcnt(3)
    v_smfmac_f32_16x16x64_bf16 v[36:39], v[20:23], a[24:31], v2
    v_smfmac_f32_16x16x64_bf16 v[40:43], v[20:23], a[80:87], v2
    s_waitcnt lgkmcnt(2)
    v_smfmac_f32_16x16x64_bf16 v[36:39], v[24:27], a[32:39], v2
    v_smfmac_f32_16x16x64_bf16 v[40:43], v[24:27], a[88:95], v2
    s_waitcnt lgkmcnt(1)
    v_smfmac_f32_16x16x64_bf16 v[36:39], v[28:31], a[40:47], v2
    v_smfmac_f32_16x16x64_bf16 v[40:43], v[28:31], a[96:103], v2
    s_waitcnt lgkmcnt(0)
    v_smfmac_f32_16x16x64_bf16 v[36:39], v[32:35], a[48:55], v2
    v_smfmac_f32_16x16x64_bf16 v[40:43], v[32:35], a[104:111], v2
    v_smfmac_f32_16x16x64_bf16 v[44:47], v[16:19], a[128:135], v2
    v_smfmac_f32_16x16x64_bf16 v[48:51], v[16:19], a[184:191], v2
    v_smfmac_f32_16x16x64_bf16 v[44:47], v[20:23], a[136:143], v2
    v_smfmac_f32_16x16x64_bf16 v[48:51], v[20:23], a[192:199], v2
    s_nop 2
    v_add_f32 v36, v36, v37
    v_smfmac_f32_16x16x64_bf16 v[44:47], v[24:27], a[144:151], v2
    v_add_f32 v38, v38, v39
    v_smfmac_f32_16x16x64_bf16 v[48:51], v[24:27], a[200:207], v2
    v_cmp_u_f32 vcc, v36, v38
    v_smfmac_f32_16x16x64_bf16 v[44:47], v[28:31], a[152:159], v2
    s_cbranch_vccnz K3a0f0_slow
K3a0f0_back:
    v_smfmac_f32_16x16x64_bf16 v[48:51], v[28:31], a[208:215], v2
    v_cvt_pk_bf16_f32 v36, v36, v38
    v_smfmac_f32_16x16x64_bf16 v[44:47], v[32:35], a[160:167], v2
    v_add_f32 v40, v40, v41
    v_smfmac_f32_16x16x64_bf16 v[48:51], v[32:35], a[216:223], v2
    v_add_f32 v42, v42, v43
    v_smfmac_f32_16x16x64_bf16 v[52:55], v[16:19], a[240:247], v2
    v_cvt_pk_bf16_f32 v40, v40, v42
    v_smfmac_f32_16x16x64_bf16 v[56:59], v[16:19], v[160:167], v2
    ds_write2st64_b32 v5, v36, v40 offset0:0 offset1:1
    v_smfmac_f32_16x16x64_bf16 v[52:55], v[20:23], a[248:255], v2
    v_smfmac_f32_16x16x64_bf16 v[56:59], v[20:23], v[168:175], v2
    v_add_f32 v44, v44, v45
    v_smfmac_f32_16x16x64_bf16 v[52:55], v[24:27], v[120:127], v2
    v_add_f32 v46, v46, v47
    v_smfmac_f32_16x16x64_bf16 v[56:59], v[24:27], v[176:183], v2
    v_cvt_pk_bf16_f32 v44, v44, v46
    v_smfmac_f32_16x16x64_bf16 v[52:55], v[28:31], v[128:135], v2
    v_add_f32 v48, v48, v49
    v_smfmac_f32_16x16x64_bf16 v[56:59], v[28:31], v[184:191], v2
    v_add_f32 v50, v50, v51
    v_smfmac_f32_16x16x64_bf16 v[52:55], v[32:35], v[136:143], v2
    v_cvt_pk_bf16_f32 v48, v48, v50
    v_smfmac_f32_16x16x64_bf16 v[56:59], v[32:35], v[192:199], v2
    ds_write2st64_b32 v5, v44, v48 offset0:2 offset1:3
    v_smfmac_f32_16x16x64_bf16 v[60:63], v[16:19], v[216:223], v2
    v_smfmac_f32_16x16x64_bf16 v[60:63], v[20:23], v[224:231], v2
    v_smfmac_f32_16x16x64_bf16 v[60:63], v[24:27], v[232:239], v2
    s_nop 1
    v_add_f32 v52, v52, v53
    v_add_f32 v54, v54, v55
    v_smfmac_f32_16x16x64_bf16 v[60:63], v[28:31], v[240:247], v2
    v_cvt_pk_bf16_f32 v52, v52, v54
    v_add_f32 v56, v56, v57
    v_smfmac_f32_16x16x64_bf16 v[60:63], v[32:35], v[248:255], v2
    v_add_f32 v58, v58, v59
    v_cvt_pk_bf16_f32 v56, v56, v58
    ds_write2st64_b32 v5, v52, v56 offset0:4 offset1:5
    s_nop 4
    v_add_f32 v60, v60, v61
    v_add_f32 v62, v62, v63
    v_cvt_pk_bf16_f32 v60, v60, v62
    ds_write_b32 v6, v60
    s_waitcnt lgkmcnt(0)
    s_barrier
    ds_read_b64_tr_b16 v[36:37], v0 offset:0
    ds_read_b64_tr_b16 v[38:39], v0 offset:32
    ds_read_b64_tr_b16 v[40:41], v0 offset:1024
    ds_read_b64_tr_b16 v[42:43], v0 offset:1056
    ds_read_b64_tr_b16 v[44:45], v0 offset:2048
    ds_read_b64_tr_b16 v[46:47], v0 offset:2080
    ds_read_b64_tr_b16 v[48:49], v0 offset:3072
    ds_read_b64_tr_b16 v[50:51], v0 offset:3104
    ds_read_b64_tr_b16 v[52:53], v0 offset:4096
    ds_read_b64_tr_b16 v[54:55], v0 offset:4128
    ds_read_b64_tr_b16 v[56:57], v0 offset:5120
    ds_read_b64_tr_b16 v[58:59], v0 offset:5152
    ds_read_b64_tr_b16 v[60:61], v0 offset:6144
    ds_read_b64_tr_b16 v[62:63], v0 offset:6176
    s_waitcnt lgkmcnt(12)
    v_mfma_f32_16x16x32_bf16 v[72:75], v[8:11], v[36:39], 0
    s_waitcnt lgkmcnt(10)
    v_mfma_f32_16x16x32_bf16 v[72:75], v[12:15], v[40:43], v[72:75]
    s_waitcnt lgkmcnt(8)
    v_mfma_f32_16x16x32_bf16 v[72:75], v[16:19], v[44:47], v[72:75]
    s_waitcnt lgkmcnt(6)
    v_mfma_f32_16x16x32_bf16 v[72:75], v[20:23], v[48:51], v[72:75]
    s_waitcnt lgkmcnt(4)
    v_mfma_f32_16x16x32_bf16 v[72:75], v[24:27], v[52:55], v[72:75]
    s_waitcnt lgkmcnt(2)
    v_mfma_f32_16x16x32_bf16 v[72:75], v[28:31], v[56:59], v[72:75]
    s_waitcnt lgkmcnt(0)
    v_mfma_f32_16x16x32_bf16 v[72:75], v[32:35], v[60:63], v[72:75]
    s_nop 7
    v_add_f32_dpp v72, v73, v72 row_ror:8 row_mask:0xf bank_mask:0xf
    v_add_f32_dpp v73, v75, v74 row_ror:8 row_mask:0xf bank_mask:0xf
    ds_write_b64 v106, v[72:73]
    s_waitcnt lgkmcnt(0)
    s_barrier
    ds_read_b32 v68, v105
    ds_read_b128 v[64:67], v7
    s_waitcnt lgkmcnt(0)
    v_max3_f32 v76, v68, v64, v65
    v_max3_f32 v76, v76, v66, v67
    s_nop 1
    v_max_f32_dpp v76, v76, v76 quad_perm:[1,0,3,2] row_mask:0xf bank_mask:0xf
    buffer_store_dword v112, v110, s[40:43], s32 offen
    s_nop 0
    v_max_f32_dpp v76, v76, v76 quad_perm:[2,3,0,1] row_mask:0xf bank_mask:0xf
    s_nop 1
    v_max_f32_dpp v76, v76, v76 row_half_mirror row_mask:0xf bank_mask:0xf
    v_sub_f32 v68, v68, v76
    v_pk_add_f32 v[64:65], v[64:65], v[76:77] op_sel_hi:[1,0] neg_lo:[0,1] neg_hi:[0,1]
    v_pk_add_f32 v[66:67], v[66:67], v[76:77] op_sel_hi:[1,0] neg_lo:[0,1] neg_hi:[0,1]
    v_exp_f32 v68, v68
    v_exp_f32 v64, v64
    v_exp_f32 v65, v65
    v_exp_f32 v66, v66
    v_exp_f32 v67, v67
    v_add_f32 v78, v68, v64
    v_add_f32 v77, v65, v66
    v_add_f32 v78, v78, v67
    v_add_f32 v78, v78, v77
    s_nop 1
    v_add_f32_dpp v78, v78, v78 quad_perm:[1,0,3,2] row_mask:0xf bank_mask:0xf
    s_nop 1
    v_add_f32_dpp v78, v78, v78 quad_perm:[2,3,0,1] row_mask:0xf bank_mask:0xf
    s_nop 1
    v_add_f32_dpp v78, v78, v78 row_half_mirror row_mask:0xf bank_mask:0xf
    v_rcp_f32 v78, v78
    s_nop 0
    v_pk_mul_f32 v[64:65], v[64:65], v[78:79] op_sel_hi:[1,0] clamp
    v_pk_mul_f32 v[66:67], v[66:67], v[78:79] op_sel_hi:[1,0] clamp
    v_mul_f32 v68, v68, v78 clamp
    v_cvt_pk_bf16_f32 v64, v64, v65
    v_cvt_pk_bf16_f32 v65, v66, v67
    buffer_store_dwordx2 v[64:65], v116, s[44:47], s31 offen
    v_cvt_pk_bf16_f32 v68, v68, v68
    buffer_store_short v68, v117, s[44:47], s31 offen
    s_barrier
    s_add_u32 s64, s64, 1
    s_cmp_lt_u32 s64, 63
    s_cbranch_scc1 K3a0f0_loop
    s_branch K3_end
K3a0f0_slow:
    s_waitcnt vmcnt(0)
    v_pk_max_u16 v37, v8, v9
    v_pk_max_u16 v37, v37, v10
    v_pk_max_u16 v37, v37, v11
    v_pk_max_u16 v37, v37, v12
    v_pk_max_u16 v37, v37, v13
    v_pk_max_u16 v37, v37, v14
    v_pk_max_u16 v37, v37, v15
    v_pk_max_u16 v37, v37, v16
    v_pk_max_u16 v37, v37, v17
    v_pk_max_u16 v37, v37, v18
    v_pk_max_u16 v37, v37, v19
    v_pk_max_u16 v37, v37, v20
    v_pk_max_u16 v37, v37, v21
    v_pk_max_u16 v37, v37, v22
    v_pk_max_u16 v37, v37, v23
    v_pk_max_u16 v37, v37, v24
    v_pk_max_u16 v37, v37, v25
    v_pk_max_u16 v37, v37, v26
    v_pk_max_u16 v37, v37, v27
    v_pk_max_u16 v37, v37, v28
    v_pk_max_u16 v37, v37, v29
    v_pk_max_u16 v37, v37, v30
    v_pk_max_u16 v37, v37, v31
    v_pk_max_u16 v37, v37, v32
    v_pk_max_u16 v37, v37, v33
    v_pk_max_u16 v37, v37, v34
    v_pk_max_u16 v37, v37, v35
    v_lshlrev_b32 v39, 16, v37
    v_max_u32 v37, v37, v39
    v_cmp_le_u32 vcc, s26, v37
    s_cbranch_vccz K3a0f0_back
    s_add_u32 s27, s27, 1
    s_cmp_gt_u32 s27, 65536
    s_cbranch_scc1 K3_bail
    s_branch K3a0f0_retry
K3a0f0_retry:
    v_mov_b32 v36, 0
    v_mov_b32 v37, 0
    v_mov_b32 v38, 0
    v_mov_b32 v39, 0
    v_mov_b32 v40, 0
    v_mov_b32 v41, 0
    v_mov_b32 v42, 0
    v_mov_b32 v43, 0
    v_mov_b32 v44, 0
    v_mov_b32 v45, 0
    v_mov_b32 v46, 0
    v_mov_b32 v47, 0
    v_mov_b32 v48, 0
    v_mov_b32 v49, 0
    v_mov_b32 v50, 0
    v_mov_b32 v51, 0
    v_mov_b32 v52, 0
    v_mov_b32 v53, 0
    v_mov_b32 v54, 0
    v_mov_b32 v55, 0
    v_mov_b32 v56, 0
    v_mov_b32 v57, 0
    v_mov_b32 v58, 0
    v_mov_b32 v59, 0
    v_mov_b32 v60, 0
    v_mov_b32 v61, 0
    v_mov_b32 v62, 0
    v_mov_b32 v63, 0
    s_mov_b32 s30, 0x40000000
    s_mov_b32 m0, 12288
    s_barrier
    s_branch K3a0f0_go
K3a_r3f0:
K3a3f0_loop:
    s_lshl_b32 s32, s64, 13
    s_add_u32 s34, s32, 4096
    s_add_u32 s33, s64, 1
    s_min_u32 s33, s33, 63
    s_mov_b32 s27, 0
    v_mov_b32 v36, 0
    v_mov_b32 v37, 0
    v_mov_b32 v38, 0
    v_mov_b32 v39, 0
    v_mov_b32 v40, 0
    v_mov_b32 v41, 0
    v_mov_b32 v42, 0
    v_mov_b32 v43, 0
    v_mov_b32 v44, 0
    v_mov_b32 v45, 0
    v_mov_b32 v46, 0
    v_mov_b32 v47, 0
    v_mov_b32 v48, 0
    v_mov_b32 v49, 0
    v_mov_b32 v50, 0
    v_mov_b32 v51, 0
    v_mov_b32 v52, 0
    v_mov_b32 v53, 0
    v_mov_b32 v54, 0
    v_mov_b32 v55, 0
    v_mov_b32 v56, 0
    v_mov_b32 v57, 0
    v_mov_b32 v58, 0
    v_mov_b32 v59, 0
    v_mov_b32 v60, 0
    v_mov_b32 v61, 0
    v_mov_b32 v62, 0
    v_mov_b32 v63, 0
K3a3f0_go:
    s_barrier
    ds_read_b128 v[8:11], v1 offset:0
    ds_read_b128 v[12:15], v1 offset:1024
    s_waitcnt lgkmcnt(1)
    v_smfmac_f32_16x16x64_bf16 v[36:39], v[8:11], a[0:7], v2
    v_smfmac_f32_16x16x64_bf16 v[40:43], v[8:11], a[56:63], v2
    v_smfmac_f32_16x16x64_bf16 v[44:47], v[8:11], a[112:119], v2
    v_smfmac_f32_16x16x64_bf16 v[48:51], v[8:11], a[168:175], v2
    s_barrier
    ds_read_b128 v[16:19], v1 offset:2048
    ds_read_b128 v[20:23], v1 offset:3072
    ds_read_b128 v[24:27], v1 offset:4096
    ds_read_b128 v[28:31], v1 offset:5120
    ds_read_b128 v[32:35], v1 offset:6144
    v_smfmac_f32_16x16x64_bf16 v[52:55], v[8:11], a[224:231], v2
    v_smfmac_f32_16x16x64_bf16 v[56:59], v[8:11], v[144:151], v2
    v_smfmac_f32_16x16x64_bf16 v[60:63], v[8:11], v[200:207], v2
    s_waitcnt lgkmcnt(5)
    v_smfmac_f32_16x16x64_bf16 v[36:39], v[12:15], a[8:15], v2
    v_smfmac_f32_16x16x64_bf16 v[40:43], v[12:15], a[64:71], v2
    v_smfmac_f32_16x16x64_bf16 v[44:47], v[12:15], a[120:127], v2
    v_smfmac_f32_16x16x64_bf16 v[48:51], v[12:15], a[176:183], v2
    v_smfmac_f32_16x16x64_bf16 v[52:55], v[12:15], a[232:239], v2
    v_smfmac_f32_16x16x64_bf16 v[56:59], v[12:15], v[152:159], v2
    v_smfmac_f32_16x16x64_bf16 v[60:63], v[12:15], v[208:215], v2
    s_waitcnt lgkmcnt(4)
    v_smfmac_f32_16x16x64_bf16 v[36:39], v[16:19], a[16:23], v2
    v_smfmac_f32_16x16x64_bf16 v[40:43], v[16:19], a[72:79], v2
    s_waitcnt lgkmcnt(3)
    v_smfmac_f32_16x16x64_bf16 v[36:39], v[20:23], a[24:31], v2
    v_smfmac_f32_16x16x64_bf16 v[40:43], v[20:23], a[80:87], v2
    s_waitcnt lgkmcnt(2)
    v_smfmac_f32_16x16x64_bf16 v[36:39], v[24:27], a[32:39], v2
    v_smfmac_f32_16x16x64_bf16 v[40:43], v[24:27], a[88:95], v2
    s_waitcnt lgkmcnt(1)
    v_smfmac_f32_16x16x64_bf16 v[36:39], v[28:31], a[40:47], v2
    v_smfmac_f32_16x16x64_bf16 v[40:43], v[28:31], a[96:103], v2
    s_waitcnt lgkmcnt(0)
    v_smfmac_f32_16x16x64_bf16 v[36:39], v[32:35], a[48:55], v2
    v_smfmac_f32_16x16x64_bf16 v[40:43], v[32:35], a[104:111], v2
    v_smfmac_f32_16x16x64_bf16 v[44:47], v[16:19], a[128:135], v2
    v_smfmac_f32_16x16x64_bf16 v[48:51], v[16:19], a[184:191], v2
    v_smfmac_f32_16x16x64_bf16 v[44:47], v[20:23], a[136:143], v2
    v_smfmac_f32_16x16x64_bf16 v[48:51], v[20:23], a[192:199], v2
    s_nop 2
    v_add_f32 v36, v36, v37
    v_smfmac_f32_16x16x64_bf16 v[44:47], v[24:27], a[144:151], v2
    v_add_f32 v38, v38, v39
    v_smfmac_f32_16x16x64_bf16 v[48:51], v[24:27], a[200:207], v2
    v_cmp_u_f32 vcc, v36, v38
    v_smfmac_f32_16x16x64_bf16 v[44:47], v[28:31], a[152:159], v2
    s_cbranch_vccnz K3a3f0_slow
K3a3f0_back:
    v_smfmac_f32_16x16x64_bf16 v[48:51], v[28:31], a[208:215], v2
    v_cvt_pk_bf16_f32 v36, v36, v38
    v_smfmac_f32_16x16x64_bf16 v[44:47], v[32:35], a[160:167], v2
    v_add_f32 v40, v40, v41
    v_smfmac_f32_16x16x64_bf16 v[48:51], v[32:35], a[216:223], v2
    v_add_f32 v42, v42, v43
    v_smfmac_f32_16x16x64_bf16 v[52:55], v[16:19], a[240:247], v2
    v_cvt_pk_bf16_f32 v40, v40, v42
    v_smfmac_f32_16x16x64_bf16 v[56:59], v[16:19], v[160:167], v2
    ds_write2st64_b32 v5, v36, v40 offset0:0 offset1:1
    v_smfmac_f32_16x16x64_bf16 v[52:55], v[20:23], a[248:255], v2
    v_smfmac_f32_16x16x64_bf16 v[56:59], v[20:23], v[168:175], v2
    v_add_f32 v44, v44, v45
    v_smfmac_f32_16x16x64_bf16 v[52:55], v[24:27], v[120:127], v2
    v_add_f32 v46, v46, v47
    v_smfmac_f32_16x16x64_bf16 v[56:59], v[24:27], v[176:183], v2
    v_cvt_pk_bf16_f32 v44, v44, v46
    v_smfmac_f32_16x16x64_bf16 v[52:55], v[28:31], v[128:135], v2
    v_add_f32 v48, v48, v49
    v_smfmac_f32_16x16x64_bf16 v[56:59], v[28:31], v[184:191], v2
    v_add_f32 v50, v50, v51
    v_smfmac_f32_16x16x64_bf16 v[52:55], v[32:35], v[136:143], v2
    v_cvt_pk_bf16_f32 v48, v48, v50
    v_smfmac_f32_16x16x64_bf16 v[56:59], v[32:35], v[192:199], v2
    ds_write2st64_b32 v5, v44, v48 offset0:2 offset1:3
    v_smfmac_f32_16x16x64_bf16 v[60:63], v[16:19], v[216:223], v2
    v_smfmac_f32_16x16x64_bf16 v[60:63], v[20:23], v[224:231], v2
    v_smfmac_f32_16x16x64_bf16 v[60:63], v[24:27], v[232:239], v2
    s_nop 1
    v_add_f32 v52, v52, v53
    v_add_f32 v54, v54, v55
    v_smfmac_f32_16x16x64_bf16 v[60:63], v[28:31], v[240:247], v2
    v_cvt_pk_bf16_f32 v52, v52, v54
    v_add_f32 v56, v56, v57
    v_smfmac_f32_16x16x64_bf16 v[60:63], v[32:35], v[248:255], v2
    v_add_f32 v58, v58, v59
    v_cvt_pk_bf16_f32 v56, v56, v58
    ds_write2st64_b32 v5, v52, v56 offset0:4 offset1:5
    s_nop 4
    v_add_f32 v60, v60, v61
    v_add_f32 v62, v62, v63
    v_cvt_pk_bf16_f32 v60, v60, v62
    ds_write_b32 v6, v60
    s_waitcnt lgkmcnt(0)
    s_barrier
    s_barrier
    s_waitcnt vmcnt(0)
    s_barrier
    s_add_u32 s64, s64, 1
    s_cmp_lt_u32 s64, 63
    s_cbranch_scc1 K3a3f0_loop
    s_branch K3_end
K3a3f0_slow:
    s_waitcnt vmcnt(0)
    v_pk_max_u16 v37, v8, v9
    v_pk_max_u16 v37, v37, v10
    v_pk_max_u16 v37, v37, v11
    v_pk_max_u16 v37, v37, v12
    v_pk_max_u16 v37, v37, v13
    v_pk_max_u16 v37, v37, v14
    v_pk_max_u16 v37, v37, v15
    v_pk_max_u16 v37, v37, v16
    v_pk_max_u16 v37, v37, v17
    v_pk_max_u16 v37, v37, v18
    v_pk_max_u16 v37, v37, v19
    v_pk_max_u16 v37, v37, v20
    v_pk_max_u16 v37, v37, v21
    v_pk_max_u16 v37, v37, v22
    v_pk_max_u16 v37, v37, v23
    v_pk_max_u16 v37, v37, v24
    v_pk_max_u16 v37, v37, v25
    v_pk_max_u16 v37, v37, v26
    v_pk_max_u16 v37, v37, v27
    v_pk_max_u16 v37, v37, v28
    v_pk_max_u16 v37, v37, v29
    v_pk_max_u16 v37, v37, v30
    v_pk_max_u16 v37, v37, v31
    v_pk_max_u16 v37, v37, v32
    v_pk_max_u16 v37, v37, v33
    v_pk_max_u16 v37, v37, v34
    v_pk_max_u16 v37, v37, v35
    v_lshlrev_b32 v39, 16, v37
    v_max_u32 v37, v37, v39
    v_cmp_le_u32 vcc, s26, v37
    s_cbranch_vccz K3a3f0_back
    s_add_u32 s27, s27, 1
    s_cmp_gt_u32 s27, 65536
    s_cbranch_scc1 K3_bail
    s_branch K3a3f0_retry
K3a3f0_retry:
    v_mov_b32 v36, 0
    v_mov_b32 v37, 0
    v_mov_b32 v38, 0
    v_mov_b32 v39, 0
    v_mov_b32 v40, 0
    v_mov_b32 v41, 0
    v_mov_b32 v42, 0
    v_mov_b32 v43, 0
    v_mov_b32 v44, 0
    v_mov_b32 v45, 0
    v_mov_b32 v46, 0
    v_mov_b32 v47, 0
    v_mov_b32 v48, 0
    v_mov_b32 v49, 0
    v_mov_b32 v50, 0
    v_mov_b32 v51, 0
    v_mov_b32 v52, 0
    v_mov_b32 v53, 0
    v_mov_b32 v54, 0
    v_mov_b32 v55, 0
    v_mov_b32 v56, 0
    v_mov_b32 v57, 0
    v_mov_b32 v58, 0
    v_mov_b32 v59, 0
    v_mov_b32 v60, 0
    v_mov_b32 v61, 0
    v_mov_b32 v62, 0
    v_mov_b32 v63, 0
    s_mov_b32 m0, 12288
    s_barrier
    s_branch K3a3f0_go
K3a_fl1:
    s_cmp_eq_u32 s3, 0
    s_cbranch_scc1 K3a_r0f1
    s_cmp_eq_u32 s3, 3
    s_cbranch_scc1 K3a_r3f1
K3a1f1_loop:
    s_lshl_b32 s32, s64, 13
    s_add_u32 s34, s32, 4096
    s_add_u32 s33, s64, 1
    s_min_u32 s33, s33, 63
    s_mov_b32 s27, 0
    v_mov_b32 v36, 0
    v_mov_b32 v37, 0
    v_mov_b32 v38, 0
    v_mov_b32 v39, 0
    v_mov_b32 v40, 0
    v_mov_b32 v41, 0
    v_mov_b32 v42, 0
    v_mov_b32 v43, 0
    v_mov_b32 v44, 0
    v_mov_b32 v45, 0
    v_mov_b32 v46, 0
    v_mov_b32 v47, 0
    v_mov_b32 v48, 0
    v_mov_b32 v49, 0
    v_mov_b32 v50, 0
    v_mov_b32 v51, 0
    v_mov_b32 v52, 0
    v_mov_b32 v53, 0
    v_mov_b32 v54, 0
    v_mov_b32 v55, 0
    v_mov_b32 v56, 0
    v_mov_b32 v57, 0
    v_mov_b32 v58, 0
    v_mov_b32 v59, 0
    v_mov_b32 v60, 0
    v_mov_b32 v61, 0
    v_mov_b32 v62, 0
    v_mov_b32 v63, 0
K3a1f1_go:
    s_barrier
    ds_read_b128 v[8:11], v1 offset:0
    ds_read_b128 v[12:15], v1 offset:1024
    s_waitcnt lgkmcnt(1)
    v_smfmac_f32_16x16x64_bf16 v[36:39], v[8:11], a[0:7], v2
    v_smfmac_f32_16x16x64_bf16 v[40:43], v[8:11], a[56:63], v2
    v_smfmac_f32_16x16x64_bf16 v[44:47], v[8:11], a[112:119], v2
    v_smfmac_f32_16x16x64_bf16 v[48:51], v[8:11], a[168:175], v2
    s_barrier
    ds_read_b128 v[16:19], v1 offset:2048
    ds_read_b128 v[20:23], v1 offset:3072
    ds_read_b128 v[24:27], v1 offset:4096
    ds_read_b128 v[28:31], v1 offset:5120
    ds_read_b128 v[32:35], v1 offset:6144
    v_smfmac_f32_16x16x64_bf16 v[52:55], v[8:11], a[224:231], v2
    v_smfmac_f32_16x16x64_bf16 v[56:59], v[8:11], v[144:151], v2
    v_smfmac_f32_16x16x64_bf16 v[60:63], v[8:11], v[200:207], v2
    s_waitcnt lgkmcnt(5)
    v_smfmac_f32_16x16x64_bf16 v[36:39], v[12:15], a[8:15], v2
    v_smfmac_f32_16x16x64_bf16 v[40:43], v[12:15], a[64:71], v2
    v_smfmac_f32_16x16x64_bf16 v[44:47], v[12:15], a[120:127], v2
    v_smfmac_f32_16x16x64_bf16 v[48:51], v[12:15], a[176:183], v2
    v_smfmac_f32_16x16x64_bf16 v[52:55], v[12:15], a[232:239], v2
    v_smfmac_f32_16x16x64_bf16 v[56:59], v[12:15], v[152:159], v2
    v_smfmac_f32_16x16x64_bf16 v[60:63], v[12:15], v[208:215], v2
    s_waitcnt lgkmcnt(4)
    v_smfmac_f32_16x16x64_bf16 v[36:39], v[16:19], a[16:23], v2
    v_smfmac_f32_16x16x64_bf16 v[40:43], v[16:19], a[72:79], v2
    s_waitcnt lgkmcnt(3)
    v_smfmac_f32_16x16x64_bf16 v[36:39], v[20:23], a[24:31], v2
    v_smfmac_f32_16x16x64_bf16 v[40:43], v[20:23], a[80:87], v2
    s_waitcnt lgkmcnt(2)
    v_smfmac_f32_16x16x64_bf16 v[36:39], v[24:27], a[32:39], v2
    v_smfmac_f32_16x16x64_bf16 v[40:43], v[24:27], a[88:95], v2
    s_waitcnt lgkmcnt(1)
    v_smfmac_f32_16x16x64_bf16 v[36:39], v[28:31], a[40:47], v2
    v_smfmac_f32_16x16x64_bf16 v[40:43], v[28:31], a[96:103], v2
    s_waitcnt lgkmcnt(0)
    v_smfmac_f32_16x16x64_bf16 v[36:39], v[32:35], a[48:55], v2
    v_smfmac_f32_16x16x64_bf16 v[40:43], v[32:35], a[104:111], v2
    v_smfmac_f32_16x16x64_bf16 v[44:47], v[16:19], a[128:135], v2
    v_smfmac_f32_16x16x64_bf16 v[48:51], v[16:19], a[184:191], v2
    v_smfmac_f32_16x16x64_bf16 v[44:47], v[20:23], a[136:143], v2
    v_smfmac_f32_16x16x64_bf16 v[48:51], v[20:23], a[192:199], v2
    s_nop 2
    v_add_f32 v36, v36, v37
    v_smfmac_f32_16x16x64_bf16 v[44:47], v[24:27], a[144:151], v2
    v_add_f32 v38, v38, v39
    v_smfmac_f32_16x16x64_bf16 v[48:51], v[24:27], a[200:207], v2
    v_cmp_u_f32 vcc, v36, v38
    v_smfmac_f32_16x16x64_bf16 v[44:47], v[28:31], a[152:159], v2
    s_cbranch_vccnz K3a1f1_slow
K3a1f1_back:
    v_smfmac_f32_16x16x64_bf16 v[48:51], v[28:31], a[208:215], v2
    v_cvt_pk_bf16_f32 v36, v36, v38
    v_smfmac_f32_16x16x64_bf16 v[44:47], v[32:35], a[160:167], v2
    v_add_f32 v40, v40, v41
    v_smfmac_f32_16x16x64_bf16 v[48:51], v[32:35], a[216:223], v2
    v_add_f32 v42, v42, v43
    v_smfmac_f32_16x16x64_bf16 v[52:55], v[16:19], a[240:247], v2
    v_cvt_pk_bf16_f32 v40, v40, v42
    v_smfmac_f32_16x16x64_bf16 v[56:59], v[16:19], v[160:167], v2
    ds_write2st64_b32 v5, v36, v40 offset0:0 offset1:1
    v_smfmac_f32_16x16x64_bf16 v[52:55], v[20:23], a[248:255], v2
    v_smfmac_f32_16x16x64_bf16 v[56:59], v[20:23], v[168:175], v2
    v_add_f32 v44, v44, v45
    v_smfmac_f32_16x16x64_bf16 v[52:55], v[24:27], v[120:127], v2
    v_add_f32 v46, v46, v47
    v_smfmac_f32_16x16x64_bf16 v[56:59], v[24:27], v[176:183], v2
    v_cvt_pk_bf16_f32 v44, v44, v46
    v_smfmac_f32_16x16x64_bf16 v[52:55], v[28:31], v[128:135], v2
    v_add_f32 v48, v48, v49
    v_smfmac_f32_16x16x64_bf16 v[56:59], v[28:31], v[184:191], v2
    v_add_f32 v50, v50, v51
    v_smfmac_f32_16x16x64_bf16 v[52:55], v[32:35], v[136:143], v2
    v_cvt_pk_bf16_f32 v48, v48, v50
    v_smfmac_f32_16x16x64_bf16 v[56:59], v[32:35], v[192:199], v2
    ds_write2st64_b32 v5, v44, v48 offset0:2 offset1:3
    v_smfmac_f32_16x16x64_bf16 v[60:63], v[16:19], v[216:223], v2
    v_mov_b32 v36, 0
    v_smfmac_f32_16x16x64_bf16 v[60:63], v[20:23], v[224:231], v2
    v_smfmac_f32_16x16x64_bf16 v[60:63], v[24:27], v[232:239], v2
    v_mov_b32 v37, 0
    v_mov_b32 v38, 0
    v_smfmac_f32_16x16x64_bf16 v[60:63], v[28:31], v[240:247], v2
    v_mov_b32 v39, 0
    v_add_f32 v52, v52, v53
    v_smfmac_f32_16x16x64_bf16 v[60:63], v[32:35], v[248:255], v2
    v_add_f32 v54, v54, v55
    v_cvt_pk_bf16_f32 v52, v52, v54
    v_add_f32 v56, v56, v57
    v_add_f32 v58, v58, v59
    v_cvt_pk_bf16_f32 v56, v56, v58
    ds_write2st64_b32 v5, v52, v56 offset0:4 offset1:5
    s_nop 1
    v_add_f32 v60, v60, v61
    v_add_f32 v62, v62, v63
    v_cvt_pk_bf16_f32 v60, v60, v62
    ds_write_b32 v6, v60
    s_waitcnt lgkmcnt(0)
    s_barrier
    ds_read_b64_tr_b16 v[8:9], v0 offset:0
    ds_read_b64_tr_b16 v[10:11], v0 offset:32
    ds_read_b64_tr_b16 v[40:41], v0 offset:1024
    ds_read_b64_tr_b16 v[42:43], v0 offset:1056
    ds_read_b64_tr_b16 v[44:45], v0 offset:2048
    ds_read_b64_tr_b16 v[46:47], v0 offset:2080
    ds_read_b64_tr_b16 v[48:49], v0 offset:3072
    ds_read_b64_tr_b16 v[50:51], v0 offset:3104
    ds_read_b64_tr_b16 v[52:53], v0 offset:4096
    ds_read_b64_tr_b16 v[54:55], v0 offset:4128
    ds_read_b64_tr_b16 v[56:57], v0 offset:5120
    ds_read_b64_tr_b16 v[58:59], v0 offset:5152
    ds_read_b64_tr_b16 v[60:61], v0 offset:6144
    ds_read_b64_tr_b16 v[62:63], v0 offset:6176
    s_waitcnt lgkmcnt(12) vmcnt(0)
    v_smfmac_f32_16x16x64_bf16 v[36:39], v[8:11], v[64:71], v3
    s_waitcnt lgkmcnt(10)
    v_smfmac_f32_16x16x64_bf16 v[36:39], v[40:43], v[72:79], v3
    s_waitcnt lgkmcnt(8)
    v_smfmac_f32_16x16x64_bf16 v[36:39], v[44:47], v[80:87], v3
    s_waitcnt lgkmcnt(6)
    v_smfmac_f32_16x16x64_bf16 v[36:39], v[48:51], v[88:95], v3
    s_waitcnt lgkmcnt(4)
    v_smfmac_f32_16x16x64_bf16 v[36:39], v[52:55], v[96:103], v3
    s_waitcnt lgkmcnt(2)
    v_smfmac_f32_16x16x64_bf16 v[36:39], v[56:59], v[104:111], v3
    s_waitcnt lgkmcnt(0)
    v_smfmac_f32_16x16x64_bf16 v[36:39], v[60:63], v[112:119], v3
    s_nop 7
    v_permlane32_swap_b32 v36, v37
    v_permlane32_swap_b32 v38, v39
    v_add_f32 v36, v36, v37
    v_add_f32 v38, v38, v39
    ds_write2_b32 v7, v36, v38 offset0:0 offset1:72
    s_waitcnt lgkmcnt(0)
    s_barrier
    s_mul_i32 s28, s33, 28672
    s_add_u32 s28, s28, s94
    s_barrier
    buffer_load_dwordx4 v[64:67], v4, s[52:55], s28 offen offset:0
    buffer_load_dwordx4 v[68:71], v4, s[52:55], s28 offen offset:1024
    buffer_load_dwordx4 v[72:75], v4, s[52:55], s28 offen offset:2048
    buffer_load_dwordx4 v[76:79], v4, s[52:55], s28 offen offset:3072
    s_add_u32 s28, s28, 4096
    buffer_load_dwordx4 v[80:83], v4, s[52:55], s28 offen offset:0
    buffer_load_dwordx4 v[84:87], v4, s[52:55], s28 offen offset:1024
    buffer_load_dwordx4 v[88:91], v4, s[52:55], s28 offen offset:2048
    buffer_load_dwordx4 v[92:95], v4, s[52:55], s28 offen offset:3072
    s_add_u32 s28, s28, 4096
    buffer_load_dwordx4 v[96:99], v4, s[52:55], s28 offen offset:0
    buffer_load_dwordx4 v[100:103], v4, s[52:55], s28 offen offset:1024
    buffer_load_dwordx4 v[104:107], v4, s[52:55], s28 offen offset:2048
    buffer_load_dwordx4 v[108:111], v4, s[52:55], s28 offen offset:3072
    s_add_u32 s28, s28, 4096
    buffer_load_dwordx4 v[112:115], v4, s[52:55], s28 offen offset:0
    buffer_load_dwordx4 v[116:119], v4, s[52:55], s28 offen offset:1024
    s_add_u32 s64, s64, 1
    s_cmp_lt_u32 s64, 63
    s_cbranch_scc1 K3a1f1_loop
    s_branch K3_end
K3a1f1_slow:
    s_waitcnt vmcnt(0)
    v_pk_max_u16 v37, v8, v9
    v_pk_max_u16 v37, v37, v10
    v_pk_max_u16 v37, v37, v11
    v_pk_max_u16 v37, v37, v12
    v_pk_max_u16 v37, v37, v13
    v_pk_max_u16 v37, v37, v14
    v_pk_max_u16 v37, v37, v15
    v_pk_max_u16 v37, v37, v16
    v_pk_max_u16 v37, v37, v17
    v_pk_max_u16 v37, v37, v18
    v_pk_max_u16 v37, v37, v19
    v_pk_max_u16 v37, v37, v20
    v_pk_max_u16 v37, v37, v21
    v_pk_max_u16 v37, v37, v22
    v_pk_max_u16 v37, v37, v23
    v_pk_max_u16 v37, v37, v24
    v_pk_max_u16 v37, v37, v25
    v_pk_max_u16 v37, v37, v26
    v_pk_max_u16 v37, v37, v27
    v_pk_max_u16 v37, v37, v28
    v_pk_max_u16 v37, v37, v29
    v_pk_max_u16 v37, v37, v30
    v_pk_max_u16 v37, v37, v31
    v_pk_max_u16 v37, v37, v32
    v_pk_max_u16 v37, v37, v33
    v_pk_max_u16 v37, v37, v34
    v_pk_max_u16 v37, v37, v35
    v_lshlrev_b32 v39, 16, v37
    v_max_u32 v37, v37, v39
    v_cmp_le_u32 vcc, s26, v37
    s_cbranch_vccz K3a1f1_back
    s_add_u32 s27, s27, 1
    s_cmp_gt_u32 s27, 65536
    s_cbranch_scc1 K3_bail
    s_branch K3a1f1_retry
K3a1f1_retry:
    v_mov_b32 v36, 0
    v_mov_b32 v37, 0
    v_mov_b32 v38, 0
    v_mov_b32 v39, 0
    v_mov_b32 v40, 0
    v_mov_b32 v41, 0
    v_mov_b32 v42, 0
    v_mov_b32 v43, 0
    v_mov_b32 v44, 0
    v_mov_b32 v45, 0
    v_mov_b32 v46, 0
    v_mov_b32 v47, 0
    v_mov_b32 v48, 0
    v_mov_b32 v49, 0
    v_mov_b32 v50, 0
    v_mov_b32 v51, 0
    v_mov_b32 v52, 0
    v_mov_b32 v53, 0
    v_mov_b32 v54, 0
    v_mov_b32 v55, 0
    v_mov_b32 v56, 0
    v_mov_b32 v57, 0
    v_mov_b32 v58, 0
    v_mov_b32 v59, 0
    v_mov_b32 v60, 0
    v_mov_b32 v61, 0
    v_mov_b32 v62, 0
    v_mov_b32 v63, 0
    s_mov_b32 m0, 12288
    s_barrier
    s_branch K3a1f1_go
K3a_r0f1:
K3a0f1_loop:
    s_lshl_b32 s32, s64, 13
    s_add_u32 s34, s32, 4096
    s_add_u32 s33, s64, 1
    s_min_u32 s33, s33, 63
    s_mov_b32 s27, 0
    v_mov_b32 v36, 0
    v_mov_b32 v37, 0
    v_mov_b32 v38, 0
    v_mov_b32 v39, 0
    v_mov_b32 v40, 0
    v_mov_b32 v41, 0
    v_mov_b32 v42, 0
    v_mov_b32 v43, 0
    v_mov_b32 v44, 0
    v_mov_b32 v45, 0
    v_mov_b32 v46, 0
    v_mov_b32 v47, 0
    v_mov_b32 v48, 0
    v_mov_b32 v49, 0
    v_mov_b32 v50, 0
    v_mov_b32 v51, 0
    v_mov_b32 v52, 0
    v_mov_b32 v53, 0
    v_mov_b32 v54, 0
    v_mov_b32 v55, 0
    v_mov_b32 v56, 0
    v_mov_b32 v57, 0
    v_mov_b32 v58, 0
    v_mov_b32 v59, 0
    v_mov_b32 v60, 0
    v_mov_b32 v61, 0
    v_mov_b32 v62, 0
    v_mov_b32 v63, 0
    s_mul_i32 s30, s33, 458752
    s_lshl_b32 s29, s33, 13
    s_add_u32 s29, s29, 8192
    s_waitcnt vmcnt(0)
    v_cmp_ne_u32 vcc, s96, v115
    s_cmp_eq_u64 vcc, 0
    s_cselect_b32 s93, s94, 0x40000000
    s_add_u32 s30, s30, s93
    s_mul_i32 s31, s64, 10240
    s_mov_b32 m0, 12288
    s_cmp_eq_u32 s64, 0
    s_cbranch_scc1 K3a0f1_hu_ok
    s_mov_b32 s23, 0
    buffer_load_dword v108, v111, s[40:43], s32 offen sc1
    buffer_load_dword v109, v111, s[40:43], s32 offen sc1
    buffer_load_dword v107, v111, s[40:43], s32 offen sc1
    buffer_load_dword v104, v111, s[40:43], s32 offen sc1
K3a0f1_hu:
    buffer_load_dword v103, v111, s[40:43], s32 offen sc1
    s_waitcnt vmcnt(4)
    v_cmp_eq_u32 vcc, -1, v108
    s_cbranch_vccz K3a0f1_hu_ok
    buffer_load_dword v108, v111, s[40:43], s32 offen sc1
    s_waitcnt vmcnt(4)
    v_cmp_eq_u32 vcc, -1, v109
    s_cbranch_vccz K3a0f1_hu_ok
    buffer_load_dword v109, v111, s[40:43], s32 offen sc1
    s_waitcnt vmcnt(4)
    v_cmp_eq_u32 vcc, -1, v107
    s_cbranch_vccz K3a0f1_hu_ok
    buffer_load_dword v107, v111, s[40:43], s32 offen sc1
    s_waitcnt vmcnt(4)
    v_cmp_eq_u32 vcc, -1, v104
    s_cbranch_vccz K3a0f1_hu_ok
    buffer_load_dword v104, v111, s[40:43], s32 offen sc1
    s_waitcnt vmcnt(4)
    v_cmp_eq_u32 vcc, -1, v103
    s_cbranch_vccz K3a0f1_hu_ok
    s_add_u32 s23, s23, 1
    s_cmp_gt_u32 s23, 65536
    s_cbranch_scc0 K3a0f1_hu
    s_branch K3_bail
K3a0f1_hu_ok:
K3a0f1_go:
    buffer_load_dwordx4 v4, s[40:43], s32 offen offset:0 sc1 lds
    buffer_load_dwordx4 v4, s[40:43], s32 offen offset:1024 sc1 lds
    buffer_load_dwordx4 v4, s[40:43], s32 offen offset:2048 sc1 lds
    buffer_load_dwordx4 v4, s[40:43], s32 offen offset:3072 sc1 lds
    s_add_u32 m0, m0, 4096
    s_nop 0
    buffer_load_dwordx4 v4, s[40:43], s34 offen offset:0 sc1 lds
    buffer_load_dwordx4 v4, s[40:43], s34 offen offset:1024 sc1 lds
    buffer_load_dwordx4 v4, s[40:43], s34 offen offset:2048 sc1 lds
    buffer_load_dword v119, v118, s[48:51], s30 offen sc1
    s_add_u32 s30, s30, 4096
    buffer_load_dword v119, v118, s[48:51], s30 offen sc1
    s_add_u32 s30, s30, 4096
    buffer_load_dword v119, v118, s[48:51], s30 offen sc1
    s_add_u32 s30, s30, 4096
    buffer_load_dword v119, v118, s[48:51], s30 offen sc1
    s_add_u32 s30, s30, 4096
    buffer_load_dword v119, v118, s[48:51], s30 offen sc1
    s_add_u32 s30, s30, 4096
    buffer_load_dword v119, v118, s[48:51], s30 offen sc1
    s_add_u32 s30, s30, 4096
    buffer_load_dword v119, v118, s[48:51], s30 offen sc1
    s_add_u32 s30, s30, 4096
    buffer_load_dword v115, v114, s[56:59], s29 offen sc1
    s_waitcnt vmcnt(13)
    s_barrier
    ds_read_b128 v[8:11], v1 offset:0
    ds_read_b128 v[12:15], v1 offset:1024
    s_waitcnt lgkmcnt(1)
    v_smfmac_f32_16x16x64_bf16 v[36:39], v[8:11], a[0:7], v2
    v_smfmac_f32_16x16x64_bf16 v[40:43], v[8:11], a[56:63], v2
    v_smfmac_f32_16x16x64_bf16 v[44:47], v[8:11], a[112:119], v2
    v_smfmac_f32_16x16x64_bf16 v[48:51], v[8:11], a[168:175], v2
    s_waitcnt vmcnt(8)
    s_barrier
    ds_read_b128 v[16:19], v1 offset:2048
    ds_read_b128 v[20:23], v1 offset:3072
    ds_read_b128 v[24:27], v1 offset:4096
    ds_read_b128 v[28:31], v1 offset:5120
    ds_read_b128 v[32:35], v1 offset:6144
    v_smfmac_f32_16x16x64_bf16 v[52:55], v[8:11], a[224:231], v2
    v_smfmac_f32_16x16x64_bf16 v[56:59], v[8:11], v[144:151], v2
    v_smfmac_f32_16x16x64_bf16 v[60:63], v[8:11], v[200:207], v2
    s_waitcnt lgkmcnt(5)
    v_smfmac_f32_16x16x64_bf16 v[36:39], v[12:15], a[8:15], v2
    v_smfmac_f32_16x16x64_bf16 v[40:43], v[12:15], a[64:71], v2
    v_smfmac_f32_16x16x64_bf16 v[44:47], v[12:15], a[120:127], v2
    v_smfmac_f32_16x16x64_bf16 v[48:51], v[12:15], a[176:183], v2
    v_smfmac_f32_16x16x64_bf16 v[52:55], v[12:15], a[232:239], v2
    v_smfmac_f32_16x16x64_bf16 v[56:59], v[12:15], v[152:159], v2
    v_smfmac_f32_16x16x64_bf16 v[60:63], v[12:15], v[208:215], v2
    s_waitcnt lgkmcnt(4)
    v_smfmac_f32_16x16x64_bf16 v[36:39], v[16:19], a[16:23], v2
    v_smfmac_f32_16x16x64_bf16 v[40:43], v[16:19], a[72:79], v2
    s_waitcnt lgkmcnt(3)
    v_smfmac_f32_16x16x64_bf16 v[36:39], v[20:23], a[24:31], v2
    v_smfmac_f32_16x16x64_bf16 v[40:43], v[20:23], a[80:87], v2
    s_waitcnt lgkmcnt(2)
    v_smfmac_f32_16x16x64_bf16 v[36:39], v[24:27], a[32:39], v2
    v_smfmac_f32_16x16x64_bf16 v[40:43], v[24:27], a[88:95], v2
    s_waitcnt lgkmcnt(1)
    v_smfmac_f32_16x16x64_bf16 v[36:39], v[28:31], a[40:47], v2
    v_smfmac_f32_16x16x64_bf16 v[40:43], v[28:31], a[96:103], v2
    s_waitcnt lgkmcnt(0)
    v_smfmac_f32_16x16x64_bf16 v[36:39], v[32:35], a[48:55], v2
    v_smfmac_f32_16x16x64_bf16 v[40:43], v[32:35], a[104:111], v2
    v_smfmac_f32_16x16x64_bf16 v[44:47], v[16:19], a[128:135], v2
    v_smfmac_f32_16x16x64_bf16 v[48:51], v[16:19], a[184:191], v2
    v_smfmac_f32_16x16x64_bf16 v[44:47], v[20:23], a[136:143], v2
    v_smfmac_f32_16x16x64_bf16 v[48:51], v[20:23], a[192:199], v2
    s_nop 2
    v_add_f32 v36, v36, v37
    v_smfmac_f32_16x16x64_bf16 v[44:47], v[24:27], a[144:151], v2
    v_add_f32 v38, v38, v39
    v_smfmac_f32_16x16x64_bf16 v[48:51], v[24:27], a[200:207], v2
    v_cmp_u_f32 vcc, v36, v38
    v_smfmac_f32_16x16x64_bf16 v[44:47], v[28:31], a[152:159], v2
    s_cbranch_vccnz K3a0f1_slow
K3a0f1_back:
    v_smfmac_f32_16x16x64_bf16 v[48:51], v[28:31], a[208:215], v2
    v_cvt_pk_bf16_f32 v36, v36, v38
    v_smfmac_f32_16x16x64_bf16 v[44:47], v[32:35], a[160:167], v2
    v_add_f32 v40, v40, v41
    v_smfmac_f32_16x16x64_bf16 v[48:51], v[32:35], a[216:223], v2
    v_add_f32 v42, v42, v43
    v_smfmac_f32_16x16x64_bf16 v[52:55], v[16:19], a[240:247], v2
    v_cvt_pk_bf16_f32 v40, v40, v42
    v_smfmac_f32_16x16x64_bf16 v[56:59], v[16:19], v[160:167], v2
    ds_write2st64_b32 v5, v36, v40 offset0:0 offset1:1
    v_smfmac_f32_16x16x64_bf16 v[52:55], v[20:23], a[248:255], v2
    v_smfmac_f32_16x16x64_bf16 v[56:59], v[20:23], v[168:175], v2
    v_add_f32 v44, v44, v45
    v_smfmac_f32_16x16x64_bf16 v[52:55], v[24:27], v[120:127], v2
    v_add_f32 v46, v46, v47
    v_smfmac_f32_16x16x64_bf16 v[56:59], v[24:27], v[176:183], v2
    v_cvt_pk_bf16_f32 v44, v44, v46
    v_smfmac_f32_16x16x64_bf16 v[52:55], v[28:31], v[128:135], v2
    v_add_f32 v48, v48, v49
    v_smfmac_f32_16x16x64_bf16 v[56:59], v[28:31], v[184:191], v2
    v_add_f32 v50, v50, v51
    v_smfmac_f32_16x16x64_bf16 v[52:55], v[32:35], v[136:143], v2
    v_cvt_pk_bf16_f32 v48, v48, v50
    v_smfmac_f32_16x16x64_bf16 v[56:59], v[32:35], v[192:199], v2
    ds_write2st64_b32 v5, v44, v48 offset0:2 offset1:3
    v_smfmac_f32_16x16x64_bf16 v[60:63], v[16:19], v[216:223], v2
    v_smfmac_f32_16x16x64_bf16 v[60:63], v[20:23], v[224:231], v2
    v_smfmac_f32_16x16x64_bf16 v[60:63], v[24:27], v[232:239], v2
    s_nop 1
    v_add_f32 v52, v52, v53
    v_add_f32 v54, v54, v55
    v_smfmac_f32_16x16x64_bf16 v[60:63], v[28:31], v[240:247], v2
    v_cvt_pk_bf16_f32 v52, v52, v54
    v_add_f32 v56, v56, v57
    v_smfmac_f32_16x16x64_bf16 v[60:63], v[32:35], v[248:255], v2
    v_add_f32 v58, v58, v59
    v_cvt_pk_bf16_f32 v56, v56, v58
    ds_write2st64_b32 v5, v52, v56 offset0:4 offset1:5
    s_nop 4
    v_add_f32 v60, v60, v61
    v_add_f32 v62, v62, v63
    v_cvt_pk_bf16_f32 v60, v60, v62
    ds_write_b32 v6, v60
    s_waitcnt lgkmcnt(0)
    s_barrier
    ds_read_b64_tr_b16 v[36:37], v0 offset:0
    ds_read_b64_tr_b16 v[38:39], v0 offset:32
    ds_read_b64_tr_b16 v[40:41], v0 offset:1024
    ds_read_b64_tr_b16 v[42:43], v0 offset:1056
    ds_read_b64_tr_b16 v[44:45], v0 offset:2048
    ds_read_b64_tr_b16 v[46:47], v0 offset:2080
    ds_read_b64_tr_b16 v[48:49], v0 offset:3072
    ds_read_b64_tr_b16 v[50:51], v0 offset:3104
    ds_read_b64_tr_b16 v[52:53], v0 offset:4096
    ds_read_b64_tr_b16 v[54:55], v0 offset:4128
    ds_read_b64_tr_b16 v[56:57], v0 offset:5120
    ds_read_b64_tr_b16 v[58:59], v0 offset:5152
    ds_read_b64_tr_b16 v[60:61], v0 offset:6144
    ds_read_b64_tr_b16 v[62:63], v0 offset:6176
    s_waitcnt lgkmcnt(12)
    v_mfma_f32_16x16x32_bf16 v[72:75], v[8:11], v[36:39], 0
    s_waitcnt lgkmcnt(10)
    v_mfma_f32_16x16x32_bf16 v[72:75], v[12:15], v[40:43], v[72:75]
    s_waitcnt lgkmcnt(8)
    v_mfma_f32_16x16x32_bf16 v[72:75], v[16:19], v[44:47], v[72:75]
    s_waitcnt lgkmcnt(6)
    v_mfma_f32_16x16x32_bf16 v[72:75], v[20:23], v[48:51], v[72:75]
    s_waitcnt lgkmcnt(4)
    v_mfma_f32_16x16x32_bf16 v[72:75], v[24:27], v[52:55], v[72:75]
    s_waitcnt lgkmcnt(2)
    v_mfma_f32_16x16x32_bf16 v[72:75], v[28:31], v[56:59], v[72:75]
    s_waitcnt lgkmcnt(0)
    v_mfma_f32_16x16x32_bf16 v[72:75], v[32:35], v[60:63], v[72:75]
    s_nop 7
    v_add_f32_dpp v72, v73, v72 row_ror:8 row_mask:0xf bank_mask:0xf
    v_add_f32_dpp v73, v75, v74 row_ror:8 row_mask:0xf bank_mask:0xf
    ds_write_b64 v106, v[72:73]
    s_waitcnt lgkmcnt(0)
    s_barrier
    ds_read_b32 v68, v105
    ds_read_b128 v[64:67], v7
    s_waitcnt lgkmcnt(0)
    v_max3_f32 v76, v68, v64, v65
    v_max3_f32 v76, v76, v66, v67
    s_nop 1
    v_max_f32_dpp v76, v76, v76 quad_perm:[1,0,3,2] row_mask:0xf bank_mask:0xf
    buffer_store_dword v112, v110, s[40:43], s32 offen sc1
    s_nop 0
    v_max_f32_dpp v76, v76, v76 quad_perm:[2,3,0,1] row_mask:0xf bank_mask:0xf
    s_nop 1
    v_max_f32_dpp v76, v76, v76 row_half_mirror row_mask:0xf bank_mask:0xf
    v_sub_f32 v68, v68, v76
    v_pk_add_f32 v[64:65], v[64:65], v[76:77] op_sel_hi:[1,0] neg_lo:[0,1] neg_hi:[0,1]
    v_pk_add_f32 v[66:67], v[66:67], v[76:77] op_sel_hi:[1,0] neg_lo:[0,1] neg_hi:[0,1]
    v_exp_f32 v68, v68
    v_exp_f32 v64, v64
    v_exp_f32 v65, v65
    v_exp_f32 v66, v66
    v_exp_f32 v67, v67
    v_add_f32 v78, v68, v64
    v_add_f32 v77, v65, v66
    v_add_f32 v78, v78, v67
    v_add_f32 v78, v78, v77
    s_nop 1
    v_add_f32_dpp v78, v78, v78 quad_perm:[1,0,3,2] row_mask:0xf bank_mask:0xf
    s_nop 1
    v_add_f32_dpp v78, v78, v78 quad_perm:[2,3,0,1] row_mask:0xf bank_mask:0xf
    s_nop 1
    v_add_f32_dpp v78, v78, v78 row_half_mirror row_mask:0xf bank_mask:0xf
    v_rcp_f32 v78, v78
    s_nop 0
    v_pk_mul_f32 v[64:65], v[64:65], v[78:79] op_sel_hi:[1,0] clamp
    v_pk_mul_f32 v[66:67], v[66:67], v[78:79] op_sel_hi:[1,0] clamp
    v_mul_f32 v68, v68, v78 clamp
    v_cvt_pk_bf16_f32 v64, v64, v65
    v_cvt_pk_bf16_f32 v65, v66, v67
    buffer_store_dwordx2 v[64:65], v116, s[44:47], s31 offen sc1
    v_cvt_pk_bf16_f32 v68, v68, v68
    buffer_store_short v68, v117, s[44:47], s31 offen sc1
    s_barrier
    s_add_u32 s64, s64, 1
    s_cmp_lt_u32 s64, 63
    s_cbranch_scc1 K3a0f1_loop
    s_branch K3_end
K3a0f1_slow:
    s_waitcnt vmcnt(0)
    v_pk_max_u16 v37, v8, v9
    v_pk_max_u16 v37, v37, v10
    v_pk_max_u16 v37, v37, v11
    v_pk_max_u16 v37, v37, v12
    v_pk_max_u16 v37, v37, v13
    v_pk_max_u16 v37, v37, v14
    v_pk_max_u16 v37, v37, v15
    v_pk_max_u16 v37, v37, v16
    v_pk_max_u16 v37, v37, v17
    v_pk_max_u16 v37, v37, v18
    v_pk_max_u16 v37, v37, v19
    v_pk_max_u16 v37, v37, v20
    v_pk_max_u16 v37, v37, v21
    v_pk_max_u16 v37, v37, v22
    v_pk_max_u16 v37, v37, v23
    v_pk_max_u16 v37, v37, v24
    v_pk_max_u16 v37, v37, v25
    v_pk_max_u16 v37, v37, v26
    v_pk_max_u16 v37, v37, v27
    v_pk_max_u16 v37, v37, v28
    v_pk_max_u16 v37, v37, v29
    v_pk_max_u16 v37, v37, v30
    v_pk_max_u16 v37, v37, v31
    v_pk_max_u16 v37, v37, v32
    v_pk_max_u16 v37, v37, v33
    v_pk_max_u16 v37, v37, v34
    v_pk_max_u16 v37, v37, v35
    v_lshlrev_b32 v39, 16, v37
    v_max_u32 v37, v37, v39
    v_cmp_le_u32 vcc, s26, v37
    s_cbranch_vccz K3a0f1_back
    s_add_u32 s27, s27, 1
    s_cmp_gt_u32 s27, 65536
    s_cbranch_scc1 K3_bail
    s_branch K3a0f1_retry
K3a0f1_retry:
    v_mov_b32 v36, 0
    v_mov_b32 v37, 0
    v_mov_b32 v38, 0
    v_mov_b32 v39, 0
    v_mov_b32 v40, 0
    v_mov_b32 v41, 0
    v_mov_b32 v42, 0
    v_mov_b32 v43, 0
    v_mov_b32 v44, 0
    v_mov_b32 v45, 0
    v_mov_b32 v46, 0
    v_mov_b32 v47, 0
    v_mov_b32 v48, 0
    v_mov_b32 v49, 0
    v_mov_b32 v50, 0
    v_mov_b32 v51, 0
    v_mov_b32 v52, 0
    v_mov_b32 v53, 0
    v_mov_b32 v54, 0
    v_mov_b32 v55, 0
    v_mov_b32 v56, 0
    v_mov_b32 v57, 0
    v_mov_b32 v58, 0
    v_mov_b32 v59, 0
    v_mov_b32 v60, 0
    v_mov_b32 v61, 0
    v_mov_b32 v62, 0
    v_mov_b32 v63, 0
    s_mov_b32 s30, 0x40000000
    s_mov_b32 m0, 12288
    s_barrier
    s_branch K3a0f1_go
K3a_r3f1:
K3a3f1_loop:
    s_lshl_b32 s32, s64, 13
    s_add_u32 s34, s32, 4096
    s_add_u32 s33, s64, 1
    s_min_u32 s33, s33, 63
    s_mov_b32 s27, 0
    v_mov_b32 v36, 0
    v_mov_b32 v37, 0
    v_mov_b32 v38, 0
    v_mov_b32 v39, 0
    v_mov_b32 v40, 0
    v_mov_b32 v41, 0
    v_mov_b32 v42, 0
    v_mov_b32 v43, 0
    v_mov_b32 v44, 0
    v_mov_b32 v45, 0
    v_mov_b32 v46, 0
    v_mov_b32 v47, 0
    v_mov_b32 v48, 0
    v_mov_b32 v49, 0
    v_mov_b32 v50, 0
    v_mov_b32 v51, 0
    v_mov_b32 v52, 0
    v_mov_b32 v53, 0
    v_mov_b32 v54, 0
    v_mov_b32 v55, 0
    v_mov_b32 v56, 0
    v_mov_b32 v57, 0
    v_mov_b32 v58, 0
    v_mov_b32 v59, 0
    v_mov_b32 v60, 0
    v_mov_b32 v61, 0
    v_mov_b32 v62, 0
    v_mov_b32 v63, 0
K3a3f1_go:
    s_barrier
    ds_read_b128 v[8:11], v1 offset:0
    ds_read_b128 v[12:15], v1 offset:1024
    s_waitcnt lgkmcnt(1)
    v_smfmac_f32_16x16x64_bf16 v[36:39], v[8:11], a[0:7], v2
    v_smfmac_f32_16x16x64_bf16 v[40:43], v[8:11], a[56:63], v2
    v_smfmac_f32_16x16x64_bf16 v[44:47], v[8:11], a[112:119], v2
    v_smfmac_f32_16x16x64_bf16 v[48:51], v[8:11], a[168:175], v2
    s_barrier
    ds_read_b128 v[16:19], v1 offset:2048
    ds_read_b128 v[20:23], v1 offset:3072
    ds_read_b128 v[24:27], v1 offset:4096
    ds_read_b128 v[28:31], v1 offset:5120
    ds_read_b128 v[32:35], v1 offset:6144
    v_smfmac_f32_16x16x64_bf16 v[52:55], v[8:11], a[224:231], v2
    v_smfmac_f32_16x16x64_bf16 v[56:59], v[8:11], v[144:151], v2
    v_smfmac_f32_16x16x64_bf16 v[60:63], v[8:11], v[200:207], v2
    s_waitcnt lgkmcnt(5)
    v_smfmac_f32_16x16x64_bf16 v[36:39], v[12:15], a[8:15], v2
    v_smfmac_f32_16x16x64_bf16 v[40:43], v[12:15], a[64:71], v2
    v_smfmac_f32_16x16x64_bf16 v[44:47], v[12:15], a[120:127], v2
    v_smfmac_f32_16x16x64_bf16 v[48:51], v[12:15], a[176:183], v2
    v_smfmac_f32_16x16x64_bf16 v[52:55], v[12:15], a[232:239], v2
    v_smfmac_f32_16x16x64_bf16 v[56:59], v[12:15], v[152:159], v2
    v_smfmac_f32_16x16x64_bf16 v[60:63], v[12:15], v[208:215], v2
    s_waitcnt lgkmcnt(4)
    v_smfmac_f32_16x16x64_bf16 v[36:39], v[16:19], a[16:23], v2
    v_smfmac_f32_16x16x64_bf16 v[40:43], v[16:19], a[72:79], v2
    s_waitcnt lgkmcnt(3)
    v_smfmac_f32_16x16x64_bf16 v[36:39], v[20:23], a[24:31], v2
    v_smfmac_f32_16x16x64_bf16 v[40:43], v[20:23], a[80:87], v2
    s_waitcnt lgkmcnt(2)
    v_smfmac_f32_16x16x64_bf16 v[36:39], v[24:27], a[32:39], v2
    v_smfmac_f32_16x16x64_bf16 v[40:43], v[24:27], a[88:95], v2
    s_waitcnt lgkmcnt(1)
    v_smfmac_f32_16x16x64_bf16 v[36:39], v[28:31], a[40:47], v2
    v_smfmac_f32_16x16x64_bf16 v[40:43], v[28:31], a[96:103], v2
    s_waitcnt lgkmcnt(0)
    v_smfmac_f32_16x16x64_bf16 v[36:39], v[32:35], a[48:55], v2
    v_smfmac_f32_16x16x64_bf16 v[40:43], v[32:35], a[104:111], v2
    v_smfmac_f32_16x16x64_bf16 v[44:47], v[16:19], a[128:135], v2
    v_smfmac_f32_16x16x64_bf16 v[48:51], v[16:19], a[184:191], v2
    v_smfmac_f32_16x16x64_bf16 v[44:47], v[20:23], a[136:143], v2
    v_smfmac_f32_16x16x64_bf16 v[48:51], v[20:23], a[192:199], v2
    s_nop 2
    v_add_f32 v36, v36, v37
    v_smfmac_f32_16x16x64_bf16 v[44:47], v[24:27], a[144:151], v2
    v_add_f32 v38, v38, v39
    v_smfmac_f32_16x16x64_bf16 v[48:51], v[24:27], a[200:207], v2
    v_cmp_u_f32 vcc, v36, v38
    v_smfmac_f32_16x16x64_bf16 v[44:47], v[28:31], a[152:159], v2
    s_cbranch_vccnz K3a3f1_slow
K3a3f1_back:
    v_smfmac_f32_16x16x64_bf16 v[48:51], v[28:31], a[208:215], v2
    v_cvt_pk_bf16_f32 v36, v36, v38
    v_smfmac_f32_16x16x64_bf16 v[44:47], v[32:35], a[160:167], v2
    v_add_f32 v40, v40, v41
    v_smfmac_f32_16x16x64_bf16 v[48:51], v[32:35], a[216:223], v2
    v_add_f32 v42, v42, v43
    v_smfmac_f32_16x16x64_bf16 v[52:55], v[16:19], a[240:247], v2
    v_cvt_pk_bf16_f32 v40, v40, v42
    v_smfmac_f32_16x16x64_bf16 v[56:59], v[16:19], v[160:167], v2
    ds_write2st64_b32 v5, v36, v40 offset0:0 offset1:1
    v_smfmac_f32_16x16x64_bf16 v[52:55], v[20:23], a[248:255], v2
    v_smfmac_f32_16x16x64_bf16 v[56:59], v[20:23], v[168:175], v2
    v_add_f32 v44, v44, v45
    v_smfmac_f32_16x16x64_bf16 v[52:55], v[24:27], v[120:127], v2
    v_add_f32 v46, v46, v47
    v_smfmac_f32_16x16x64_bf16 v[56:59], v[24:27], v[176:183], v2
    v_cvt_pk_bf16_f32 v44, v44, v46
    v_smfmac_f32_16x16x64_bf16 v[52:55], v[28:31], v[128:135], v2
    v_add_f32 v48, v48, v49
    v_smfmac_f32_16x16x64_bf16 v[56:59], v[28:31], v[184:191], v2
    v_add_f32 v50, v50, v51
    v_smfmac_f32_16x16x64_bf16 v[52:55], v[32:35], v[136:143], v2
    v_cvt_pk_bf16_f32 v48, v48, v50
    v_smfmac_f32_16x16x64_bf16 v[56:59], v[32:35], v[192:199], v2
    ds_write2st64_b32 v5, v44, v48 offset0:2 offset1:3
    v_smfmac_f32_16x16x64_bf16 v[60:63], v[16:19], v[216:223], v2
    v_smfmac_f32_16x16x64_bf16 v[60:63], v[20:23], v[224:231], v2
    v_smfmac_f32_16x16x64_bf16 v[60:63], v[24:27], v[232:239], v2
    s_nop 1
    v_add_f32 v52, v52, v53
    v_add_f32 v54, v54, v55
    v_smfmac_f32_16x16x64_bf16 v[60:63], v[28:31], v[240:247], v2
    v_cvt_pk_bf16_f32 v52, v52, v54
    v_add_f32 v56, v56, v57
    v_smfmac_f32_16x16x64_bf16 v[60:63], v[32:35], v[248:255], v2
    v_add_f32 v58, v58, v59
    v_cvt_pk_bf16_f32 v56, v56, v58
    ds_write2st64_b32 v5, v52, v56 offset0:4 offset1:5
    s_nop 4
    v_add_f32 v60, v60, v61
    v_add_f32 v62, v62, v63
    v_cvt_pk_bf16_f32 v60, v60, v62
    ds_write_b32 v6, v60
    s_waitcnt lgkmcnt(0)
    s_barrier
    s_barrier
    s_waitcnt vmcnt(0)
    s_barrier
    s_add_u32 s64, s64, 1
    s_cmp_lt_u32 s64, 63
    s_cbranch_scc1 K3a3f1_loop
    s_branch K3_end
K3a3f1_slow:
    s_waitcnt vmcnt(0)
    v_pk_max_u16 v37, v8, v9
    v_pk_max_u16 v37, v37, v10
    v_pk_max_u16 v37, v37, v11
    v_pk_max_u16 v37, v37, v12
    v_pk_max_u16 v37, v37, v13
    v_pk_max_u16 v37, v37, v14
    v_pk_max_u16 v37, v37, v15
    v_pk_max_u16 v37, v37, v16
    v_pk_max_u16 v37, v37, v17
    v_pk_max_u16 v37, v37, v18
    v_pk_max_u16 v37, v37, v19
    v_pk_max_u16 v37, v37, v20
    v_pk_max_u16 v37, v37, v21
    v_pk_max_u16 v37, v37, v22
    v_pk_max_u16 v37, v37, v23
    v_pk_max_u16 v37, v37, v24
    v_pk_max_u16 v37, v37, v25
    v_pk_max_u16 v37, v37, v26
    v_pk_max_u16 v37, v37, v27
    v_pk_max_u16 v37, v37, v28
    v_pk_max_u16 v37, v37, v29
    v_pk_max_u16 v37, v37, v30
    v_pk_max_u16 v37, v37, v31
    v_pk_max_u16 v37, v37, v32
    v_pk_max_u16 v37, v37, v33
    v_pk_max_u16 v37, v37, v34
    v_pk_max_u16 v37, v37, v35
    v_lshlrev_b32 v39, 16, v37
    v_max_u32 v37, v37, v39
    v_cmp_le_u32 vcc, s26, v37
    s_cbranch_vccz K3a3f1_back
    s_add_u32 s27, s27, 1
    s_cmp_gt_u32 s27, 65536
    s_cbranch_scc1 K3_bail
    s_branch K3a3f1_retry
K3a3f1_retry:
    v_mov_b32 v36, 0
    v_mov_b32 v37, 0
    v_mov_b32 v38, 0
    v_mov_b32 v39, 0
    v_mov_b32 v40, 0
    v_mov_b32 v41, 0
    v_mov_b32 v42, 0
    v_mov_b32 v43, 0
    v_mov_b32 v44, 0
    v_mov_b32 v45, 0
    v_mov_b32 v46, 0
    v_mov_b32 v47, 0
    v_mov_b32 v48, 0
    v_mov_b32 v49, 0
    v_mov_b32 v50, 0
    v_mov_b32 v51, 0
    v_mov_b32 v52, 0
    v_mov_b32 v53, 0
    v_mov_b32 v54, 0
    v_mov_b32 v55, 0
    v_mov_b32 v56, 0
    v_mov_b32 v57, 0
    v_mov_b32 v58, 0
    v_mov_b32 v59, 0
    v_mov_b32 v60, 0
    v_mov_b32 v61, 0
    v_mov_b32 v62, 0
    v_mov_b32 v63, 0
    s_mov_b32 m0, 12288
    s_barrier
    s_branch K3a3f1_go
K3_b:
    s_sub_u32 s22, s21, 16
    s_add_u32 s36, s18, 0xe20000
    s_addc_u32 s37, s19, 0
    s_mov_b32 s38, 0x620000
    s_mov_b32 s39, 0x20000
    s_add_u32 s48, s18, 0x3400000
    s_addc_u32 s49, s19, 0
    s_mov_b32 s50, 0x1c00000
    s_mov_b32 s51, 0x20000
    s_add_u32 s68, s18, 0x5d00000
    s_addc_u32 s69, s19, 0
    s_mov_b32 s70, 0xb8000
    s_mov_b32 s71, 0x20000
    s_add_u32 s76, s18, 0x5c00000
    s_addc_u32 s77, s19, 0
    s_mov_b32 s78, 0x80000
    s_mov_b32 s79, 0x20000
    v_bfe_u32 v5, v1, 2, 2
    v_mul_u32_u24 v5, 3584, v5
    v_and_b32 v6, 3, v1
    v_lshl_add_u32 v5, v6, 7, v5
    s_mul_i32 s33, s3, 14336
    s_lshr_b32 s28, s22, 1
    s_lshl_b32 s28, s28, 9
    s_add_u32 s33, s33, s28
    s_add_u32 s33, s33, 647168
    s_mov_b32 s27, 0
K3b_wp0:
    buffer_load_dword v6, v5, s[68:71], s33 offen sc1
    s_add_u32 s27, s27, 1
    s_cmp_gt_u32 s27, 65536
    s_cbranch_scc1 K3_bail
K3b_wp0_chk:
    s_waitcnt vmcnt(0)
    v_subrev_u32 v6, s95, v6
    v_subrev_u32 v6, 1, v6
    v_cmp_lt_u32 vcc, 4, v6
    s_cbranch_vccz K3b_wp0_ok
    s_sleep 6
    s_branch K3b_wp0
K3b_wp0_ok:
    s_lshl_b32 s28, s3, 2
    s_add_u32 s28, s28, 0
    s_mul_i32 s28, s28, 401408
    s_mul_i32 s29, s22, 28672
    s_add_u32 s28, s28, s29
    s_add_u32 s28, s28, 0
    buffer_load_dwordx4 a[0:3], v4, s[36:39], s28 offen offset:0 sc1
    buffer_load_dwordx4 a[4:7], v4, s[36:39], s28 offen offset:1024 sc1
    buffer_load_dwordx4 a[8:11], v4, s[36:39], s28 offen offset:2048 sc1
    buffer_load_dwordx4 a[12:15], v4, s[36:39], s28 offen offset:3072 sc1
    s_lshl_b32 s28, s3, 2
    s_add_u32 s28, s28, 1
    s_mul_i32 s28, s28, 401408
    s_mul_i32 s29, s22, 28672
    s_add_u32 s28, s28, s29
    s_add_u32 s28, s28, 0
    buffer_load_dwordx4 a[56:59], v4, s[36:39], s28 offen offset:0 sc1
    buffer_load_dwordx4 a[60:63], v4, s[36:39], s28 offen offset:1024 sc1
    buffer_load_dwordx4 a[64:67], v4, s[36:39], s28 offen offset:2048 sc1
    buffer_load_dwordx4 a[68:71], v4, s[36:39], s28 offen offset:3072 sc1
    s_lshl_b32 s28, s3, 2
    s_add_u32 s28, s28, 2
    s_mul_i32 s28, s28, 401408
    s_mul_i32 s29, s22, 28672
    s_add_u32 s28, s28, s29
    s_add_u32 s28, s28, 0
    buffer_load_dwordx4 a[112:115], v4, s[36:39], s28 offen offset:0 sc1
    buffer_load_dwordx4 a[116:119], v4, s[36:39], s28 offen offset:1024 sc1
    buffer_load_dwordx4 a[120:123], v4, s[36:39], s28 offen offset:2048 sc1
    buffer_load_dwordx4 a[124:127], v4, s[36:39], s28 offen offset:3072 sc1
    s_lshl_b32 s28, s3, 2
    s_add_u32 s28, s28, 3
    s_mul_i32 s28, s28, 401408
    s_mul_i32 s29, s22, 28672
    s_add_u32 s28, s28, s29
    s_add_u32 s28, s28, 0
    buffer_load_dwordx4 a[168:171], v4, s[36:39], s28 offen offset:0 sc1
    buffer_load_dwordx4 a[172:175], v4, s[36:39], s28 offen offset:1024 sc1
    buffer_load_dwordx4 a[176:179], v4, s[36:39], s28 offen offset:2048 sc1
    buffer_load_dwordx4 a[180:183], v4, s[36:39], s28 offen offset:3072 sc1
    s_lshl_b32 s28, s3, 2
    s_add_u32 s28, s28, 0
    s_mul_i32 s28, s28, 401408
    s_mul_i32 s29, s22, 28672
    s_add_u32 s28, s28, s29
    s_add_u32 s28, s28, 14336
    buffer_load_dwordx4 a[224:227], v4, s[36:39], s28 offen offset:0 sc1
    buffer_load_dwordx4 a[228:231], v4, s[36:39], s28 offen offset:1024 sc1
    buffer_load_dwordx4 a[232:235], v4, s[36:39], s28 offen offset:2048 sc1
    buffer_load_dwordx4 a[236:239], v4, s[36:39], s28 offen offset:3072 sc1
    s_lshl_b32 s28, s3, 2
    s_add_u32 s28, s28, 1
    s_mul_i32 s28, s28, 401408
    s_mul_i32 s29, s22, 28672
    s_add_u32 s28, s28, s29
    s_add_u32 s28, s28, 14336
    buffer_load_dwordx4 v[200:203], v4, s[36:39], s28 offen offset:0 sc1
    buffer_load_dwordx4 v[204:207], v4, s[36:39], s28 offen offset:1024 sc1
    buffer_load_dwordx4 v[208:211], v4, s[36:39], s28 offen offset:2048 sc1
    buffer_load_dwordx4 v[212:215], v4, s[36:39], s28 offen offset:3072 sc1
    s_lshl_b32 s28, s3, 2
    s_add_u32 s28, s28, 2
    s_mul_i32 s28, s28, 401408
    s_mul_i32 s29, s22, 28672
    s_add_u32 s28, s28, s29
    s_add_u32 s28, s28, 14336
    s_mul_i32 s29, s3, 28672
    s_add_u32 m0, s29, 0
    s_nop 0
    buffer_load_dwordx4 v4, s[36:39], s28 offen offset:0 sc1 lds
    buffer_load_dwordx4 v4, s[36:39], s28 offen offset:1024 sc1 lds
    buffer_load_dwordx4 v4, s[36:39], s28 offen offset:2048 sc1 lds
    buffer_load_dwordx4 v4, s[36:39], s28 offen offset:3072 sc1 lds
    s_lshl_b32 s28, s3, 2
    s_add_u32 s28, s28, 3
    s_mul_i32 s28, s28, 401408
    s_mul_i32 s29, s22, 28672
    s_add_u32 s28, s28, s29
    s_add_u32 s28, s28, 14336
    s_mul_i32 s29, s3, 28672
    s_add_u32 m0, s29, 14336
    s_nop 0
    buffer_load_dwordx4 v4, s[36:39], s28 offen offset:0 sc1 lds
    buffer_load_dwordx4 v4, s[36:39], s28 offen offset:1024 sc1 lds
    buffer_load_dwordx4 v4, s[36:39], s28 offen offset:2048 sc1 lds
    buffer_load_dwordx4 v4, s[36:39], s28 offen offset:3072 sc1 lds
    buffer_load_dword v6, v5, s[68:71], s33 offen sc1
    s_mov_b32 s27, 0
    s_branch K3b_wp1_chk
K3b_wp1:
    buffer_load_dword v6, v5, s[68:71], s33 offen sc1
    s_add_u32 s27, s27, 1
    s_cmp_gt_u32 s27, 65536
    s_cbranch_scc1 K3_bail
K3b_wp1_chk:
    s_waitcnt vmcnt(0)
    v_subrev_u32 v6, s95, v6
    v_subrev_u32 v6, 2, v6
    v_cmp_lt_u32 vcc, 3, v6
    s_cbranch_vccz K3b_wp1_ok
    s_sleep 6
    s_branch K3b_wp1
K3b_wp1_ok:
    s_lshl_b32 s28, s3, 2
    s_add_u32 s28, s28, 0
    s_mul_i32 s28, s28, 401408
    s_mul_i32 s29, s22, 28672
    s_add_u32 s28, s28, s29
    s_add_u32 s28, s28, 4096
    buffer_load_dwordx4 a[16:19], v4, s[36:39], s28 offen offset:0 sc1
    buffer_load_dwordx4 a[20:23], v4, s[36:39], s28 offen offset:1024 sc1
    buffer_load_dwordx4 a[24:27], v4, s[36:39], s28 offen offset:2048 sc1
    buffer_load_dwordx4 a[28:31], v4, s[36:39], s28 offen offset:3072 sc1
    s_lshl_b32 s28, s3, 2
    s_add_u32 s28, s28, 1
    s_mul_i32 s28, s28, 401408
    s_mul_i32 s29, s22, 28672
    s_add_u32 s28, s28, s29
    s_add_u32 s28, s28, 4096
    buffer_load_dwordx4 a[72:75], v4, s[36:39], s28 offen offset:0 sc1
    buffer_load_dwordx4 a[76:79], v4, s[36:39], s28 offen offset:1024 sc1
    buffer_load_dwordx4 a[80:83], v4, s[36:39], s28 offen offset:2048 sc1
    buffer_load_dwordx4 a[84:87], v4, s[36:39], s28 offen offset:3072 sc1
    s_lshl_b32 s28, s3, 2
    s_add_u32 s28, s28, 2
    s_mul_i32 s28, s28, 401408
    s_mul_i32 s29, s22, 28672
    s_add_u32 s28, s28, s29
    s_add_u32 s28, s28, 4096
    buffer_load_dwordx4 a[128:131], v4, s[36:39], s28 offen offset:0 sc1
    buffer_load_dwordx4 a[132:135], v4, s[36:39], s28 offen offset:1024 sc1
    buffer_load_dwordx4 a[136:139], v4, s[36:39], s28 offen offset:2048 sc1
    buffer_load_dwordx4 a[140:143], v4, s[36:39], s28 offen offset:3072 sc1
    s_lshl_b32 s28, s3, 2
    s_add_u32 s28, s28, 3
    s_mul_i32 s28, s28, 401408
    s_mul_i32 s29, s22, 28672
    s_add_u32 s28, s28, s29
    s_add_u32 s28, s28, 4096
    buffer_load_dwordx4 a[184:187], v4, s[36:39], s28 offen offset:0 sc1
    buffer_load_dwordx4 a[188:191], v4, s[36:39], s28 offen offset:1024 sc1
    buffer_load_dwordx4 a[192:195], v4, s[36:39], s28 offen offset:2048 sc1
    buffer_load_dwordx4 a[196:199], v4, s[36:39], s28 offen offset:3072 sc1
    s_lshl_b32 s28, s3, 2
    s_add_u32 s28, s28, 0
    s_mul_i32 s28, s28, 401408
    s_mul_i32 s29, s22, 28672
    s_add_u32 s28, s28, s29
    s_add_u32 s28, s28, 18432
    buffer_load_dwordx4 a[240:243], v4, s[36:39], s28 offen offset:0 sc1
    buffer_load_dwordx4 a[244:247], v4, s[36:39], s28 offen offset:1024 sc1
    buffer_load_dwordx4 a[248:251], v4, s[36:39], s28 offen offset:2048 sc1
    buffer_load_dwordx4 a[252:255], v4, s[36:39], s28 offen offset:3072 sc1
    s_lshl_b32 s28, s3, 2
    s_add_u32 s28, s28, 1
    s_mul_i32 s28, s28, 401408
    s_mul_i32 s29, s22, 28672
    s_add_u32 s28, s28, s29
    s_add_u32 s28, s28, 18432
    buffer_load_dwordx4 v[216:219], v4, s[36:39], s28 offen offset:0 sc1
    buffer_load_dwordx4 v[220:223], v4, s[36:39], s28 offen offset:1024 sc1
    buffer_load_dwordx4 v[224:227], v4, s[36:39], s28 offen offset:2048 sc1
    buffer_load_dwordx4 v[228:231], v4, s[36:39], s28 offen offset:3072 sc1
    s_lshl_b32 s28, s3, 2
    s_add_u32 s28, s28, 2
    s_mul_i32 s28, s28, 401408
    s_mul_i32 s29, s22, 28672
    s_add_u32 s28, s28, s29
    s_add_u32 s28, s28, 18432
    s_mul_i32 s29, s3, 28672
    s_add_u32 m0, s29, 4096
    s_nop 0
    buffer_load_dwordx4 v4, s[36:39], s28 offen offset:0 sc1 lds
    buffer_load_dwordx4 v4, s[36:39], s28 offen offset:1024 sc1 lds
    buffer_load_dwordx4 v4, s[36:39], s28 offen offset:2048 sc1 lds
    buffer_load_dwordx4 v4, s[36:39], s28 offen offset:3072 sc1 lds
    s_lshl_b32 s28, s3, 2
    s_add_u32 s28, s28, 3
    s_mul_i32 s28, s28, 401408
    s_mul_i32 s29, s22, 28672
    s_add_u32 s28, s28, s29
    s_add_u32 s28, s28, 18432
    s_mul_i32 s29, s3, 28672
    s_add_u32 m0, s29, 18432
    s_nop 0
    buffer_load_dwordx4 v4, s[36:39], s28 offen offset:0 sc1 lds
    buffer_load_dwordx4 v4, s[36:39], s28 offen offset:1024 sc1 lds
    buffer_load_dwordx4 v4, s[36:39], s28 offen offset:2048 sc1 lds
    buffer_load_dwordx4 v4, s[36:39], s28 offen offset:3072 sc1 lds
    buffer_load_dword v6, v5, s[68:71], s33 offen sc1
    s_mov_b32 s27, 0
    s_branch K3b_wp2_chk
K3b_wp2:
    buffer_load_dword v6, v5, s[68:71], s33 offen sc1
    s_add_u32 s27, s27, 1
    s_cmp_gt_u32 s27, 65536
    s_cbranch_scc1 K3_bail
K3b_wp2_chk:
    s_waitcnt vmcnt(0)
    v_subrev_u32 v6, s95, v6
    v_subrev_u32 v6, 3, v6
    v_cmp_lt_u32 vcc, 2, v6
    s_cbranch_vccz K3b_wp2_ok
    s_sleep 6
    s_branch K3b_wp2
K3b_wp2_ok:
    s_lshl_b32 s28, s3, 2
    s_add_u32 s28, s28, 0
    s_mul_i32 s28, s28, 401408
    s_mul_i32 s29, s22, 28672
    s_add_u32 s28, s28, s29
    s_add_u32 s28, s28, 8192
    buffer_load_dwordx4 a[32:35], v4, s[36:39], s28 offen offset:0 sc1
    buffer_load_dwordx4 a[36:39], v4, s[36:39], s28 offen offset:1024 sc1
    buffer_load_dwordx4 a[40:43], v4, s[36:39], s28 offen offset:2048 sc1
    buffer_load_dwordx4 a[44:47], v4, s[36:39], s28 offen offset:3072 sc1
    s_lshl_b32 s28, s3, 2
    s_add_u32 s28, s28, 1
    s_mul_i32 s28, s28, 401408
    s_mul_i32 s29, s22, 28672
    s_add_u32 s28, s28, s29
    s_add_u32 s28, s28, 8192
    buffer_load_dwordx4 a[88:91], v4, s[36:39], s28 offen offset:0 sc1
    buffer_load_dwordx4 a[92:95], v4, s[36:39], s28 offen offset:1024 sc1
    buffer_load_dwordx4 a[96:99], v4, s[36:39], s28 offen offset:2048 sc1
    buffer_load_dwordx4 a[100:103], v4, s[36:39], s28 offen offset:3072 sc1
    s_lshl_b32 s28, s3, 2
    s_add_u32 s28, s28, 2
    s_mul_i32 s28, s28, 401408
    s_mul_i32 s29, s22, 28672
    s_add_u32 s28, s28, s29
    s_add_u32 s28, s28, 8192
    buffer_load_dwordx4 a[144:147], v4, s[36:39], s28 offen offset:0 sc1
    buffer_load_dwordx4 a[148:151], v4, s[36:39], s28 offen offset:1024 sc1
    buffer_load_dwordx4 a[152:155], v4, s[36:39], s28 offen offset:2048 sc1
    buffer_load_dwordx4 a[156:159], v4, s[36:39], s28 offen offset:3072 sc1
    s_lshl_b32 s28, s3, 2
    s_add_u32 s28, s28, 3
    s_mul_i32 s28, s28, 401408
    s_mul_i32 s29, s22, 28672
    s_add_u32 s28, s28, s29
    s_add_u32 s28, s28, 8192
    buffer_load_dwordx4 a[200:203], v4, s[36:39], s28 offen offset:0 sc1
    buffer_load_dwordx4 a[204:207], v4, s[36:39], s28 offen offset:1024 sc1
    buffer_load_dwordx4 a[208:211], v4, s[36:39], s28 offen offset:2048 sc1
    buffer_load_dwordx4 a[212:215], v4, s[36:39], s28 offen offset:3072 sc1
    s_lshl_b32 s28, s3, 2
    s_add_u32 s28, s28, 0
    s_mul_i32 s28, s28, 401408
    s_mul_i32 s29, s22, 28672
    s_add_u32 s28, s28, s29
    s_add_u32 s28, s28, 22528
    buffer_load_dwordx4 v[176:179], v4, s[36:39], s28 offen offset:0 sc1
    buffer_load_dwordx4 v[180:183], v4, s[36:39], s28 offen offset:1024 sc1
    buffer_load_dwordx4 v[184:187], v4, s[36:39], s28 offen offset:2048 sc1
    buffer_load_dwordx4 v[188:191], v4, s[36:39], s28 offen offset:3072 sc1
    s_lshl_b32 s28, s3, 2
    s_add_u32 s28, s28, 1
    s_mul_i32 s28, s28, 401408
    s_mul_i32 s29, s22, 28672
    s_add_u32 s28, s28, s29
    s_add_u32 s28, s28, 22528
    buffer_load_dwordx4 v[232:235], v4, s[36:39], s28 offen offset:0 sc1
    buffer_load_dwordx4 v[236:239], v4, s[36:39], s28 offen offset:1024 sc1
    buffer_load_dwordx4 v[240:243], v4, s[36:39], s28 offen offset:2048 sc1
    buffer_load_dwordx4 v[244:247], v4, s[36:39], s28 offen offset:3072 sc1
    s_lshl_b32 s28, s3, 2
    s_add_u32 s28, s28, 2
    s_mul_i32 s28, s28, 401408
    s_mul_i32 s29, s22, 28672
    s_add_u32 s28, s28, s29
    s_add_u32 s28, s28, 22528
    s_mul_i32 s29, s3, 28672
    s_add_u32 m0, s29, 8192
    s_nop 0
    buffer_load_dwordx4 v4, s[36:39], s28 offen offset:0 sc1 lds
    buffer_load_dwordx4 v4, s[36:39], s28 offen offset:1024 sc1 lds
    buffer_load_dwordx4 v4, s[36:39], s28 offen offset:2048 sc1 lds
    buffer_load_dwordx4 v4, s[36:39], s28 offen offset:3072 sc1 lds
    s_lshl_b32 s28, s3, 2
    s_add_u32 s28, s28, 3
    s_mul_i32 s28, s28, 401408
    s_mul_i32 s29, s22, 28672
    s_add_u32 s28, s28, s29
    s_add_u32 s28, s28, 22528
    s_mul_i32 s29, s3, 28672
    s_add_u32 m0, s29, 22528
    s_nop 0
    buffer_load_dwordx4 v4, s[36:39], s28 offen offset:0 sc1 lds
    buffer_load_dwordx4 v4, s[36:39], s28 offen offset:1024 sc1 lds
    buffer_load_dwordx4 v4, s[36:39], s28 offen offset:2048 sc1 lds
    buffer_load_dwordx4 v4, s[36:39], s28 offen offset:3072 sc1 lds
    buffer_load_dword v6, v5, s[68:71], s33 offen sc1
    s_mov_b32 s27, 0
    s_branch K3b_wp3_chk
K3b_wp3:
    buffer_load_dword v6, v5, s[68:71], s33 offen sc1
    s_add_u32 s27, s27, 1
    s_cmp_gt_u32 s27, 65536
    s_cbranch_scc1 K3_bail
K3b_wp3_chk:
    s_waitcnt vmcnt(0)
    v_subrev_u32 v6, s95, v6
    v_subrev_u32 v6, 4, v6
    v_cmp_lt_u32 vcc, 1, v6
    s_cbranch_vccz K3b_wp3_ok
    s_sleep 6
    s_branch K3b_wp3
K3b_wp3_ok:
    v_lshlrev_b32 v163, 3, v4
    v_min_u32 v163, 1920, v163
    v_add_u32 v163, 2048, v163
    s_mov_b32 s28, 0
    s_mov_b32 s27, 0
K3b_v0:
    buffer_load_dword v6, v163, s[68:71], s28 offen sc1
    s_add_u32 s27, s27, 1
    s_cmp_gt_u32 s27, 65536
    s_cbranch_scc1 K3_bail
    s_waitcnt vmcnt(0)
    v_cmp_ne_u32 vcc, s96, v6
    s_cbranch_vccz K3b_v0_ok
    s_sleep 2
    s_branch K3b_v0
K3b_v0_ok:
    s_lshl_b32 s30, s22, 15
    s_lshl_b32 s31, s3, 13
    s_add_u32 s30, s30, s31
    s_add_u32 s31, s31, 114688
    s_mov_b32 m0, s31
    s_nop 0
    buffer_load_dwordx4 v4, s[48:51], s30 offen offset:0 sc1 lds
    buffer_load_dwordx4 v4, s[48:51], s30 offen offset:1024 sc1 lds
    buffer_load_dwordx4 v4, s[48:51], s30 offen offset:2048 sc1 lds
    buffer_load_dwordx4 v4, s[48:51], s30 offen offset:3072 sc1 lds
    s_add_u32 s30, s30, 4096
    s_add_u32 m0, m0, 4096
    s_nop 0
    buffer_load_dwordx4 v4, s[48:51], s30 offen offset:0 sc1 lds
    buffer_load_dwordx4 v4, s[48:51], s30 offen offset:1024 sc1 lds
    buffer_load_dwordx4 v4, s[48:51], s30 offen offset:2048 sc1 lds
    buffer_load_dwordx4 v4, s[48:51], s30 offen offset:3072 sc1 lds
    s_lshl_b32 s28, s3, 2
    s_add_u32 s28, s28, 0
    s_mul_i32 s28, s28, 401408
    s_mul_i32 s29, s22, 28672
    s_add_u32 s28, s28, s29
    s_add_u32 s28, s28, 12288
    buffer_load_dwordx4 a[48:51], v4, s[36:39], s28 offen offset:0 sc1
    buffer_load_dwordx4 a[52:55], v4, s[36:39], s28 offen offset:1024 sc1
    s_lshl_b32 s28, s3, 2
    s_add_u32 s28, s28, 1
    s_mul_i32 s28, s28, 401408
    s_mul_i32 s29, s22, 28672
    s_add_u32 s28, s28, s29
    s_add_u32 s28, s28, 12288
    buffer_load_dwordx4 a[104:107], v4, s[36:39], s28 offen offset:0 sc1
    buffer_load_dwordx4 a[108:111], v4, s[36:39], s28 offen offset:1024 sc1
    s_lshl_b32 s28, s3, 2
    s_add_u32 s28, s28, 2
    s_mul_i32 s28, s28, 401408
    s_mul_i32 s29, s22, 28672
    s_add_u32 s28, s28, s29
    s_add_u32 s28, s28, 12288
    buffer_load_dwordx4 a[160:163], v4, s[36:39], s28 offen offset:0 sc1
    buffer_load_dwordx4 a[164:167], v4, s[36:39], s28 offen offset:1024 sc1
    s_lshl_b32 s28, s3, 2
    s_add_u32 s28, s28, 3
    s_mul_i32 s28, s28, 401408
    s_mul_i32 s29, s22, 28672
    s_add_u32 s28, s28, s29
    s_add_u32 s28, s28, 12288
    buffer_load_dwordx4 a[216:219], v4, s[36:39], s28 offen offset:0 sc1
    buffer_load_dwordx4 a[220:223], v4, s[36:39], s28 offen offset:1024 sc1
    s_lshl_b32 s28, s3, 2
    s_add_u32 s28, s28, 0
    s_mul_i32 s28, s28, 401408
    s_mul_i32 s29, s22, 28672
    s_add_u32 s28, s28, s29
    s_add_u32 s28, s28, 26624
    buffer_load_dwordx4 v[192:195], v4, s[36:39], s28 offen offset:0 sc1
    buffer_load_dwordx4 v[196:199], v4, s[36:39], s28 offen offset:1024 sc1
    s_lshl_b32 s28, s3, 2
    s_add_u32 s28, s28, 1
    s_mul_i32 s28, s28, 401408
    s_mul_i32 s29, s22, 28672
    s_add_u32 s28, s28, s29
    s_add_u32 s28, s28, 26624
    buffer_load_dwordx4 v[248:251], v4, s[36:39], s28 offen offset:0 sc1
    buffer_load_dwordx4 v[252:255], v4, s[36:39], s28 offen offset:1024 sc1
    s_lshl_b32 s28, s3, 2
    s_add_u32 s28, s28, 2
    s_mul_i32 s28, s28, 401408
    s_mul_i32 s29, s22, 28672
    s_add_u32 s28, s28, s29
    s_add_u32 s28, s28, 26624
    s_mul_i32 s29, s3, 28672
    s_add_u32 m0, s29, 12288
    s_nop 0
    buffer_load_dwordx4 v4, s[36:39], s28 offen offset:0 sc1 lds
    buffer_load_dwordx4 v4, s[36:39], s28 offen offset:1024 sc1 lds
    s_lshl_b32 s28, s3, 2
    s_add_u32 s28, s28, 3
    s_mul_i32 s28, s28, 401408
    s_mul_i32 s29, s22, 28672
    s_add_u32 s28, s28, s29
    s_add_u32 s28, s28, 26624
    s_mul_i32 s29, s3, 28672
    s_add_u32 m0, s29, 26624
    s_nop 0
    buffer_load_dwordx4 v4, s[36:39], s28 offen offset:0 sc1 lds
    buffer_load_dwordx4 v4, s[36:39], s28 offen offset:1024 sc1 lds
    v_min_u32 v20, 31, v1
    v_lshlrev_b32 v20, 7, v20
    s_mov_b32 s27, 0
    s_mov_b32 s28, 737280
    buffer_load_dword v21, v20, s[56:59], s28 offen sc1
    s_mul_i32 s28, s3, 28672
    v_add_u32 v5, s28, v4
    v_and_b32 v9, 1, v2
    v_cmp_eq_u32 vcc, 1, v9
    v_mov_b32 v160, 0x4444
    v_mov_b32 v161, 0xeeee
    v_cndmask_b32 v160, v160, v161, vcc
    s_mov_b32 s25, 0xfffefffe
    s_mov_b32 s26, 0xffff0000
    s_mov_b32 s64, 0
    s_mov_b32 s66, 147456
    s_and_b32 s24, s3, 1
    s_lshl_b32 s28, s24, 14
    s_add_u32 s28, s28, 114688
    v_add_u32 v6, s28, v4
    v_bfe_u32 v8, v2, 1, 1
    v_lshl_add_u32 v8, v3, 2, v8
    v_lshlrev_b32 v7, 4, v8
    v_lshrrev_b32 v8, 2, v2
    v_lshl_add_u32 v7, v8, 2, v7
    v_lshl_add_u32 v7, v9, 1, v7
    s_lshl_b32 s28, s22, 1
    s_add_u32 s28, s28, s24
    s_lshl_b32 s67, s28, 12
    s_lshl_b32 s29, s28, 8
    v_add_u32 v7, s29, v7
    v_min_u32 v161, 27, v1
    v_lshlrev_b32 v161, 2, v161
    v_add_u32 v161, 7168, v161
    v_min_u32 v172, 15, v1
    v_lshlrev_b32 v172, 2, v172
    s_and_b32 s29, s22, 0
    s_lshl_b32 s29, s29, 7
    s_add_u32 s29, s29, 15872
    v_add_u32 v172, s29, v172
    s_lshl_b32 s28, s28, 2
    s_add_u32 s28, s28, 15360
    v_lshlrev_b32 v173, 7, v1
    v_add_u32 v173, s28, v173
    v_mov_b32 v8, 0x7ffffff0
    v_cmp_gt_u32 vcc, 1, v1
    s_nop 1
    v_cndmask_b32 v173, v8, v173, vcc
    v_mov_b32 v175, 0
    v_not_b32 v0, s96
    v_lshlrev_b32 v2, 2, v4
    s_mov_b32 s73, 0
    s_lshl_b32 s74, s22, 14
    s_add_u32 s74, s74, 688128
    v_add_u32 v162, 155648, v4
    s_mov_b32 s97, 155648
    s_mul_i32 s98, s24, 3072
    s_mov_b32 s27, 0
    s_mov_b32 s28, 737280
    s_branch K3_end_fl3623_chk
K3_end_fl3623:
    buffer_load_dword v21, v20, s[56:59], s28 offen sc1
    s_add_u32 s27, s27, 1
    s_cmp_gt_u32 s27, 65536
    s_cbranch_scc1 K3_bail
K3_end_fl3623_chk:
    s_waitcnt vmcnt(0)
    v_xor_b32 v21, s35, v21
    v_cmp_lt_u32 vcc, 15, v21
    s_cbranch_vccnz K3_end_fl3623
    v_cmp_ne_u32 vcc, 0, v21
    s_nop 0
    s_cmp_lg_u64 vcc, 0
    s_cselect_b32 s65, 1, 0
    s_cmp_lg_u32 s65, 0
    s_cbranch_scc1 K3bf1_loop
K3bf0_loop:
    v_mov_b32 v36, 0
    v_mov_b32 v37, 0
    v_mov_b32 v38, 0
    v_mov_b32 v39, 0
    v_mov_b32 v40, 0
    v_mov_b32 v41, 0
    v_mov_b32 v42, 0
    v_mov_b32 v43, 0
    v_mov_b32 v44, 0
    v_mov_b32 v45, 0
    v_mov_b32 v46, 0
    v_mov_b32 v47, 0
    v_mov_b32 v48, 0
    v_mov_b32 v49, 0
    v_mov_b32 v50, 0
    v_mov_b32 v51, 0
    v_mov_b32 v52, 0
    v_mov_b32 v53, 0
    v_mov_b32 v54, 0
    v_mov_b32 v55, 0
    v_mov_b32 v56, 0
    v_mov_b32 v57, 0
    v_mov_b32 v58, 0
    v_mov_b32 v59, 0
    v_mov_b32 v60, 0
    v_mov_b32 v61, 0
    v_mov_b32 v62, 0
    v_mov_b32 v63, 0
    v_mov_b32 v64, 0
    v_mov_b32 v65, 0
    v_mov_b32 v66, 0
    v_mov_b32 v67, 0
    ds_read_b128 v[68:71], v5 offset:0
    ds_read_b128 v[72:75], v5 offset:1024
    ds_read_b128 v[76:79], v5 offset:2048
    ds_read_b128 v[80:83], v5 offset:3072
    ds_read_b128 v[84:87], v5 offset:4096
    ds_read_b128 v[88:91], v5 offset:5120
    ds_read_b128 v[92:95], v5 offset:6144
    ds_read_b128 v[96:99], v5 offset:7168
    s_lshl_b32 s32, s64, 13
    s_add_u32 s34, s32, 4096
    s_mul_i32 s30, s64, 458752
    s_lshl_b32 s31, s22, 15
    s_add_u32 s30, s30, s31
    s_lshl_b32 s31, s3, 13
    s_add_u32 s30, s30, s31
    s_add_u32 s29, s30, 4096
    s_add_u32 s31, s31, 114688
    s_lshl_b32 s28, s3, 10
    s_add_u32 s28, s28, s66
    v_add_u32 v174, s28, v4
    v_lshlrev_b32 v163, 3, v4
    v_min_u32 v163, 1920, v163
    v_add_u32 v163, 2048, v163
    s_lshl_b32 s28, s64, 13
    s_add_u32 s33, s28, 8192
    s_mov_b32 s72, 0x40000000
    s_cmp_lg_u32 s3, 3
    s_cbranch_scc1 K3bf0_wv_x
    v_cmp_ne_u32 vcc, s96, v0
    s_cbranch_vccz K3bf0_wv_ok
    s_mov_b32 s27, 0
K3bf0_wv:
    buffer_load_dword v116, v163, s[68:71], s28 offen sc1
    s_add_u32 s27, s27, 1
    s_cmp_gt_u32 s27, 65536
    s_cbranch_scc1 K3_bail
    s_waitcnt vmcnt(0)
    v_cmp_ne_u32 vcc, s96, v116
    s_cbranch_vccz K3bf0_wv_ok
    s_sleep 2
    s_branch K3bf0_wv
K3bf0_wv_ok:
K3bf0_wv_x:
    s_mov_b32 s27, 0
    s_waitcnt lgkmcnt(0)
    s_cmp_lg_u32 s3, 2
    s_cbranch_scc1 K3bf0_join
    s_cmp_eq_u32 s64, 0
    s_cbranch_scc1 K3bf0_hm_ok
    s_mov_b32 s27, 0
    buffer_load_dword v116, v161, s[40:43], s32 offen sc1
    buffer_load_dword v117, v161, s[40:43], s32 offen sc1
    buffer_load_dword v118, v161, s[40:43], s32 offen sc1
    buffer_load_dword v119, v161, s[40:43], s32 offen sc1
K3bf0_hm:
    buffer_load_dword v120, v161, s[40:43], s32 offen sc1
    s_waitcnt vmcnt(4)
    v_cmp_eq_u32 vcc, -1, v116
    s_cbranch_vccz K3bf0_hm_ok
    buffer_load_dword v116, v161, s[40:43], s32 offen sc1
    s_waitcnt vmcnt(4)
    v_cmp_eq_u32 vcc, -1, v117
    s_cbranch_vccz K3bf0_hm_ok
    buffer_load_dword v117, v161, s[40:43], s32 offen sc1
    s_waitcnt vmcnt(4)
    v_cmp_eq_u32 vcc, -1, v118
    s_cbranch_vccz K3bf0_hm_ok
    buffer_load_dword v118, v161, s[40:43], s32 offen sc1
    s_waitcnt vmcnt(4)
    v_cmp_eq_u32 vcc, -1, v119
    s_cbranch_vccz K3bf0_hm_ok
    buffer_load_dword v119, v161, s[40:43], s32 offen sc1
    s_waitcnt vmcnt(4)
    v_cmp_eq_u32 vcc, -1, v120
    s_cbranch_vccz K3bf0_hm_ok
    s_add_u32 s27, s27, 1
    s_cmp_gt_u32 s27, 65536
    s_cbranch_scc0 K3bf0_hm
    s_branch K3_bail
K3bf0_hm_ok:
    s_mov_b32 s27, 0
K3bf0_go:
    s_mov_b32 s97, 155648
    s_mov_b32 m0, s97
    s_nop 0
    buffer_load_dwordx4 v4, s[40:43], s32 offen offset:0 sc1 lds
    buffer_load_dwordx4 v4, s[40:43], s32 offen offset:1024 sc1 lds
    buffer_load_dwordx4 v4, s[40:43], s32 offen offset:2048 sc1 lds
    buffer_load_dwordx4 v4, s[40:43], s32 offen offset:3072 sc1 lds
    s_add_u32 m0, m0, 4096
    s_nop 0
    buffer_load_dwordx4 v4, s[40:43], s34 offen offset:0 sc1 lds
    buffer_load_dwordx4 v4, s[40:43], s34 offen offset:1024 sc1 lds
    buffer_load_dwordx4 v4, s[40:43], s34 offen offset:2048 sc1 lds
    s_waitcnt vmcnt(0)
K3bf0_join:
    s_barrier
    ds_read_b128 v[8:11], v162 offset:0
    ds_read_b128 v[12:15], v162 offset:1024
    ds_read_b128 v[16:19], v162 offset:2048
    ds_read_b128 v[20:23], v162 offset:3072
    ds_read_b128 v[24:27], v162 offset:4096
    ds_read_b128 v[28:31], v162 offset:5120
    ds_read_b128 v[32:35], v162 offset:6144
    s_waitcnt lgkmcnt(6)
    v_smfmac_f32_16x16x64_bf16 v[36:39], v[8:11], a[0:7], v160
    s_waitcnt lgkmcnt(5)
    v_smfmac_f32_16x16x64_bf16 v[36:39], v[12:15], a[8:15], v160
    s_waitcnt lgkmcnt(4)
    v_smfmac_f32_16x16x64_bf16 v[36:39], v[16:19], a[16:23], v160
    s_waitcnt lgkmcnt(3)
    v_smfmac_f32_16x16x64_bf16 v[36:39], v[20:23], a[24:31], v160
    s_waitcnt lgkmcnt(2)
    v_smfmac_f32_16x16x64_bf16 v[36:39], v[24:27], a[32:39], v160
    s_waitcnt lgkmcnt(1)
    v_smfmac_f32_16x16x64_bf16 v[36:39], v[28:31], a[40:47], v160
    s_waitcnt lgkmcnt(0)
    v_smfmac_f32_16x16x64_bf16 v[36:39], v[32:35], a[48:55], v160
    v_smfmac_f32_16x16x64_bf16 v[40:43], v[8:11], a[56:63], v160
    v_smfmac_f32_16x16x64_bf16 v[40:43], v[12:15], a[64:71], v160
    v_smfmac_f32_16x16x64_bf16 v[40:43], v[16:19], a[72:79], v160
    v_smfmac_f32_16x16x64_bf16 v[40:43], v[20:23], a[80:87], v160
    s_nop 3
    v_add_f32 v36, v36, v37
    v_smfmac_f32_16x16x64_bf16 v[40:43], v[24:27], a[88:95], v160
    v_add_f32 v38, v38, v39
    v_smfmac_f32_16x16x64_bf16 v[40:43], v[28:31], a[96:103], v160
    v_cmp_u_f32 vcc, v36, v38
    v_smfmac_f32_16x16x64_bf16 v[40:43], v[32:35], a[104:111], v160
    s_cbranch_vccnz K3bf0_slowm
K3bf0_backm:
    s_waitcnt lgkmcnt(6)
    v_smfmac_f32_16x16x64_bf16 v[60:63], v[8:11], v[68:75], v160
    s_mov_b32 m0, s31
    s_nop 0
    buffer_load_dwordx4 v4, s[48:51], s30 offen offset:0 sc1 lds
    v_smfmac_f32_16x16x64_bf16 v[44:47], v[8:11], a[112:119], v160
    ds_read_b128 v[68:71], v5 offset:8192
    ds_read_b128 v[72:75], v5 offset:9216
    s_waitcnt lgkmcnt(6)
    v_smfmac_f32_16x16x64_bf16 v[60:63], v[12:15], v[76:83], v160
    buffer_load_dwordx4 v4, s[48:51], s30 offen offset:1024 sc1 lds
    v_smfmac_f32_16x16x64_bf16 v[44:47], v[12:15], a[120:127], v160
    ds_read_b128 v[76:79], v5 offset:10240
    ds_read_b128 v[80:83], v5 offset:11264
    s_waitcnt lgkmcnt(6)
    v_smfmac_f32_16x16x64_bf16 v[60:63], v[16:19], v[84:91], v160
    buffer_load_dwordx4 v4, s[48:51], s30 offen offset:2048 sc1 lds
    v_smfmac_f32_16x16x64_bf16 v[44:47], v[16:19], a[128:135], v160
    ds_read_b128 v[84:87], v5 offset:12288
    ds_read_b128 v[88:91], v5 offset:13312
    s_waitcnt lgkmcnt(6)
    v_smfmac_f32_16x16x64_bf16 v[60:63], v[20:23], v[92:99], v160
    buffer_load_dwordx4 v4, s[48:51], s30 offen offset:3072 sc1 lds
    v_smfmac_f32_16x16x64_bf16 v[44:47], v[20:23], a[136:143], v160
    ds_read_b128 v[92:95], v5 offset:14336
    ds_read_b128 v[96:99], v5 offset:15360
    s_waitcnt lgkmcnt(6)
    v_smfmac_f32_16x16x64_bf16 v[60:63], v[24:27], v[68:75], v160
    s_add_u32 m0, m0, 4096
    s_nop 0
    buffer_load_dwordx4 v4, s[48:51], s29 offen offset:0 sc1 lds
    v_smfmac_f32_16x16x64_bf16 v[44:47], v[24:27], a[144:151], v160
    ds_read_b128 v[68:71], v5 offset:16384
    ds_read_b128 v[72:75], v5 offset:17408
    s_waitcnt lgkmcnt(6)
    v_smfmac_f32_16x16x64_bf16 v[60:63], v[28:31], v[76:83], v160
    buffer_load_dwordx4 v4, s[48:51], s29 offen offset:1024 sc1 lds
    v_smfmac_f32_16x16x64_bf16 v[44:47], v[28:31], a[152:159], v160
    ds_read_b128 v[76:79], v5 offset:18432
    ds_read_b128 v[80:83], v5 offset:19456
    s_waitcnt lgkmcnt(6)
    v_smfmac_f32_16x16x64_bf16 v[60:63], v[32:35], v[84:91], v160
    buffer_load_dwordx4 v4, s[48:51], s29 offen offset:2048 sc1 lds
    v_smfmac_f32_16x16x64_bf16 v[44:47], v[32:35], a[160:167], v160
    ds_read_b128 v[84:87], v5 offset:20480
    ds_read_b128 v[88:91], v5 offset:21504
    s_waitcnt lgkmcnt(6)
    v_smfmac_f32_16x16x64_bf16 v[64:67], v[8:11], v[92:99], v160
    buffer_load_dwordx4 v4, s[48:51], s29 offen offset:3072 sc1 lds
    v_smfmac_f32_16x16x64_bf16 v[48:51], v[8:11], a[168:175], v160
    ds_read_b128 v[92:95], v5 offset:22528
    ds_read_b128 v[96:99], v5 offset:23552
    s_waitcnt lgkmcnt(6)
    v_smfmac_f32_16x16x64_bf16 v[64:67], v[12:15], v[68:75], v160
    buffer_load_dword v0, v163, s[68:71], s33 offen sc1
    v_smfmac_f32_16x16x64_bf16 v[48:51], v[12:15], a[176:183], v160
    ds_read_b128 v[68:71], v5 offset:24576
    ds_read_b128 v[72:75], v5 offset:25600
    s_waitcnt lgkmcnt(6)
    v_smfmac_f32_16x16x64_bf16 v[64:67], v[16:19], v[76:83], v160
    v_smfmac_f32_16x16x64_bf16 v[48:51], v[16:19], a[184:191], v160
    ds_read_b128 v[76:79], v5 offset:26624
    ds_read_b128 v[80:83], v5 offset:27648
    s_waitcnt lgkmcnt(6)
    v_smfmac_f32_16x16x64_bf16 v[64:67], v[20:23], v[84:91], v160
    v_smfmac_f32_16x16x64_bf16 v[48:51], v[20:23], a[192:199], v160
    s_waitcnt lgkmcnt(4)
    v_smfmac_f32_16x16x64_bf16 v[64:67], v[24:27], v[92:99], v160
    v_smfmac_f32_16x16x64_bf16 v[48:51], v[24:27], a[200:207], v160
    s_waitcnt lgkmcnt(2)
    v_smfmac_f32_16x16x64_bf16 v[64:67], v[28:31], v[68:75], v160
    v_smfmac_f32_16x16x64_bf16 v[48:51], v[28:31], a[208:215], v160
    s_waitcnt lgkmcnt(0)
    v_smfmac_f32_16x16x64_bf16 v[64:67], v[32:35], v[76:83], v160
    v_smfmac_f32_16x16x64_bf16 v[48:51], v[32:35], a[216:223], v160
    v_smfmac_f32_16x16x64_bf16 v[52:55], v[8:11], a[224:231], v160
    v_cvt_pk_bf16_f32 v164, v36, v38
    v_smfmac_f32_16x16x64_bf16 v[56:59], v[8:11], v[200:207], v160
    v_add_f32 v40, v40, v41
    v_smfmac_f32_16x16x64_bf16 v[52:55], v[12:15], a[232:239], v160
    v_add_f32 v42, v42, v43
    v_smfmac_f32_16x16x64_bf16 v[56:59], v[12:15], v[208:215], v160
    v_cvt_pk_bf16_f32 v165, v40, v42
    v_smfmac_f32_16x16x64_bf16 v[52:55], v[16:19], a[240:247], v160
    v_add_f32 v44, v44, v45
    v_smfmac_f32_16x16x64_bf16 v[56:59], v[16:19], v[216:223], v160
    v_add_f32 v46, v46, v47
    v_smfmac_f32_16x16x64_bf16 v[52:55], v[20:23], a[248:255], v160
    v_cvt_pk_bf16_f32 v166, v44, v46
    v_smfmac_f32_16x16x64_bf16 v[56:59], v[20:23], v[224:231], v160
    v_add_f32 v60, v60, v61
    v_smfmac_f32_16x16x64_bf16 v[52:55], v[24:27], v[176:183], v160
    v_add_f32 v62, v62, v63
    v_smfmac_f32_16x16x64_bf16 v[56:59], v[24:27], v[232:239], v160
    v_cvt_pk_bf16_f32 v170, v60, v62
    v_smfmac_f32_16x16x64_bf16 v[52:55], v[28:31], v[184:191], v160
    v_add_f32 v48, v48, v49
    v_smfmac_f32_16x16x64_bf16 v[56:59], v[28:31], v[240:247], v160
    v_add_f32 v50, v50, v51
    v_smfmac_f32_16x16x64_bf16 v[52:55], v[32:35], v[192:199], v160
    v_cvt_pk_bf16_f32 v167, v48, v50
    v_smfmac_f32_16x16x64_bf16 v[56:59], v[32:35], v[248:255], v160
    ds_write_b128 v174, v[164:167]
    v_add_f32 v64, v64, v65
    v_add_f32 v66, v66, v67
    v_cvt_pk_bf16_f32 v171, v64, v66
    s_nop 1
    v_add_f32 v52, v52, v53
    v_add_f32 v54, v54, v55
    v_cvt_pk_bf16_f32 v168, v52, v54
    v_add_f32 v56, v56, v57
    v_add_f32 v58, v58, v59
    v_cvt_pk_bf16_f32 v169, v56, v58
    ds_write_b128 v174, v[168:171] offset:4096
    s_waitcnt vmcnt(0) lgkmcnt(0)
    s_barrier
    s_cmp_ge_u32 s3, 2
    s_cbranch_scc1 K3bf0_idle
    s_lshl_b32 s28, s24, 12
    s_add_u32 s28, s28, s66
    v_add_u32 v163, s28, v4
    ds_read_b128 v[36:39], v6 offset:0
    ds_read_b128 v[40:43], v6 offset:1024
    ds_read_b128 v[44:47], v6 offset:2048
    ds_read_b128 v[48:51], v6 offset:3072
    ds_read_b128 v[52:55], v6 offset:4096
    ds_read_b128 v[56:59], v6 offset:5120
    ds_read_b128 v[60:63], v6 offset:6144
    ds_read_b128 v[64:67], v6 offset:7168
    ds_read_b128 v[68:71], v6 offset:8192
    ds_read_b128 v[72:75], v6 offset:9216
    ds_read_b128 v[76:79], v6 offset:10240
    ds_read_b128 v[80:83], v6 offset:11264
    s_waitcnt lgkmcnt(4)
    ds_read_b128 v[84:87], v6 offset:12288
    ds_read_b128 v[88:91], v6 offset:13312
    ds_read_b128 v[92:95], v6 offset:14336
    ds_read_b128 v[96:99], v6 offset:15360
    ds_read_b128 v[100:103], v163 offset:0
    ds_read_b128 v[104:107], v163 offset:1024
    ds_read_b128 v[108:111], v163 offset:2048
    ds_read_b128 v[112:115], v163 offset:3072
    v_mov_b32 v156, 0
    v_mov_b32 v157, 0
    v_mov_b32 v158, 0
    v_mov_b32 v159, 0
    s_mul_i32 s28, s64, 10240
    s_add_u32 s29, s28, 4096
    s_add_u32 s30, s28, 8192
    s_add_u32 s34, s32, 8192
    s_mov_b32 s27, 0
    s_waitcnt lgkmcnt(0)
    s_cmp_lg_u32 s3, 0
    s_cbranch_scc1 K3bf0_hp_ok
    s_mov_b32 s23, 0
    buffer_load_dword v116, v172, s[40:43], s32 offen sc1
    buffer_load_dword v117, v172, s[40:43], s32 offen sc1
    buffer_load_dword v118, v172, s[40:43], s32 offen sc1
    buffer_load_dword v119, v172, s[40:43], s32 offen sc1
K3bf0_hp:
    buffer_load_dword v120, v172, s[40:43], s32 offen sc1
    s_waitcnt vmcnt(4)
    v_cmp_eq_u32 vcc, -1, v116
    s_cbranch_vccz K3bf0_hp_ok
    buffer_load_dword v116, v172, s[40:43], s32 offen sc1
    s_waitcnt vmcnt(4)
    v_cmp_eq_u32 vcc, -1, v117
    s_cbranch_vccz K3bf0_hp_ok
    buffer_load_dword v117, v172, s[40:43], s32 offen sc1
    s_waitcnt vmcnt(4)
    v_cmp_eq_u32 vcc, -1, v118
    s_cbranch_vccz K3bf0_hp_ok
    buffer_load_dword v118, v172, s[40:43], s32 offen sc1
    s_waitcnt vmcnt(4)
    v_cmp_eq_u32 vcc, -1, v119
    s_cbranch_vccz K3bf0_hp_ok
    buffer_load_dword v119, v172, s[40:43], s32 offen sc1
    s_waitcnt vmcnt(4)
    v_cmp_eq_u32 vcc, -1, v120
    s_cbranch_vccz K3bf0_hp_ok
    s_add_u32 s23, s23, 1
    s_cmp_gt_u32 s23, 65536
    s_cbranch_scc0 K3bf0_hp
    s_branch K3_bail
K3bf0_hp_ok:
    s_barrier
K3bf0_gop:
    buffer_load_dwordx4 v[148:151], v4, s[44:47], s30 offen offset:0
    buffer_load_dwordx4 v[152:155], v4, s[44:47], s30 offen offset:1024
    buffer_load_dwordx4 v[116:119], v4, s[44:47], s28 offen offset:0
    buffer_load_dwordx4 v[120:123], v4, s[44:47], s28 offen offset:1024
    buffer_load_dwordx4 v[124:127], v4, s[44:47], s28 offen offset:2048
    buffer_load_dwordx4 v[128:131], v4, s[44:47], s28 offen offset:3072
    buffer_load_dwordx4 v[132:135], v4, s[44:47], s29 offen offset:0
    buffer_load_dwordx4 v[136:139], v4, s[44:47], s29 offen offset:1024
    buffer_load_dwordx4 v[140:143], v4, s[44:47], s29 offen offset:2048
    buffer_load_dwordx4 v[144:147], v4, s[44:47], s29 offen offset:3072
K3bf0_gop2:
    s_waitcnt vmcnt(9)
    v_smfmac_f32_16x16x64_bf16 v[156:159], v[148:151], v[100:107], v160
    v_max_u32 v164, v148, v149
    s_waitcnt vmcnt(8)
    v_smfmac_f32_16x16x64_bf16 v[156:159], v[152:155], v[108:115], v160
    v_max3_u32 v164, v164, v152, v153
    v_cmp_eq_u32 vcc, -1, v164
    s_cbranch_vccnz K3bf0_early
    s_waitcnt vmcnt(7)
    v_smfmac_f32_16x16x64_bf16 v[156:159], v[116:119], v[36:43], v160
    s_waitcnt vmcnt(6)
    v_smfmac_f32_16x16x64_bf16 v[156:159], v[120:123], v[44:51], v160
    buffer_store_dword v175, v173, s[40:43], s32 offen
    s_waitcnt vmcnt(6)
    v_smfmac_f32_16x16x64_bf16 v[156:159], v[124:127], v[52:59], v160
    s_waitcnt vmcnt(5)
    v_smfmac_f32_16x16x64_bf16 v[156:159], v[128:131], v[60:67], v160
    s_waitcnt vmcnt(4)
    v_smfmac_f32_16x16x64_bf16 v[156:159], v[132:135], v[68:75], v160
    s_waitcnt vmcnt(3)
    v_smfmac_f32_16x16x64_bf16 v[156:159], v[136:139], v[76:83], v160
    s_waitcnt vmcnt(2)
    v_smfmac_f32_16x16x64_bf16 v[156:159], v[140:143], v[84:91], v160
    s_waitcnt vmcnt(1)
    v_smfmac_f32_16x16x64_bf16 v[156:159], v[144:147], v[92:99], v160
    s_nop 7
    v_add_f32 v156, v156, v157
    v_add_f32 v158, v158, v159
    v_cmp_u_f32 vcc, v156, v158
    v_cvt_pk_bf16_f32 v156, v156, v158
    s_cbranch_vccnz K3bf0_slowp
K3bf0_backp:
    buffer_store_short v156, v7, s[40:43], s34 offen
    buffer_store_short_d16_hi v156, v7, s[40:43], s34 offen offset:32
    s_cmp_lg_u32 s64, 62
    s_cbranch_scc1 K3bf0_next
    buffer_store_short v156, v7, s[76:79], s34 offen sc1
    buffer_store_short_d16_hi v156, v7, s[76:79], s34 offen offset:32 sc1
K3bf0_next:
    s_add_u32 s64, s64, 1
    s_cmp_lt_u32 s64, 63
    s_cbranch_scc1 K3bf0_loop
K3bf0_exit:
    s_branch K3_end
K3bf0_idle:
    s_waitcnt vmcnt(0)
    s_barrier
    s_branch K3bf0_next
K3bf0_slowm:
    s_waitcnt vmcnt(0)
    v_pk_max_u16 v164, v8, v9
    v_pk_max_u16 v164, v164, v10
    v_pk_max_u16 v164, v164, v11
    v_pk_max_u16 v164, v164, v12
    v_pk_max_u16 v164, v164, v13
    v_pk_max_u16 v164, v164, v14
    v_pk_max_u16 v164, v164, v15
    v_pk_max_u16 v164, v164, v16
    v_pk_max_u16 v164, v164, v17
    v_pk_max_u16 v164, v164, v18
    v_pk_max_u16 v164, v164, v19
    v_pk_max_u16 v164, v164, v20
    v_pk_max_u16 v164, v164, v21
    v_pk_max_u16 v164, v164, v22
    v_pk_max_u16 v164, v164, v23
    v_pk_max_u16 v164, v164, v24
    v_pk_max_u16 v164, v164, v25
    v_pk_max_u16 v164, v164, v26
    v_pk_max_u16 v164, v164, v27
    v_pk_max_u16 v164, v164, v28
    v_pk_max_u16 v164, v164, v29
    v_pk_max_u16 v164, v164, v30
    v_pk_max_u16 v164, v164, v31
    v_pk_max_u16 v164, v164, v32
    v_pk_max_u16 v164, v164, v33
    v_pk_max_u16 v164, v164, v34
    v_pk_max_u16 v164, v164, v35
    v_lshlrev_b32 v165, 16, v164
    v_max_u32 v164, v164, v165
    v_cmp_le_u32 vcc, s26, v164
    s_cbranch_vccz K3bf0_backm
    s_add_u32 s27, s27, 1
    s_cmp_gt_u32 s27, 65536
    s_cbranch_scc1 K3_bail
    s_branch K3bf0_retrym
K3bf0_retrym:
    v_mov_b32 v36, 0
    v_mov_b32 v37, 0
    v_mov_b32 v38, 0
    v_mov_b32 v39, 0
    v_mov_b32 v40, 0
    v_mov_b32 v41, 0
    v_mov_b32 v42, 0
    v_mov_b32 v43, 0
    s_barrier
    s_cmp_lg_u32 s3, 2
    s_cbranch_scc1 K3bf0_join
    s_branch K3bf0_go
K3bf0_slowp:
    s_waitcnt vmcnt(0)
    v_pk_max_u16 v164, v116, v117
    v_pk_max_u16 v164, v164, v118
    v_pk_max_u16 v164, v164, v119
    v_pk_max_u16 v164, v164, v120
    v_pk_max_u16 v164, v164, v121
    v_pk_max_u16 v164, v164, v122
    v_pk_max_u16 v164, v164, v123
    v_pk_max_u16 v164, v164, v124
    v_pk_max_u16 v164, v164, v125
    v_pk_max_u16 v164, v164, v126
    v_pk_max_u16 v164, v164, v127
    v_pk_max_u16 v164, v164, v128
    v_pk_max_u16 v164, v164, v129
    v_pk_max_u16 v164, v164, v130
    v_pk_max_u16 v164, v164, v131
    v_pk_max_u16 v164, v164, v132
    v_pk_max_u16 v164, v164, v133
    v_pk_max_u16 v164, v164, v134
    v_pk_max_u16 v164, v164, v135
    v_pk_max_u16 v164, v164, v136
    v_pk_max_u16 v164, v164, v137
    v_pk_max_u16 v164, v164, v138
    v_pk_max_u16 v164, v164, v139
    v_pk_max_u16 v164, v164, v140
    v_pk_max_u16 v164, v164, v141
    v_pk_max_u16 v164, v164, v142
    v_pk_max_u16 v164, v164, v143
    v_pk_max_u16 v164, v164, v144
    v_pk_max_u16 v164, v164, v145
    v_pk_max_u16 v164, v164, v146
    v_pk_max_u16 v164, v164, v147
    v_pk_max_u16 v164, v164, v148
    v_pk_max_u16 v164, v164, v149
    v_pk_max_u16 v164, v164, v150
    v_pk_max_u16 v164, v164, v151
    v_pk_max_u16 v164, v164, v152
    v_pk_max_u16 v164, v164, v153
    v_pk_max_u16 v164, v164, v154
    v_pk_max_u16 v164, v164, v155
    v_lshlrev_b32 v165, 16, v164
    v_max_u32 v164, v164, v165
    v_cmp_le_u32 vcc, s26, v164
    s_cbranch_vccz K3bf0_nanp
    s_add_u32 s27, s27, 1
    s_cmp_gt_u32 s27, 65536
    s_cbranch_scc1 K3_bail
    s_branch K3bf0_retryp
K3bf0_nanp:
    v_pk_min_u16 v156, v156, s25
    s_branch K3bf0_backp
K3bf0_early:
    s_add_u32 s27, s27, 1
    s_cmp_gt_u32 s27, 65536
    s_cbranch_scc1 K3_bail
    s_waitcnt vmcnt(0)
    s_nop 7
K3bf0_retryp:
    v_mov_b32 v156, 0
    v_mov_b32 v157, 0
    v_mov_b32 v158, 0
    v_mov_b32 v159, 0
    buffer_load_dwordx4 v[148:151], v4, s[44:47], s30 offen offset:0 sc1
    buffer_load_dwordx4 v[152:155], v4, s[44:47], s30 offen offset:1024 sc1
    buffer_load_dwordx4 v[116:119], v4, s[44:47], s28 offen offset:0 sc1
    buffer_load_dwordx4 v[120:123], v4, s[44:47], s28 offen offset:1024 sc1
    buffer_load_dwordx4 v[124:127], v4, s[44:47], s28 offen offset:2048 sc1
    buffer_load_dwordx4 v[128:131], v4, s[44:47], s28 offen offset:3072 sc1
    buffer_load_dwordx4 v[132:135], v4, s[44:47], s29 offen offset:0 sc1
    buffer_load_dwordx4 v[136:139], v4, s[44:47], s29 offen offset:1024 sc1
    buffer_load_dwordx4 v[140:143], v4, s[44:47], s29 offen offset:2048 sc1
    buffer_load_dwordx4 v[144:147], v4, s[44:47], s29 offen offset:3072 sc1
    s_branch K3bf0_gop2
K3bf1_loop:
    v_mov_b32 v36, 0
    v_mov_b32 v37, 0
    v_mov_b32 v38, 0
    v_mov_b32 v39, 0
    v_mov_b32 v40, 0
    v_mov_b32 v41, 0
    v_mov_b32 v42, 0
    v_mov_b32 v43, 0
    v_mov_b32 v44, 0
    v_mov_b32 v45, 0
    v_mov_b32 v46, 0
    v_mov_b32 v47, 0
    v_mov_b32 v48, 0
    v_mov_b32 v49, 0
    v_mov_b32 v50, 0
    v_mov_b32 v51, 0
    v_mov_b32 v52, 0
    v_mov_b32 v53, 0
    v_mov_b32 v54, 0
    v_mov_b32 v55, 0
    v_mov_b32 v56, 0
    v_mov_b32 v57, 0
    v_mov_b32 v58, 0
    v_mov_b32 v59, 0
    v_mov_b32 v60, 0
    v_mov_b32 v61, 0
    v_mov_b32 v62, 0
    v_mov_b32 v63, 0
    v_mov_b32 v64, 0
    v_mov_b32 v65, 0
    v_mov_b32 v66, 0
    v_mov_b32 v67, 0
    ds_read_b128 v[68:71], v5 offset:0
    ds_read_b128 v[72:75], v5 offset:1024
    ds_read_b128 v[76:79], v5 offset:2048
    ds_read_b128 v[80:83], v5 offset:3072
    ds_read_b128 v[84:87], v5 offset:4096
    ds_read_b128 v[88:91], v5 offset:5120
    ds_read_b128 v[92:95], v5 offset:6144
    ds_read_b128 v[96:99], v5 offset:7168
    s_lshl_b32 s32, s64, 13
    s_add_u32 s34, s32, 4096
    s_mul_i32 s30, s64, 458752
    s_lshl_b32 s31, s22, 15
    s_add_u32 s30, s30, s31
    s_lshl_b32 s31, s3, 13
    s_add_u32 s30, s30, s31
    s_add_u32 s29, s30, 4096
    s_add_u32 s31, s31, 114688
    s_lshl_b32 s28, s3, 10
    s_add_u32 s28, s28, s66
    v_add_u32 v174, s28, v4
    v_lshlrev_b32 v163, 3, v4
    v_min_u32 v163, 1920, v163
    v_add_u32 v163, 2048, v163
    s_lshl_b32 s28, s64, 13
    s_add_u32 s33, s28, 8192
    s_mov_b32 s72, 0x40000000
    s_cmp_lg_u32 s3, 3
    s_cbranch_scc1 K3bf1_wv_x
    v_cmp_ne_u32 vcc, s96, v0
    s_cbranch_vccz K3bf1_wv_ok
    s_mov_b32 s27, 0
K3bf1_wv:
    buffer_load_dword v116, v163, s[68:71], s28 offen sc1
    s_add_u32 s27, s27, 1
    s_cmp_gt_u32 s27, 65536
    s_cbranch_scc1 K3_bail
    s_waitcnt vmcnt(0)
    v_cmp_ne_u32 vcc, s96, v116
    s_cbranch_vccz K3bf1_wv_ok
    s_sleep 2
    s_branch K3bf1_wv
K3bf1_wv_ok:
K3bf1_wv_x:
    s_mov_b32 s27, 0
    s_waitcnt lgkmcnt(0)
    s_cmp_lg_u32 s3, 2
    s_cbranch_scc1 K3bf1_join
    s_cmp_eq_u32 s64, 0
    s_cbranch_scc1 K3bf1_hm_ok
    s_mov_b32 s27, 0
    buffer_load_dword v116, v161, s[40:43], s32 offen sc1
    buffer_load_dword v117, v161, s[40:43], s32 offen sc1
    buffer_load_dword v118, v161, s[40:43], s32 offen sc1
    buffer_load_dword v119, v161, s[40:43], s32 offen sc1
K3bf1_hm:
    buffer_load_dword v120, v161, s[40:43], s32 offen sc1
    s_waitcnt vmcnt(4)
    v_cmp_eq_u32 vcc, -1, v116
    s_cbranch_vccz K3bf1_hm_ok
    buffer_load_dword v116, v161, s[40:43], s32 offen sc1
    s_waitcnt vmcnt(4)
    v_cmp_eq_u32 vcc, -1, v117
    s_cbranch_vccz K3bf1_hm_ok
    buffer_load_dword v117, v161, s[40:43], s32 offen sc1
    s_waitcnt vmcnt(4)
    v_cmp_eq_u32 vcc, -1, v118
    s_cbranch_vccz K3bf1_hm_ok
    buffer_load_dword v118, v161, s[40:43], s32 offen sc1
    s_waitcnt vmcnt(4)
    v_cmp_eq_u32 vcc, -1, v119
    s_cbranch_vccz K3bf1_hm_ok
    buffer_load_dword v119, v161, s[40:43], s32 offen sc1
    s_waitcnt vmcnt(4)
    v_cmp_eq_u32 vcc, -1, v120
    s_cbranch_vccz K3bf1_hm_ok
    s_add_u32 s27, s27, 1
    s_cmp_gt_u32 s27, 65536
    s_cbranch_scc0 K3bf1_hm
    s_branch K3_bail
K3bf1_hm_ok:
    s_mov_b32 s27, 0
K3bf1_go:
    s_mov_b32 s97, 155648
    s_mov_b32 m0, s97
    s_nop 0
    buffer_load_dwordx4 v4, s[40:43], s32 offen offset:0 sc1 lds
    buffer_load_dwordx4 v4, s[40:43], s32 offen offset:1024 sc1 lds
    buffer_load_dwordx4 v4, s[40:43], s32 offen offset:2048 sc1 lds
    buffer_load_dwordx4 v4, s[40:43], s32 offen offset:3072 sc1 lds
    s_add_u32 m0, m0, 4096
    s_nop 0
    buffer_load_dwordx4 v4, s[40:43], s34 offen offset:0 sc1 lds
    buffer_load_dwordx4 v4, s[40:43], s34 offen offset:1024 sc1 lds
    buffer_load_dwordx4 v4, s[40:43], s34 offen offset:2048 sc1 lds
    s_waitcnt vmcnt(0)
K3bf1_join:
    s_barrier
    ds_read_b128 v[8:11], v162 offset:0
    ds_read_b128 v[12:15], v162 offset:1024
    ds_read_b128 v[16:19], v162 offset:2048
    ds_read_b128 v[20:23], v162 offset:3072
    ds_read_b128 v[24:27], v162 offset:4096
    ds_read_b128 v[28:31], v162 offset:5120
    ds_read_b128 v[32:35], v162 offset:6144
    s_waitcnt lgkmcnt(6)
    v_smfmac_f32_16x16x64_bf16 v[36:39], v[8:11], a[0:7], v160
    s_waitcnt lgkmcnt(5)
    v_smfmac_f32_16x16x64_bf16 v[36:39], v[12:15], a[8:15], v160
    s_waitcnt lgkmcnt(4)
    v_smfmac_f32_16x16x64_bf16 v[36:39], v[16:19], a[16:23], v160
    s_waitcnt lgkmcnt(3)
    v_smfmac_f32_16x16x64_bf16 v[36:39], v[20:23], a[24:31], v160
    s_waitcnt lgkmcnt(2)
    v_smfmac_f32_16x16x64_bf16 v[36:39], v[24:27], a[32:39], v160
    s_waitcnt lgkmcnt(1)
    v_smfmac_f32_16x16x64_bf16 v[36:39], v[28:31], a[40:47], v160
    s_waitcnt lgkmcnt(0)
    v_smfmac_f32_16x16x64_bf16 v[36:39], v[32:35], a[48:55], v160
    v_smfmac_f32_16x16x64_bf16 v[40:43], v[8:11], a[56:63], v160
    v_smfmac_f32_16x16x64_bf16 v[40:43], v[12:15], a[64:71], v160
    v_smfmac_f32_16x16x64_bf16 v[40:43], v[16:19], a[72:79], v160
    v_smfmac_f32_16x16x64_bf16 v[40:43], v[20:23], a[80:87], v160
    s_nop 3
    v_add_f32 v36, v36, v37
    v_smfmac_f32_16x16x64_bf16 v[40:43], v[24:27], a[88:95], v160
    v_add_f32 v38, v38, v39
    v_smfmac_f32_16x16x64_bf16 v[40:43], v[28:31], a[96:103], v160
    v_cmp_u_f32 vcc, v36, v38
    v_smfmac_f32_16x16x64_bf16 v[40:43], v[32:35], a[104:111], v160
    s_cbranch_vccnz K3bf1_slowm
K3bf1_backm:
    s_waitcnt lgkmcnt(6)
    v_smfmac_f32_16x16x64_bf16 v[60:63], v[8:11], v[68:75], v160
    s_mov_b32 m0, s31
    s_nop 0
    buffer_load_dwordx4 v4, s[48:51], s30 offen offset:0 sc1 lds
    v_smfmac_f32_16x16x64_bf16 v[44:47], v[8:11], a[112:119], v160
    ds_read_b128 v[68:71], v5 offset:8192
    ds_read_b128 v[72:75], v5 offset:9216
    s_waitcnt lgkmcnt(6)
    v_smfmac_f32_16x16x64_bf16 v[60:63], v[12:15], v[76:83], v160
    buffer_load_dwordx4 v4, s[48:51], s30 offen offset:1024 sc1 lds
    v_smfmac_f32_16x16x64_bf16 v[44:47], v[12:15], a[120:127], v160
    ds_read_b128 v[76:79], v5 offset:10240
    ds_read_b128 v[80:83], v5 offset:11264
    s_waitcnt lgkmcnt(6)
    v_smfmac_f32_16x16x64_bf16 v[60:63], v[16:19], v[84:91], v160
    buffer_load_dwordx4 v4, s[48:51], s30 offen offset:2048 sc1 lds
    v_smfmac_f32_16x16x64_bf16 v[44:47], v[16:19], a[128:135], v160
    ds_read_b128 v[84:87], v5 offset:12288
    ds_read_b128 v[88:91], v5 offset:13312
    s_waitcnt lgkmcnt(6)
    v_smfmac_f32_16x16x64_bf16 v[60:63], v[20:23], v[92:99], v160
    buffer_load_dwordx4 v4, s[48:51], s30 offen offset:3072 sc1 lds
    v_smfmac_f32_16x16x64_bf16 v[44:47], v[20:23], a[136:143], v160
    ds_read_b128 v[92:95], v5 offset:14336
    ds_read_b128 v[96:99], v5 offset:15360
    s_waitcnt lgkmcnt(6)
    v_smfmac_f32_16x16x64_bf16 v[60:63], v[24:27], v[68:75], v160
    s_add_u32 m0, m0, 4096
    s_nop 0
    buffer_load_dwordx4 v4, s[48:51], s29 offen offset:0 sc1 lds
    v_smfmac_f32_16x16x64_bf16 v[44:47], v[24:27], a[144:151], v160
    ds_read_b128 v[68:71], v5 offset:16384
    ds_read_b128 v[72:75], v5 offset:17408
    s_waitcnt lgkmcnt(6)
    v_smfmac_f32_16x16x64_bf16 v[60:63], v[28:31], v[76:83], v160
    buffer_load_dwordx4 v4, s[48:51], s29 offen offset:1024 sc1 lds
    v_smfmac_f32_16x16x64_bf16 v[44:47], v[28:31], a[152:159], v160
    ds_read_b128 v[76:79], v5 offset:18432
    ds_read_b128 v[80:83], v5 offset:19456
    s_waitcnt lgkmcnt(6)
    v_smfmac_f32_16x16x64_bf16 v[60:63], v[32:35], v[84:91], v160
    buffer_load_dwordx4 v4, s[48:51], s29 offen offset:2048 sc1 lds
    v_smfmac_f32_16x16x64_bf16 v[44:47], v[32:35], a[160:167], v160
    ds_read_b128 v[84:87], v5 offset:20480
    ds_read_b128 v[88:91], v5 offset:21504
    s_waitcnt lgkmcnt(6)
    v_smfmac_f32_16x16x64_bf16 v[64:67], v[8:11], v[92:99], v160
    buffer_load_dwordx4 v4, s[48:51], s29 offen offset:3072 sc1 lds
    v_smfmac_f32_16x16x64_bf16 v[48:51], v[8:11], a[168:175], v160
    ds_read_b128 v[92:95], v5 offset:22528
    ds_read_b128 v[96:99], v5 offset:23552
    s_waitcnt lgkmcnt(6)
    v_smfmac_f32_16x16x64_bf16 v[64:67], v[12:15], v[68:75], v160
    buffer_load_dword v0, v163, s[68:71], s33 offen sc1
    v_smfmac_f32_16x16x64_bf16 v[48:51], v[12:15], a[176:183], v160
    ds_read_b128 v[68:71], v5 offset:24576
    ds_read_b128 v[72:75], v5 offset:25600
    s_waitcnt lgkmcnt(6)
    v_smfmac_f32_16x16x64_bf16 v[64:67], v[16:19], v[76:83], v160
    v_smfmac_f32_16x16x64_bf16 v[48:51], v[16:19], a[184:191], v160
    ds_read_b128 v[76:79], v5 offset:26624
    ds_read_b128 v[80:83], v5 offset:27648
    s_waitcnt lgkmcnt(6)
    v_smfmac_f32_16x16x64_bf16 v[64:67], v[20:23], v[84:91], v160
    v_smfmac_f32_16x16x64_bf16 v[48:51], v[20:23], a[192:199], v160
    s_waitcnt lgkmcnt(4)
    v_smfmac_f32_16x16x64_bf16 v[64:67], v[24:27], v[92:99], v160
    v_smfmac_f32_16x16x64_bf16 v[48:51], v[24:27], a[200:207], v160
    s_waitcnt lgkmcnt(2)
    v_smfmac_f32_16x16x64_bf16 v[64:67], v[28:31], v[68:75], v160
    v_smfmac_f32_16x16x64_bf16 v[48:51], v[28:31], a[208:215], v160
    s_waitcnt lgkmcnt(0)
    v_smfmac_f32_16x16x64_bf16 v[64:67], v[32:35], v[76:83], v160
    v_smfmac_f32_16x16x64_bf16 v[48:51], v[32:35], a[216:223], v160
    v_smfmac_f32_16x16x64_bf16 v[52:55], v[8:11], a[224:231], v160
    v_cvt_pk_bf16_f32 v164, v36, v38
    v_smfmac_f32_16x16x64_bf16 v[56:59], v[8:11], v[200:207], v160
    v_add_f32 v40, v40, v41
    v_smfmac_f32_16x16x64_bf16 v[52:55], v[12:15], a[232:239], v160
    v_add_f32 v42, v42, v43
    v_smfmac_f32_16x16x64_bf16 v[56:59], v[12:15], v[208:215], v160
    v_cvt_pk_bf16_f32 v165, v40, v42
    v_smfmac_f32_16x16x64_bf16 v[52:55], v[16:19], a[240:247], v160
    v_add_f32 v44, v44, v45
    v_smfmac_f32_16x16x64_bf16 v[56:59], v[16:19], v[216:223], v160
    v_add_f32 v46, v46, v47
    v_smfmac_f32_16x16x64_bf16 v[52:55], v[20:23], a[248:255], v160
    v_cvt_pk_bf16_f32 v166, v44, v46
    v_smfmac_f32_16x16x64_bf16 v[56:59], v[20:23], v[224:231], v160
    v_add_f32 v60, v60, v61
    v_smfmac_f32_16x16x64_bf16 v[52:55], v[24:27], v[176:183], v160
    v_add_f32 v62, v62, v63
    v_smfmac_f32_16x16x64_bf16 v[56:59], v[24:27], v[232:239], v160
    v_cvt_pk_bf16_f32 v170, v60, v62
    v_smfmac_f32_16x16x64_bf16 v[52:55], v[28:31], v[184:191], v160
    v_add_f32 v48, v48, v49
    v_smfmac_f32_16x16x64_bf16 v[56:59], v[28:31], v[240:247], v160
    v_add_f32 v50, v50, v51
    v_smfmac_f32_16x16x64_bf16 v[52:55], v[32:35], v[192:199], v160
    v_cvt_pk_bf16_f32 v167, v48, v50
    v_smfmac_f32_16x16x64_bf16 v[56:59], v[32:35], v[248:255], v160
    ds_write_b128 v174, v[164:167]
    v_add_f32 v64, v64, v65
    v_add_f32 v66, v66, v67
    v_cvt_pk_bf16_f32 v171, v64, v66
    s_nop 1
    v_add_f32 v52, v52, v53
    v_add_f32 v54, v54, v55
    v_cvt_pk_bf16_f32 v168, v52, v54
    v_add_f32 v56, v56, v57
    v_add_f32 v58, v58, v59
    v_cvt_pk_bf16_f32 v169, v56, v58
    ds_write_b128 v174, v[168:171] offset:4096
    s_waitcnt vmcnt(0) lgkmcnt(0)
    s_barrier
    s_cmp_ge_u32 s3, 2
    s_cbranch_scc1 K3bf1_idle
    s_lshl_b32 s28, s24, 12
    s_add_u32 s28, s28, s66
    v_add_u32 v163, s28, v4
    ds_read_b128 v[36:39], v6 offset:0
    ds_read_b128 v[40:43], v6 offset:1024
    ds_read_b128 v[44:47], v6 offset:2048
    ds_read_b128 v[48:51], v6 offset:3072
    ds_read_b128 v[52:55], v6 offset:4096
    ds_read_b128 v[56:59], v6 offset:5120
    ds_read_b128 v[60:63], v6 offset:6144
    ds_read_b128 v[64:67], v6 offset:7168
    ds_read_b128 v[68:71], v6 offset:8192
    ds_read_b128 v[72:75], v6 offset:9216
    ds_read_b128 v[76:79], v6 offset:10240
    ds_read_b128 v[80:83], v6 offset:11264
    s_waitcnt lgkmcnt(4)
    ds_read_b128 v[84:87], v6 offset:12288
    ds_read_b128 v[88:91], v6 offset:13312
    ds_read_b128 v[92:95], v6 offset:14336
    ds_read_b128 v[96:99], v6 offset:15360
    ds_read_b128 v[100:103], v163 offset:0
    ds_read_b128 v[104:107], v163 offset:1024
    ds_read_b128 v[108:111], v163 offset:2048
    ds_read_b128 v[112:115], v163 offset:3072
    v_mov_b32 v156, 0
    v_mov_b32 v157, 0
    v_mov_b32 v158, 0
    v_mov_b32 v159, 0
    s_mul_i32 s28, s64, 10240
    s_add_u32 s29, s28, 4096
    s_add_u32 s30, s28, 8192
    s_add_u32 s34, s32, 8192
    s_mov_b32 s27, 0
    s_waitcnt lgkmcnt(0)
    s_cmp_lg_u32 s3, 0
    s_cbranch_scc1 K3bf1_hp_ok
    s_mov_b32 s23, 0
    buffer_load_dword v116, v172, s[40:43], s32 offen sc1
    buffer_load_dword v117, v172, s[40:43], s32 offen sc1
    buffer_load_dword v118, v172, s[40:43], s32 offen sc1
    buffer_load_dword v119, v172, s[40:43], s32 offen sc1
K3bf1_hp:
    buffer_load_dword v120, v172, s[40:43], s32 offen sc1
    s_waitcnt vmcnt(4)
    v_cmp_eq_u32 vcc, -1, v116
    s_cbranch_vccz K3bf1_hp_ok
    buffer_load_dword v116, v172, s[40:43], s32 offen sc1
    s_waitcnt vmcnt(4)
    v_cmp_eq_u32 vcc, -1, v117
    s_cbranch_vccz K3bf1_hp_ok
    buffer_load_dword v117, v172, s[40:43], s32 offen sc1
    s_waitcnt vmcnt(4)
    v_cmp_eq_u32 vcc, -1, v118
    s_cbranch_vccz K3bf1_hp_ok
    buffer_load_dword v118, v172, s[40:43], s32 offen sc1
    s_waitcnt vmcnt(4)
    v_cmp_eq_u32 vcc, -1, v119
    s_cbranch_vccz K3bf1_hp_ok
    buffer_load_dword v119, v172, s[40:43], s32 offen sc1
    s_waitcnt vmcnt(4)
    v_cmp_eq_u32 vcc, -1, v120
    s_cbranch_vccz K3bf1_hp_ok
    s_add_u32 s23, s23, 1
    s_cmp_gt_u32 s23, 65536
    s_cbranch_scc0 K3bf1_hp
    s_branch K3_bail
K3bf1_hp_ok:
    s_barrier
K3bf1_gop:
    buffer_load_dwordx4 v[148:151], v4, s[44:47], s30 offen offset:0 sc1
    buffer_load_dwordx4 v[152:155], v4, s[44:47], s30 offen offset:1024 sc1
    buffer_load_dwordx4 v[116:119], v4, s[44:47], s28 offen offset:0 sc1
    buffer_load_dwordx4 v[120:123], v4, s[44:47], s28 offen offset:1024 sc1
    buffer_load_dwordx4 v[124:127], v4, s[44:47], s28 offen offset:2048 sc1
    buffer_load_dwordx4 v[128:131], v4, s[44:47], s28 offen offset:3072 sc1
    buffer_load_dwordx4 v[132:135], v4, s[44:47], s29 offen offset:0 sc1
    buffer_load_dwordx4 v[136:139], v4, s[44:47], s29 offen offset:1024 sc1
    buffer_load_dwordx4 v[140:143], v4, s[44:47], s29 offen offset:2048 sc1
    buffer_load_dwordx4 v[144:147], v4, s[44:47], s29 offen offset:3072 sc1
K3bf1_gop2:
    s_waitcnt vmcnt(9)
    v_smfmac_f32_16x16x64_bf16 v[156:159], v[148:151], v[100:107], v160
    v_max_u32 v164, v148, v149
    s_waitcnt vmcnt(8)
    v_smfmac_f32_16x16x64_bf16 v[156:159], v[152:155], v[108:115], v160
    v_max3_u32 v164, v164, v152, v153
    v_cmp_eq_u32 vcc, -1, v164
    s_cbranch_vccnz K3bf1_early
    s_waitcnt vmcnt(7)
    v_smfmac_f32_16x16x64_bf16 v[156:159], v[116:119], v[36:43], v160
    s_waitcnt vmcnt(6)
    v_smfmac_f32_16x16x64_bf16 v[156:159], v[120:123], v[44:51], v160
    buffer_store_dword v175, v173, s[40:43], s32 offen sc1
    s_waitcnt vmcnt(6)
    v_smfmac_f32_16x16x64_bf16 v[156:159], v[124:127], v[52:59], v160
    s_waitcnt vmcnt(5)
    v_smfmac_f32_16x16x64_bf16 v[156:159], v[128:131], v[60:67], v160
    s_waitcnt vmcnt(4)
    v_smfmac_f32_16x16x64_bf16 v[156:159], v[132:135], v[68:75], v160
    s_waitcnt vmcnt(3)
    v_smfmac_f32_16x16x64_bf16 v[156:159], v[136:139], v[76:83], v160
    s_waitcnt vmcnt(2)
    v_smfmac_f32_16x16x64_bf16 v[156:159], v[140:143], v[84:91], v160
    s_waitcnt vmcnt(1)
    v_smfmac_f32_16x16x64_bf16 v[156:159], v[144:147], v[92:99], v160
    s_nop 7
    v_add_f32 v156, v156, v157
    v_add_f32 v158, v158, v159
    v_cmp_u_f32 vcc, v156, v158
    v_cvt_pk_bf16_f32 v156, v156, v158
    s_cbranch_vccnz K3bf1_slowp
K3bf1_backp:
    buffer_store_short v156, v7, s[40:43], s34 offen sc1
    buffer_store_short_d16_hi v156, v7, s[40:43], s34 offen offset:32 sc1
    s_cmp_lg_u32 s64, 62
    s_cbranch_scc1 K3bf1_next
    buffer_store_short v156, v7, s[76:79], s34 offen sc1
    buffer_store_short_d16_hi v156, v7, s[76:79], s34 offen offset:32 sc1
K3bf1_next:
    s_add_u32 s64, s64, 1
    s_cmp_lt_u32 s64, 63
    s_cbranch_scc1 K3bf1_loop
K3bf1_exit:
    s_branch K3_end
K3bf1_idle:
    s_waitcnt vmcnt(0)
    s_barrier
    s_branch K3bf1_next
K3bf1_slowm:
    s_waitcnt vmcnt(0)
    v_pk_max_u16 v164, v8, v9
    v_pk_max_u16 v164, v164, v10
    v_pk_max_u16 v164, v164, v11
    v_pk_max_u16 v164, v164, v12
    v_pk_max_u16 v164, v164, v13
    v_pk_max_u16 v164, v164, v14
    v_pk_max_u16 v164, v164, v15
    v_pk_max_u16 v164, v164, v16
    v_pk_max_u16 v164, v164, v17
    v_pk_max_u16 v164, v164, v18
    v_pk_max_u16 v164, v164, v19
    v_pk_max_u16 v164, v164, v20
    v_pk_max_u16 v164, v164, v21
    v_pk_max_u16 v164, v164, v22
    v_pk_max_u16 v164, v164, v23
    v_pk_max_u16 v164, v164, v24
    v_pk_max_u16 v164, v164, v25
    v_pk_max_u16 v164, v164, v26
    v_pk_max_u16 v164, v164, v27
    v_pk_max_u16 v164, v164, v28
    v_pk_max_u16 v164, v164, v29
    v_pk_max_u16 v164, v164, v30
    v_pk_max_u16 v164, v164, v31
    v_pk_max_u16 v164, v164, v32
    v_pk_max_u16 v164, v164, v33
    v_pk_max_u16 v164, v164, v34
    v_pk_max_u16 v164, v164, v35
    v_lshlrev_b32 v165, 16, v164
    v_max_u32 v164, v164, v165
    v_cmp_le_u32 vcc, s26, v164
    s_cbranch_vccz K3bf1_backm
    s_add_u32 s27, s27, 1
    s_cmp_gt_u32 s27, 65536
    s_cbranch_scc1 K3_bail
    s_branch K3bf1_retrym
K3bf1_retrym:
    v_mov_b32 v36, 0
    v_mov_b32 v37, 0
    v_mov_b32 v38, 0
    v_mov_b32 v39, 0
    v_mov_b32 v40, 0
    v_mov_b32 v41, 0
    v_mov_b32 v42, 0
    v_mov_b32 v43, 0
    s_barrier
    s_cmp_lg_u32 s3, 2
    s_cbranch_scc1 K3bf1_join
    s_branch K3bf1_go
K3bf1_slowp:
    s_waitcnt vmcnt(0)
    v_pk_max_u16 v164, v116, v117
    v_pk_max_u16 v164, v164, v118
    v_pk_max_u16 v164, v164, v119
    v_pk_max_u16 v164, v164, v120
    v_pk_max_u16 v164, v164, v121
    v_pk_max_u16 v164, v164, v122
    v_pk_max_u16 v164, v164, v123
    v_pk_max_u16 v164, v164, v124
    v_pk_max_u16 v164, v164, v125
    v_pk_max_u16 v164, v164, v126
    v_pk_max_u16 v164, v164, v127
    v_pk_max_u16 v164, v164, v128
    v_pk_max_u16 v164, v164, v129
    v_pk_max_u16 v164, v164, v130
    v_pk_max_u16 v164, v164, v131
    v_pk_max_u16 v164, v164, v132
    v_pk_max_u16 v164, v164, v133
    v_pk_max_u16 v164, v164, v134
    v_pk_max_u16 v164, v164, v135
    v_pk_max_u16 v164, v164, v136
    v_pk_max_u16 v164, v164, v137
    v_pk_max_u16 v164, v164, v138
    v_pk_max_u16 v164, v164, v139
    v_pk_max_u16 v164, v164, v140
    v_pk_max_u16 v164, v164, v141
    v_pk_max_u16 v164, v164, v142
    v_pk_max_u16 v164, v164, v143
    v_pk_max_u16 v164, v164, v144
    v_pk_max_u16 v164, v164, v145
    v_pk_max_u16 v164, v164, v146
    v_pk_max_u16 v164, v164, v147
    v_pk_max_u16 v164, v164, v148
    v_pk_max_u16 v164, v164, v149
    v_pk_max_u16 v164, v164, v150
    v_pk_max_u16 v164, v164, v151
    v_pk_max_u16 v164, v164, v152
    v_pk_max_u16 v164, v164, v153
    v_pk_max_u16 v164, v164, v154
    v_pk_max_u16 v164, v164, v155
    v_lshlrev_b32 v165, 16, v164
    v_max_u32 v164, v164, v165
    v_cmp_le_u32 vcc, s26, v164
    s_cbranch_vccz K3bf1_nanp
    s_add_u32 s27, s27, 1
    s_cmp_gt_u32 s27, 65536
    s_cbranch_scc1 K3_bail
    s_branch K3bf1_retryp
K3bf1_nanp:
    v_pk_min_u16 v156, v156, s25
    s_branch K3bf1_backp
K3bf1_early:
    s_add_u32 s27, s27, 1
    s_cmp_gt_u32 s27, 65536
    s_cbranch_scc1 K3_bail
    s_waitcnt vmcnt(0)
    s_nop 7
K3bf1_retryp:
    v_mov_b32 v156, 0
    v_mov_b32 v157, 0
    v_mov_b32 v158, 0
    v_mov_b32 v159, 0
    buffer_load_dwordx4 v[148:151], v4, s[44:47], s30 offen offset:0 sc1
    buffer_load_dwordx4 v[152:155], v4, s[44:47], s30 offen offset:1024 sc1
    buffer_load_dwordx4 v[116:119], v4, s[44:47], s28 offen offset:0 sc1
    buffer_load_dwordx4 v[120:123], v4, s[44:47], s28 offen offset:1024 sc1
    buffer_load_dwordx4 v[124:127], v4, s[44:47], s28 offen offset:2048 sc1
    buffer_load_dwordx4 v[128:131], v4, s[44:47], s28 offen offset:3072 sc1
    buffer_load_dwordx4 v[132:135], v4, s[44:47], s29 offen offset:0 sc1
    buffer_load_dwordx4 v[136:139], v4, s[44:47], s29 offen offset:1024 sc1
    buffer_load_dwordx4 v[140:143], v4, s[44:47], s29 offen offset:2048 sc1
    buffer_load_dwordx4 v[144:147], v4, s[44:47], s29 offen offset:3072 sc1
    s_branch K3bf1_gop2
K3_w:
    s_add_u32 s52, s18, 0x200000
    s_addc_u32 s53, s19, 0
    s_mov_b32 s54, 0x1c0000
    s_mov_b32 s55, 0x20000
    v_min_u32 v5, 27, v1
    v_lshlrev_b32 v5, 2, v5
    v_add_u32 v5, 7168, v5
    s_lshl_b32 s28, s3, 10
    v_add_u32 v6, s28, v4
    s_mov_b32 s64, 0
    v_mov_b32 v7, 0
    s_mov_b32 s28, 741376
    s_mov_b32 s27, 0
K3w_v0:
    buffer_load_dword v8, v7, s[56:59], s28 offen sc1
    s_add_u32 s27, s27, 1
    s_cmp_gt_u32 s27, 65536
    s_cbranch_scc1 K3_bail
    s_waitcnt vmcnt(0)
    v_cmp_ne_u32 vcc, s96, v8
    s_cbranch_vccz K3w_v0_ok
    s_sleep 4
    s_branch K3w_v0
K3w_v0_ok:
    s_mov_b32 s28, 0
    s_mov_b32 s30, 0
    buffer_load_dwordx4 v[16:19], v6, s[40:43], s28 offen sc1
    s_add_u32 s28, s28, 4096
    buffer_load_dwordx4 v[16:19], v6, s[40:43], s28 offen sc1
    s_add_u32 s28, s28, 4096
    buffer_load_dwordx4 v[16:19], v6, s[52:55], s30 offen sc1
    s_add_u32 s30, s30, 4096
    buffer_load_dwordx4 v[16:19], v6, s[52:55], s30 offen sc1
    s_add_u32 s30, s30, 4096
    buffer_load_dwordx4 v[16:19], v6, s[52:55], s30 offen sc1
    s_add_u32 s30, s30, 4096
    buffer_load_dwordx4 v[16:19], v6, s[52:55], s30 offen sc1
    s_add_u32 s30, s30, 4096
    buffer_load_dwordx4 v[16:19], v6, s[52:55], s30 offen sc1
    s_add_u32 s30, s30, 4096
    buffer_load_dwordx4 v[16:19], v6, s[52:55], s30 offen sc1
    s_add_u32 s30, s30, 4096
    buffer_load_dwordx4 v[16:19], v6, s[52:55], s30 offen sc1
    s_add_u32 s30, s30, 4096
    s_mov_b32 s33, 0
    s_lshl_b32 s28, s33, 13
    s_add_u32 s28, s28, 8192
    s_mul_i32 s29, s33, 10240
    s_mul_i32 s30, s33, 28672
    s_add_u32 s30, s30, 28672
    buffer_load_dwordx4 v[16:19], v6, s[40:43], s28 offen sc1
    s_add_u32 s28, s28, 4096
    buffer_load_dwordx4 v[16:19], v6, s[40:43], s28 offen sc1
    s_add_u32 s28, s28, 4096
    buffer_load_dwordx4 v[16:19], v6, s[44:47], s29 offen sc1
    s_add_u32 s29, s29, 4096
    buffer_load_dwordx4 v[16:19], v6, s[44:47], s29 offen sc1
    s_add_u32 s29, s29, 4096
    buffer_load_dwordx4 v[16:19], v6, s[44:47], s29 offen sc1
    s_add_u32 s29, s29, 4096
    buffer_load_dwordx4 v[16:19], v6, s[52:55], s30 offen sc1
    s_add_u32 s30, s30, 4096
    buffer_load_dwordx4 v[16:19], v6, s[52:55], s30 offen sc1
    s_add_u32 s30, s30, 4096
    buffer_load_dwordx4 v[16:19], v6, s[52:55], s30 offen sc1
    s_add_u32 s30, s30, 4096
    buffer_load_dwordx4 v[16:19], v6, s[52:55], s30 offen sc1
    s_add_u32 s30, s30, 4096
    buffer_load_dwordx4 v[16:19], v6, s[52:55], s30 offen sc1
    s_add_u32 s30, s30, 4096
    buffer_load_dwordx4 v[16:19], v6, s[52:55], s30 offen sc1
    s_add_u32 s30, s30, 4096
    buffer_load_dwordx4 v[16:19], v6, s[52:55], s30 offen sc1
    s_add_u32 s30, s30, 4096
    s_mov_b32 s33, 1
    s_lshl_b32 s28, s33, 13
    s_add_u32 s28, s28, 8192
    s_mul_i32 s29, s33, 10240
    s_mul_i32 s30, s33, 28672
    s_add_u32 s30, s30, 28672
    buffer_load_dwordx4 v[16:19], v6, s[40:43], s28 offen sc1
    s_add_u32 s28, s28, 4096
    buffer_load_dwordx4 v[16:19], v6, s[40:43], s28 offen sc1
    s_add_u32 s28, s28, 4096
    buffer_load_dwordx4 v[16:19], v6, s[44:47], s29 offen sc1
    s_add_u32 s29, s29, 4096
    buffer_load_dwordx4 v[16:19], v6, s[44:47], s29 offen sc1
    s_add_u32 s29, s29, 4096
    buffer_load_dwordx4 v[16:19], v6, s[44:47], s29 offen sc1
    s_add_u32 s29, s29, 4096
    buffer_load_dwordx4 v[16:19], v6, s[52:55], s30 offen sc1
    s_add_u32 s30, s30, 4096
    buffer_load_dwordx4 v[16:19], v6, s[52:55], s30 offen sc1
    s_add_u32 s30, s30, 4096
    buffer_load_dwordx4 v[16:19], v6, s[52:55], s30 offen sc1
    s_add_u32 s30, s30, 4096
    buffer_load_dwordx4 v[16:19], v6, s[52:55], s30 offen sc1
    s_add_u32 s30, s30, 4096
    buffer_load_dwordx4 v[16:19], v6, s[52:55], s30 offen sc1
    s_add_u32 s30, s30, 4096
    buffer_load_dwordx4 v[16:19], v6, s[52:55], s30 offen sc1
    s_add_u32 s30, s30, 4096
    buffer_load_dwordx4 v[16:19], v6, s[52:55], s30 offen sc1
    s_add_u32 s30, s30, 4096
    s_mov_b32 s33, 2
    s_lshl_b32 s28, s33, 13
    s_add_u32 s28, s28, 8192
    s_mul_i32 s29, s33, 10240
    s_mul_i32 s30, s33, 28672
    s_add_u32 s30, s30, 28672
    buffer_load_dwordx4 v[16:19], v6, s[40:43], s28 offen sc1
    s_add_u32 s28, s28, 4096
    buffer_load_dwordx4 v[16:19], v6, s[40:43], s28 offen sc1
    s_add_u32 s28, s28, 4096
    buffer_load_dwordx4 v[16:19], v6, s[44:47], s29 offen sc1
    s_add_u32 s29, s29, 4096
    buffer_load_dwordx4 v[16:19], v6, s[44:47], s29 offen sc1
    s_add_u32 s29, s29, 4096
    buffer_load_dwordx4 v[16:19], v6, s[44:47], s29 offen sc1
    s_add_u32 s29, s29, 4096
    buffer_load_dwordx4 v[16:19], v6, s[52:55], s30 offen sc1
    s_add_u32 s30, s30, 4096
    buffer_load_dwordx4 v[16:19], v6, s[52:55], s30 offen sc1
    s_add_u32 s30, s30, 4096
    buffer_load_dwordx4 v[16:19], v6, s[52:55], s30 offen sc1
    s_add_u32 s30, s30, 4096
    buffer_load_dwordx4 v[16:19], v6, s[52:55], s30 offen sc1
    s_add_u32 s30, s30, 4096
    buffer_load_dwordx4 v[16:19], v6, s[52:55], s30 offen sc1
    s_add_u32 s30, s30, 4096
    buffer_load_dwordx4 v[16:19], v6, s[52:55], s30 offen sc1
    s_add_u32 s30, s30, 4096
    buffer_load_dwordx4 v[16:19], v6, s[52:55], s30 offen sc1
    s_add_u32 s30, s30, 4096
    s_mov_b32 s33, 3
    s_lshl_b32 s28, s33, 13
    s_add_u32 s28, s28, 8192
    s_mul_i32 s29, s33, 10240
    s_mul_i32 s30, s33, 28672
    s_add_u32 s30, s30, 28672
    buffer_load_dwordx4 v[16:19], v6, s[40:43], s28 offen sc1
    s_add_u32 s28, s28, 4096
    buffer_load_dwordx4 v[16:19], v6, s[40:43], s28 offen sc1
    s_add_u32 s28, s28, 4096
    buffer_load_dwordx4 v[16:19], v6, s[44:47], s29 offen sc1
    s_add_u32 s29, s29, 4096
    buffer_load_dwordx4 v[16:19], v6, s[44:47], s29 offen sc1
    s_add_u32 s29, s29, 4096
    buffer_load_dwordx4 v[16:19], v6, s[44:47], s29 offen sc1
    s_add_u32 s29, s29, 4096
    buffer_load_dwordx4 v[16:19], v6, s[52:55], s30 offen sc1
    s_add_u32 s30, s30, 4096
    buffer_load_dwordx4 v[16:19], v6, s[52:55], s30 offen sc1
    s_add_u32 s30, s30, 4096
    buffer_load_dwordx4 v[16:19], v6, s[52:55], s30 offen sc1
    s_add_u32 s30, s30, 4096
    buffer_load_dwordx4 v[16:19], v6, s[52:55], s30 offen sc1
    s_add_u32 s30, s30, 4096
    buffer_load_dwordx4 v[16:19], v6, s[52:55], s30 offen sc1
    s_add_u32 s30, s30, 4096
    buffer_load_dwordx4 v[16:19], v6, s[52:55], s30 offen sc1
    s_add_u32 s30, s30, 4096
    buffer_load_dwordx4 v[16:19], v6, s[52:55], s30 offen sc1
    s_add_u32 s30, s30, 4096
    s_mov_b32 s33, 4
    s_lshl_b32 s28, s33, 13
    s_add_u32 s28, s28, 8192
    s_mul_i32 s29, s33, 10240
    s_mul_i32 s30, s33, 28672
    s_add_u32 s30, s30, 28672
    buffer_load_dwordx4 v[16:19], v6, s[40:43], s28 offen sc1
    s_add_u32 s28, s28, 4096
    buffer_load_dwordx4 v[16:19], v6, s[40:43], s28 offen sc1
    s_add_u32 s28, s28, 4096
    buffer_load_dwordx4 v[16:19], v6, s[44:47], s29 offen sc1
    s_add_u32 s29, s29, 4096
    buffer_load_dwordx4 v[16:19], v6, s[44:47], s29 offen sc1
    s_add_u32 s29, s29, 4096
    buffer_load_dwordx4 v[16:19], v6, s[44:47], s29 offen sc1
    s_add_u32 s29, s29, 4096
    buffer_load_dwordx4 v[16:19], v6, s[52:55], s30 offen sc1
    s_add_u32 s30, s30, 4096
    buffer_load_dwordx4 v[16:19], v6, s[52:55], s30 offen sc1
    s_add_u32 s30, s30, 4096
    buffer_load_dwordx4 v[16:19], v6, s[52:55], s30 offen sc1
    s_add_u32 s30, s30, 4096
    buffer_load_dwordx4 v[16:19], v6, s[52:55], s30 offen sc1
    s_add_u32 s30, s30, 4096
    buffer_load_dwordx4 v[16:19], v6, s[52:55], s30 offen sc1
    s_add_u32 s30, s30, 4096
    buffer_load_dwordx4 v[16:19], v6, s[52:55], s30 offen sc1
    s_add_u32 s30, s30, 4096
    buffer_load_dwordx4 v[16:19], v6, s[52:55], s30 offen sc1
    s_add_u32 s30, s30, 4096
K3w_loop:
    s_add_u32 s64, s64, 1
    s_cmp_ge_u32 s64, 59
    s_cbranch_scc1 K3_end
    s_lshl_b32 s32, s64, 13
    s_mov_b32 s27, 0
K3w_w:
    s_sleep 4
    buffer_load_dword v8, v5, s[40:43], s32 offen sc1
    s_add_u32 s27, s27, 1
    s_cmp_gt_u32 s27, 65536
    s_cbranch_scc1 K3_bail
    s_waitcnt vmcnt(0)
    v_cmp_eq_u32 vcc, -1, v8
    s_cbranch_vccnz K3w_w
    s_add_u32 s33, s64, 4
    s_lshl_b32 s28, s33, 13
    s_add_u32 s28, s28, 8192
    s_mul_i32 s29, s33, 10240
    s_mul_i32 s30, s33, 28672
    s_add_u32 s30, s30, 28672
    buffer_load_dwordx4 v[16:19], v6, s[40:43], s28 offen sc1
    s_add_u32 s28, s28, 4096
    buffer_load_dwordx4 v[16:19], v6, s[40:43], s28 offen sc1
    s_add_u32 s28, s28, 4096
    buffer_load_dwordx4 v[16:19], v6, s[44:47], s29 offen sc1
    s_add_u32 s29, s29, 4096
    buffer_load_dwordx4 v[16:19], v6, s[44:47], s29 offen sc1
    s_add_u32 s29, s29, 4096
    buffer_load_dwordx4 v[16:19], v6, s[44:47], s29 offen sc1
    s_add_u32 s29, s29, 4096
    buffer_load_dwordx4 v[16:19], v6, s[52:55], s30 offen sc1
    s_add_u32 s30, s30, 4096
    buffer_load_dwordx4 v[16:19], v6, s[52:55], s30 offen sc1
    s_add_u32 s30, s30, 4096
    buffer_load_dwordx4 v[16:19], v6, s[52:55], s30 offen sc1
    s_add_u32 s30, s30, 4096
    buffer_load_dwordx4 v[16:19], v6, s[52:55], s30 offen sc1
    s_add_u32 s30, s30, 4096
    buffer_load_dwordx4 v[16:19], v6, s[52:55], s30 offen sc1
    s_add_u32 s30, s30, 4096
    buffer_load_dwordx4 v[16:19], v6, s[52:55], s30 offen sc1
    s_add_u32 s30, s30, 4096
    buffer_load_dwordx4 v[16:19], v6, s[52:55], s30 offen sc1
    s_add_u32 s30, s30, 4096
    s_branch K3w_loop
K3_f:
    s_add_u32 s52, s18, 0x5c00000
    s_addc_u32 s53, s19, 0
    s_mov_b32 s54, 0x80000
    s_mov_b32 s55, 0x20000
    s_add_u32 s56, s18, 0x5d00000
    s_addc_u32 s57, s19, 0
    s_mov_b32 s58, 0xb8000
    s_mov_b32 s59, 0x20000
    v_min_u32 v5, 27, v1
    v_lshlrev_b32 v5, 2, v5
    v_add_u32 v5, 7168, v5
    s_lshl_b32 s28, s3, 11
    s_min_u32 s28, s28, 5120
    v_add_u32 v6, s28, v4
    s_mov_b32 s26, 0xffff0000
    s_mov_b32 s64, 0
    v_min_u32 v10, 31, v1
    v_lshlrev_b32 v10, 7, v10
    s_mov_b32 s27, 0
    s_mov_b32 s28, 737280
K3_end_fl4970:
    buffer_load_dword v11, v10, s[56:59], s28 offen sc1
    s_add_u32 s27, s27, 1
    s_cmp_gt_u32 s27, 65536
    s_cbranch_scc1 K3_bail
K3_end_fl4970_chk:
    s_waitcnt vmcnt(0)
    v_xor_b32 v11, s35, v11
    v_cmp_lt_u32 vcc, 15, v11
    s_cbranch_vccnz K3_end_fl4970
    v_cmp_ne_u32 vcc, 0, v11
    s_nop 0
    s_cmp_lg_u64 vcc, 0
    s_cselect_b32 s65, 1, 0
K3f_loop:
    s_lshl_b32 s32, s64, 13
    s_mov_b32 s27, 0
    s_cmp_eq_u32 s64, 0
    s_cbranch_scc1 K3f_hu
K3f_w:
    s_sleep 1
    buffer_load_dword v8, v5, s[40:43], s32 offen sc1
    s_add_u32 s27, s27, 1
    s_cmp_gt_u32 s27, 65536
    s_cbranch_scc1 K3_bail
    s_waitcnt vmcnt(0)
    v_cmp_eq_u32 vcc, -1, v8
    s_cbranch_vccnz K3f_w
K3f_hu:
    s_lshl_b32 s28, s64, 13
    s_add_u32 s28, s28, 6144
    s_cmp_lg_u32 s3, 0
    s_cbranch_scc1 K3f_get
    v_mov_b32 v8, s96
    v_mov_b32 v9, 0
    s_mov_b64 exec, 1
    buffer_store_dword v8, v9, s[56:59], s28 offen sc1
    s_mov_b64 exec, -1
K3f_get:
    buffer_load_dwordx4 v[16:19], v6, s[40:43], s32 offen sc1
    buffer_load_dwordx4 v[20:23], v6, s[40:43], s32 offen offset:1024 sc1
K3f_chk:
    s_waitcnt vmcnt(0)
    v_pk_max_u16 v8, v16, v17
    v_pk_max_u16 v8, v8, v18
    v_pk_max_u16 v8, v8, v19
    v_pk_max_u16 v8, v8, v20
    v_pk_max_u16 v8, v8, v21
    v_pk_max_u16 v8, v8, v22
    v_pk_max_u16 v8, v8, v23
    v_lshlrev_b32 v9, 16, v8
    v_max_u32 v8, v8, v9
    v_cmp_le_u32 vcc, s26, v8
    s_cbranch_vccz K3f_ok
    s_add_u32 s27, s27, 1
    s_cmp_gt_u32 s27, 65536
    s_cbranch_scc1 K3_bail
    s_branch K3f_get
K3f_ok:
    buffer_store_dwordx4 v[16:19], v6, s[52:55], s32 offen sc1
    buffer_store_dwordx4 v[20:23], v6, s[52:55], s32 offen offset:1024 sc1
    s_add_u32 s64, s64, 1
    s_cmp_lt_u32 s64, 64
    s_cbranch_scc1 K3f_loop
    s_branch K3_end
KM_worker:
    s_load_dwordx4 s[76:79], s[0:1], 16
    s_load_dwordx4 s[80:83], s[0:1], 32
    s_sub_u32 s20, s20, 1
    s_lshl_b32 s20, s20, 5
    s_add_u32 s20, s20, s21
    s_mul_i32 s22, s20, 9363
    s_lshr_b32 s22, s22, 16
    s_mul_i32 s23, s22, 7
    s_sub_u32 s23, s20, s23
    s_mov_b32 s21, s23
    s_waitcnt lgkmcnt(0)
    s_add_u32 s96, s96, 1
    s_lshl_b32 s95, s96, 3
    s_add_u32 s48, s18, 0x5d00000
    s_addc_u32 s49, s19, 0
    s_mov_b32 s50, 0xb8000
    s_mov_b32 s51, 0x20000
    s_and_b32 s24, s22, 15
    s_lshl_b32 s25, s24, 9
    s_mul_i32 s26, s22, 401408
    s_add_u32 s26, s26, 0x800000
    s_add_u32 s36, s18, s26
    s_addc_u32 s37, s19, 0
    s_mov_b32 s38, 0x62000
    s_mov_b32 s39, 0x20000
    v_lshrrev_b32 v5, 5, v1
    v_and_b32 v6, 31, v1
    v_xor_b32 v6, v6, v5
    v_lshlrev_b32 v6, 4, v6
    v_lshl_add_u32 v6, v5, 13, v6
    v_xor_b32 v216, 0, v6
    v_add_u32 v216, 0, v216
    v_xor_b32 v217, 32, v6
    v_add_u32 v217, 16384, v217
    v_xor_b32 v218, 64, v6
    v_add_u32 v218, 65536, v218
    v_xor_b32 v219, 96, v6
    v_add_u32 v219, 81920, v219
    v_xor_b32 v220, 128, v6
    v_add_u32 v220, 131072, v220
    v_xor_b32 v221, 160, v6
    v_add_u32 v221, 147456, v221
    v_xor_b32 v222, 192, v6
    v_add_u32 v222, 196608, v222
    v_xor_b32 v223, 224, v6
    v_add_u32 v223, 212992, v223
    s_lshl_b32 s32, s3, 15
    s_add_u32 s32, s32, 32768
    s_mov_b32 s30, 1.0
    s_cmp_ge_u32 s22, 16
    s_cbranch_scc1 KP_t1
    s_mov_b32 s40, s76
    s_mov_b32 s41, s77
    s_mov_b32 s42, 0x380000
    s_mov_b32 s43, 0x20000
    s_mov_b32 s44, s78
    s_mov_b32 s45, s79
    s_mov_b32 s46, 0x380000
    s_mov_b32 s47, 0x20000
    v_lshrrev_b32 v250, 3, v1
    v_and_b32 v251, 7, v1
    v_lshlrev_b32 v251, 6, v251
    v_lshl_add_u32 v250, v250, 13, v251
    s_lshl_b32 s27, s23, 19
    s_lshl_b32 s28, s3, 17
    s_add_u32 s27, s27, s28
    s_add_u32 s27, s27, s25
    buffer_load_dword v251, v250, s[40:43], s27 offen
    s_add_u32 s27, s27, 65536
    buffer_load_dword v252, v250, s[40:43], s27 offen
    s_mov_b32 s30, 0x3db8aa3b
    s_lshl_b32 s27, s23, 19
    s_lshr_b32 s28, s3, 1
    s_lshl_b32 s28, s28, 18
    s_add_u32 s27, s27, s28
    s_and_b32 s28, s3, 1
    s_lshl_b32 s28, s28, 15
    s_add_u32 s27, s27, s28
    s_add_u32 s27, s27, s25
    s_lshl_b32 m0, s3, 13
    s_nop 0
    buffer_load_dwordx4 v216, s[44:47], s27 offen lds
    s_add_u32 m0, m0, 1024
    s_nop 0
    buffer_load_dwordx4 v217, s[44:47], s27 offen lds
    s_add_u32 m0, m0, 1024
    s_nop 0
    buffer_load_dwordx4 v218, s[44:47], s27 offen lds
    s_add_u32 m0, m0, 1024
    s_nop 0
    buffer_load_dwordx4 v219, s[44:47], s27 offen lds
    s_add_u32 m0, m0, 1024
    s_nop 0
    buffer_load_dwordx4 v220, s[44:47], s27 offen lds
    s_add_u32 m0, m0, 1024
    s_nop 0
    buffer_load_dwordx4 v221, s[44:47], s27 offen lds
    s_add_u32 m0, m0, 1024
    s_nop 0
    buffer_load_dwordx4 v222, s[44:47], s27 offen lds
    s_add_u32 m0, m0, 1024
    s_nop 0
    buffer_load_dwordx4 v223, s[44:47], s27 offen lds
    s_add_u32 m0, m0, 1024
    s_add_u32 s27, s3, 0
    s_lshl_b32 s27, s27, 18
    s_add_u32 s27, s27, s25
    s_add_u32 m0, s32, 0
    s_nop 0
    buffer_load_dwordx4 v216, s[40:43], s27 offen lds
    s_add_u32 m0, m0, 1024
    s_nop 0
    buffer_load_dwordx4 v217, s[40:43], s27 offen lds
    s_add_u32 m0, m0, 1024
    s_nop 0
    buffer_load_dwordx4 v218, s[40:43], s27 offen lds
    s_add_u32 m0, m0, 1024
    s_nop 0
    buffer_load_dwordx4 v219, s[40:43], s27 offen lds
    s_add_u32 m0, m0, 1024
    s_nop 0
    buffer_load_dwordx4 v220, s[40:43], s27 offen lds
    s_add_u32 m0, m0, 1024
    s_nop 0
    buffer_load_dwordx4 v221, s[40:43], s27 offen lds
    s_add_u32 m0, m0, 1024
    s_nop 0
    buffer_load_dwordx4 v222, s[40:43], s27 offen lds
    s_add_u32 m0, m0, 1024
    s_nop 0
    buffer_load_dwordx4 v223, s[40:43], s27 offen lds
    s_add_u32 m0, m0, 1024
    s_add_u32 s27, s27, 32768
    buffer_load_dwordx4 v216, s[40:43], s27 offen lds
    s_add_u32 m0, m0, 1024
    s_nop 0
    buffer_load_dwordx4 v217, s[40:43], s27 offen lds
    s_add_u32 m0, m0, 1024
    s_nop 0
    buffer_load_dwordx4 v218, s[40:43], s27 offen lds
    s_add_u32 m0, m0, 1024
    s_nop 0
    buffer_load_dwordx4 v219, s[40:43], s27 offen lds
    s_add_u32 m0, m0, 1024
    s_nop 0
    buffer_load_dwordx4 v220, s[40:43], s27 offen lds
    s_add_u32 m0, m0, 1024
    s_nop 0
    buffer_load_dwordx4 v221, s[40:43], s27 offen lds
    s_add_u32 m0, m0, 1024
    s_nop 0
    buffer_load_dwordx4 v222, s[40:43], s27 offen lds
    s_add_u32 m0, m0, 1024
    s_nop 0
    buffer_load_dwordx4 v223, s[40:43], s27 offen lds
    s_add_u32 m0, m0, 1024
    s_branch KP_c0
KP_t1:
    s_mov_b32 s40, s80
    s_mov_b32 s41, s81
    s_mov_b32 s42, 0x380000
    s_mov_b32 s43, 0x20000
    v_lshrrev_b32 v250, 3, v1
    v_and_b32 v251, 7, v1
    v_lshlrev_b32 v251, 6, v251
    v_lshl_add_u32 v250, v250, 13, v251
    s_lshl_b32 s27, s23, 19
    s_lshl_b32 s28, s3, 17
    s_add_u32 s27, s27, s28
    s_add_u32 s27, s27, s25
    buffer_load_dword v251, v250, s[40:43], s27 offen
    s_add_u32 s27, s27, 65536
    buffer_load_dword v252, v250, s[40:43], s27 offen
    s_mul_i32 s27, s24, 229376
    s_add_u32 s44, s82, s27
    s_addc_u32 s45, s83, 0
    s_mov_b32 s46, 0x38000
    s_mov_b32 s47, 0x20000
    v_lshrrev_b32 v5, 3, v1
    v_and_b32 v6, 7, v1
    v_and_b32 v7, 6, v5
    v_xor_b32 v6, v6, v7
    v_lshlrev_b32 v6, 4, v6
    v_and_b32 v7, 3, v5
    v_lshrrev_b32 v5, 2, v5
    v_lshl_add_u32 v7, v5, 3, v7
    v_mul_u32_u24 v7, 896, v7
    v_add_u32 v7, v7, v6
    s_lshl_b32 s27, s23, 7
    s_mul_i32 s28, s3, 57344
    s_add_u32 s27, s27, s28
    s_lshl_b32 m0, s3, 13
    s_nop 0
    buffer_load_dwordx4 v7, s[44:47], s27 offen lds
    s_add_u32 m0, m0, 1024
    s_add_u32 s27, s27, 3584
    buffer_load_dwordx4 v7, s[44:47], s27 offen lds
    s_add_u32 m0, m0, 1024
    s_add_u32 s27, s27, 10752
    buffer_load_dwordx4 v7, s[44:47], s27 offen lds
    s_add_u32 m0, m0, 1024
    s_add_u32 s27, s27, 3584
    buffer_load_dwordx4 v7, s[44:47], s27 offen lds
    s_add_u32 m0, m0, 1024
    s_add_u32 s27, s27, 10752
    buffer_load_dwordx4 v7, s[44:47], s27 offen lds
    s_add_u32 m0, m0, 1024
    s_add_u32 s27, s27, 3584
    buffer_load_dwordx4 v7, s[44:47], s27 offen lds
    s_add_u32 m0, m0, 1024
    s_add_u32 s27, s27, 10752
    buffer_load_dwordx4 v7, s[44:47], s27 offen lds
    s_add_u32 m0, m0, 1024
    s_add_u32 s27, s27, 3584
    buffer_load_dwordx4 v7, s[44:47], s27 offen lds
    s_add_u32 m0, m0, 1024
    s_add_u32 s27, s27, 10752
    s_add_u32 s27, s3, 0
    s_lshl_b32 s27, s27, 18
    s_add_u32 s27, s27, s25
    s_add_u32 m0, s32, 0
    s_nop 0
    buffer_load_dwordx4 v216, s[40:43], s27 offen lds
    s_add_u32 m0, m0, 1024
    s_nop 0
    buffer_load_dwordx4 v217, s[40:43], s27 offen lds
    s_add_u32 m0, m0, 1024
    s_nop 0
    buffer_load_dwordx4 v218, s[40:43], s27 offen lds
    s_add_u32 m0, m0, 1024
    s_nop 0
    buffer_load_dwordx4 v219, s[40:43], s27 offen lds
    s_add_u32 m0, m0, 1024
    s_nop 0
    buffer_load_dwordx4 v220, s[40:43], s27 offen lds
    s_add_u32 m0, m0, 1024
    s_nop 0
    buffer_load_dwordx4 v221, s[40:43], s27 offen lds
    s_add_u32 m0, m0, 1024
    s_nop 0
    buffer_load_dwordx4 v222, s[40:43], s27 offen lds
    s_add_u32 m0, m0, 1024
    s_nop 0
    buffer_load_dwordx4 v223, s[40:43], s27 offen lds
    s_add_u32 m0, m0, 1024
    s_add_u32 s27, s27, 32768
    buffer_load_dwordx4 v216, s[40:43], s27 offen lds
    s_add_u32 m0, m0, 1024
    s_nop 0
    buffer_load_dwordx4 v217, s[40:43], s27 offen lds
    s_add_u32 m0, m0, 1024
    s_nop 0
    buffer_load_dwordx4 v218, s[40:43], s27 offen lds
    s_add_u32 m0, m0, 1024
    s_nop 0
    buffer_load_dwordx4 v219, s[40:43], s27 offen lds
    s_add_u32 m0, m0, 1024
    s_nop 0
    buffer_load_dwordx4 v220, s[40:43], s27 offen lds
    s_add_u32 m0, m0, 1024
    s_nop 0
    buffer_load_dwordx4 v221, s[40:43], s27 offen lds
    s_add_u32 m0, m0, 1024
    s_nop 0
    buffer_load_dwordx4 v222, s[40:43], s27 offen lds
    s_add_u32 m0, m0, 1024
    s_nop 0
    buffer_load_dwordx4 v223, s[40:43], s27 offen lds
    s_add_u32 m0, m0, 1024
KP_c0:
    v_and_b32 v5, 3, v2
    v_xor_b32 v5, v5, v3
    v_and_b32 v6, 12, v2
    v_or_b32 v5, v5, v6
    v_lshlrev_b32 v5, 4, v5
    v_lshl_add_u32 v5, v2, 9, v5
    v_xor_b32 v224, 0, v5
    v_xor_b32 v225, 64, v5
    v_xor_b32 v226, 128, v5
    v_xor_b32 v227, 192, v5
    v_xor_b32 v228, 256, v5
    v_xor_b32 v229, 320, v5
    v_xor_b32 v230, 384, v5
    v_xor_b32 v231, 448, v5
    s_mov_b64 exec, 0
    s_cmp_eq_u32 s3, 0
    s_cbranch_scc1 KP_wm_p0
    s_cmp_eq_u32 s3, 1
    s_cbranch_scc1 KP_wm_p17
    s_cmp_eq_u32 s3, 2
    s_cbranch_scc1 KP_wm_p35
    s_branch KP_wm_p53
KP_wm_ret:
    s_mov_b64 exec, -1
KP_wm_p0:
    s_cbranch_execz KP_wm_p1
    s_waitcnt vmcnt(16)
    s_barrier
    s_cmp_ge_u32 s22, 16
    s_cbranch_scc1 KP_r1
    ds_read_b128 v[8:11], v224 offset:0
    ds_read_b128 v[12:15], v225 offset:0
    ds_read_b128 v[16:19], v226 offset:0
    ds_read_b128 v[20:23], v227 offset:0
    ds_read_b128 v[24:27], v228 offset:0
    ds_read_b128 v[28:31], v229 offset:0
    ds_read_b128 v[32:35], v230 offset:0
    ds_read_b128 v[36:39], v231 offset:0
    s_waitcnt lgkmcnt(7)
    ds_read_b128 v[40:43], v224 offset:8192
    ds_read_b128 v[44:47], v225 offset:8192
    ds_read_b128 v[48:51], v226 offset:8192
KP_wm_p1:
    s_cbranch_execz KP_wm_p2
    ds_read_b128 v[52:55], v227 offset:8192
    ds_read_b128 v[56:59], v228 offset:8192
    ds_read_b128 v[60:63], v229 offset:8192
    ds_read_b128 v[64:67], v230 offset:8192
    ds_read_b128 v[68:71], v231 offset:8192
    s_waitcnt lgkmcnt(7)
    ds_read_b128 v[72:75], v224 offset:16384
    ds_read_b128 v[76:79], v225 offset:16384
    ds_read_b128 v[80:83], v226 offset:16384
    ds_read_b128 v[84:87], v227 offset:16384
    ds_read_b128 v[88:91], v228 offset:16384
    ds_read_b128 v[92:95], v229 offset:16384
    ds_read_b128 v[96:99], v230 offset:16384
    ds_read_b128 v[100:103], v231 offset:16384
KP_wm_p2:
    s_cbranch_execz KP_wm_p3
    s_waitcnt lgkmcnt(7)
    ds_read_b128 v[104:107], v224 offset:24576
    ds_read_b128 v[108:111], v225 offset:24576
    ds_read_b128 v[112:115], v226 offset:24576
    ds_read_b128 v[116:119], v227 offset:24576
    ds_read_b128 v[120:123], v228 offset:24576
    ds_read_b128 v[124:127], v229 offset:24576
    ds_read_b128 v[128:131], v230 offset:24576
    ds_read_b128 v[132:135], v231 offset:24576
    s_waitcnt lgkmcnt(7)
    s_branch KP_c1
KP_r1:
    v_lshrrev_b32 v5, 2, v2
    v_and_b32 v6, 1, v3
    v_lshl_add_u32 v6, v6, 2, v5
    v_lshrrev_b32 v7, 1, v6
    v_lshrrev_b32 v5, 1, v3
    v_lshl_add_u32 v6, v5, 4, v6
KP_wm_p3:
    s_cbranch_execz KP_wm_p4
    v_lshlrev_b32 v6, 7, v6
    v_and_b32 v5, 3, v2
    v_lshl_add_u32 v6, v5, 3, v6
    v_xor_b32 v5, 0, v7
    v_lshl_add_u32 v5, v5, 5, v6
    ds_read_b64_tr_b16 v[8:9], v5 offset:0
    ds_read_b64_tr_b16 v[10:11], v5 offset:1024
    ds_read_b64_tr_b16 v[12:13], v5 offset:4096
    ds_read_b64_tr_b16 v[14:15], v5 offset:5120
    ds_read_b64_tr_b16 v[16:17], v5 offset:8192
    ds_read_b64_tr_b16 v[18:19], v5 offset:9216
    ds_read_b64_tr_b16 v[20:21], v5 offset:12288
    ds_read_b64_tr_b16 v[22:23], v5 offset:13312
    s_waitcnt lgkmcnt(7)
    ds_read_b64_tr_b16 v[24:25], v5 offset:16384
    ds_read_b64_tr_b16 v[26:27], v5 offset:17408
KP_wm_p4:
    s_cbranch_execz KP_wm_p5
    ds_read_b64_tr_b16 v[28:29], v5 offset:20480
    ds_read_b64_tr_b16 v[30:31], v5 offset:21504
    ds_read_b64_tr_b16 v[32:33], v5 offset:24576
    ds_read_b64_tr_b16 v[34:35], v5 offset:25600
    ds_read_b64_tr_b16 v[36:37], v5 offset:28672
    ds_read_b64_tr_b16 v[38:39], v5 offset:29696
    s_waitcnt lgkmcnt(7)
    v_xor_b32 v5, 1, v7
    v_lshl_add_u32 v5, v5, 5, v6
    ds_read_b64_tr_b16 v[40:41], v5 offset:0
    ds_read_b64_tr_b16 v[42:43], v5 offset:1024
    ds_read_b64_tr_b16 v[44:45], v5 offset:4096
    ds_read_b64_tr_b16 v[46:47], v5 offset:5120
    ds_read_b64_tr_b16 v[48:49], v5 offset:8192
    ds_read_b64_tr_b16 v[50:51], v5 offset:9216
KP_wm_p5:
    s_cbranch_execz KP_wm_p6
    ds_read_b64_tr_b16 v[52:53], v5 offset:12288
    ds_read_b64_tr_b16 v[54:55], v5 offset:13312
    s_waitcnt lgkmcnt(7)
    ds_read_b64_tr_b16 v[56:57], v5 offset:16384
    ds_read_b64_tr_b16 v[58:59], v5 offset:17408
    ds_read_b64_tr_b16 v[60:61], v5 offset:20480
    ds_read_b64_tr_b16 v[62:63], v5 offset:21504
    ds_read_b64_tr_b16 v[64:65], v5 offset:24576
    ds_read_b64_tr_b16 v[66:67], v5 offset:25600
    ds_read_b64_tr_b16 v[68:69], v5 offset:28672
    ds_read_b64_tr_b16 v[70:71], v5 offset:29696
    s_waitcnt lgkmcnt(7)
    v_xor_b32 v5, 2, v7
    v_lshl_add_u32 v5, v5, 5, v6
    ds_read_b64_tr_b16 v[72:73], v5 offset:0
KP_wm_p6:
    s_cbranch_execz KP_wm_p7
    ds_read_b64_tr_b16 v[74:75], v5 offset:1024
    ds_read_b64_tr_b16 v[76:77], v5 offset:4096
    ds_read_b64_tr_b16 v[78:79], v5 offset:5120
    ds_read_b64_tr_b16 v[80:81], v5 offset:8192
    ds_read_b64_tr_b16 v[82:83], v5 offset:9216
    ds_read_b64_tr_b16 v[84:85], v5 offset:12288
    ds_read_b64_tr_b16 v[86:87], v5 offset:13312
    s_waitcnt lgkmcnt(7)
    ds_read_b64_tr_b16 v[88:89], v5 offset:16384
    ds_read_b64_tr_b16 v[90:91], v5 offset:17408
    ds_read_b64_tr_b16 v[92:93], v5 offset:20480
    ds_read_b64_tr_b16 v[94:95], v5 offset:21504
    ds_read_b64_tr_b16 v[96:97], v5 offset:24576
    ds_read_b64_tr_b16 v[98:99], v5 offset:25600
KP_wm_p7:
    s_cbranch_execz KP_wm_p8
    ds_read_b64_tr_b16 v[100:101], v5 offset:28672
    ds_read_b64_tr_b16 v[102:103], v5 offset:29696
    s_waitcnt lgkmcnt(7)
    v_xor_b32 v5, 3, v7
    v_lshl_add_u32 v5, v5, 5, v6
    ds_read_b64_tr_b16 v[104:105], v5 offset:0
    ds_read_b64_tr_b16 v[106:107], v5 offset:1024
    ds_read_b64_tr_b16 v[108:109], v5 offset:4096
    ds_read_b64_tr_b16 v[110:111], v5 offset:5120
    ds_read_b64_tr_b16 v[112:113], v5 offset:8192
    ds_read_b64_tr_b16 v[114:115], v5 offset:9216
    ds_read_b64_tr_b16 v[116:117], v5 offset:12288
    ds_read_b64_tr_b16 v[118:119], v5 offset:13312
    s_waitcnt lgkmcnt(7)
    ds_read_b64_tr_b16 v[120:121], v5 offset:16384
KP_wm_p8:
    s_cbranch_execz KP_wm_p9
    ds_read_b64_tr_b16 v[122:123], v5 offset:17408
    ds_read_b64_tr_b16 v[124:125], v5 offset:20480
    ds_read_b64_tr_b16 v[126:127], v5 offset:21504
    ds_read_b64_tr_b16 v[128:129], v5 offset:24576
    ds_read_b64_tr_b16 v[130:131], v5 offset:25600
    ds_read_b64_tr_b16 v[132:133], v5 offset:28672
    ds_read_b64_tr_b16 v[134:135], v5 offset:29696
    s_waitcnt lgkmcnt(7)
KP_c1:
    s_add_u32 s27, s3, 4
    s_lshl_b32 s27, s27, 18
    s_add_u32 s27, s27, s25
    s_add_u32 m0, s32, 16384
    s_nop 0
    buffer_load_dwordx4 v216, s[40:43], s27 offen lds
    s_add_u32 m0, m0, 1024
    s_nop 0
    buffer_load_dwordx4 v217, s[40:43], s27 offen lds
    s_add_u32 m0, m0, 1024
KP_wm_p9:
    s_cbranch_execz KP_wm_p10
    buffer_load_dwordx4 v218, s[40:43], s27 offen lds
    s_add_u32 m0, m0, 1024
    s_nop 0
    buffer_load_dwordx4 v219, s[40:43], s27 offen lds
    s_add_u32 m0, m0, 1024
    s_nop 0
    buffer_load_dwordx4 v220, s[40:43], s27 offen lds
    s_add_u32 m0, m0, 1024
    s_nop 0
    buffer_load_dwordx4 v221, s[40:43], s27 offen lds
    s_add_u32 m0, m0, 1024
    s_nop 0
    buffer_load_dwordx4 v222, s[40:43], s27 offen lds
    s_add_u32 m0, m0, 1024
    s_nop 0
    buffer_load_dwordx4 v223, s[40:43], s27 offen lds
    s_add_u32 m0, m0, 1024
    s_add_u32 s27, s27, 32768
    buffer_load_dwordx4 v216, s[40:43], s27 offen lds
KP_wm_p10:
    s_cbranch_execz KP_wm_p11
    s_add_u32 m0, m0, 1024
    s_nop 0
    buffer_load_dwordx4 v217, s[40:43], s27 offen lds
    s_add_u32 m0, m0, 1024
    s_nop 0
    buffer_load_dwordx4 v218, s[40:43], s27 offen lds
    s_add_u32 m0, m0, 1024
    s_nop 0
    buffer_load_dwordx4 v219, s[40:43], s27 offen lds
    s_add_u32 m0, m0, 1024
    s_nop 0
    buffer_load_dwordx4 v220, s[40:43], s27 offen lds
    s_add_u32 m0, m0, 1024
    s_nop 0
    buffer_load_dwordx4 v221, s[40:43], s27 offen lds
    s_add_u32 m0, m0, 1024
    s_nop 0
    buffer_load_dwordx4 v222, s[40:43], s27 offen lds
    s_add_u32 m0, m0, 1024
    s_nop 0
    buffer_load_dwordx4 v223, s[40:43], s27 offen lds
KP_wm_p11:
    s_cbranch_execz KP_wm_p12
    s_add_u32 m0, m0, 1024
    v_add_u32 v224, s32, v224
    v_add_u32 v225, s32, v225
    v_add_u32 v226, s32, v226
    v_add_u32 v227, s32, v227
    v_add_u32 v228, s32, v228
    v_add_u32 v229, s32, v229
    v_add_u32 v230, s32, v230
    v_add_u32 v231, s32, v231
    s_mul_i32 s31, s23, 57344
    s_lshl_b32 s28, s3, 10
    s_add_u32 s31, s31, s28
    s_lshl_b32 s33, s20, 9
    s_lshl_b32 s28, s3, 7
    s_add_u32 s33, s33, s28
    s_add_u32 s33, s33, 589824
    v_mov_b32 v6, 0x7ffffff0
    v_cmp_eq_u32 vcc, 0, v1
    s_nop 1
    v_cndmask_b32 v6, v6, v1, vcc
    v_accvgpr_write_b32 a176, 0
    v_accvgpr_write_b32 a177, 0
KP_wm_p12:
    s_cbranch_execz KP_wm_p13
    v_accvgpr_write_b32 a178, 0
    v_accvgpr_write_b32 a179, 0
    v_accvgpr_write_b32 a180, 0
    v_accvgpr_write_b32 a181, 0
    v_accvgpr_write_b32 a182, 0
    v_accvgpr_write_b32 a183, 0
    v_accvgpr_write_b32 a184, 0
    v_accvgpr_write_b32 a185, 0
    v_accvgpr_write_b32 a186, 0
    v_accvgpr_write_b32 a187, 0
    v_accvgpr_write_b32 a188, 0
    v_accvgpr_write_b32 a189, 0
    v_accvgpr_write_b32 a190, 0
    v_accvgpr_write_b32 a191, 0
KP_wm_p13:
    s_cbranch_execz KP_wm_p14
    s_waitcnt vmcnt(16)
    ds_read_b128 v[136:139], v224 offset:0
    ds_read_b128 v[140:143], v225 offset:0
    ds_read_b128 v[144:147], v226 offset:0
    ds_read_b128 v[148:151], v227 offset:0
    ds_read_b128 v[152:155], v228 offset:0
    ds_read_b128 v[156:159], v229 offset:0
    ds_read_b128 v[160:163], v230 offset:0
    ds_read_b128 v[164:167], v231 offset:0
    s_waitcnt lgkmcnt(7)
    ds_read_b128 v[168:171], v224 offset:8192
    ds_read_b128 v[172:175], v225 offset:8192
    ds_read_b128 v[176:179], v226 offset:8192
    ds_read_b128 v[180:183], v227 offset:8192
    ds_read_b128 v[184:187], v228 offset:8192
KP_wm_p14:
    s_cbranch_execz KP_wm_p15
    ds_read_b128 v[188:191], v229 offset:8192
    ds_read_b128 v[192:195], v230 offset:8192
    ds_read_b128 v[196:199], v231 offset:8192
    s_waitcnt lgkmcnt(15)
    v_mfma_f32_16x16x32_bf16 a[0:3], v[136:139], v[8:11], 0
    v_mfma_f32_16x16x32_bf16 a[8:11], v[136:139], v[40:43], 0
    v_mfma_f32_16x16x32_bf16 a[16:19], v[136:139], v[72:75], 0
    v_mfma_f32_16x16x32_bf16 a[24:27], v[136:139], v[104:107], 0
    s_waitcnt lgkmcnt(14)
    v_mfma_f32_16x16x32_bf16 a[0:3], v[140:143], v[12:15], a[0:3]
    v_mfma_f32_16x16x32_bf16 a[8:11], v[140:143], v[44:47], a[8:11]
    v_mfma_f32_16x16x32_bf16 a[16:19], v[140:143], v[76:79], a[16:19]
    v_mfma_f32_16x16x32_bf16 a[24:27], v[140:143], v[108:111], a[24:27]
    s_waitcnt lgkmcnt(13)
    v_mfma_f32_16x16x32_bf16 a[0:3], v[144:147], v[16:19], a[0:3]
KP_wm_p15:
    s_cbranch_execz KP_wm_p16
    v_mfma_f32_16x16x32_bf16 a[8:11], v[144:147], v[48:51], a[8:11]
    v_mfma_f32_16x16x32_bf16 a[16:19], v[144:147], v[80:83], a[16:19]
    v_mfma_f32_16x16x32_bf16 a[24:27], v[144:147], v[112:115], a[24:27]
    s_waitcnt lgkmcnt(12)
    v_mfma_f32_16x16x32_bf16 a[0:3], v[148:151], v[20:23], a[0:3]
    v_mfma_f32_16x16x32_bf16 a[8:11], v[148:151], v[52:55], a[8:11]
    v_mfma_f32_16x16x32_bf16 a[16:19], v[148:151], v[84:87], a[16:19]
    v_mfma_f32_16x16x32_bf16 a[24:27], v[148:151], v[116:119], a[24:27]
    s_waitcnt lgkmcnt(11)
    v_mfma_f32_16x16x32_bf16 a[0:3], v[152:155], v[24:27], a[0:3]
    v_mfma_f32_16x16x32_bf16 a[8:11], v[152:155], v[56:59], a[8:11]
    v_mfma_f32_16x16x32_bf16 a[16:19], v[152:155], v[88:91], a[16:19]
    v_mfma_f32_16x16x32_bf16 a[24:27], v[152:155], v[120:123], a[24:27]
    s_waitcnt lgkmcnt(10)
    v_mfma_f32_16x16x32_bf16 a[0:3], v[156:159], v[28:31], a[0:3]
KP_wm_p16:
    s_cbranch_execz KP_wm_ret
    v_mfma_f32_16x16x32_bf16 a[8:11], v[156:159], v[60:63], a[8:11]
    v_mfma_f32_16x16x32_bf16 a[16:19], v[156:159], v[92:95], a[16:19]
    v_mfma_f32_16x16x32_bf16 a[24:27], v[156:159], v[124:127], a[24:27]
    s_waitcnt lgkmcnt(9)
    v_mfma_f32_16x16x32_bf16 a[0:3], v[160:163], v[32:35], a[0:3]
    v_mfma_f32_16x16x32_bf16 a[8:11], v[160:163], v[64:67], a[8:11]
    v_mfma_f32_16x16x32_bf16 a[16:19], v[160:163], v[96:99], a[16:19]
    v_mfma_f32_16x16x32_bf16 a[24:27], v[160:163], v[128:131], a[24:27]
    s_waitcnt lgkmcnt(8)
    v_mfma_f32_16x16x32_bf16 a[0:3], v[164:167], v[36:39], a[0:3]
    v_mfma_f32_16x16x32_bf16 a[8:11], v[164:167], v[68:71], a[8:11]
    v_mfma_f32_16x16x32_bf16 a[16:19], v[164:167], v[100:103], a[16:19]
    v_mfma_f32_16x16x32_bf16 a[24:27], v[164:167], v[132:135], a[24:27]
    s_waitcnt lgkmcnt(7)
    v_mfma_f32_16x16x32_bf16 a[4:7], v[168:171], v[8:11], 0
KP_wm_p17:
    s_cbranch_execz KP_wm_p18
    v_mfma_f32_16x16x32_bf16 a[12:15], v[168:171], v[40:43], 0
    v_mfma_f32_16x16x32_bf16 a[20:23], v[168:171], v[72:75], 0
    v_mfma_f32_16x16x32_bf16 a[28:31], v[168:171], v[104:107], 0
    s_waitcnt lgkmcnt(6)
    v_mfma_f32_16x16x32_bf16 a[4:7], v[172:175], v[12:15], a[4:7]
    v_mfma_f32_16x16x32_bf16 a[12:15], v[172:175], v[44:47], a[12:15]
    v_mfma_f32_16x16x32_bf16 a[20:23], v[172:175], v[76:79], a[20:23]
    v_mfma_f32_16x16x32_bf16 a[28:31], v[172:175], v[108:111], a[28:31]
    s_waitcnt lgkmcnt(5)
    v_mfma_f32_16x16x32_bf16 a[4:7], v[176:179], v[16:19], a[4:7]
    v_mfma_f32_16x16x32_bf16 a[12:15], v[176:179], v[48:51], a[12:15]
    v_mfma_f32_16x16x32_bf16 a[20:23], v[176:179], v[80:83], a[20:23]
    v_mfma_f32_16x16x32_bf16 a[28:31], v[176:179], v[112:115], a[28:31]
    s_waitcnt lgkmcnt(4)
    v_mfma_f32_16x16x32_bf16 a[4:7], v[180:183], v[20:23], a[4:7]
KP_wm_p18:
    s_cbranch_execz KP_wm_p19
    v_mfma_f32_16x16x32_bf16 a[12:15], v[180:183], v[52:55], a[12:15]
    v_mfma_f32_16x16x32_bf16 a[20:23], v[180:183], v[84:87], a[20:23]
    v_mfma_f32_16x16x32_bf16 a[28:31], v[180:183], v[116:119], a[28:31]
    s_waitcnt lgkmcnt(3)
    v_mfma_f32_16x16x32_bf16 a[4:7], v[184:187], v[24:27], a[4:7]
    v_mfma_f32_16x16x32_bf16 a[12:15], v[184:187], v[56:59], a[12:15]
    v_mfma_f32_16x16x32_bf16 a[20:23], v[184:187], v[88:91], a[20:23]
    v_mfma_f32_16x16x32_bf16 a[28:31], v[184:187], v[120:123], a[28:31]
    s_waitcnt lgkmcnt(2)
    v_mfma_f32_16x16x32_bf16 a[4:7], v[188:191], v[28:31], a[4:7]
    v_mfma_f32_16x16x32_bf16 a[12:15], v[188:191], v[60:63], a[12:15]
    v_mfma_f32_16x16x32_bf16 a[20:23], v[188:191], v[92:95], a[20:23]
    v_mfma_f32_16x16x32_bf16 a[28:31], v[188:191], v[124:127], a[28:31]
    s_waitcnt lgkmcnt(1)
    v_mfma_f32_16x16x32_bf16 a[4:7], v[192:195], v[32:35], a[4:7]
KP_wm_p19:
    s_cbranch_execz KP_wm_p20
    v_mfma_f32_16x16x32_bf16 a[12:15], v[192:195], v[64:67], a[12:15]
    v_mfma_f32_16x16x32_bf16 a[20:23], v[192:195], v[96:99], a[20:23]
    v_mfma_f32_16x16x32_bf16 a[28:31], v[192:195], v[128:131], a[28:31]
    s_waitcnt lgkmcnt(0)
    v_mfma_f32_16x16x32_bf16 a[4:7], v[196:199], v[36:39], a[4:7]
    v_mfma_f32_16x16x32_bf16 a[12:15], v[196:199], v[68:71], a[12:15]
    v_mfma_f32_16x16x32_bf16 a[20:23], v[196:199], v[100:103], a[20:23]
    v_mfma_f32_16x16x32_bf16 a[28:31], v[196:199], v[132:135], a[28:31]
    v_accvgpr_read_b32 v240, a0
    v_accvgpr_read_b32 v241, a1
    v_accvgpr_read_b32 v242, a2
    v_accvgpr_read_b32 v243, a3
    v_pk_mul_f32 v[240:241], v[240:241], s[30:31] op_sel_hi:[1,0]
    v_pk_mul_f32 v[242:243], v[242:243], s[30:31] op_sel_hi:[1,0]
KP_wm_p20:
    s_cbranch_execz KP_wm_p21
    v_cvt_pk_bf16_f32 v232, v240, v241
    v_cvt_pk_bf16_f32 v233, v242, v243
    v_accvgpr_read_b32 v240, a4
    v_accvgpr_read_b32 v241, a5
    v_accvgpr_read_b32 v242, a6
    v_accvgpr_read_b32 v243, a7
    v_pk_mul_f32 v[240:241], v[240:241], s[30:31] op_sel_hi:[1,0]
    v_pk_mul_f32 v[242:243], v[242:243], s[30:31] op_sel_hi:[1,0]
    v_cvt_pk_bf16_f32 v234, v240, v241
    v_cvt_pk_bf16_f32 v235, v242, v243
    v_accvgpr_write_b32 a128, v232
    v_accvgpr_write_b32 a129, v233
    v_accvgpr_write_b32 a130, v234
    v_accvgpr_write_b32 a131, v235
KP_wm_p21:
    s_cbranch_execz KP_wm_p22
    s_add_u32 s28, s31, 0
    buffer_store_dwordx4 v[232:235], v4, s[36:39], s28 offen sc1
    v_accvgpr_read_b32 v240, a8
    v_accvgpr_read_b32 v241, a9
    v_accvgpr_read_b32 v242, a10
    v_accvgpr_read_b32 v243, a11
    v_pk_mul_f32 v[240:241], v[240:241], s[30:31] op_sel_hi:[1,0]
    v_pk_mul_f32 v[242:243], v[242:243], s[30:31] op_sel_hi:[1,0]
    v_cvt_pk_bf16_f32 v236, v240, v241
    v_cvt_pk_bf16_f32 v237, v242, v243
    v_accvgpr_read_b32 v240, a12
    v_accvgpr_read_b32 v241, a13
    v_accvgpr_read_b32 v242, a14
    v_accvgpr_read_b32 v243, a15
KP_wm_p22:
    s_cbranch_execz KP_wm_p23
    v_pk_mul_f32 v[240:241], v[240:241], s[30:31] op_sel_hi:[1,0]
    v_pk_mul_f32 v[242:243], v[242:243], s[30:31] op_sel_hi:[1,0]
    v_cvt_pk_bf16_f32 v238, v240, v241
    v_cvt_pk_bf16_f32 v239, v242, v243
    v_accvgpr_write_b32 a132, v236
    v_accvgpr_write_b32 a133, v237
    v_accvgpr_write_b32 a134, v238
    v_accvgpr_write_b32 a135, v239
    s_add_u32 s28, s31, 14336
    buffer_store_dwordx4 v[236:239], v4, s[36:39], s28 offen sc1
    v_accvgpr_read_b32 v240, a16
    v_accvgpr_read_b32 v241, a17
    v_accvgpr_read_b32 v242, a18
    v_accvgpr_read_b32 v243, a19
KP_wm_p23:
    s_cbranch_execz KP_wm_p24
    v_pk_mul_f32 v[240:241], v[240:241], s[30:31] op_sel_hi:[1,0]
    v_pk_mul_f32 v[242:243], v[242:243], s[30:31] op_sel_hi:[1,0]
    v_cvt_pk_bf16_f32 v232, v240, v241
    v_cvt_pk_bf16_f32 v233, v242, v243
    v_accvgpr_read_b32 v240, a20
    v_accvgpr_read_b32 v241, a21
    v_accvgpr_read_b32 v242, a22
    v_accvgpr_read_b32 v243, a23
    v_pk_mul_f32 v[240:241], v[240:241], s[30:31] op_sel_hi:[1,0]
    v_pk_mul_f32 v[242:243], v[242:243], s[30:31] op_sel_hi:[1,0]
    v_cvt_pk_bf16_f32 v234, v240, v241
    v_cvt_pk_bf16_f32 v235, v242, v243
    v_accvgpr_write_b32 a136, v232
    v_accvgpr_write_b32 a137, v233
KP_wm_p24:
    s_cbranch_execz KP_wm_p25
    v_accvgpr_write_b32 a138, v234
    v_accvgpr_write_b32 a139, v235
    s_add_u32 s28, s31, 28672
    buffer_store_dwordx4 v[232:235], v4, s[36:39], s28 offen sc1
    v_accvgpr_read_b32 v240, a24
    v_accvgpr_read_b32 v241, a25
    v_accvgpr_read_b32 v242, a26
    v_accvgpr_read_b32 v243, a27
    v_pk_mul_f32 v[240:241], v[240:241], s[30:31] op_sel_hi:[1,0]
    v_pk_mul_f32 v[242:243], v[242:243], s[30:31] op_sel_hi:[1,0]
    v_cvt_pk_bf16_f32 v236, v240, v241
    v_cvt_pk_bf16_f32 v237, v242, v243
    v_accvgpr_read_b32 v240, a28
    v_accvgpr_read_b32 v241, a29
KP_wm_p25:
    s_cbranch_execz KP_wm_p26
    v_accvgpr_read_b32 v242, a30
    v_accvgpr_read_b32 v243, a31
    v_pk_mul_f32 v[240:241], v[240:241], s[30:31] op_sel_hi:[1,0]
    v_pk_mul_f32 v[242:243], v[242:243], s[30:31] op_sel_hi:[1,0]
    v_cvt_pk_bf16_f32 v238, v240, v241
    v_cvt_pk_bf16_f32 v239, v242, v243
    v_accvgpr_write_b32 a140, v236
    v_accvgpr_write_b32 a141, v237
    v_accvgpr_write_b32 a142, v238
    v_accvgpr_write_b32 a143, v239
    s_add_u32 s28, s31, 43008
    buffer_store_dwordx4 v[236:239], v4, s[36:39], s28 offen sc1
    s_add_u32 s27, s3, 8
    s_lshl_b32 s27, s27, 18
    s_add_u32 s27, s27, s25
KP_wm_p26:
    s_cbranch_execz KP_wm_p27
    s_add_u32 m0, s32, 0
    s_nop 0
    buffer_load_dwordx4 v216, s[40:43], s27 offen lds
    s_add_u32 m0, m0, 1024
    s_nop 0
    buffer_load_dwordx4 v217, s[40:43], s27 offen lds
    s_add_u32 m0, m0, 1024
    s_nop 0
    buffer_load_dwordx4 v218, s[40:43], s27 offen lds
    s_add_u32 m0, m0, 1024
    s_nop 0
    buffer_load_dwordx4 v219, s[40:43], s27 offen lds
    s_add_u32 m0, m0, 1024
    s_nop 0
    buffer_load_dwordx4 v220, s[40:43], s27 offen lds
    s_add_u32 m0, m0, 1024
    s_nop 0
    buffer_load_dwordx4 v221, s[40:43], s27 offen lds
    s_add_u32 m0, m0, 1024
    s_nop 0
    buffer_load_dwordx4 v222, s[40:43], s27 offen lds
KP_wm_p27:
    s_cbranch_execz KP_wm_p28
    s_add_u32 m0, m0, 1024
    s_nop 0
    buffer_load_dwordx4 v223, s[40:43], s27 offen lds
    s_add_u32 m0, m0, 1024
    s_add_u32 s27, s27, 32768
    buffer_load_dwordx4 v216, s[40:43], s27 offen lds
    s_add_u32 m0, m0, 1024
    s_nop 0
    buffer_load_dwordx4 v217, s[40:43], s27 offen lds
    s_add_u32 m0, m0, 1024
    s_nop 0
    buffer_load_dwordx4 v218, s[40:43], s27 offen lds
    s_add_u32 m0, m0, 1024
    s_nop 0
    buffer_load_dwordx4 v219, s[40:43], s27 offen lds
    s_add_u32 m0, m0, 1024
    s_nop 0
    buffer_load_dwordx4 v220, s[40:43], s27 offen lds
    s_add_u32 m0, m0, 1024
KP_wm_p28:
    s_cbranch_execz KP_wm_p29
    buffer_load_dwordx4 v221, s[40:43], s27 offen lds
    s_add_u32 m0, m0, 1024
    s_nop 0
    buffer_load_dwordx4 v222, s[40:43], s27 offen lds
    s_add_u32 m0, m0, 1024
    s_nop 0
    buffer_load_dwordx4 v223, s[40:43], s27 offen lds
    s_add_u32 m0, m0, 1024
    s_waitcnt vmcnt(20)
    ds_read_b128 v[136:139], v224 offset:16384
    ds_read_b128 v[140:143], v225 offset:16384
    ds_read_b128 v[144:147], v226 offset:16384
    ds_read_b128 v[148:151], v227 offset:16384
    ds_read_b128 v[152:155], v228 offset:16384
    ds_read_b128 v[156:159], v229 offset:16384
    ds_read_b128 v[160:163], v230 offset:16384
KP_wm_p29:
    s_cbranch_execz KP_wm_p30
    ds_read_b128 v[164:167], v231 offset:16384
    s_waitcnt lgkmcnt(7)
    ds_read_b128 v[168:171], v224 offset:24576
    ds_read_b128 v[172:175], v225 offset:24576
    ds_read_b128 v[176:179], v226 offset:24576
    ds_read_b128 v[180:183], v227 offset:24576
    ds_read_b128 v[184:187], v228 offset:24576
    ds_read_b128 v[188:191], v229 offset:24576
    ds_read_b128 v[192:195], v230 offset:24576
    ds_read_b128 v[196:199], v231 offset:24576
    s_waitcnt lgkmcnt(15)
    v_mfma_f32_16x16x32_bf16 a[32:35], v[136:139], v[8:11], 0
    v_mfma_f32_16x16x32_bf16 a[40:43], v[136:139], v[40:43], 0
    v_mfma_f32_16x16x32_bf16 a[48:51], v[136:139], v[72:75], 0
    v_mfma_f32_16x16x32_bf16 a[56:59], v[136:139], v[104:107], 0
KP_wm_p30:
    s_cbranch_execz KP_wm_p31
    s_waitcnt lgkmcnt(14)
    v_mfma_f32_16x16x32_bf16 a[32:35], v[140:143], v[12:15], a[32:35]
    v_mfma_f32_16x16x32_bf16 a[40:43], v[140:143], v[44:47], a[40:43]
    v_mfma_f32_16x16x32_bf16 a[48:51], v[140:143], v[76:79], a[48:51]
    v_mfma_f32_16x16x32_bf16 a[56:59], v[140:143], v[108:111], a[56:59]
    s_waitcnt lgkmcnt(13)
    v_mfma_f32_16x16x32_bf16 a[32:35], v[144:147], v[16:19], a[32:35]
    v_mfma_f32_16x16x32_bf16 a[40:43], v[144:147], v[48:51], a[40:43]
    v_mfma_f32_16x16x32_bf16 a[48:51], v[144:147], v[80:83], a[48:51]
    v_mfma_f32_16x16x32_bf16 a[56:59], v[144:147], v[112:115], a[56:59]
    s_waitcnt lgkmcnt(12)
    v_mfma_f32_16x16x32_bf16 a[32:35], v[148:151], v[20:23], a[32:35]
    v_mfma_f32_16x16x32_bf16 a[40:43], v[148:151], v[52:55], a[40:43]
    v_mfma_f32_16x16x32_bf16 a[48:51], v[148:151], v[84:87], a[48:51]
    v_mfma_f32_16x16x32_bf16 a[56:59], v[148:151], v[116:119], a[56:59]
KP_wm_p31:
    s_cbranch_execz KP_wm_p32
    s_waitcnt lgkmcnt(11)
    v_mfma_f32_16x16x32_bf16 a[32:35], v[152:155], v[24:27], a[32:35]
    v_mfma_f32_16x16x32_bf16 a[40:43], v[152:155], v[56:59], a[40:43]
    v_mfma_f32_16x16x32_bf16 a[48:51], v[152:155], v[88:91], a[48:51]
    v_mfma_f32_16x16x32_bf16 a[56:59], v[152:155], v[120:123], a[56:59]
    s_waitcnt lgkmcnt(10)
    v_mfma_f32_16x16x32_bf16 a[32:35], v[156:159], v[28:31], a[32:35]
    v_mfma_f32_16x16x32_bf16 a[40:43], v[156:159], v[60:63], a[40:43]
    v_mfma_f32_16x16x32_bf16 a[48:51], v[156:159], v[92:95], a[48:51]
    v_mfma_f32_16x16x32_bf16 a[56:59], v[156:159], v[124:127], a[56:59]
    s_waitcnt lgkmcnt(9)
    v_mfma_f32_16x16x32_bf16 a[32:35], v[160:163], v[32:35], a[32:35]
    v_mfma_f32_16x16x32_bf16 a[40:43], v[160:163], v[64:67], a[40:43]
    v_mfma_f32_16x16x32_bf16 a[48:51], v[160:163], v[96:99], a[48:51]
    v_mfma_f32_16x16x32_bf16 a[56:59], v[160:163], v[128:131], a[56:59]
KP_wm_p32:
    s_cbranch_execz KP_wm_p33
    s_waitcnt lgkmcnt(8)
    v_mfma_f32_16x16x32_bf16 a[32:35], v[164:167], v[36:39], a[32:35]
    v_mfma_f32_16x16x32_bf16 a[40:43], v[164:167], v[68:71], a[40:43]
    v_mfma_f32_16x16x32_bf16 a[48:51], v[164:167], v[100:103], a[48:51]
    v_mfma_f32_16x16x32_bf16 a[56:59], v[164:167], v[132:135], a[56:59]
    s_waitcnt lgkmcnt(7)
    v_mfma_f32_16x16x32_bf16 a[36:39], v[168:171], v[8:11], 0
    v_mfma_f32_16x16x32_bf16 a[44:47], v[168:171], v[40:43], 0
    v_mfma_f32_16x16x32_bf16 a[52:55], v[168:171], v[72:75], 0
    v_mfma_f32_16x16x32_bf16 a[60:63], v[168:171], v[104:107], 0
    s_waitcnt lgkmcnt(6)
    v_mfma_f32_16x16x32_bf16 a[36:39], v[172:175], v[12:15], a[36:39]
    v_mfma_f32_16x16x32_bf16 a[44:47], v[172:175], v[44:47], a[44:47]
    v_mfma_f32_16x16x32_bf16 a[52:55], v[172:175], v[76:79], a[52:55]
    v_mfma_f32_16x16x32_bf16 a[60:63], v[172:175], v[108:111], a[60:63]
KP_wm_p33:
    s_cbranch_execz KP_wm_p34
    s_waitcnt lgkmcnt(5)
    v_mfma_f32_16x16x32_bf16 a[36:39], v[176:179], v[16:19], a[36:39]
    v_mfma_f32_16x16x32_bf16 a[44:47], v[176:179], v[48:51], a[44:47]
    v_mfma_f32_16x16x32_bf16 a[52:55], v[176:179], v[80:83], a[52:55]
    v_mfma_f32_16x16x32_bf16 a[60:63], v[176:179], v[112:115], a[60:63]
    s_waitcnt lgkmcnt(4)
    v_mfma_f32_16x16x32_bf16 a[36:39], v[180:183], v[20:23], a[36:39]
    v_mfma_f32_16x16x32_bf16 a[44:47], v[180:183], v[52:55], a[44:47]
    v_mfma_f32_16x16x32_bf16 a[52:55], v[180:183], v[84:87], a[52:55]
    v_mfma_f32_16x16x32_bf16 a[60:63], v[180:183], v[116:119], a[60:63]
    s_waitcnt lgkmcnt(3)
    v_mfma_f32_16x16x32_bf16 a[36:39], v[184:187], v[24:27], a[36:39]
    v_mfma_f32_16x16x32_bf16 a[44:47], v[184:187], v[56:59], a[44:47]
    v_mfma_f32_16x16x32_bf16 a[52:55], v[184:187], v[88:91], a[52:55]
    v_mfma_f32_16x16x32_bf16 a[60:63], v[184:187], v[120:123], a[60:63]
KP_wm_p34:
    s_cbranch_execz KP_wm_ret
    s_waitcnt lgkmcnt(2)
    v_mfma_f32_16x16x32_bf16 a[36:39], v[188:191], v[28:31], a[36:39]
    v_mfma_f32_16x16x32_bf16 a[44:47], v[188:191], v[60:63], a[44:47]
    v_mfma_f32_16x16x32_bf16 a[52:55], v[188:191], v[92:95], a[52:55]
    v_mfma_f32_16x16x32_bf16 a[60:63], v[188:191], v[124:127], a[60:63]
    s_waitcnt lgkmcnt(1)
    v_mfma_f32_16x16x32_bf16 a[36:39], v[192:195], v[32:35], a[36:39]
    v_mfma_f32_16x16x32_bf16 a[44:47], v[192:195], v[64:67], a[44:47]
    v_mfma_f32_16x16x32_bf16 a[52:55], v[192:195], v[96:99], a[52:55]
    v_mfma_f32_16x16x32_bf16 a[60:63], v[192:195], v[128:131], a[60:63]
    s_waitcnt lgkmcnt(0)
    v_mfma_f32_16x16x32_bf16 a[36:39], v[196:199], v[36:39], a[36:39]
    v_mfma_f32_16x16x32_bf16 a[44:47], v[196:199], v[68:71], a[44:47]
    v_mfma_f32_16x16x32_bf16 a[52:55], v[196:199], v[100:103], a[52:55]
    v_mfma_f32_16x16x32_bf16 a[60:63], v[196:199], v[132:135], a[60:63]
KP_wm_p35:
    s_cbranch_execz KP_wm_p36
    s_waitcnt vmcnt(16)
    s_add_u32 s28, s95, 1
    v_mov_b32 v7, s28
    buffer_store_dword v7, v6, s[48:51], s33 offen sc1
    v_accvgpr_read_b32 v240, a32
    v_accvgpr_read_b32 v241, a33
    v_accvgpr_read_b32 v242, a34
    v_accvgpr_read_b32 v243, a35
    v_pk_mul_f32 v[240:241], v[240:241], s[30:31] op_sel_hi:[1,0]
    v_pk_mul_f32 v[242:243], v[242:243], s[30:31] op_sel_hi:[1,0]
    v_cvt_pk_bf16_f32 v232, v240, v241
    v_cvt_pk_bf16_f32 v233, v242, v243
    v_accvgpr_read_b32 v240, a36
    v_accvgpr_read_b32 v241, a37
    v_accvgpr_read_b32 v242, a38
KP_wm_p36:
    s_cbranch_execz KP_wm_p37
    v_accvgpr_read_b32 v243, a39
    v_pk_mul_f32 v[240:241], v[240:241], s[30:31] op_sel_hi:[1,0]
    v_pk_mul_f32 v[242:243], v[242:243], s[30:31] op_sel_hi:[1,0]
    v_cvt_pk_bf16_f32 v234, v240, v241
    v_cvt_pk_bf16_f32 v235, v242, v243
    v_accvgpr_write_b32 a144, v232
    v_accvgpr_write_b32 a145, v233
    v_accvgpr_write_b32 a146, v234
    v_accvgpr_write_b32 a147, v235
    s_add_u32 s28, s31, 4096
    buffer_store_dwordx4 v[232:235], v4, s[36:39], s28 offen sc1
    v_accvgpr_read_b32 v240, a40
    v_accvgpr_read_b32 v241, a41
    v_accvgpr_read_b32 v242, a42
KP_wm_p37:
    s_cbranch_execz KP_wm_p38
    v_accvgpr_read_b32 v243, a43
    v_pk_mul_f32 v[240:241], v[240:241], s[30:31] op_sel_hi:[1,0]
    v_pk_mul_f32 v[242:243], v[242:243], s[30:31] op_sel_hi:[1,0]
    v_cvt_pk_bf16_f32 v236, v240, v241
    v_cvt_pk_bf16_f32 v237, v242, v243
    v_accvgpr_read_b32 v240, a44
    v_accvgpr_read_b32 v241, a45
    v_accvgpr_read_b32 v242, a46
    v_accvgpr_read_b32 v243, a47
    v_pk_mul_f32 v[240:241], v[240:241], s[30:31] op_sel_hi:[1,0]
    v_pk_mul_f32 v[242:243], v[242:243], s[30:31] op_sel_hi:[1,0]
    v_cvt_pk_bf16_f32 v238, v240, v241
    v_cvt_pk_bf16_f32 v239, v242, v243
    v_accvgpr_write_b32 a148, v236
KP_wm_p38:
    s_cbranch_execz KP_wm_p39
    v_accvgpr_write_b32 a149, v237
    v_accvgpr_write_b32 a150, v238
    v_accvgpr_write_b32 a151, v239
    s_add_u32 s28, s31, 18432
    buffer_store_dwordx4 v[236:239], v4, s[36:39], s28 offen sc1
    v_accvgpr_read_b32 v240, a48
    v_accvgpr_read_b32 v241, a49
    v_accvgpr_read_b32 v242, a50
    v_accvgpr_read_b32 v243, a51
    v_pk_mul_f32 v[240:241], v[240:241], s[30:31] op_sel_hi:[1,0]
    v_pk_mul_f32 v[242:243], v[242:243], s[30:31] op_sel_hi:[1,0]
    v_cvt_pk_bf16_f32 v232, v240, v241
    v_cvt_pk_bf16_f32 v233, v242, v243
    v_accvgpr_read_b32 v240, a52
KP_wm_p39:
    s_cbranch_execz KP_wm_p40
    v_accvgpr_read_b32 v241, a53
    v_accvgpr_read_b32 v242, a54
    v_accvgpr_read_b32 v243, a55
    v_pk_mul_f32 v[240:241], v[240:241], s[30:31] op_sel_hi:[1,0]
    v_pk_mul_f32 v[242:243], v[242:243], s[30:31] op_sel_hi:[1,0]
    v_cvt_pk_bf16_f32 v234, v240, v241
    v_cvt_pk_bf16_f32 v235, v242, v243
    v_accvgpr_write_b32 a152, v232
    v_accvgpr_write_b32 a153, v233
    v_accvgpr_write_b32 a154, v234
    v_accvgpr_write_b32 a155, v235
    s_add_u32 s28, s31, 32768
    buffer_store_dwordx4 v[232:235], v4, s[36:39], s28 offen sc1
    v_accvgpr_read_b32 v240, a56
KP_wm_p40:
    s_cbranch_execz KP_wm_p41
    v_accvgpr_read_b32 v241, a57
    v_accvgpr_read_b32 v242, a58
    v_accvgpr_read_b32 v243, a59
    v_pk_mul_f32 v[240:241], v[240:241], s[30:31] op_sel_hi:[1,0]
    v_pk_mul_f32 v[242:243], v[242:243], s[30:31] op_sel_hi:[1,0]
    v_cvt_pk_bf16_f32 v236, v240, v241
    v_cvt_pk_bf16_f32 v237, v242, v243
    v_accvgpr_read_b32 v240, a60
    v_accvgpr_read_b32 v241, a61
    v_accvgpr_read_b32 v242, a62
    v_accvgpr_read_b32 v243, a63
    v_pk_mul_f32 v[240:241], v[240:241], s[30:31] op_sel_hi:[1,0]
    v_pk_mul_f32 v[242:243], v[242:243], s[30:31] op_sel_hi:[1,0]
    v_cvt_pk_bf16_f32 v238, v240, v241
KP_wm_p41:
    s_cbranch_execz KP_wm_p42
    v_cvt_pk_bf16_f32 v239, v242, v243
    v_accvgpr_write_b32 a156, v236
    v_accvgpr_write_b32 a157, v237
    v_accvgpr_write_b32 a158, v238
    v_accvgpr_write_b32 a159, v239
    s_add_u32 s28, s31, 47104
    buffer_store_dwordx4 v[236:239], v4, s[36:39], s28 offen sc1
    s_add_u32 s27, s3, 12
    s_lshl_b32 s27, s27, 18
    s_add_u32 s27, s27, s25
    s_add_u32 m0, s32, 16384
    s_nop 0
    buffer_load_dwordx4 v216, s[40:43], s27 offen lds
    s_add_u32 m0, m0, 1024
    s_nop 0
    buffer_load_dwordx4 v217, s[40:43], s27 offen lds
    s_add_u32 m0, m0, 1024
KP_wm_p42:
    s_cbranch_execz KP_wm_p43
    buffer_load_dwordx4 v218, s[40:43], s27 offen lds
    s_add_u32 m0, m0, 1024
    s_nop 0
    buffer_load_dwordx4 v219, s[40:43], s27 offen lds
    s_add_u32 m0, m0, 1024
    s_nop 0
    buffer_load_dwordx4 v220, s[40:43], s27 offen lds
    s_add_u32 m0, m0, 1024
    s_nop 0
    buffer_load_dwordx4 v221, s[40:43], s27 offen lds
    s_add_u32 m0, m0, 1024
    s_nop 0
    buffer_load_dwordx4 v222, s[40:43], s27 offen lds
    s_add_u32 m0, m0, 1024
    s_nop 0
    buffer_load_dwordx4 v223, s[40:43], s27 offen lds
    s_add_u32 m0, m0, 1024
    s_add_u32 s27, s27, 32768
    buffer_load_dwordx4 v216, s[40:43], s27 offen lds
KP_wm_p43:
    s_cbranch_execz KP_wm_p44
    s_add_u32 m0, m0, 1024
    s_nop 0
    buffer_load_dwordx4 v217, s[40:43], s27 offen lds
    s_add_u32 m0, m0, 1024
    s_nop 0
    buffer_load_dwordx4 v218, s[40:43], s27 offen lds
    s_add_u32 m0, m0, 1024
    s_nop 0
    buffer_load_dwordx4 v219, s[40:43], s27 offen lds
    s_add_u32 m0, m0, 1024
    s_nop 0
    buffer_load_dwordx4 v220, s[40:43], s27 offen lds
    s_add_u32 m0, m0, 1024
    s_nop 0
    buffer_load_dwordx4 v221, s[40:43], s27 offen lds
    s_add_u32 m0, m0, 1024
    s_nop 0
    buffer_load_dwordx4 v222, s[40:43], s27 offen lds
    s_add_u32 m0, m0, 1024
    s_nop 0
    buffer_load_dwordx4 v223, s[40:43], s27 offen lds
KP_wm_p44:
    s_cbranch_execz KP_wm_p45
    s_add_u32 m0, m0, 1024
    s_waitcnt vmcnt(21)
    ds_read_b128 v[136:139], v224 offset:0
    ds_read_b128 v[140:143], v225 offset:0
    ds_read_b128 v[144:147], v226 offset:0
    ds_read_b128 v[148:151], v227 offset:0
    ds_read_b128 v[152:155], v228 offset:0
    ds_read_b128 v[156:159], v229 offset:0
    ds_read_b128 v[160:163], v230 offset:0
    ds_read_b128 v[164:167], v231 offset:0
    s_waitcnt lgkmcnt(7)
    ds_read_b128 v[168:171], v224 offset:8192
    ds_read_b128 v[172:175], v225 offset:8192
    ds_read_b128 v[176:179], v226 offset:8192
    ds_read_b128 v[180:183], v227 offset:8192
KP_wm_p45:
    s_cbranch_execz KP_wm_p46
    ds_read_b128 v[184:187], v228 offset:8192
    ds_read_b128 v[188:191], v229 offset:8192
    ds_read_b128 v[192:195], v230 offset:8192
    ds_read_b128 v[196:199], v231 offset:8192
    s_waitcnt lgkmcnt(15)
    v_mfma_f32_16x16x32_bf16 a[64:67], v[136:139], v[8:11], 0
    v_mfma_f32_16x16x32_bf16 a[72:75], v[136:139], v[40:43], 0
    v_mfma_f32_16x16x32_bf16 a[80:83], v[136:139], v[72:75], 0
    v_mfma_f32_16x16x32_bf16 a[88:91], v[136:139], v[104:107], 0
    s_waitcnt lgkmcnt(14)
    v_mfma_f32_16x16x32_bf16 a[64:67], v[140:143], v[12:15], a[64:67]
    v_mfma_f32_16x16x32_bf16 a[72:75], v[140:143], v[44:47], a[72:75]
    v_mfma_f32_16x16x32_bf16 a[80:83], v[140:143], v[76:79], a[80:83]
    v_mfma_f32_16x16x32_bf16 a[88:91], v[140:143], v[108:111], a[88:91]
    s_waitcnt lgkmcnt(13)
KP_wm_p46:
    s_cbranch_execz KP_wm_p47
    v_mfma_f32_16x16x32_bf16 a[64:67], v[144:147], v[16:19], a[64:67]
    v_mfma_f32_16x16x32_bf16 a[72:75], v[144:147], v[48:51], a[72:75]
    v_mfma_f32_16x16x32_bf16 a[80:83], v[144:147], v[80:83], a[80:83]
    v_mfma_f32_16x16x32_bf16 a[88:91], v[144:147], v[112:115], a[88:91]
    s_waitcnt lgkmcnt(12)
    v_mfma_f32_16x16x32_bf16 a[64:67], v[148:151], v[20:23], a[64:67]
    v_mfma_f32_16x16x32_bf16 a[72:75], v[148:151], v[52:55], a[72:75]
    v_mfma_f32_16x16x32_bf16 a[80:83], v[148:151], v[84:87], a[80:83]
    v_mfma_f32_16x16x32_bf16 a[88:91], v[148:151], v[116:119], a[88:91]
    s_waitcnt lgkmcnt(11)
    v_mfma_f32_16x16x32_bf16 a[64:67], v[152:155], v[24:27], a[64:67]
    v_mfma_f32_16x16x32_bf16 a[72:75], v[152:155], v[56:59], a[72:75]
    v_mfma_f32_16x16x32_bf16 a[80:83], v[152:155], v[88:91], a[80:83]
    v_mfma_f32_16x16x32_bf16 a[88:91], v[152:155], v[120:123], a[88:91]
    s_waitcnt lgkmcnt(10)
KP_wm_p47:
    s_cbranch_execz KP_wm_p48
    v_mfma_f32_16x16x32_bf16 a[64:67], v[156:159], v[28:31], a[64:67]
    v_mfma_f32_16x16x32_bf16 a[72:75], v[156:159], v[60:63], a[72:75]
    v_mfma_f32_16x16x32_bf16 a[80:83], v[156:159], v[92:95], a[80:83]
    v_mfma_f32_16x16x32_bf16 a[88:91], v[156:159], v[124:127], a[88:91]
    s_waitcnt lgkmcnt(9)
    v_mfma_f32_16x16x32_bf16 a[64:67], v[160:163], v[32:35], a[64:67]
    v_mfma_f32_16x16x32_bf16 a[72:75], v[160:163], v[64:67], a[72:75]
    v_mfma_f32_16x16x32_bf16 a[80:83], v[160:163], v[96:99], a[80:83]
    v_mfma_f32_16x16x32_bf16 a[88:91], v[160:163], v[128:131], a[88:91]
    s_waitcnt lgkmcnt(8)
    v_mfma_f32_16x16x32_bf16 a[64:67], v[164:167], v[36:39], a[64:67]
    v_mfma_f32_16x16x32_bf16 a[72:75], v[164:167], v[68:71], a[72:75]
    v_mfma_f32_16x16x32_bf16 a[80:83], v[164:167], v[100:103], a[80:83]
    v_mfma_f32_16x16x32_bf16 a[88:91], v[164:167], v[132:135], a[88:91]
    s_waitcnt lgkmcnt(7)
KP_wm_p48:
    s_cbranch_execz KP_wm_p49
    v_mfma_f32_16x16x32_bf16 a[68:71], v[168:171], v[8:11], 0
    v_mfma_f32_16x16x32_bf16 a[76:79], v[168:171], v[40:43], 0
    v_mfma_f32_16x16x32_bf16 a[84:87], v[168:171], v[72:75], 0
    v_mfma_f32_16x16x32_bf16 a[92:95], v[168:171], v[104:107], 0
    s_waitcnt lgkmcnt(6)
    v_mfma_f32_16x16x32_bf16 a[68:71], v[172:175], v[12:15], a[68:71]
    v_mfma_f32_16x16x32_bf16 a[76:79], v[172:175], v[44:47], a[76:79]
    v_mfma_f32_16x16x32_bf16 a[84:87], v[172:175], v[76:79], a[84:87]
    v_mfma_f32_16x16x32_bf16 a[92:95], v[172:175], v[108:111], a[92:95]
    s_waitcnt lgkmcnt(5)
    v_mfma_f32_16x16x32_bf16 a[68:71], v[176:179], v[16:19], a[68:71]
    v_mfma_f32_16x16x32_bf16 a[76:79], v[176:179], v[48:51], a[76:79]
    v_mfma_f32_16x16x32_bf16 a[84:87], v[176:179], v[80:83], a[84:87]
    v_mfma_f32_16x16x32_bf16 a[92:95], v[176:179], v[112:115], a[92:95]
    s_waitcnt lgkmcnt(4)
KP_wm_p49:
    s_cbranch_execz KP_wm_p50
    v_mfma_f32_16x16x32_bf16 a[68:71], v[180:183], v[20:23], a[68:71]
    v_mfma_f32_16x16x32_bf16 a[76:79], v[180:183], v[52:55], a[76:79]
    v_mfma_f32_16x16x32_bf16 a[84:87], v[180:183], v[84:87], a[84:87]
    v_mfma_f32_16x16x32_bf16 a[92:95], v[180:183], v[116:119], a[92:95]
    s_waitcnt lgkmcnt(3)
    v_mfma_f32_16x16x32_bf16 a[68:71], v[184:187], v[24:27], a[68:71]
    v_mfma_f32_16x16x32_bf16 a[76:79], v[184:187], v[56:59], a[76:79]
    v_mfma_f32_16x16x32_bf16 a[84:87], v[184:187], v[88:91], a[84:87]
    v_mfma_f32_16x16x32_bf16 a[92:95], v[184:187], v[120:123], a[92:95]
    s_waitcnt lgkmcnt(2)
    v_mfma_f32_16x16x32_bf16 a[68:71], v[188:191], v[28:31], a[68:71]
    v_mfma_f32_16x16x32_bf16 a[76:79], v[188:191], v[60:63], a[76:79]
    v_mfma_f32_16x16x32_bf16 a[84:87], v[188:191], v[92:95], a[84:87]
    v_mfma_f32_16x16x32_bf16 a[92:95], v[188:191], v[124:127], a[92:95]
    s_waitcnt lgkmcnt(1)
KP_wm_p50:
    s_cbranch_execz KP_wm_p51
    v_mfma_f32_16x16x32_bf16 a[68:71], v[192:195], v[32:35], a[68:71]
    v_mfma_f32_16x16x32_bf16 a[76:79], v[192:195], v[64:67], a[76:79]
    v_mfma_f32_16x16x32_bf16 a[84:87], v[192:195], v[96:99], a[84:87]
    v_mfma_f32_16x16x32_bf16 a[92:95], v[192:195], v[128:131], a[92:95]
    s_waitcnt lgkmcnt(0)
    v_mfma_f32_16x16x32_bf16 a[68:71], v[196:199], v[36:39], a[68:71]
    v_mfma_f32_16x16x32_bf16 a[76:79], v[196:199], v[68:71], a[76:79]
    v_mfma_f32_16x16x32_bf16 a[84:87], v[196:199], v[100:103], a[84:87]
    v_mfma_f32_16x16x32_bf16 a[92:95], v[196:199], v[132:135], a[92:95]
    s_waitcnt vmcnt(16)
    s_add_u32 s28, s95, 2
    v_mov_b32 v7, s28
    buffer_store_dword v7, v6, s[48:51], s33 offen sc1
    v_accvgpr_read_b32 v240, a64
    v_accvgpr_read_b32 v241, a65
    v_accvgpr_read_b32 v242, a66
KP_wm_p51:
    s_cbranch_execz KP_wm_p52
    v_accvgpr_read_b32 v243, a67
    v_pk_mul_f32 v[240:241], v[240:241], s[30:31] op_sel_hi:[1,0]
    v_pk_mul_f32 v[242:243], v[242:243], s[30:31] op_sel_hi:[1,0]
    v_cvt_pk_bf16_f32 v232, v240, v241
    v_cvt_pk_bf16_f32 v233, v242, v243
    v_accvgpr_read_b32 v240, a68
    v_accvgpr_read_b32 v241, a69
    v_accvgpr_read_b32 v242, a70
    v_accvgpr_read_b32 v243, a71
    v_pk_mul_f32 v[240:241], v[240:241], s[30:31] op_sel_hi:[1,0]
    v_pk_mul_f32 v[242:243], v[242:243], s[30:31] op_sel_hi:[1,0]
    v_cvt_pk_bf16_f32 v234, v240, v241
    v_cvt_pk_bf16_f32 v235, v242, v243
    v_accvgpr_write_b32 a160, v232
KP_wm_p52:
    s_cbranch_execz KP_wm_ret
    v_accvgpr_write_b32 a161, v233
    v_accvgpr_write_b32 a162, v234
    v_accvgpr_write_b32 a163, v235
    s_add_u32 s28, s31, 8192
    buffer_store_dwordx4 v[232:235], v4, s[36:39], s28 offen sc1
    v_accvgpr_read_b32 v240, a72
    v_accvgpr_read_b32 v241, a73
    v_accvgpr_read_b32 v242, a74
    v_accvgpr_read_b32 v243, a75
    v_pk_mul_f32 v[240:241], v[240:241], s[30:31] op_sel_hi:[1,0]
    v_pk_mul_f32 v[242:243], v[242:243], s[30:31] op_sel_hi:[1,0]
    v_cvt_pk_bf16_f32 v236, v240, v241
    v_cvt_pk_bf16_f32 v237, v242, v243
    v_accvgpr_read_b32 v240, a76
KP_wm_p53:
    s_cbranch_execz KP_wm_p54
    v_accvgpr_read_b32 v241, a77
    v_accvgpr_read_b32 v242, a78
    v_accvgpr_read_b32 v243, a79
    v_pk_mul_f32 v[240:241], v[240:241], s[30:31] op_sel_hi:[1,0]
    v_pk_mul_f32 v[242:243], v[242:243], s[30:31] op_sel_hi:[1,0]
    v_cvt_pk_bf16_f32 v238, v240, v241
    v_cvt_pk_bf16_f32 v239, v242, v243
    v_accvgpr_write_b32 a164, v236
    v_accvgpr_write_b32 a165, v237
    v_accvgpr_write_b32 a166, v238
    v_accvgpr_write_b32 a167, v239
    s_add_u32 s28, s31, 22528
    buffer_store_dwordx4 v[236:239], v4, s[36:39], s28 offen sc1
    v_accvgpr_read_b32 v240, a80
KP_wm_p54:
    s_cbranch_execz KP_wm_p55
    v_accvgpr_read_b32 v241, a81
    v_accvgpr_read_b32 v242, a82
    v_accvgpr_read_b32 v243, a83
    v_pk_mul_f32 v[240:241], v[240:241], s[30:31] op_sel_hi:[1,0]
    v_pk_mul_f32 v[242:243], v[242:243], s[30:31] op_sel_hi:[1,0]
    v_cvt_pk_bf16_f32 v232, v240, v241
    v_cvt_pk_bf16_f32 v233, v242, v243
    v_accvgpr_read_b32 v240, a84
    v_accvgpr_read_b32 v241, a85
    v_accvgpr_read_b32 v242, a86
    v_accvgpr_read_b32 v243, a87
    v_pk_mul_f32 v[240:241], v[240:241], s[30:31] op_sel_hi:[1,0]
    v_pk_mul_f32 v[242:243], v[242:243], s[30:31] op_sel_hi:[1,0]
    v_cvt_pk_bf16_f32 v234, v240, v241
KP_wm_p55:
    s_cbranch_execz KP_wm_p56
    v_cvt_pk_bf16_f32 v235, v242, v243
    v_accvgpr_write_b32 a168, v232
    v_accvgpr_write_b32 a169, v233
    v_accvgpr_write_b32 a170, v234
    v_accvgpr_write_b32 a171, v235
    s_add_u32 s28, s31, 36864
    buffer_store_dwordx4 v[232:235], v4, s[36:39], s28 offen sc1
    v_accvgpr_read_b32 v240, a88
    v_accvgpr_read_b32 v241, a89
    v_accvgpr_read_b32 v242, a90
    v_accvgpr_read_b32 v243, a91
    v_pk_mul_f32 v[240:241], v[240:241], s[30:31] op_sel_hi:[1,0]
    v_pk_mul_f32 v[242:243], v[242:243], s[30:31] op_sel_hi:[1,0]
    v_cvt_pk_bf16_f32 v236, v240, v241
KP_wm_p56:
    s_cbranch_execz KP_wm_p57
    v_cvt_pk_bf16_f32 v237, v242, v243
    v_accvgpr_read_b32 v240, a92
    v_accvgpr_read_b32 v241, a93
    v_accvgpr_read_b32 v242, a94
    v_accvgpr_read_b32 v243, a95
    v_pk_mul_f32 v[240:241], v[240:241], s[30:31] op_sel_hi:[1,0]
    v_pk_mul_f32 v[242:243], v[242:243], s[30:31] op_sel_hi:[1,0]
    v_cvt_pk_bf16_f32 v238, v240, v241
    v_cvt_pk_bf16_f32 v239, v242, v243
    v_accvgpr_write_b32 a172, v236
    v_accvgpr_write_b32 a173, v237
    v_accvgpr_write_b32 a174, v238
    v_accvgpr_write_b32 a175, v239
    s_add_u32 s28, s31, 51200
KP_wm_p57:
    s_cbranch_execz KP_wm_p58
    buffer_store_dwordx4 v[236:239], v4, s[36:39], s28 offen sc1
    s_cmp_ge_u32 s3, 2
    s_cbranch_scc1 KP_short
    s_waitcnt vmcnt(5)
    ds_read_b128 v[136:139], v224 offset:16384
    ds_read_b128 v[140:143], v225 offset:16384
    ds_read_b128 v[144:147], v226 offset:16384
    ds_read_b128 v[148:151], v227 offset:16384
    ds_read_b128 v[152:155], v228 offset:16384
    ds_read_b128 v[156:159], v229 offset:16384
    ds_read_b128 v[160:163], v230 offset:16384
    ds_read_b128 v[164:167], v231 offset:16384
    s_waitcnt lgkmcnt(7)
    ds_read_b128 v[168:171], v224 offset:24576
    ds_read_b128 v[172:175], v225 offset:24576
    ds_read_b128 v[176:179], v226 offset:24576
KP_wm_p58:
    s_cbranch_execz KP_wm_p59
    ds_read_b128 v[180:183], v227 offset:24576
    ds_read_b128 v[184:187], v228 offset:24576
    ds_read_b128 v[188:191], v229 offset:24576
    ds_read_b128 v[192:195], v230 offset:24576
    ds_read_b128 v[196:199], v231 offset:24576
    s_waitcnt lgkmcnt(15)
    v_mfma_f32_16x16x32_bf16 a[96:99], v[136:139], v[8:11], 0
    v_mfma_f32_16x16x32_bf16 a[104:107], v[136:139], v[40:43], 0
    v_mfma_f32_16x16x32_bf16 a[112:115], v[136:139], v[72:75], 0
    v_mfma_f32_16x16x32_bf16 a[120:123], v[136:139], v[104:107], 0
    s_waitcnt lgkmcnt(14)
    v_mfma_f32_16x16x32_bf16 a[96:99], v[140:143], v[12:15], a[96:99]
    v_mfma_f32_16x16x32_bf16 a[104:107], v[140:143], v[44:47], a[104:107]
    v_mfma_f32_16x16x32_bf16 a[112:115], v[140:143], v[76:79], a[112:115]
    v_mfma_f32_16x16x32_bf16 a[120:123], v[140:143], v[108:111], a[120:123]
KP_wm_p59:
    s_cbranch_execz KP_wm_p60
    s_waitcnt lgkmcnt(13)
    v_mfma_f32_16x16x32_bf16 a[96:99], v[144:147], v[16:19], a[96:99]
    v_mfma_f32_16x16x32_bf16 a[104:107], v[144:147], v[48:51], a[104:107]
    v_mfma_f32_16x16x32_bf16 a[112:115], v[144:147], v[80:83], a[112:115]
    v_mfma_f32_16x16x32_bf16 a[120:123], v[144:147], v[112:115], a[120:123]
    s_waitcnt lgkmcnt(12)
    v_mfma_f32_16x16x32_bf16 a[96:99], v[148:151], v[20:23], a[96:99]
    v_mfma_f32_16x16x32_bf16 a[104:107], v[148:151], v[52:55], a[104:107]
    v_mfma_f32_16x16x32_bf16 a[112:115], v[148:151], v[84:87], a[112:115]
    v_mfma_f32_16x16x32_bf16 a[120:123], v[148:151], v[116:119], a[120:123]
    s_waitcnt lgkmcnt(11)
    v_mfma_f32_16x16x32_bf16 a[96:99], v[152:155], v[24:27], a[96:99]
    v_mfma_f32_16x16x32_bf16 a[104:107], v[152:155], v[56:59], a[104:107]
    v_mfma_f32_16x16x32_bf16 a[112:115], v[152:155], v[88:91], a[112:115]
    v_mfma_f32_16x16x32_bf16 a[120:123], v[152:155], v[120:123], a[120:123]
KP_wm_p60:
    s_cbranch_execz KP_wm_p61
    s_waitcnt lgkmcnt(10)
    v_mfma_f32_16x16x32_bf16 a[96:99], v[156:159], v[28:31], a[96:99]
    v_mfma_f32_16x16x32_bf16 a[104:107], v[156:159], v[60:63], a[104:107]
    v_mfma_f32_16x16x32_bf16 a[112:115], v[156:159], v[92:95], a[112:115]
    v_mfma_f32_16x16x32_bf16 a[120:123], v[156:159], v[124:127], a[120:123]
    s_waitcnt lgkmcnt(9)
    v_mfma_f32_16x16x32_bf16 a[96:99], v[160:163], v[32:35], a[96:99]
    v_mfma_f32_16x16x32_bf16 a[104:107], v[160:163], v[64:67], a[104:107]
    v_mfma_f32_16x16x32_bf16 a[112:115], v[160:163], v[96:99], a[112:115]
    v_mfma_f32_16x16x32_bf16 a[120:123], v[160:163], v[128:131], a[120:123]
    s_waitcnt lgkmcnt(8)
    v_mfma_f32_16x16x32_bf16 a[96:99], v[164:167], v[36:39], a[96:99]
    v_mfma_f32_16x16x32_bf16 a[104:107], v[164:167], v[68:71], a[104:107]
    v_mfma_f32_16x16x32_bf16 a[112:115], v[164:167], v[100:103], a[112:115]
    v_mfma_f32_16x16x32_bf16 a[120:123], v[164:167], v[132:135], a[120:123]
KP_wm_p61:
    s_cbranch_execz KP_wm_p62
    s_waitcnt lgkmcnt(7)
    v_mfma_f32_16x16x32_bf16 a[100:103], v[168:171], v[8:11], 0
    v_mfma_f32_16x16x32_bf16 a[108:111], v[168:171], v[40:43], 0
    v_mfma_f32_16x16x32_bf16 a[116:119], v[168:171], v[72:75], 0
    v_mfma_f32_16x16x32_bf16 a[124:127], v[168:171], v[104:107], 0
    s_waitcnt lgkmcnt(6)
    v_mfma_f32_16x16x32_bf16 a[100:103], v[172:175], v[12:15], a[100:103]
    v_mfma_f32_16x16x32_bf16 a[108:111], v[172:175], v[44:47], a[108:111]
    v_mfma_f32_16x16x32_bf16 a[116:119], v[172:175], v[76:79], a[116:119]
    v_mfma_f32_16x16x32_bf16 a[124:127], v[172:175], v[108:111], a[124:127]
    s_waitcnt lgkmcnt(5)
    v_mfma_f32_16x16x32_bf16 a[100:103], v[176:179], v[16:19], a[100:103]
    v_mfma_f32_16x16x32_bf16 a[108:111], v[176:179], v[48:51], a[108:111]
    v_mfma_f32_16x16x32_bf16 a[116:119], v[176:179], v[80:83], a[116:119]
    v_mfma_f32_16x16x32_bf16 a[124:127], v[176:179], v[112:115], a[124:127]
KP_wm_p62:
    s_cbranch_execz KP_wm_p63
    s_waitcnt lgkmcnt(4)
    v_mfma_f32_16x16x32_bf16 a[100:103], v[180:183], v[20:23], a[100:103]
    v_mfma_f32_16x16x32_bf16 a[108:111], v[180:183], v[52:55], a[108:111]
    v_mfma_f32_16x16x32_bf16 a[116:119], v[180:183], v[84:87], a[116:119]
    v_mfma_f32_16x16x32_bf16 a[124:127], v[180:183], v[116:119], a[124:127]
    s_waitcnt lgkmcnt(3)
    v_mfma_f32_16x16x32_bf16 a[100:103], v[184:187], v[24:27], a[100:103]
    v_mfma_f32_16x16x32_bf16 a[108:111], v[184:187], v[56:59], a[108:111]
    v_mfma_f32_16x16x32_bf16 a[116:119], v[184:187], v[88:91], a[116:119]
    v_mfma_f32_16x16x32_bf16 a[124:127], v[184:187], v[120:123], a[124:127]
    s_waitcnt lgkmcnt(2)
    v_mfma_f32_16x16x32_bf16 a[100:103], v[188:191], v[28:31], a[100:103]
    v_mfma_f32_16x16x32_bf16 a[108:111], v[188:191], v[60:63], a[108:111]
    v_mfma_f32_16x16x32_bf16 a[116:119], v[188:191], v[92:95], a[116:119]
    v_mfma_f32_16x16x32_bf16 a[124:127], v[188:191], v[124:127], a[124:127]
KP_wm_p63:
    s_cbranch_execz KP_wm_p64
    s_waitcnt lgkmcnt(1)
    v_mfma_f32_16x16x32_bf16 a[100:103], v[192:195], v[32:35], a[100:103]
    v_mfma_f32_16x16x32_bf16 a[108:111], v[192:195], v[64:67], a[108:111]
    v_mfma_f32_16x16x32_bf16 a[116:119], v[192:195], v[96:99], a[116:119]
    v_mfma_f32_16x16x32_bf16 a[124:127], v[192:195], v[128:131], a[124:127]
    s_waitcnt lgkmcnt(0)
    v_mfma_f32_16x16x32_bf16 a[100:103], v[196:199], v[36:39], a[100:103]
    v_mfma_f32_16x16x32_bf16 a[108:111], v[196:199], v[68:71], a[108:111]
    v_mfma_f32_16x16x32_bf16 a[116:119], v[196:199], v[100:103], a[116:119]
    v_mfma_f32_16x16x32_bf16 a[124:127], v[196:199], v[132:135], a[124:127]
    s_waitcnt vmcnt(0)
    s_add_u32 s28, s95, 3
    v_mov_b32 v7, s28
    buffer_store_dword v7, v6, s[48:51], s33 offen sc1
    v_accvgpr_read_b32 v240, a96
    v_accvgpr_read_b32 v241, a97
KP_wm_p64:
    s_cbranch_execz KP_wm_p65
    v_accvgpr_read_b32 v242, a98
    v_accvgpr_read_b32 v243, a99
    v_pk_mul_f32 v[240:241], v[240:241], s[30:31] op_sel_hi:[1,0]
    v_pk_mul_f32 v[242:243], v[242:243], s[30:31] op_sel_hi:[1,0]
    v_cvt_pk_bf16_f32 v232, v240, v241
    v_cvt_pk_bf16_f32 v233, v242, v243
    v_accvgpr_read_b32 v240, a100
    v_accvgpr_read_b32 v241, a101
    v_accvgpr_read_b32 v242, a102
    v_accvgpr_read_b32 v243, a103
    v_pk_mul_f32 v[240:241], v[240:241], s[30:31] op_sel_hi:[1,0]
    v_pk_mul_f32 v[242:243], v[242:243], s[30:31] op_sel_hi:[1,0]
    v_cvt_pk_bf16_f32 v234, v240, v241
    v_cvt_pk_bf16_f32 v235, v242, v243
KP_wm_p65:
    s_cbranch_execz KP_wm_p66
    v_accvgpr_write_b32 a176, v232
    v_accvgpr_write_b32 a177, v233
    v_accvgpr_write_b32 a178, v234
    v_accvgpr_write_b32 a179, v235
    s_add_u32 s28, s31, 12288
    buffer_store_dwordx4 v[232:235], v4, s[36:39], s28 offen sc1
    v_accvgpr_read_b32 v240, a104
    v_accvgpr_read_b32 v241, a105
    v_accvgpr_read_b32 v242, a106
    v_accvgpr_read_b32 v243, a107
    v_pk_mul_f32 v[240:241], v[240:241], s[30:31] op_sel_hi:[1,0]
    v_pk_mul_f32 v[242:243], v[242:243], s[30:31] op_sel_hi:[1,0]
    v_cvt_pk_bf16_f32 v236, v240, v241
    v_cvt_pk_bf16_f32 v237, v242, v243
KP_wm_p66:
    s_cbranch_execz KP_wm_p67
    v_accvgpr_read_b32 v240, a108
    v_accvgpr_read_b32 v241, a109
    v_accvgpr_read_b32 v242, a110
    v_accvgpr_read_b32 v243, a111
    v_pk_mul_f32 v[240:241], v[240:241], s[30:31] op_sel_hi:[1,0]
    v_pk_mul_f32 v[242:243], v[242:243], s[30:31] op_sel_hi:[1,0]
    v_cvt_pk_bf16_f32 v238, v240, v241
    v_cvt_pk_bf16_f32 v239, v242, v243
    v_accvgpr_write_b32 a180, v236
    v_accvgpr_write_b32 a181, v237
    v_accvgpr_write_b32 a182, v238
    v_accvgpr_write_b32 a183, v239
    s_add_u32 s28, s31, 26624
    buffer_store_dwordx4 v[236:239], v4, s[36:39], s28 offen sc1
KP_wm_p67:
    s_cbranch_execz KP_wm_p68
    v_accvgpr_read_b32 v240, a112
    v_accvgpr_read_b32 v241, a113
    v_accvgpr_read_b32 v242, a114
    v_accvgpr_read_b32 v243, a115
    v_pk_mul_f32 v[240:241], v[240:241], s[30:31] op_sel_hi:[1,0]
    v_pk_mul_f32 v[242:243], v[242:243], s[30:31] op_sel_hi:[1,0]
    v_cvt_pk_bf16_f32 v232, v240, v241
    v_cvt_pk_bf16_f32 v233, v242, v243
    v_accvgpr_read_b32 v240, a116
    v_accvgpr_read_b32 v241, a117
    v_accvgpr_read_b32 v242, a118
    v_accvgpr_read_b32 v243, a119
    v_pk_mul_f32 v[240:241], v[240:241], s[30:31] op_sel_hi:[1,0]
    v_pk_mul_f32 v[242:243], v[242:243], s[30:31] op_sel_hi:[1,0]
KP_wm_p68:
    s_cbranch_execz KP_wm_p69
    v_cvt_pk_bf16_f32 v234, v240, v241
    v_cvt_pk_bf16_f32 v235, v242, v243
    v_accvgpr_write_b32 a184, v232
    v_accvgpr_write_b32 a185, v233
    v_accvgpr_write_b32 a186, v234
    v_accvgpr_write_b32 a187, v235
    s_add_u32 s28, s31, 40960
    buffer_store_dwordx4 v[232:235], v4, s[36:39], s28 offen sc1
    v_accvgpr_read_b32 v240, a120
    v_accvgpr_read_b32 v241, a121
    v_accvgpr_read_b32 v242, a122
    v_accvgpr_read_b32 v243, a123
    v_pk_mul_f32 v[240:241], v[240:241], s[30:31] op_sel_hi:[1,0]
    v_pk_mul_f32 v[242:243], v[242:243], s[30:31] op_sel_hi:[1,0]
KP_wm_p69:
    s_cbranch_execz KP_wm_p70
    v_cvt_pk_bf16_f32 v236, v240, v241
    v_cvt_pk_bf16_f32 v237, v242, v243
    v_accvgpr_read_b32 v240, a124
    v_accvgpr_read_b32 v241, a125
    v_accvgpr_read_b32 v242, a126
    v_accvgpr_read_b32 v243, a127
    v_pk_mul_f32 v[240:241], v[240:241], s[30:31] op_sel_hi:[1,0]
    v_pk_mul_f32 v[242:243], v[242:243], s[30:31] op_sel_hi:[1,0]
    v_cvt_pk_bf16_f32 v238, v240, v241
    v_cvt_pk_bf16_f32 v239, v242, v243
    v_accvgpr_write_b32 a188, v236
    v_accvgpr_write_b32 a189, v237
    v_accvgpr_write_b32 a190, v238
    v_accvgpr_write_b32 a191, v239
KP_wm_p70:
    s_cbranch_execz KP_wm_ret
    s_add_u32 s28, s31, 55296
    buffer_store_dwordx4 v[236:239], v4, s[36:39], s28 offen sc1
KP_short:
KP_fin:
    s_waitcnt vmcnt(0)
    s_add_u32 s28, s95, 4
    v_mov_b32 v7, s28
    buffer_store_dword v7, v6, s[48:51], s33 offen sc1
    s_cmp_lt_u32 s22, 16
    s_cbranch_scc1 KP_end
    s_add_u32 s40, s18, 0x200000
    s_addc_u32 s41, s19, 0
    s_mov_b32 s42, 0x1c0000
    s_mov_b32 s43, 0x20000
    s_add_u32 s44, s18, 0x3400000
    s_addc_u32 s45, s19, 0
    s_mov_b32 s46, 0x1c0000
    s_mov_b32 s47, 0x20000
    v_and_b32 v5, 1, v1
    v_lshlrev_b32 v5, 7, v5
    s_mov_b32 s28, 565248
    s_mov_b32 s27, 0
KP_el:
    buffer_load_dword v7, v5, s[48:51], s28 offen sc1
    s_add_u32 s27, s27, 1
    s_cmp_gt_u32 s27, 65536
    s_cbranch_scc1 K3_bail
    s_waitcnt vmcnt(0)
    v_cmp_ne_u32 vcc, s96, v7
    s_cbranch_vccz KP_el_ok
    s_sleep 2
    s_branch KP_el
KP_el_ok:
    s_lshl_b32 s28, s3, 10
    s_add_u32 s28, s28, 0
    buffer_load_dwordx4 v[8:11], v4, s[40:43], s28 offen
    s_lshl_b32 s28, s3, 10
    s_add_u32 s28, s28, 4096
    buffer_load_dwordx4 v[12:15], v4, s[40:43], s28 offen
    s_lshl_b32 s28, s3, 10
    s_add_u32 s28, s28, 8192
    buffer_load_dwordx4 v[16:19], v4, s[40:43], s28 offen
    s_lshl_b32 s28, s3, 10
    s_add_u32 s28, s28, 12288
    buffer_load_dwordx4 v[20:23], v4, s[40:43], s28 offen
    s_lshl_b32 s28, s3, 10
    s_add_u32 s28, s28, 14336
    buffer_load_dwordx4 v[24:27], v4, s[40:43], s28 offen
    s_lshl_b32 s28, s3, 10
    s_add_u32 s28, s28, 18432
    buffer_load_dwordx4 v[28:31], v4, s[40:43], s28 offen
    s_lshl_b32 s28, s3, 10
    s_add_u32 s28, s28, 22528
    buffer_load_dwordx4 v[32:35], v4, s[40:43], s28 offen
    s_lshl_b32 s28, s3, 10
    s_add_u32 s28, s28, 26624
    buffer_load_dwordx4 v[36:39], v4, s[40:43], s28 offen
    s_lshl_b32 s28, s3, 10
    s_add_u32 s28, s28, 28672
    buffer_load_dwordx4 v[40:43], v4, s[40:43], s28 offen
    s_lshl_b32 s28, s3, 10
    s_add_u32 s28, s28, 32768
    buffer_load_dwordx4 v[44:47], v4, s[40:43], s28 offen
    s_lshl_b32 s28, s3, 10
    s_add_u32 s28, s28, 36864
    buffer_load_dwordx4 v[48:51], v4, s[40:43], s28 offen
    s_lshl_b32 s28, s3, 10
    s_add_u32 s28, s28, 40960
    buffer_load_dwordx4 v[52:55], v4, s[40:43], s28 offen
    s_lshl_b32 s28, s3, 10
    s_add_u32 s28, s28, 43008
    buffer_load_dwordx4 v[56:59], v4, s[40:43], s28 offen
    s_lshl_b32 s28, s3, 10
    s_add_u32 s28, s28, 47104
    buffer_load_dwordx4 v[60:63], v4, s[40:43], s28 offen
    s_lshl_b32 s28, s3, 10
    s_add_u32 s28, s28, 51200
    buffer_load_dwordx4 v[64:67], v4, s[40:43], s28 offen
    s_lshl_b32 s28, s3, 10
    s_add_u32 s28, s28, 55296
    buffer_load_dwordx4 v[68:71], v4, s[40:43], s28 offen
    s_lshl_b32 s28, s3, 10
    s_add_u32 s28, s28, 57344
    buffer_load_dwordx4 v[72:75], v4, s[40:43], s28 offen
    s_lshl_b32 s28, s3, 10
    s_add_u32 s28, s28, 61440
    buffer_load_dwordx4 v[76:79], v4, s[40:43], s28 offen
    s_lshl_b32 s28, s3, 10
    s_add_u32 s28, s28, 65536
    buffer_load_dwordx4 v[80:83], v4, s[40:43], s28 offen
    s_lshl_b32 s28, s3, 10
    s_add_u32 s28, s28, 69632
    buffer_load_dwordx4 v[84:87], v4, s[40:43], s28 offen
    s_lshl_b32 s28, s3, 10
    s_add_u32 s28, s28, 71680
    buffer_load_dwordx4 v[88:91], v4, s[40:43], s28 offen
    s_lshl_b32 s28, s3, 10
    s_add_u32 s28, s28, 75776
    buffer_load_dwordx4 v[92:95], v4, s[40:43], s28 offen
    s_lshl_b32 s28, s3, 10
    s_add_u32 s28, s28, 79872
    buffer_load_dwordx4 v[96:99], v4, s[40:43], s28 offen
    s_lshl_b32 s28, s3, 10
    s_add_u32 s28, s28, 83968
    buffer_load_dwordx4 v[100:103], v4, s[40:43], s28 offen
    s_lshl_b32 s28, s3, 10
    s_add_u32 s28, s28, 86016
    buffer_load_dwordx4 v[104:107], v4, s[40:43], s28 offen
    s_lshl_b32 s28, s3, 10
    s_add_u32 s28, s28, 90112
    buffer_load_dwordx4 v[108:111], v4, s[40:43], s28 offen
    s_lshl_b32 s28, s3, 10
    s_add_u32 s28, s28, 94208
    buffer_load_dwordx4 v[112:115], v4, s[40:43], s28 offen
    s_lshl_b32 s28, s3, 10
    s_add_u32 s28, s28, 98304
    buffer_load_dwordx4 v[116:119], v4, s[40:43], s28 offen
    s_lshl_b32 s28, s3, 10
    s_add_u32 s28, s28, 100352
    buffer_load_dwordx4 v[120:123], v4, s[40:43], s28 offen
    s_lshl_b32 s28, s3, 10
    s_add_u32 s28, s28, 104448
    buffer_load_dwordx4 v[124:127], v4, s[40:43], s28 offen
    s_lshl_b32 s28, s3, 10
    s_add_u32 s28, s28, 108544
    buffer_load_dwordx4 v[128:131], v4, s[40:43], s28 offen
    s_lshl_b32 s28, s3, 10
    s_add_u32 s28, s28, 112640
    buffer_load_dwordx4 v[132:135], v4, s[40:43], s28 offen
    s_lshl_b32 s28, s3, 15
    v_add_u32 v5, s28, v4
    s_barrier
    s_waitcnt vmcnt(28)
    v_mfma_f32_16x16x32_bf16 a[0:3], v[8:11], a[128:131], 0
    v_mfma_f32_16x16x32_bf16 a[4:7], v[8:11], a[132:135], 0
    v_mfma_f32_16x16x32_bf16 a[8:11], v[8:11], a[136:139], 0
    v_mfma_f32_16x16x32_bf16 a[12:15], v[8:11], a[140:143], 0
    v_mfma_f32_16x16x32_bf16 a[0:3], v[12:15], a[144:147], a[0:3]
    v_mfma_f32_16x16x32_bf16 a[4:7], v[12:15], a[148:151], a[4:7]
    v_mfma_f32_16x16x32_bf16 a[8:11], v[12:15], a[152:155], a[8:11]
    v_mfma_f32_16x16x32_bf16 a[12:15], v[12:15], a[156:159], a[12:15]
    v_mfma_f32_16x16x32_bf16 a[0:3], v[16:19], a[160:163], a[0:3]
    v_mfma_f32_16x16x32_bf16 a[4:7], v[16:19], a[164:167], a[4:7]
    v_mfma_f32_16x16x32_bf16 a[8:11], v[16:19], a[168:171], a[8:11]
    v_mfma_f32_16x16x32_bf16 a[12:15], v[16:19], a[172:175], a[12:15]
    v_mfma_f32_16x16x32_bf16 a[0:3], v[20:23], a[176:179], a[0:3]
    v_mfma_f32_16x16x32_bf16 a[4:7], v[20:23], a[180:183], a[4:7]
    v_mfma_f32_16x16x32_bf16 a[8:11], v[20:23], a[184:187], a[8:11]
    v_mfma_f32_16x16x32_bf16 a[12:15], v[20:23], a[188:191], a[12:15]
    s_waitcnt vmcnt(24)
    v_mfma_f32_16x16x32_bf16 a[16:19], v[24:27], a[128:131], 0
    v_mfma_f32_16x16x32_bf16 a[20:23], v[24:27], a[132:135], 0
    v_mfma_f32_16x16x32_bf16 a[24:27], v[24:27], a[136:139], 0
    v_mfma_f32_16x16x32_bf16 a[28:31], v[24:27], a[140:143], 0
    v_mfma_f32_16x16x32_bf16 a[16:19], v[28:31], a[144:147], a[16:19]
    v_mfma_f32_16x16x32_bf16 a[20:23], v[28:31], a[148:151], a[20:23]
    v_mfma_f32_16x16x32_bf16 a[24:27], v[28:31], a[152:155], a[24:27]
    v_mfma_f32_16x16x32_bf16 a[28:31], v[28:31], a[156:159], a[28:31]
    v_mfma_f32_16x16x32_bf16 a[16:19], v[32:35], a[160:163], a[16:19]
    v_mfma_f32_16x16x32_bf16 a[20:23], v[32:35], a[164:167], a[20:23]
    v_mfma_f32_16x16x32_bf16 a[24:27], v[32:35], a[168:171], a[24:27]
    v_mfma_f32_16x16x32_bf16 a[28:31], v[32:35], a[172:175], a[28:31]
    v_mfma_f32_16x16x32_bf16 a[16:19], v[36:39], a[176:179], a[16:19]
    v_mfma_f32_16x16x32_bf16 a[20:23], v[36:39], a[180:183], a[20:23]
    v_mfma_f32_16x16x32_bf16 a[24:27], v[36:39], a[184:187], a[24:27]
    v_mfma_f32_16x16x32_bf16 a[28:31], v[36:39], a[188:191], a[28:31]
    ds_write_b128 v5, a[0:3] offset:0
    ds_write_b128 v5, a[4:7] offset:1024
    ds_write_b128 v5, a[8:11] offset:2048
    ds_write_b128 v5, a[12:15] offset:3072
    s_waitcnt vmcnt(20)
    v_mfma_f32_16x16x32_bf16 a[32:35], v[40:43], a[128:131], 0
    v_mfma_f32_16x16x32_bf16 a[36:39], v[40:43], a[132:135], 0
    v_mfma_f32_16x16x32_bf16 a[40:43], v[40:43], a[136:139], 0
    v_mfma_f32_16x16x32_bf16 a[44:47], v[40:43], a[140:143], 0
    v_mfma_f32_16x16x32_bf16 a[32:35], v[44:47], a[144:147], a[32:35]
    v_mfma_f32_16x16x32_bf16 a[36:39], v[44:47], a[148:151], a[36:39]
    v_mfma_f32_16x16x32_bf16 a[40:43], v[44:47], a[152:155], a[40:43]
    v_mfma_f32_16x16x32_bf16 a[44:47], v[44:47], a[156:159], a[44:47]
    v_mfma_f32_16x16x32_bf16 a[32:35], v[48:51], a[160:163], a[32:35]
    v_mfma_f32_16x16x32_bf16 a[36:39], v[48:51], a[164:167], a[36:39]
    v_mfma_f32_16x16x32_bf16 a[40:43], v[48:51], a[168:171], a[40:43]
    v_mfma_f32_16x16x32_bf16 a[44:47], v[48:51], a[172:175], a[44:47]
    v_mfma_f32_16x16x32_bf16 a[32:35], v[52:55], a[176:179], a[32:35]
    v_mfma_f32_16x16x32_bf16 a[36:39], v[52:55], a[180:183], a[36:39]
    v_mfma_f32_16x16x32_bf16 a[40:43], v[52:55], a[184:187], a[40:43]
    v_mfma_f32_16x16x32_bf16 a[44:47], v[52:55], a[188:191], a[44:47]
    ds_write_b128 v5, a[16:19] offset:4096
    ds_write_b128 v5, a[20:23] offset:5120
    ds_write_b128 v5, a[24:27] offset:6144
    ds_write_b128 v5, a[28:31] offset:7168
    s_waitcnt vmcnt(16)
    v_mfma_f32_16x16x32_bf16 a[48:51], v[56:59], a[128:131], 0
    v_mfma_f32_16x16x32_bf16 a[52:55], v[56:59], a[132:135], 0
    v_mfma_f32_16x16x32_bf16 a[56:59], v[56:59], a[136:139], 0
    v_mfma_f32_16x16x32_bf16 a[60:63], v[56:59], a[140:143], 0
    v_mfma_f32_16x16x32_bf16 a[48:51], v[60:63], a[144:147], a[48:51]
    v_mfma_f32_16x16x32_bf16 a[52:55], v[60:63], a[148:151], a[52:55]
    v_mfma_f32_16x16x32_bf16 a[56:59], v[60:63], a[152:155], a[56:59]
    v_mfma_f32_16x16x32_bf16 a[60:63], v[60:63], a[156:159], a[60:63]
    v_mfma_f32_16x16x32_bf16 a[48:51], v[64:67], a[160:163], a[48:51]
    v_mfma_f32_16x16x32_bf16 a[52:55], v[64:67], a[164:167], a[52:55]
    v_mfma_f32_16x16x32_bf16 a[56:59], v[64:67], a[168:171], a[56:59]
    v_mfma_f32_16x16x32_bf16 a[60:63], v[64:67], a[172:175], a[60:63]
    v_mfma_f32_16x16x32_bf16 a[48:51], v[68:71], a[176:179], a[48:51]
    v_mfma_f32_16x16x32_bf16 a[52:55], v[68:71], a[180:183], a[52:55]
    v_mfma_f32_16x16x32_bf16 a[56:59], v[68:71], a[184:187], a[56:59]
    v_mfma_f32_16x16x32_bf16 a[60:63], v[68:71], a[188:191], a[60:63]
    ds_write_b128 v5, a[32:35] offset:8192
    ds_write_b128 v5, a[36:39] offset:9216
    ds_write_b128 v5, a[40:43] offset:10240
    ds_write_b128 v5, a[44:47] offset:11264
    s_waitcnt vmcnt(12)
    v_mfma_f32_16x16x32_bf16 a[64:67], v[72:75], a[128:131], 0
    v_mfma_f32_16x16x32_bf16 a[68:71], v[72:75], a[132:135], 0
    v_mfma_f32_16x16x32_bf16 a[72:75], v[72:75], a[136:139], 0
    v_mfma_f32_16x16x32_bf16 a[76:79], v[72:75], a[140:143], 0
    v_mfma_f32_16x16x32_bf16 a[64:67], v[76:79], a[144:147], a[64:67]
    v_mfma_f32_16x16x32_bf16 a[68:71], v[76:79], a[148:151], a[68:71]
    v_mfma_f32_16x16x32_bf16 a[72:75], v[76:79], a[152:155], a[72:75]
    v_mfma_f32_16x16x32_bf16 a[76:79], v[76:79], a[156:159], a[76:79]
    v_mfma_f32_16x16x32_bf16 a[64:67], v[80:83], a[160:163], a[64:67]
    v_mfma_f32_16x16x32_bf16 a[68:71], v[80:83], a[164:167], a[68:71]
    v_mfma_f32_16x16x32_bf16 a[72:75], v[80:83], a[168:171], a[72:75]
    v_mfma_f32_16x16x32_bf16 a[76:79], v[80:83], a[172:175], a[76:79]
    v_mfma_f32_16x16x32_bf16 a[64:67], v[84:87], a[176:179], a[64:67]
    v_mfma_f32_16x16x32_bf16 a[68:71], v[84:87], a[180:183], a[68:71]
    v_mfma_f32_16x16x32_bf16 a[72:75], v[84:87], a[184:187], a[72:75]
    v_mfma_f32_16x16x32_bf16 a[76:79], v[84:87], a[188:191], a[76:79]
    ds_write_b128 v5, a[48:51] offset:12288
    ds_write_b128 v5, a[52:55] offset:13312
    ds_write_b128 v5, a[56:59] offset:14336
    ds_write_b128 v5, a[60:63] offset:15360
    s_waitcnt vmcnt(8)
    v_mfma_f32_16x16x32_bf16 a[80:83], v[88:91], a[128:131], 0
    v_mfma_f32_16x16x32_bf16 a[84:87], v[88:91], a[132:135], 0
    v_mfma_f32_16x16x32_bf16 a[88:91], v[88:91], a[136:139], 0
    v_mfma_f32_16x16x32_bf16 a[92:95], v[88:91], a[140:143], 0
    v_mfma_f32_16x16x32_bf16 a[80:83], v[92:95], a[144:147], a[80:83]
    v_mfma_f32_16x16x32_bf16 a[84:87], v[92:95], a[148:151], a[84:87]
    v_mfma_f32_16x16x32_bf16 a[88:91], v[92:95], a[152:155], a[88:91]
    v_mfma_f32_16x16x32_bf16 a[92:95], v[92:95], a[156:159], a[92:95]
    v_mfma_f32_16x16x32_bf16 a[80:83], v[96:99], a[160:163], a[80:83]
    v_mfma_f32_16x16x32_bf16 a[84:87], v[96:99], a[164:167], a[84:87]
    v_mfma_f32_16x16x32_bf16 a[88:91], v[96:99], a[168:171], a[88:91]
    v_mfma_f32_16x16x32_bf16 a[92:95], v[96:99], a[172:175], a[92:95]
    v_mfma_f32_16x16x32_bf16 a[80:83], v[100:103], a[176:179], a[80:83]
    v_mfma_f32_16x16x32_bf16 a[84:87], v[100:103], a[180:183], a[84:87]
    v_mfma_f32_16x16x32_bf16 a[88:91], v[100:103], a[184:187], a[88:91]
    v_mfma_f32_16x16x32_bf16 a[92:95], v[100:103], a[188:191], a[92:95]
    ds_write_b128 v5, a[64:67] offset:16384
    ds_write_b128 v5, a[68:71] offset:17408
    ds_write_b128 v5, a[72:75] offset:18432
    ds_write_b128 v5, a[76:79] offset:19456
    s_waitcnt vmcnt(4)
    v_mfma_f32_16x16x32_bf16 a[96:99], v[104:107], a[128:131], 0
    v_mfma_f32_16x16x32_bf16 a[100:103], v[104:107], a[132:135], 0
    v_mfma_f32_16x16x32_bf16 a[104:107], v[104:107], a[136:139], 0
    v_mfma_f32_16x16x32_bf16 a[108:111], v[104:107], a[140:143], 0
    v_mfma_f32_16x16x32_bf16 a[96:99], v[108:111], a[144:147], a[96:99]
    v_mfma_f32_16x16x32_bf16 a[100:103], v[108:111], a[148:151], a[100:103]
    v_mfma_f32_16x16x32_bf16 a[104:107], v[108:111], a[152:155], a[104:107]
    v_mfma_f32_16x16x32_bf16 a[108:111], v[108:111], a[156:159], a[108:111]
    v_mfma_f32_16x16x32_bf16 a[96:99], v[112:115], a[160:163], a[96:99]
    v_mfma_f32_16x16x32_bf16 a[100:103], v[112:115], a[164:167], a[100:103]
    v_mfma_f32_16x16x32_bf16 a[104:107], v[112:115], a[168:171], a[104:107]
    v_mfma_f32_16x16x32_bf16 a[108:111], v[112:115], a[172:175], a[108:111]
    v_mfma_f32_16x16x32_bf16 a[96:99], v[116:119], a[176:179], a[96:99]
    v_mfma_f32_16x16x32_bf16 a[100:103], v[116:119], a[180:183], a[100:103]
    v_mfma_f32_16x16x32_bf16 a[104:107], v[116:119], a[184:187], a[104:107]
    v_mfma_f32_16x16x32_bf16 a[108:111], v[116:119], a[188:191], a[108:111]
    ds_write_b128 v5, a[80:83] offset:20480
    ds_write_b128 v5, a[84:87] offset:21504
    ds_write_b128 v5, a[88:91] offset:22528
    ds_write_b128 v5, a[92:95] offset:23552
    s_waitcnt vmcnt(0)
    v_mfma_f32_16x16x32_bf16 a[112:115], v[120:123], a[128:131], 0
    v_mfma_f32_16x16x32_bf16 a[116:119], v[120:123], a[132:135], 0
    v_mfma_f32_16x16x32_bf16 a[120:123], v[120:123], a[136:139], 0
    v_mfma_f32_16x16x32_bf16 a[124:127], v[120:123], a[140:143], 0
    v_mfma_f32_16x16x32_bf16 a[112:115], v[124:127], a[144:147], a[112:115]
    v_mfma_f32_16x16x32_bf16 a[116:119], v[124:127], a[148:151], a[116:119]
    v_mfma_f32_16x16x32_bf16 a[120:123], v[124:127], a[152:155], a[120:123]
    v_mfma_f32_16x16x32_bf16 a[124:127], v[124:127], a[156:159], a[124:127]
    v_mfma_f32_16x16x32_bf16 a[112:115], v[128:131], a[160:163], a[112:115]
    v_mfma_f32_16x16x32_bf16 a[116:119], v[128:131], a[164:167], a[116:119]
    v_mfma_f32_16x16x32_bf16 a[120:123], v[128:131], a[168:171], a[120:123]
    v_mfma_f32_16x16x32_bf16 a[124:127], v[128:131], a[172:175], a[124:127]
    v_mfma_f32_16x16x32_bf16 a[112:115], v[132:135], a[176:179], a[112:115]
    v_mfma_f32_16x16x32_bf16 a[116:119], v[132:135], a[180:183], a[116:119]
    v_mfma_f32_16x16x32_bf16 a[120:123], v[132:135], a[184:187], a[120:123]
    v_mfma_f32_16x16x32_bf16 a[124:127], v[132:135], a[188:191], a[124:127]
    ds_write_b128 v5, a[96:99] offset:24576
    ds_write_b128 v5, a[100:103] offset:25600
    ds_write_b128 v5, a[104:107] offset:26624
    ds_write_b128 v5, a[108:111] offset:27648
    s_nop 0
    ds_write_b128 v5, a[112:115] offset:28672
    ds_write_b128 v5, a[116:119] offset:29696
    ds_write_b128 v5, a[120:123] offset:30720
    ds_write_b128 v5, a[124:127] offset:31744
    s_lshl_b32 s28, s3, 10
    v_add_u32 v5, s28, v4
    v_add_u32 v8, 65536, v5
    s_lshl_b32 s29, s23, 2
    s_add_u32 s29, s29, s3
    s_lshl_b32 s29, s29, 14
    s_lshl_b32 s28, s24, 10
    s_add_u32 s29, s29, s28
    s_waitcnt lgkmcnt(0)
    s_barrier
    ds_read_b128 v[16:19], v5 offset:0
    ds_read_b128 v[20:23], v5 offset:32768
    ds_read_b128 v[24:27], v8 offset:0
    ds_read_b128 v[28:31], v8 offset:32768
    ds_read_b128 v[32:35], v5 offset:4096
    ds_read_b128 v[36:39], v5 offset:36864
    ds_read_b128 v[40:43], v8 offset:4096
    ds_read_b128 v[44:47], v8 offset:36864
    s_waitcnt lgkmcnt(0)
    v_pk_add_f32 v[16:17], v[16:17], v[20:21]
    v_pk_add_f32 v[18:19], v[18:19], v[22:23]
    v_pk_add_f32 v[16:17], v[16:17], v[24:25]
    v_pk_add_f32 v[18:19], v[18:19], v[26:27]
    v_pk_add_f32 v[16:17], v[16:17], v[28:29]
    v_pk_add_f32 v[18:19], v[18:19], v[30:31]
    v_cvt_pk_bf16_f32 v48, v16, v17
    v_cvt_pk_bf16_f32 v49, v18, v19
    v_pk_add_f32 v[32:33], v[32:33], v[36:37]
    v_pk_add_f32 v[34:35], v[34:35], v[38:39]
    v_pk_add_f32 v[32:33], v[32:33], v[40:41]
    v_pk_add_f32 v[34:35], v[34:35], v[42:43]
    v_pk_add_f32 v[32:33], v[32:33], v[44:45]
    v_pk_add_f32 v[34:35], v[34:35], v[46:47]
    v_cvt_pk_bf16_f32 v50, v32, v33
    v_cvt_pk_bf16_f32 v51, v34, v35
    buffer_store_dwordx4 v[48:51], v4, s[44:47], s29 offen sc1
    s_add_u32 s29, s29, 458752
    ds_read_b128 v[16:19], v5 offset:8192
    ds_read_b128 v[20:23], v5 offset:40960
    ds_read_b128 v[24:27], v8 offset:8192
    ds_read_b128 v[28:31], v8 offset:40960
    ds_read_b128 v[32:35], v5 offset:12288
    ds_read_b128 v[36:39], v5 offset:45056
    ds_read_b128 v[40:43], v8 offset:12288
    ds_read_b128 v[44:47], v8 offset:45056
    s_waitcnt lgkmcnt(0)
    v_pk_add_f32 v[16:17], v[16:17], v[20:21]
    v_pk_add_f32 v[18:19], v[18:19], v[22:23]
    v_pk_add_f32 v[16:17], v[16:17], v[24:25]
    v_pk_add_f32 v[18:19], v[18:19], v[26:27]
    v_pk_add_f32 v[16:17], v[16:17], v[28:29]
    v_pk_add_f32 v[18:19], v[18:19], v[30:31]
    v_cvt_pk_bf16_f32 v52, v16, v17
    v_cvt_pk_bf16_f32 v53, v18, v19
    v_pk_add_f32 v[32:33], v[32:33], v[36:37]
    v_pk_add_f32 v[34:35], v[34:35], v[38:39]
    v_pk_add_f32 v[32:33], v[32:33], v[40:41]
    v_pk_add_f32 v[34:35], v[34:35], v[42:43]
    v_pk_add_f32 v[32:33], v[32:33], v[44:45]
    v_pk_add_f32 v[34:35], v[34:35], v[46:47]
    v_cvt_pk_bf16_f32 v54, v32, v33
    v_cvt_pk_bf16_f32 v55, v34, v35
    buffer_store_dwordx4 v[52:55], v4, s[44:47], s29 offen sc1
    s_add_u32 s29, s29, 458752
    ds_read_b128 v[16:19], v5 offset:16384
    ds_read_b128 v[20:23], v5 offset:49152
    ds_read_b128 v[24:27], v8 offset:16384
    ds_read_b128 v[28:31], v8 offset:49152
    ds_read_b128 v[32:35], v5 offset:20480
    ds_read_b128 v[36:39], v5 offset:53248
    ds_read_b128 v[40:43], v8 offset:20480
    ds_read_b128 v[44:47], v8 offset:53248
    s_waitcnt lgkmcnt(0)
    v_pk_add_f32 v[16:17], v[16:17], v[20:21]
    v_pk_add_f32 v[18:19], v[18:19], v[22:23]
    v_pk_add_f32 v[16:17], v[16:17], v[24:25]
    v_pk_add_f32 v[18:19], v[18:19], v[26:27]
    v_pk_add_f32 v[16:17], v[16:17], v[28:29]
    v_pk_add_f32 v[18:19], v[18:19], v[30:31]
    v_cvt_pk_bf16_f32 v56, v16, v17
    v_cvt_pk_bf16_f32 v57, v18, v19
    v_pk_add_f32 v[32:33], v[32:33], v[36:37]
    v_pk_add_f32 v[34:35], v[34:35], v[38:39]
    v_pk_add_f32 v[32:33], v[32:33], v[40:41]
    v_pk_add_f32 v[34:35], v[34:35], v[42:43]
    v_pk_add_f32 v[32:33], v[32:33], v[44:45]
    v_pk_add_f32 v[34:35], v[34:35], v[46:47]
    v_cvt_pk_bf16_f32 v58, v32, v33
    v_cvt_pk_bf16_f32 v59, v34, v35
    buffer_store_dwordx4 v[56:59], v4, s[44:47], s29 offen sc1
    s_add_u32 s29, s29, 458752
    ds_read_b128 v[16:19], v5 offset:24576
    ds_read_b128 v[20:23], v5 offset:57344
    ds_read_b128 v[24:27], v8 offset:24576
    ds_read_b128 v[28:31], v8 offset:57344
    ds_read_b128 v[32:35], v5 offset:28672
    ds_read_b128 v[36:39], v5 offset:61440
    ds_read_b128 v[40:43], v8 offset:28672
    ds_read_b128 v[44:47], v8 offset:61440
    s_waitcnt lgkmcnt(0)
    v_pk_add_f32 v[16:17], v[16:17], v[20:21]
    v_pk_add_f32 v[18:19], v[18:19], v[22:23]
    v_pk_add_f32 v[16:17], v[16:17], v[24:25]
    v_pk_add_f32 v[18:19], v[18:19], v[26:27]
    v_pk_add_f32 v[16:17], v[16:17], v[28:29]
    v_pk_add_f32 v[18:19], v[18:19], v[30:31]
    v_cvt_pk_bf16_f32 v60, v16, v17
    v_cvt_pk_bf16_f32 v61, v18, v19
    v_pk_add_f32 v[32:33], v[32:33], v[36:37]
    v_pk_add_f32 v[34:35], v[34:35], v[38:39]
    v_pk_add_f32 v[32:33], v[32:33], v[40:41]
    v_pk_add_f32 v[34:35], v[34:35], v[42:43]
    v_pk_add_f32 v[32:33], v[32:33], v[44:45]
    v_pk_add_f32 v[34:35], v[34:35], v[46:47]
    v_cvt_pk_bf16_f32 v62, v32, v33
    v_cvt_pk_bf16_f32 v63, v34, v35
    buffer_store_dwordx4 v[60:63], v4, s[44:47], s29 offen sc1
    s_add_u32 s29, s29, 458752
    s_waitcnt vmcnt(0)
    s_add_u32 s28, s95, 5
    v_mov_b32 v7, s28
    buffer_store_dword v7, v6, s[48:51], s33 offen sc1
    s_cmp_lg_u32 s23, 0
    s_cbranch_scc1 KP_end
    s_cmp_lg_u32 s3, 0
    s_cbranch_scc1 KP_end
    v_min_u32 v5, 27, v1
    v_lshlrev_b32 v5, 7, v5
    s_mul_i32 s29, s22, 3584
    s_add_u32 s29, s29, 589824
    s_mov_b32 s27, 0
KP_e5:
    buffer_load_dword v7, v5, s[48:51], s29 offen sc1
    s_add_u32 s27, s27, 1
    s_cmp_gt_u32 s27, 65536
    s_cbranch_scc1 K3_bail
KP_e5_chk:
    s_waitcnt vmcnt(0)
    v_subrev_u32 v7, s95, v7
    v_subrev_u32 v7, 5, v7
    v_cmp_lt_u32 vcc, 0, v7
    s_cbranch_vccz KP_e5_ok
    s_sleep 1
    s_branch KP_e5
KP_e5_ok:
    v_lshlrev_b32 v5, 13, v1
    s_lshl_b32 s28, s22, 7
    v_mov_b32 v7, s96
    s_mov_b64 exec, 15
    buffer_store_dword v7, v5, s[48:51], s28 offen sc1
    s_mov_b64 exec, -1
KP_end:
    s_cmp_ge_u32 s22, 16
    s_cbranch_scc1 KM_g1
    s_add_u32 s36, s18, 0x502000
    s_addc_u32 s37, s19, 0
    s_mov_b32 s38, 0x7e000
    s_mov_b32 s39, 0x20000
    s_add_u32 s40, s18, 0x600000
    s_addc_u32 s41, s19, 0
    s_mov_b32 s42, 0x140000
    s_mov_b32 s43, 0x20000
    s_add_u32 s44, s18, 0x5c00000
    s_addc_u32 s45, s19, 0
    s_mov_b32 s46, 0x80000
    s_mov_b32 s47, 0x20000
    v_mov_b32 v232, -1
    v_mov_b32 v233, -1
    v_mov_b32 v234, -1
    v_mov_b32 v235, -1
    s_lshl_b32 s25, s20, 2
    s_add_u32 s25, s25, s3
    s_lshl_b32 s25, s25, 10
    s_add_u32 s24, s25, 458752
    buffer_store_dwordx4 v[232:235], v4, s[36:39], s25 offen sc1
    buffer_store_dwordx4 v[232:235], v4, s[36:39], s24 offen sc1
    buffer_store_dwordx4 v[232:235], v4, s[40:43], s25 offen sc1
    buffer_store_dwordx4 v[232:235], v4, s[40:43], s24 offen sc1
    buffer_store_dwordx4 v[232:235], v4, s[44:47], s25 offen sc1
    buffer_store_dwordx4 v[232:235], v4, s[44:47], s24 offen sc1
    s_add_u32 s24, s24, 458752
    buffer_store_dwordx4 v[232:235], v4, s[40:43], s24 offen sc1
    s_lshl_b32 s28, s20, 7
    s_add_u32 s28, s28, 720896
    s_waitcnt vmcnt(0)
    s_barrier
    s_cmp_lg_u32 s3, 0
    s_cbranch_scc1 KF_nf
    v_mov_b32 v6, s96
    v_mov_b32 v7, 0
    s_mov_b64 exec, 1
    buffer_store_dword v6, v7, s[48:51], s28 offen sc1
    s_mov_b64 exec, -1
KF_nf:
    s_cmp_lt_u32 s21, 4
    s_cbranch_scc1 KM_nomoe
    s_mul_i32 s20, s22, 3
    s_add_u32 s20, s20, s21
    s_sub_u32 s20, s20, 4
    v_min_u32 v5, 31, v1
    v_lshlrev_b32 v5, 7, v5
    s_mov_b32 s28, 565248
    s_mov_b32 s27, 0
KE_l:
    buffer_load_dword v6, v5, s[48:51], s28 offen sc1
    s_add_u32 s27, s27, 1
    s_cmp_gt_u32 s27, 65536
    s_cbranch_scc1 K3_bail
    s_waitcnt vmcnt(0)
    v_cmp_ne_u32 vcc, s96, v6
    s_cbranch_vccz KE_l_ok
    s_sleep 8
    s_branch KE_l
KE_l_ok:
    s_cmp_ge_u32 s20, 28
    s_cbranch_scc1 KM_tasks
    s_mov_b32 s22, s20
    s_barrier
    s_add_u32 s36, s18, 0x400000
    s_addc_u32 s37, s19, 0
    s_mov_b32 s38, 0x2000
    s_mov_b32 s39, 0x20000
    s_add_u32 s40, s18, 0x200000
    s_addc_u32 s41, s19, 0
    s_mov_b32 s42, 0x1c0000
    s_mov_b32 s43, 0x20000
    s_mov_b32 s44, s8
    s_mov_b32 s45, s9
    s_mov_b32 s46, 0x188000
    s_mov_b32 s47, 0x20000
    s_mov_b32 s48, s10
    s_mov_b32 s49, s11
    s_mov_b32 s50, 0x188000
    s_mov_b32 s51, 0x20000
    s_mov_b32 s52, s12
    s_mov_b32 s53, s13
    s_mov_b32 s54, 0x188000
    s_mov_b32 s55, 0x20000
    s_add_u32 s56, s18, 0x410000
    s_addc_u32 s57, s19, 0
    s_mov_b32 s58, 0x62000
    s_mov_b32 s59, 0x20000
    s_add_u32 s60, s18, 0x480000
    s_addc_u32 s61, s19, 0
    s_mov_b32 s62, 0x40
    s_mov_b32 s63, 0x20000
    v_lshlrev_b32 v4, 4, v1
    s_mov_b32 s26, 0
    buffer_load_dwordx4 v[16:19], v4, s[36:39], s26 offen offset:0
    s_mov_b32 s26, 0
    buffer_load_dwordx4 v[20:23], v4, s[36:39], s26 offen offset:1024
    s_mov_b32 s26, 0
    buffer_load_dwordx4 v[24:27], v4, s[36:39], s26 offen offset:2048
    s_mov_b32 s26, 0
    buffer_load_dwordx4 v[28:31], v4, s[36:39], s26 offen offset:3072
    s_mov_b32 s26, 4096
    buffer_load_dwordx4 v[32:35], v4, s[36:39], s26 offen offset:0
    s_mov_b32 s26, 4096
    buffer_load_dwordx4 v[36:39], v4, s[36:39], s26 offen offset:1024
    s_mov_b32 s26, 4096
    buffer_load_dwordx4 v[40:43], v4, s[36:39], s26 offen offset:2048
    s_mov_b32 s26, 4096
    buffer_load_dwordx4 v[44:47], v4, s[36:39], s26 offen offset:3072
    v_mul_u32_u24 v5, 28672, v3
    v_lshl_add_u32 v5, v2, 1, v5
    s_lshl_b32 s26, s22, 7
    s_lshl_b32 s27, s3, 5
    s_add_u32 s26, s26, s27
    v_add_u32 v5, s26, v5
    v_mul_u32_u24 v6, 3584, v3
    v_lshl_add_u32 v6, v2, 1, v6
    s_mul_i32 s26, s22, 57344
    s_mul_i32 s27, s3, 224
    s_add_u32 s26, s26, s27
    v_add_u32 v6, s26, v6
    s_waitcnt vmcnt(0)
    s_mov_b32 s28, 0xffff0000
    s_mov_b32 s29, 0x80000000
    v_ashrrev_i32 v7, 31, v16
    v_or_b32 v7, s29, v7
    v_xor_b32 v16, v7, v16
    v_lshlrev_b32 v7, 2, v1
    v_sub_u32 v7, 2047, v7
    v_and_or_b32 v16, v16, s28, v7
    v_ashrrev_i32 v7, 31, v17
    v_or_b32 v7, s29, v7
    v_xor_b32 v17, v7, v17
    v_lshlrev_b32 v7, 2, v1
    v_sub_u32 v7, 2046, v7
    v_and_or_b32 v17, v17, s28, v7
    v_ashrrev_i32 v7, 31, v18
    v_or_b32 v7, s29, v7
    v_xor_b32 v18, v7, v18
    v_lshlrev_b32 v7, 2, v1
    v_sub_u32 v7, 2045, v7
    v_and_or_b32 v18, v18, s28, v7
    v_ashrrev_i32 v7, 31, v19
    v_or_b32 v7, s29, v7
    v_xor_b32 v19, v7, v19
    v_lshlrev_b32 v7, 2, v1
    v_sub_u32 v7, 2044, v7
    v_and_or_b32 v19, v19, s28, v7
    v_ashrrev_i32 v7, 31, v20
    v_or_b32 v7, s29, v7
    v_xor_b32 v20, v7, v20
    v_lshlrev_b32 v7, 2, v1
    v_sub_u32 v7, 1791, v7
    v_and_or_b32 v20, v20, s28, v7
    v_ashrrev_i32 v7, 31, v21
    v_or_b32 v7, s29, v7
    v_xor_b32 v21, v7, v21
    v_lshlrev_b32 v7, 2, v1
    v_sub_u32 v7, 1790, v7
    v_and_or_b32 v21, v21, s28, v7
    v_ashrrev_i32 v7, 31, v22
    v_or_b32 v7, s29, v7
    v_xor_b32 v22, v7, v22
    v_lshlrev_b32 v7, 2, v1
    v_sub_u32 v7, 1789, v7
    v_and_or_b32 v22, v22, s28, v7
    v_ashrrev_i32 v7, 31, v23
    v_or_b32 v7, s29, v7
    v_xor_b32 v23, v7, v23
    v_lshlrev_b32 v7, 2, v1
    v_sub_u32 v7, 1788, v7
    v_and_or_b32 v23, v23, s28, v7
    v_ashrrev_i32 v7, 31, v24
    v_or_b32 v7, s29, v7
    v_xor_b32 v24, v7, v24
    v_lshlrev_b32 v7, 2, v1
    v_sub_u32 v7, 1535, v7
    v_and_or_b32 v24, v24, s28, v7
    v_ashrrev_i32 v7, 31, v25
    v_or_b32 v7, s29, v7
    v_xor_b32 v25, v7, v25
    v_lshlrev_b32 v7, 2, v1
    v_sub_u32 v7, 1534, v7
    v_and_or_b32 v25, v25, s28, v7
    v_ashrrev_i32 v7, 31, v26
    v_or_b32 v7, s29, v7
    v_xor_b32 v26, v7, v26
    v_lshlrev_b32 v7, 2, v1
    v_sub_u32 v7, 1533, v7
    v_and_or_b32 v26, v26, s28, v7
    v_ashrrev_i32 v7, 31, v27
    v_or_b32 v7, s29, v7
    v_xor_b32 v27, v7, v27
    v_lshlrev_b32 v7, 2, v1
    v_sub_u32 v7, 1532, v7
    v_and_or_b32 v27, v27, s28, v7
    v_ashrrev_i32 v7, 31, v28
    v_or_b32 v7, s29, v7
    v_xor_b32 v28, v7, v28
    v_lshlrev_b32 v7, 2, v1
    v_sub_u32 v7, 1279, v7
    v_and_or_b32 v28, v28, s28, v7
    v_ashrrev_i32 v7, 31, v29
    v_or_b32 v7, s29, v7
    v_xor_b32 v29, v7, v29
    v_lshlrev_b32 v7, 2, v1
    v_sub_u32 v7, 1278, v7
    v_and_or_b32 v29, v29, s28, v7
    v_ashrrev_i32 v7, 31, v30
    v_or_b32 v7, s29, v7
    v_xor_b32 v30, v7, v30
    v_lshlrev_b32 v7, 2, v1
    v_sub_u32 v7, 1277, v7
    v_and_or_b32 v30, v30, s28, v7
    v_ashrrev_i32 v7, 31, v31
    v_or_b32 v7, s29, v7
    v_xor_b32 v31, v7, v31
    v_lshlrev_b32 v7, 2, v1
    v_sub_u32 v7, 1276, v7
    v_and_or_b32 v31, v31, s28, v7
    v_ashrrev_i32 v7, 31, v32
    v_or_b32 v7, s29, v7
    v_xor_b32 v32, v7, v32
    v_lshlrev_b32 v7, 2, v1
    v_sub_u32 v7, 1023, v7
    v_and_or_b32 v32, v32, s28, v7
    v_ashrrev_i32 v7, 31, v33
    v_or_b32 v7, s29, v7
    v_xor_b32 v33, v7, v33
    v_lshlrev_b32 v7, 2, v1
    v_sub_u32 v7, 1022, v7
    v_and_or_b32 v33, v33, s28, v7
    v_ashrrev_i32 v7, 31, v34
    v_or_b32 v7, s29, v7
    v_xor_b32 v34, v7, v34
    v_lshlrev_b32 v7, 2, v1
    v_sub_u32 v7, 1021, v7
    v_and_or_b32 v34, v34, s28, v7
    v_ashrrev_i32 v7, 31, v35
    v_or_b32 v7, s29, v7
    v_xor_b32 v35, v7, v35
    v_lshlrev_b32 v7, 2, v1
    v_sub_u32 v7, 1020, v7
    v_and_or_b32 v35, v35, s28, v7
    v_ashrrev_i32 v7, 31, v36
    v_or_b32 v7, s29, v7
    v_xor_b32 v36, v7, v36
    v_lshlrev_b32 v7, 2, v1
    v_sub_u32 v7, 767, v7
    v_and_or_b32 v36, v36, s28, v7
    v_ashrrev_i32 v7, 31, v37
    v_or_b32 v7, s29, v7
    v_xor_b32 v37, v7, v37
    v_lshlrev_b32 v7, 2, v1
    v_sub_u32 v7, 766, v7
    v_and_or_b32 v37, v37, s28, v7
    v_ashrrev_i32 v7, 31, v38
    v_or_b32 v7, s29, v7
    v_xor_b32 v38, v7, v38
    v_lshlrev_b32 v7, 2, v1
    v_sub_u32 v7, 765, v7
    v_and_or_b32 v38, v38, s28, v7
    v_ashrrev_i32 v7, 31, v39
    v_or_b32 v7, s29, v7
    v_xor_b32 v39, v7, v39
    v_lshlrev_b32 v7, 2, v1
    v_sub_u32 v7, 764, v7
    v_and_or_b32 v39, v39, s28, v7
    v_ashrrev_i32 v7, 31, v40
    v_or_b32 v7, s29, v7
    v_xor_b32 v40, v7, v40
    v_lshlrev_b32 v7, 2, v1
    v_sub_u32 v7, 511, v7
    v_and_or_b32 v40, v40, s28, v7
    v_ashrrev_i32 v7, 31, v41
    v_or_b32 v7, s29, v7
    v_xor_b32 v41, v7, v41
    v_lshlrev_b32 v7, 2, v1
    v_sub_u32 v7, 510, v7
    v_and_or_b32 v41, v41, s28, v7
    v_ashrrev_i32 v7, 31, v42
    v_or_b32 v7, s29, v7
    v_xor_b32 v42, v7, v42
    v_lshlrev_b32 v7, 2, v1
    v_sub_u32 v7, 509, v7
    v_and_or_b32 v42, v42, s28, v7
    v_ashrrev_i32 v7, 31, v43
    v_or_b32 v7, s29, v7
    v_xor_b32 v43, v7, v43
    v_lshlrev_b32 v7, 2, v1
    v_sub_u32 v7, 508, v7
    v_and_or_b32 v43, v43, s28, v7
    v_ashrrev_i32 v7, 31, v44
    v_or_b32 v7, s29, v7
    v_xor_b32 v44, v7, v44
    v_lshlrev_b32 v7, 2, v1
    v_sub_u32 v7, 255, v7
    v_and_or_b32 v44, v44, s28, v7
    v_ashrrev_i32 v7, 31, v45
    v_or_b32 v7, s29, v7
    v_xor_b32 v45, v7, v45
    v_lshlrev_b32 v7, 2, v1
    v_sub_u32 v7, 254, v7
    v_and_or_b32 v45, v45, s28, v7
    v_ashrrev_i32 v7, 31, v46
    v_or_b32 v7, s29, v7
    v_xor_b32 v46, v7, v46
    v_lshlrev_b32 v7, 2, v1
    v_sub_u32 v7, 253, v7
    v_and_or_b32 v46, v46, s28, v7
    v_ashrrev_i32 v7, 31, v47
    v_or_b32 v7, s29, v7
    v_xor_b32 v47, v7, v47
    v_lshlrev_b32 v7, 2, v1
    v_sub_u32 v7, 252, v7
    v_and_or_b32 v47, v47, s28, v7
    v_mov_b32 v52, 0
    v_accvgpr_write_b32 a4, 0
    v_mov_b32 v53, 0
    v_accvgpr_write_b32 a5, 0
    v_mov_b32 v54, 0
    v_accvgpr_write_b32 a6, 0
    v_mov_b32 v55, 0
    v_accvgpr_write_b32 a7, 0
    v_mov_b32 v60, 0
    v_accvgpr_write_b32 a12, 0
    v_mov_b32 v61, 0
    v_accvgpr_write_b32 a13, 0
    v_mov_b32 v62, 0
    v_accvgpr_write_b32 a14, 0
    v_mov_b32 v63, 0
    v_accvgpr_write_b32 a15, 0
    v_mov_b32 v68, 0
    v_accvgpr_write_b32 a20, 0
    v_mov_b32 v69, 0
    v_accvgpr_write_b32 a21, 0
    v_mov_b32 v70, 0
    v_accvgpr_write_b32 a22, 0
    v_mov_b32 v71, 0
    v_accvgpr_write_b32 a23, 0
    v_mov_b32 v76, 0
    v_accvgpr_write_b32 a28, 0
    v_mov_b32 v77, 0
    v_accvgpr_write_b32 a29, 0
    v_mov_b32 v78, 0
    v_accvgpr_write_b32 a30, 0
    v_mov_b32 v79, 0
    v_accvgpr_write_b32 a31, 0
    v_mov_b32 v84, 0
    v_accvgpr_write_b32 a36, 0
    v_mov_b32 v85, 0
    v_accvgpr_write_b32 a37, 0
    v_mov_b32 v86, 0
    v_accvgpr_write_b32 a38, 0
    v_mov_b32 v87, 0
    v_accvgpr_write_b32 a39, 0
    v_mov_b32 v92, 0
    v_accvgpr_write_b32 a44, 0
    v_mov_b32 v93, 0
    v_accvgpr_write_b32 a45, 0
    v_mov_b32 v94, 0
    v_accvgpr_write_b32 a46, 0
    v_mov_b32 v95, 0
    v_accvgpr_write_b32 a47, 0
    v_mov_b32 v100, 0
    v_accvgpr_write_b32 a52, 0
    v_mov_b32 v101, 0
    v_accvgpr_write_b32 a53, 0
    v_mov_b32 v102, 0
    v_accvgpr_write_b32 a54, 0
    v_mov_b32 v103, 0
    v_accvgpr_write_b32 a55, 0
    v_mov_b32 v108, 0
    v_accvgpr_write_b32 a60, 0
    v_mov_b32 v109, 0
    v_accvgpr_write_b32 a61, 0
    v_mov_b32 v110, 0
    v_accvgpr_write_b32 a62, 0
    v_mov_b32 v111, 0
    v_accvgpr_write_b32 a63, 0
    v_mov_b32 v116, 0
    v_accvgpr_write_b32 a68, 0
    v_mov_b32 v117, 0
    v_accvgpr_write_b32 a69, 0
    v_mov_b32 v118, 0
    v_accvgpr_write_b32 a70, 0
    v_mov_b32 v119, 0
    v_accvgpr_write_b32 a71, 0
    v_mov_b32 v124, 0
    v_accvgpr_write_b32 a76, 0
    v_mov_b32 v125, 0
    v_accvgpr_write_b32 a77, 0
    v_mov_b32 v126, 0
    v_accvgpr_write_b32 a78, 0
    v_mov_b32 v127, 0
    v_accvgpr_write_b32 a79, 0
    v_mov_b32 v132, 0
    v_accvgpr_write_b32 a84, 0
    v_mov_b32 v133, 0
    v_accvgpr_write_b32 a85, 0
    v_mov_b32 v134, 0
    v_accvgpr_write_b32 a86, 0
    v_mov_b32 v135, 0
    v_accvgpr_write_b32 a87, 0
    v_mov_b32 v140, 0
    v_accvgpr_write_b32 a92, 0
    v_mov_b32 v141, 0
    v_accvgpr_write_b32 a93, 0
    v_mov_b32 v142, 0
    v_accvgpr_write_b32 a94, 0
    v_mov_b32 v143, 0
    v_accvgpr_write_b32 a95, 0
    v_mov_b32 v148, 0
    v_accvgpr_write_b32 a100, 0
    v_mov_b32 v149, 0
    v_accvgpr_write_b32 a101, 0
    v_mov_b32 v150, 0
    v_accvgpr_write_b32 a102, 0
    v_mov_b32 v151, 0
    v_accvgpr_write_b32 a103, 0
    v_mov_b32 v156, 0
    v_accvgpr_write_b32 a108, 0
    v_mov_b32 v157, 0
    v_accvgpr_write_b32 a109, 0
    v_mov_b32 v158, 0
    v_accvgpr_write_b32 a110, 0
    v_mov_b32 v159, 0
    v_accvgpr_write_b32 a111, 0
    v_accvgpr_write_b32 a114, 0
    v_accvgpr_write_b32 a115, 0
    v_accvgpr_write_b32 a118, 0
    v_accvgpr_write_b32 a119, 0
    v_accvgpr_write_b32 a122, 0
    v_accvgpr_write_b32 a123, 0
    v_accvgpr_write_b32 a126, 0
    v_accvgpr_write_b32 a127, 0
    v_accvgpr_write_b32 a130, 0
    v_accvgpr_write_b32 a131, 0
    v_accvgpr_write_b32 a134, 0
    v_accvgpr_write_b32 a135, 0
    v_accvgpr_write_b32 a138, 0
    v_accvgpr_write_b32 a139, 0
    v_accvgpr_write_b32 a142, 0
    v_accvgpr_write_b32 a143, 0
    v_accvgpr_write_b32 a146, 0
    v_accvgpr_write_b32 a147, 0
    v_accvgpr_write_b32 a150, 0
    v_accvgpr_write_b32 a151, 0
    v_accvgpr_write_b32 a154, 0
    v_accvgpr_write_b32 a155, 0
    v_accvgpr_write_b32 a158, 0
    v_accvgpr_write_b32 a159, 0
    v_accvgpr_write_b32 a162, 0
    v_accvgpr_write_b32 a163, 0
    v_accvgpr_write_b32 a166, 0
    v_accvgpr_write_b32 a167, 0
    v_accvgpr_write_b32 a170, 0
    v_accvgpr_write_b32 a171, 0
    v_accvgpr_write_b32 a174, 0
    v_accvgpr_write_b32 a175, 0
    v_accvgpr_write_b32 a178, 0
    v_accvgpr_write_b32 a179, 0
    v_accvgpr_write_b32 a182, 0
    v_accvgpr_write_b32 a183, 0
    v_accvgpr_write_b32 a186, 0
    v_accvgpr_write_b32 a187, 0
    v_accvgpr_write_b32 a190, 0
    v_accvgpr_write_b32 a191, 0
    v_accvgpr_write_b32 a194, 0
    v_accvgpr_write_b32 a195, 0
    v_accvgpr_write_b32 a198, 0
    v_accvgpr_write_b32 a199, 0
    v_accvgpr_write_b32 a202, 0
    v_accvgpr_write_b32 a203, 0
    v_accvgpr_write_b32 a206, 0
    v_accvgpr_write_b32 a207, 0
    v_accvgpr_write_b32 a210, 0
    v_accvgpr_write_b32 a211, 0
    v_accvgpr_write_b32 a214, 0
    v_accvgpr_write_b32 a215, 0
    v_accvgpr_write_b32 a218, 0
    v_accvgpr_write_b32 a219, 0
    v_accvgpr_write_b32 a222, 0
    v_accvgpr_write_b32 a223, 0
    s_mov_b32 s26, 0
    buffer_load_ushort v48, v5, s[44:47], s26 offen offset:0
    buffer_load_ushort a0, v5, s[48:51], s26 offen offset:0
    buffer_load_short_d16_hi v52, v5, s[44:47], s26 offen offset:3584
    buffer_load_short_d16_hi a4, v5, s[48:51], s26 offen offset:3584
    s_mov_b32 s26, 7168
    buffer_load_ushort v49, v5, s[44:47], s26 offen offset:0
    buffer_load_ushort a1, v5, s[48:51], s26 offen offset:0
    buffer_load_short_d16_hi v53, v5, s[44:47], s26 offen offset:3584
    buffer_load_short_d16_hi a5, v5, s[48:51], s26 offen offset:3584
    s_mov_b32 s26, 14336
    buffer_load_ushort v50, v5, s[44:47], s26 offen offset:0
    buffer_load_ushort a2, v5, s[48:51], s26 offen offset:0
    buffer_load_short_d16_hi v54, v5, s[44:47], s26 offen offset:3584
    buffer_load_short_d16_hi a6, v5, s[48:51], s26 offen offset:3584
    s_mov_b32 s26, 21504
    buffer_load_ushort v51, v5, s[44:47], s26 offen offset:0
    buffer_load_ushort a3, v5, s[48:51], s26 offen offset:0
    buffer_load_short_d16_hi v55, v5, s[44:47], s26 offen offset:3584
    buffer_load_short_d16_hi a7, v5, s[48:51], s26 offen offset:3584
    s_mov_b32 s26, 114688
    buffer_load_ushort v56, v5, s[44:47], s26 offen offset:0
    buffer_load_ushort a8, v5, s[48:51], s26 offen offset:0
    buffer_load_short_d16_hi v60, v5, s[44:47], s26 offen offset:3584
    buffer_load_short_d16_hi a12, v5, s[48:51], s26 offen offset:3584
    s_mov_b32 s26, 121856
    buffer_load_ushort v57, v5, s[44:47], s26 offen offset:0
    buffer_load_ushort a9, v5, s[48:51], s26 offen offset:0
    buffer_load_short_d16_hi v61, v5, s[44:47], s26 offen offset:3584
    buffer_load_short_d16_hi a13, v5, s[48:51], s26 offen offset:3584
    s_mov_b32 s26, 129024
    buffer_load_ushort v58, v5, s[44:47], s26 offen offset:0
    buffer_load_ushort a10, v5, s[48:51], s26 offen offset:0
    buffer_load_short_d16_hi v62, v5, s[44:47], s26 offen offset:3584
    buffer_load_short_d16_hi a14, v5, s[48:51], s26 offen offset:3584
    s_mov_b32 s26, 136192
    buffer_load_ushort v59, v5, s[44:47], s26 offen offset:0
    buffer_load_ushort a11, v5, s[48:51], s26 offen offset:0
    buffer_load_short_d16_hi v63, v5, s[44:47], s26 offen offset:3584
    buffer_load_short_d16_hi a15, v5, s[48:51], s26 offen offset:3584
    s_mov_b32 s26, 229376
    buffer_load_ushort v64, v5, s[44:47], s26 offen offset:0
    buffer_load_ushort a16, v5, s[48:51], s26 offen offset:0
    buffer_load_short_d16_hi v68, v5, s[44:47], s26 offen offset:3584
    buffer_load_short_d16_hi a20, v5, s[48:51], s26 offen offset:3584
    s_mov_b32 s26, 236544
    buffer_load_ushort v65, v5, s[44:47], s26 offen offset:0
    buffer_load_ushort a17, v5, s[48:51], s26 offen offset:0
    buffer_load_short_d16_hi v69, v5, s[44:47], s26 offen offset:3584
    buffer_load_short_d16_hi a21, v5, s[48:51], s26 offen offset:3584
    s_mov_b32 s26, 243712
    buffer_load_ushort v66, v5, s[44:47], s26 offen offset:0
    buffer_load_ushort a18, v5, s[48:51], s26 offen offset:0
    buffer_load_short_d16_hi v70, v5, s[44:47], s26 offen offset:3584
    buffer_load_short_d16_hi a22, v5, s[48:51], s26 offen offset:3584
    s_mov_b32 s26, 250880
    buffer_load_ushort v67, v5, s[44:47], s26 offen offset:0
    buffer_load_ushort a19, v5, s[48:51], s26 offen offset:0
    buffer_load_short_d16_hi v71, v5, s[44:47], s26 offen offset:3584
    buffer_load_short_d16_hi a23, v5, s[48:51], s26 offen offset:3584
    s_mov_b32 s26, 344064
    buffer_load_ushort v72, v5, s[44:47], s26 offen offset:0
    buffer_load_ushort a24, v5, s[48:51], s26 offen offset:0
    buffer_load_short_d16_hi v76, v5, s[44:47], s26 offen offset:3584
    buffer_load_short_d16_hi a28, v5, s[48:51], s26 offen offset:3584
    s_mov_b32 s26, 351232
    buffer_load_ushort v73, v5, s[44:47], s26 offen offset:0
    buffer_load_ushort a25, v5, s[48:51], s26 offen offset:0
    buffer_load_short_d16_hi v77, v5, s[44:47], s26 offen offset:3584
    buffer_load_short_d16_hi a29, v5, s[48:51], s26 offen offset:3584
    s_mov_b32 s26, 358400
    buffer_load_ushort v74, v5, s[44:47], s26 offen offset:0
    buffer_load_ushort a26, v5, s[48:51], s26 offen offset:0
    buffer_load_short_d16_hi v78, v5, s[44:47], s26 offen offset:3584
    buffer_load_short_d16_hi a30, v5, s[48:51], s26 offen offset:3584
    s_mov_b32 s26, 365568
    buffer_load_ushort v75, v5, s[44:47], s26 offen offset:0
    buffer_load_ushort a27, v5, s[48:51], s26 offen offset:0
    buffer_load_short_d16_hi v79, v5, s[44:47], s26 offen offset:3584
    buffer_load_short_d16_hi a31, v5, s[48:51], s26 offen offset:3584
    s_mov_b32 s26, 458752
    buffer_load_ushort v80, v5, s[44:47], s26 offen offset:0
    buffer_load_ushort a32, v5, s[48:51], s26 offen offset:0
    buffer_load_short_d16_hi v84, v5, s[44:47], s26 offen offset:3584
    buffer_load_short_d16_hi a36, v5, s[48:51], s26 offen offset:3584
    s_mov_b32 s26, 465920
    buffer_load_ushort v81, v5, s[44:47], s26 offen offset:0
    buffer_load_ushort a33, v5, s[48:51], s26 offen offset:0
    buffer_load_short_d16_hi v85, v5, s[44:47], s26 offen offset:3584
    buffer_load_short_d16_hi a37, v5, s[48:51], s26 offen offset:3584
    s_mov_b32 s26, 473088
    buffer_load_ushort v82, v5, s[44:47], s26 offen offset:0
    buffer_load_ushort a34, v5, s[48:51], s26 offen offset:0
    buffer_load_short_d16_hi v86, v5, s[44:47], s26 offen offset:3584
    buffer_load_short_d16_hi a38, v5, s[48:51], s26 offen offset:3584
    s_mov_b32 s26, 480256
    buffer_load_ushort v83, v5, s[44:47], s26 offen offset:0
    buffer_load_ushort a35, v5, s[48:51], s26 offen offset:0
    buffer_load_short_d16_hi v87, v5, s[44:47], s26 offen offset:3584
    buffer_load_short_d16_hi a39, v5, s[48:51], s26 offen offset:3584
    s_mov_b32 s26, 573440
    buffer_load_ushort v88, v5, s[44:47], s26 offen offset:0
    buffer_load_ushort a40, v5, s[48:51], s26 offen offset:0
    buffer_load_short_d16_hi v92, v5, s[44:47], s26 offen offset:3584
    buffer_load_short_d16_hi a44, v5, s[48:51], s26 offen offset:3584
    s_mov_b32 s26, 580608
    buffer_load_ushort v89, v5, s[44:47], s26 offen offset:0
    buffer_load_ushort a41, v5, s[48:51], s26 offen offset:0
    buffer_load_short_d16_hi v93, v5, s[44:47], s26 offen offset:3584
    buffer_load_short_d16_hi a45, v5, s[48:51], s26 offen offset:3584
    s_mov_b32 s26, 587776
    buffer_load_ushort v90, v5, s[44:47], s26 offen offset:0
    buffer_load_ushort a42, v5, s[48:51], s26 offen offset:0
    buffer_load_short_d16_hi v94, v5, s[44:47], s26 offen offset:3584
    buffer_load_short_d16_hi a46, v5, s[48:51], s26 offen offset:3584
    s_mov_b32 s26, 594944
    buffer_load_ushort v91, v5, s[44:47], s26 offen offset:0
    buffer_load_ushort a43, v5, s[48:51], s26 offen offset:0
    buffer_load_short_d16_hi v95, v5, s[44:47], s26 offen offset:3584
    buffer_load_short_d16_hi a47, v5, s[48:51], s26 offen offset:3584
    s_mov_b32 s26, 688128
    buffer_load_ushort v96, v5, s[44:47], s26 offen offset:0
    buffer_load_ushort a48, v5, s[48:51], s26 offen offset:0
    buffer_load_short_d16_hi v100, v5, s[44:47], s26 offen offset:3584
    buffer_load_short_d16_hi a52, v5, s[48:51], s26 offen offset:3584
    s_mov_b32 s26, 695296
    buffer_load_ushort v97, v5, s[44:47], s26 offen offset:0
    buffer_load_ushort a49, v5, s[48:51], s26 offen offset:0
    buffer_load_short_d16_hi v101, v5, s[44:47], s26 offen offset:3584
    buffer_load_short_d16_hi a53, v5, s[48:51], s26 offen offset:3584
    s_mov_b32 s26, 702464
    buffer_load_ushort v98, v5, s[44:47], s26 offen offset:0
    buffer_load_ushort a50, v5, s[48:51], s26 offen offset:0
    buffer_load_short_d16_hi v102, v5, s[44:47], s26 offen offset:3584
    buffer_load_short_d16_hi a54, v5, s[48:51], s26 offen offset:3584
    s_mov_b32 s26, 709632
    buffer_load_ushort v99, v5, s[44:47], s26 offen offset:0
    buffer_load_ushort a51, v5, s[48:51], s26 offen offset:0
    buffer_load_short_d16_hi v103, v5, s[44:47], s26 offen offset:3584
    buffer_load_short_d16_hi a55, v5, s[48:51], s26 offen offset:3584
    s_mov_b32 s26, 802816
    buffer_load_ushort v104, v5, s[44:47], s26 offen offset:0
    buffer_load_ushort a56, v5, s[48:51], s26 offen offset:0
    buffer_load_short_d16_hi v108, v5, s[44:47], s26 offen offset:3584
    buffer_load_short_d16_hi a60, v5, s[48:51], s26 offen offset:3584
    s_mov_b32 s26, 809984
    buffer_load_ushort v105, v5, s[44:47], s26 offen offset:0
    buffer_load_ushort a57, v5, s[48:51], s26 offen offset:0
    buffer_load_short_d16_hi v109, v5, s[44:47], s26 offen offset:3584
    buffer_load_short_d16_hi a61, v5, s[48:51], s26 offen offset:3584
    s_mov_b32 s26, 817152
    buffer_load_ushort v106, v5, s[44:47], s26 offen offset:0
    buffer_load_ushort a58, v5, s[48:51], s26 offen offset:0
    buffer_load_short_d16_hi v110, v5, s[44:47], s26 offen offset:3584
    buffer_load_short_d16_hi a62, v5, s[48:51], s26 offen offset:3584
    s_mov_b32 s26, 824320
    buffer_load_ushort v107, v5, s[44:47], s26 offen offset:0
    buffer_load_ushort a59, v5, s[48:51], s26 offen offset:0
    buffer_load_short_d16_hi v111, v5, s[44:47], s26 offen offset:3584
    buffer_load_short_d16_hi a63, v5, s[48:51], s26 offen offset:3584
    s_mov_b32 s26, 917504
    buffer_load_ushort v112, v5, s[44:47], s26 offen offset:0
    buffer_load_ushort a64, v5, s[48:51], s26 offen offset:0
    buffer_load_short_d16_hi v116, v5, s[44:47], s26 offen offset:3584
    buffer_load_short_d16_hi a68, v5, s[48:51], s26 offen offset:3584
    s_mov_b32 s26, 924672
    buffer_load_ushort v113, v5, s[44:47], s26 offen offset:0
    buffer_load_ushort a65, v5, s[48:51], s26 offen offset:0
    buffer_load_short_d16_hi v117, v5, s[44:47], s26 offen offset:3584
    buffer_load_short_d16_hi a69, v5, s[48:51], s26 offen offset:3584
    s_mov_b32 s26, 931840
    buffer_load_ushort v114, v5, s[44:47], s26 offen offset:0
    buffer_load_ushort a66, v5, s[48:51], s26 offen offset:0
    buffer_load_short_d16_hi v118, v5, s[44:47], s26 offen offset:3584
    buffer_load_short_d16_hi a70, v5, s[48:51], s26 offen offset:3584
    s_mov_b32 s26, 939008
    buffer_load_ushort v115, v5, s[44:47], s26 offen offset:0
    buffer_load_ushort a67, v5, s[48:51], s26 offen offset:0
    buffer_load_short_d16_hi v119, v5, s[44:47], s26 offen offset:3584
    buffer_load_short_d16_hi a71, v5, s[48:51], s26 offen offset:3584
    s_mov_b32 s26, 1032192
    buffer_load_ushort v120, v5, s[44:47], s26 offen offset:0
    buffer_load_ushort a72, v5, s[48:51], s26 offen offset:0
    buffer_load_short_d16_hi v124, v5, s[44:47], s26 offen offset:3584
    buffer_load_short_d16_hi a76, v5, s[48:51], s26 offen offset:3584
    s_mov_b32 s26, 1039360
    buffer_load_ushort v121, v5, s[44:47], s26 offen offset:0
    buffer_load_ushort a73, v5, s[48:51], s26 offen offset:0
    buffer_load_short_d16_hi v125, v5, s[44:47], s26 offen offset:3584
    buffer_load_short_d16_hi a77, v5, s[48:51], s26 offen offset:3584
    s_mov_b32 s26, 1046528
    buffer_load_ushort v122, v5, s[44:47], s26 offen offset:0
    buffer_load_ushort a74, v5, s[48:51], s26 offen offset:0
    buffer_load_short_d16_hi v126, v5, s[44:47], s26 offen offset:3584
    buffer_load_short_d16_hi a78, v5, s[48:51], s26 offen offset:3584
    s_mov_b32 s26, 1053696
    buffer_load_ushort v123, v5, s[44:47], s26 offen offset:0
    buffer_load_ushort a75, v5, s[48:51], s26 offen offset:0
    buffer_load_short_d16_hi v127, v5, s[44:47], s26 offen offset:3584
    buffer_load_short_d16_hi a79, v5, s[48:51], s26 offen offset:3584
    s_mov_b32 s26, 1146880
    buffer_load_ushort v128, v5, s[44:47], s26 offen offset:0
    buffer_load_ushort a80, v5, s[48:51], s26 offen offset:0
    buffer_load_short_d16_hi v132, v5, s[44:47], s26 offen offset:3584
    buffer_load_short_d16_hi a84, v5, s[48:51], s26 offen offset:3584
    s_mov_b32 s26, 1154048
    buffer_load_ushort v129, v5, s[44:47], s26 offen offset:0
    buffer_load_ushort a81, v5, s[48:51], s26 offen offset:0
    buffer_load_short_d16_hi v133, v5, s[44:47], s26 offen offset:3584
    buffer_load_short_d16_hi a85, v5, s[48:51], s26 offen offset:3584
    s_mov_b32 s26, 1161216
    buffer_load_ushort v130, v5, s[44:47], s26 offen offset:0
    buffer_load_ushort a82, v5, s[48:51], s26 offen offset:0
    buffer_load_short_d16_hi v134, v5, s[44:47], s26 offen offset:3584
    buffer_load_short_d16_hi a86, v5, s[48:51], s26 offen offset:3584
    s_mov_b32 s26, 1168384
    buffer_load_ushort v131, v5, s[44:47], s26 offen offset:0
    buffer_load_ushort a83, v5, s[48:51], s26 offen offset:0
    buffer_load_short_d16_hi v135, v5, s[44:47], s26 offen offset:3584
    buffer_load_short_d16_hi a87, v5, s[48:51], s26 offen offset:3584
    s_mov_b32 s26, 1261568
    buffer_load_ushort v136, v5, s[44:47], s26 offen offset:0
    buffer_load_ushort a88, v5, s[48:51], s26 offen offset:0
    buffer_load_short_d16_hi v140, v5, s[44:47], s26 offen offset:3584
    buffer_load_short_d16_hi a92, v5, s[48:51], s26 offen offset:3584
    s_mov_b32 s26, 1268736
    buffer_load_ushort v137, v5, s[44:47], s26 offen offset:0
    buffer_load_ushort a89, v5, s[48:51], s26 offen offset:0
    buffer_load_short_d16_hi v141, v5, s[44:47], s26 offen offset:3584
    buffer_load_short_d16_hi a93, v5, s[48:51], s26 offen offset:3584
    s_mov_b32 s26, 1275904
    buffer_load_ushort v138, v5, s[44:47], s26 offen offset:0
    buffer_load_ushort a90, v5, s[48:51], s26 offen offset:0
    buffer_load_short_d16_hi v142, v5, s[44:47], s26 offen offset:3584
    buffer_load_short_d16_hi a94, v5, s[48:51], s26 offen offset:3584
    s_mov_b32 s26, 1283072
    buffer_load_ushort v139, v5, s[44:47], s26 offen offset:0
    buffer_load_ushort a91, v5, s[48:51], s26 offen offset:0
    buffer_load_short_d16_hi v143, v5, s[44:47], s26 offen offset:3584
    buffer_load_short_d16_hi a95, v5, s[48:51], s26 offen offset:3584
    s_mov_b32 s26, 1376256
    buffer_load_ushort v144, v5, s[44:47], s26 offen offset:0
    buffer_load_ushort a96, v5, s[48:51], s26 offen offset:0
    buffer_load_short_d16_hi v148, v5, s[44:47], s26 offen offset:3584
    buffer_load_short_d16_hi a100, v5, s[48:51], s26 offen offset:3584
    s_mov_b32 s26, 1383424
    buffer_load_ushort v145, v5, s[44:47], s26 offen offset:0
    buffer_load_ushort a97, v5, s[48:51], s26 offen offset:0
    buffer_load_short_d16_hi v149, v5, s[44:47], s26 offen offset:3584
    buffer_load_short_d16_hi a101, v5, s[48:51], s26 offen offset:3584
    s_mov_b32 s26, 1390592
    buffer_load_ushort v146, v5, s[44:47], s26 offen offset:0
    buffer_load_ushort a98, v5, s[48:51], s26 offen offset:0
    buffer_load_short_d16_hi v150, v5, s[44:47], s26 offen offset:3584
    buffer_load_short_d16_hi a102, v5, s[48:51], s26 offen offset:3584
    s_mov_b32 s26, 1397760
    buffer_load_ushort v147, v5, s[44:47], s26 offen offset:0
    buffer_load_ushort a99, v5, s[48:51], s26 offen offset:0
    buffer_load_short_d16_hi v151, v5, s[44:47], s26 offen offset:3584
    buffer_load_short_d16_hi a103, v5, s[48:51], s26 offen offset:3584
    s_mov_b32 s26, 1490944
    buffer_load_ushort v152, v5, s[44:47], s26 offen offset:0
    buffer_load_ushort a104, v5, s[48:51], s26 offen offset:0
    buffer_load_short_d16_hi v156, v5, s[44:47], s26 offen offset:3584
    buffer_load_short_d16_hi a108, v5, s[48:51], s26 offen offset:3584
    s_mov_b32 s26, 1498112
    buffer_load_ushort v153, v5, s[44:47], s26 offen offset:0
    buffer_load_ushort a105, v5, s[48:51], s26 offen offset:0
    buffer_load_short_d16_hi v157, v5, s[44:47], s26 offen offset:3584
    buffer_load_short_d16_hi a109, v5, s[48:51], s26 offen offset:3584
    s_mov_b32 s26, 1505280
    buffer_load_ushort v154, v5, s[44:47], s26 offen offset:0
    buffer_load_ushort a106, v5, s[48:51], s26 offen offset:0
    buffer_load_short_d16_hi v158, v5, s[44:47], s26 offen offset:3584
    buffer_load_short_d16_hi a110, v5, s[48:51], s26 offen offset:3584
    s_mov_b32 s26, 1512448
    buffer_load_ushort v155, v5, s[44:47], s26 offen offset:0
    buffer_load_ushort a107, v5, s[48:51], s26 offen offset:0
    buffer_load_short_d16_hi v159, v5, s[44:47], s26 offen offset:3584
    buffer_load_short_d16_hi a111, v5, s[48:51], s26 offen offset:3584
    s_mov_b32 s26, 0
    buffer_load_ushort a112, v6, s[52:55], s26 offen offset:0
    buffer_load_ushort a128, v6, s[52:55], s26 offen offset:32
    buffer_load_ushort a144, v6, s[52:55], s26 offen offset:64
    buffer_load_ushort a160, v6, s[52:55], s26 offen offset:96
    buffer_load_ushort a176, v6, s[52:55], s26 offen offset:128
    buffer_load_ushort a192, v6, s[52:55], s26 offen offset:160
    buffer_load_ushort a208, v6, s[52:55], s26 offen offset:192
    s_mov_b32 s26, 896
    buffer_load_short_d16_hi a114, v6, s[52:55], s26 offen offset:0
    buffer_load_short_d16_hi a130, v6, s[52:55], s26 offen offset:32
    buffer_load_short_d16_hi a146, v6, s[52:55], s26 offen offset:64
    buffer_load_short_d16_hi a162, v6, s[52:55], s26 offen offset:96
    buffer_load_short_d16_hi a178, v6, s[52:55], s26 offen offset:128
    buffer_load_short_d16_hi a194, v6, s[52:55], s26 offen offset:160
    buffer_load_short_d16_hi a210, v6, s[52:55], s26 offen offset:192
    s_mov_b32 s26, 1792
    buffer_load_ushort a113, v6, s[52:55], s26 offen offset:0
    buffer_load_ushort a129, v6, s[52:55], s26 offen offset:32
    buffer_load_ushort a145, v6, s[52:55], s26 offen offset:64
    buffer_load_ushort a161, v6, s[52:55], s26 offen offset:96
    buffer_load_ushort a177, v6, s[52:55], s26 offen offset:128
    buffer_load_ushort a193, v6, s[52:55], s26 offen offset:160
    buffer_load_ushort a209, v6, s[52:55], s26 offen offset:192
    s_mov_b32 s26, 2688
    buffer_load_short_d16_hi a115, v6, s[52:55], s26 offen offset:0
    buffer_load_short_d16_hi a131, v6, s[52:55], s26 offen offset:32
    buffer_load_short_d16_hi a147, v6, s[52:55], s26 offen offset:64
    buffer_load_short_d16_hi a163, v6, s[52:55], s26 offen offset:96
    buffer_load_short_d16_hi a179, v6, s[52:55], s26 offen offset:128
    buffer_load_short_d16_hi a195, v6, s[52:55], s26 offen offset:160
    buffer_load_short_d16_hi a211, v6, s[52:55], s26 offen offset:192
    s_mov_b32 s26, 14336
    buffer_load_ushort a116, v6, s[52:55], s26 offen offset:0
    buffer_load_ushort a132, v6, s[52:55], s26 offen offset:32
    buffer_load_ushort a148, v6, s[52:55], s26 offen offset:64
    buffer_load_ushort a164, v6, s[52:55], s26 offen offset:96
    buffer_load_ushort a180, v6, s[52:55], s26 offen offset:128
    buffer_load_ushort a196, v6, s[52:55], s26 offen offset:160
    buffer_load_ushort a212, v6, s[52:55], s26 offen offset:192
    s_mov_b32 s26, 15232
    buffer_load_short_d16_hi a118, v6, s[52:55], s26 offen offset:0
    buffer_load_short_d16_hi a134, v6, s[52:55], s26 offen offset:32
    buffer_load_short_d16_hi a150, v6, s[52:55], s26 offen offset:64
    buffer_load_short_d16_hi a166, v6, s[52:55], s26 offen offset:96
    buffer_load_short_d16_hi a182, v6, s[52:55], s26 offen offset:128
    buffer_load_short_d16_hi a198, v6, s[52:55], s26 offen offset:160
    buffer_load_short_d16_hi a214, v6, s[52:55], s26 offen offset:192
    s_mov_b32 s26, 16128
    buffer_load_ushort a117, v6, s[52:55], s26 offen offset:0
    buffer_load_ushort a133, v6, s[52:55], s26 offen offset:32
    buffer_load_ushort a149, v6, s[52:55], s26 offen offset:64
    buffer_load_ushort a165, v6, s[52:55], s26 offen offset:96
    buffer_load_ushort a181, v6, s[52:55], s26 offen offset:128
    buffer_load_ushort a197, v6, s[52:55], s26 offen offset:160
    buffer_load_ushort a213, v6, s[52:55], s26 offen offset:192
    s_mov_b32 s26, 17024
    buffer_load_short_d16_hi a119, v6, s[52:55], s26 offen offset:0
    buffer_load_short_d16_hi a135, v6, s[52:55], s26 offen offset:32
    buffer_load_short_d16_hi a151, v6, s[52:55], s26 offen offset:64
    buffer_load_short_d16_hi a167, v6, s[52:55], s26 offen offset:96
    buffer_load_short_d16_hi a183, v6, s[52:55], s26 offen offset:128
    buffer_load_short_d16_hi a199, v6, s[52:55], s26 offen offset:160
    buffer_load_short_d16_hi a215, v6, s[52:55], s26 offen offset:192
    s_mov_b32 s26, 28672
    buffer_load_ushort a120, v6, s[52:55], s26 offen offset:0
    buffer_load_ushort a136, v6, s[52:55], s26 offen offset:32
    buffer_load_ushort a152, v6, s[52:55], s26 offen offset:64
    buffer_load_ushort a168, v6, s[52:55], s26 offen offset:96
    buffer_load_ushort a184, v6, s[52:55], s26 offen offset:128
    buffer_load_ushort a200, v6, s[52:55], s26 offen offset:160
    buffer_load_ushort a216, v6, s[52:55], s26 offen offset:192
    s_mov_b32 s26, 29568
    buffer_load_short_d16_hi a122, v6, s[52:55], s26 offen offset:0
    buffer_load_short_d16_hi a138, v6, s[52:55], s26 offen offset:32
    buffer_load_short_d16_hi a154, v6, s[52:55], s26 offen offset:64
    buffer_load_short_d16_hi a170, v6, s[52:55], s26 offen offset:96
    buffer_load_short_d16_hi a186, v6, s[52:55], s26 offen offset:128
    buffer_load_short_d16_hi a202, v6, s[52:55], s26 offen offset:160
    buffer_load_short_d16_hi a218, v6, s[52:55], s26 offen offset:192
    s_mov_b32 s26, 30464
    buffer_load_ushort a121, v6, s[52:55], s26 offen offset:0
    buffer_load_ushort a137, v6, s[52:55], s26 offen offset:32
    buffer_load_ushort a153, v6, s[52:55], s26 offen offset:64
    buffer_load_ushort a169, v6, s[52:55], s26 offen offset:96
    buffer_load_ushort a185, v6, s[52:55], s26 offen offset:128
    buffer_load_ushort a201, v6, s[52:55], s26 offen offset:160
    buffer_load_ushort a217, v6, s[52:55], s26 offen offset:192
    s_mov_b32 s26, 31360
    buffer_load_short_d16_hi a123, v6, s[52:55], s26 offen offset:0
    buffer_load_short_d16_hi a139, v6, s[52:55], s26 offen offset:32
    buffer_load_short_d16_hi a155, v6, s[52:55], s26 offen offset:64
    buffer_load_short_d16_hi a171, v6, s[52:55], s26 offen offset:96
    buffer_load_short_d16_hi a187, v6, s[52:55], s26 offen offset:128
    buffer_load_short_d16_hi a203, v6, s[52:55], s26 offen offset:160
    buffer_load_short_d16_hi a219, v6, s[52:55], s26 offen offset:192
    s_mov_b32 s26, 43008
    buffer_load_ushort a124, v6, s[52:55], s26 offen offset:0
    buffer_load_ushort a140, v6, s[52:55], s26 offen offset:32
    buffer_load_ushort a156, v6, s[52:55], s26 offen offset:64
    buffer_load_ushort a172, v6, s[52:55], s26 offen offset:96
    buffer_load_ushort a188, v6, s[52:55], s26 offen offset:128
    buffer_load_ushort a204, v6, s[52:55], s26 offen offset:160
    buffer_load_ushort a220, v6, s[52:55], s26 offen offset:192
    s_mov_b32 s26, 43904
    buffer_load_short_d16_hi a126, v6, s[52:55], s26 offen offset:0
    buffer_load_short_d16_hi a142, v6, s[52:55], s26 offen offset:32
    buffer_load_short_d16_hi a158, v6, s[52:55], s26 offen offset:64
    buffer_load_short_d16_hi a174, v6, s[52:55], s26 offen offset:96
    buffer_load_short_d16_hi a190, v6, s[52:55], s26 offen offset:128
    buffer_load_short_d16_hi a206, v6, s[52:55], s26 offen offset:160
    buffer_load_short_d16_hi a222, v6, s[52:55], s26 offen offset:192
    s_mov_b32 s26, 44800
    buffer_load_ushort a125, v6, s[52:55], s26 offen offset:0
    buffer_load_ushort a141, v6, s[52:55], s26 offen offset:32
    buffer_load_ushort a157, v6, s[52:55], s26 offen offset:64
    buffer_load_ushort a173, v6, s[52:55], s26 offen offset:96
    buffer_load_ushort a189, v6, s[52:55], s26 offen offset:128
    buffer_load_ushort a205, v6, s[52:55], s26 offen offset:160
    buffer_load_ushort a221, v6, s[52:55], s26 offen offset:192
    s_mov_b32 s26, 45696
    buffer_load_short_d16_hi a127, v6, s[52:55], s26 offen offset:0
    buffer_load_short_d16_hi a143, v6, s[52:55], s26 offen offset:32
    buffer_load_short_d16_hi a159, v6, s[52:55], s26 offen offset:64
    buffer_load_short_d16_hi a175, v6, s[52:55], s26 offen offset:96
    buffer_load_short_d16_hi a191, v6, s[52:55], s26 offen offset:128
    buffer_load_short_d16_hi a207, v6, s[52:55], s26 offen offset:160
    buffer_load_short_d16_hi a223, v6, s[52:55], s26 offen offset:192
    v_max3_u32 v7, v16, v17, v18
    v_max3_u32 v7, v7, v19, v20
    v_max3_u32 v7, v7, v21, v22
    v_max3_u32 v7, v7, v23, v24
    v_max3_u32 v7, v7, v25, v26
    v_max3_u32 v7, v7, v27, v28
    v_max3_u32 v7, v7, v29, v30
    v_max3_u32 v7, v7, v31, v32
    v_max3_u32 v7, v7, v33, v34
    v_max3_u32 v7, v7, v35, v36
    v_max3_u32 v7, v7, v37, v38
    v_max3_u32 v7, v7, v39, v40
    v_max3_u32 v7, v7, v41, v42
    v_max3_u32 v7, v7, v43, v44
    v_max3_u32 v7, v7, v45, v46
    v_max_u32 v7, v7, v47
    s_nop 1
    v_max_u32_dpp v7, v7, v7 row_ror:8 row_mask:0xf bank_mask:0xf
    s_nop 1
    v_max_u32_dpp v7, v7, v7 row_ror:4 row_mask:0xf bank_mask:0xf
    s_nop 1
    v_max_u32_dpp v7, v7, v7 row_ror:2 row_mask:0xf bank_mask:0xf
    s_nop 1
    v_max_u32_dpp v7, v7, v7 row_ror:1 row_mask:0xf bank_mask:0xf
    v_mov_b32 v8, v7
    s_nop 1
    v_permlane16_swap_b32 v7, v8
    v_max_u32 v7, v7, v8
    v_mov_b32 v8, v7
    s_nop 1
    v_permlane32_swap_b32 v7, v8
    v_max_u32 v7, v7, v8
    s_nop 0
    v_readfirstlane_b32 s64, v7
    s_nop 1
    s_sub_u32 s30, s64, 1
    v_sub_u32 v7, s30, v16
    v_sub_u32 v8, s30, v17
    v_sub_u32 v9, s30, v18
    v_min3_u32 v7, v7, v8, v9
    v_sub_u32 v8, s30, v19
    v_sub_u32 v9, s30, v20
    v_min3_u32 v7, v7, v8, v9
    v_sub_u32 v8, s30, v21
    v_sub_u32 v9, s30, v22
    v_min3_u32 v7, v7, v8, v9
    v_sub_u32 v8, s30, v23
    v_sub_u32 v9, s30, v24
    v_min3_u32 v7, v7, v8, v9
    v_sub_u32 v8, s30, v25
    v_sub_u32 v9, s30, v26
    v_min3_u32 v7, v7, v8, v9
    v_sub_u32 v8, s30, v27
    v_sub_u32 v9, s30, v28
    v_min3_u32 v7, v7, v8, v9
    v_sub_u32 v8, s30, v29
    v_sub_u32 v9, s30, v30
    v_min3_u32 v7, v7, v8, v9
    v_sub_u32 v8, s30, v31
    v_sub_u32 v9, s30, v32
    v_min3_u32 v7, v7, v8, v9
    v_sub_u32 v8, s30, v33
    v_sub_u32 v9, s30, v34
    v_min3_u32 v7, v7, v8, v9
    v_sub_u32 v8, s30, v35
    v_sub_u32 v9, s30, v36
    v_min3_u32 v7, v7, v8, v9
    v_sub_u32 v8, s30, v37
    v_sub_u32 v9, s30, v38
    v_min3_u32 v7, v7, v8, v9
    v_sub_u32 v8, s30, v39
    v_sub_u32 v9, s30, v40
    v_min3_u32 v7, v7, v8, v9
    v_sub_u32 v8, s30, v41
    v_sub_u32 v9, s30, v42
    v_min3_u32 v7, v7, v8, v9
    v_sub_u32 v8, s30, v43
    v_sub_u32 v9, s30, v44
    v_min3_u32 v7, v7, v8, v9
    v_sub_u32 v8, s30, v45
    v_sub_u32 v9, s30, v46
    v_min3_u32 v7, v7, v8, v9
    v_sub_u32 v8, s30, v47
    v_min_u32 v7, v7, v8
    s_nop 1
    v_min_u32_dpp v7, v7, v7 row_ror:8 row_mask:0xf bank_mask:0xf
    s_nop 1
    v_min_u32_dpp v7, v7, v7 row_ror:4 row_mask:0xf bank_mask:0xf
    s_nop 1
    v_min_u32_dpp v7, v7, v7 row_ror:2 row_mask:0xf bank_mask:0xf
    s_nop 1
    v_min_u32_dpp v7, v7, v7 row_ror:1 row_mask:0xf bank_mask:0xf
    v_mov_b32 v8, v7
    s_nop 1
    v_permlane16_swap_b32 v7, v8
    v_min_u32 v7, v7, v8
    v_mov_b32 v8, v7
    s_nop 1
    v_permlane32_swap_b32 v7, v8
    v_min_u32 v7, v7, v8
    s_nop 0
    v_readfirstlane_b32 s65, v7
    s_nop 1
    s_sub_u32 s65, s30, s65
    s_sub_u32 s30, s65, 1
    v_sub_u32 v7, s30, v16
    v_sub_u32 v8, s30, v17
    v_sub_u32 v9, s30, v18
    v_min3_u32 v7, v7, v8, v9
    v_sub_u32 v8, s30, v19
    v_sub_u32 v9, s30, v20
    v_min3_u32 v7, v7, v8, v9
    v_sub_u32 v8, s30, v21
    v_sub_u32 v9, s30, v22
    v_min3_u32 v7, v7, v8, v9
    v_sub_u32 v8, s30, v23
    v_sub_u32 v9, s30, v24
    v_min3_u32 v7, v7, v8, v9
    v_sub_u32 v8, s30, v25
    v_sub_u32 v9, s30, v26
    v_min3_u32 v7, v7, v8, v9
    v_sub_u32 v8, s30, v27
    v_sub_u32 v9, s30, v28
    v_min3_u32 v7, v7, v8, v9
    v_sub_u32 v8, s30, v29
    v_sub_u32 v9, s30, v30
    v_min3_u32 v7, v7, v8, v9
    v_sub_u32 v8, s30, v31
    v_sub_u32 v9, s30, v32
    v_min3_u32 v7, v7, v8, v9
    v_sub_u32 v8, s30, v33
    v_sub_u32 v9, s30, v34
    v_min3_u32 v7, v7, v8, v9
    v_sub_u32 v8, s30, v35
    v_sub_u32 v9, s30, v36
    v_min3_u32 v7, v7, v8, v9
    v_sub_u32 v8, s30, v37
    v_sub_u32 v9, s30, v38
    v_min3_u32 v7, v7, v8, v9
    v_sub_u32 v8, s30, v39
    v_sub_u32 v9, s30, v40
    v_min3_u32 v7, v7, v8, v9
    v_sub_u32 v8, s30, v41
    v_sub_u32 v9, s30, v42
    v_min3_u32 v7, v7, v8, v9
    v_sub_u32 v8, s30, v43
    v_sub_u32 v9, s30, v44
    v_min3_u32 v7, v7, v8, v9
    v_sub_u32 v8, s30, v45
    v_sub_u32 v9, s30, v46
    v_min3_u32 v7, v7, v8, v9
    v_sub_u32 v8, s30, v47
    v_min_u32 v7, v7, v8
    s_nop 1
    v_min_u32_dpp v7, v7, v7 row_ror:8 row_mask:0xf bank_mask:0xf
    s_nop 1
    v_min_u32_dpp v7, v7, v7 row_ror:4 row_mask:0xf bank_mask:0xf
    s_nop 1
    v_min_u32_dpp v7, v7, v7 row_ror:2 row_mask:0xf bank_mask:0xf
    s_nop 1
    v_min_u32_dpp v7, v7, v7 row_ror:1 row_mask:0xf bank_mask:0xf
    v_mov_b32 v8, v7
    s_nop 1
    v_permlane16_swap_b32 v7, v8
    v_min_u32 v7, v7, v8
    v_mov_b32 v8, v7
    s_nop 1
    v_permlane32_swap_b32 v7, v8
    v_min_u32 v7, v7, v8
    s_nop 0
    v_readfirstlane_b32 s66, v7
    s_nop 1
    s_sub_u32 s66, s30, s66
    s_sub_u32 s30, s66, 1
    v_sub_u32 v7, s30, v16
    v_sub_u32 v8, s30, v17
    v_sub_u32 v9, s30, v18
    v_min3_u32 v7, v7, v8, v9
    v_sub_u32 v8, s30, v19
    v_sub_u32 v9, s30, v20
    v_min3_u32 v7, v7, v8, v9
    v_sub_u32 v8, s30, v21
    v_sub_u32 v9, s30, v22
    v_min3_u32 v7, v7, v8, v9
    v_sub_u32 v8, s30, v23
    v_sub_u32 v9, s30, v24
    v_min3_u32 v7, v7, v8, v9
    v_sub_u32 v8, s30, v25
    v_sub_u32 v9, s30, v26
    v_min3_u32 v7, v7, v8, v9
    v_sub_u32 v8, s30, v27
    v_sub_u32 v9, s30, v28
    v_min3_u32 v7, v7, v8, v9
    v_sub_u32 v8, s30, v29
    v_sub_u32 v9, s30, v30
    v_min3_u32 v7, v7, v8, v9
    v_sub_u32 v8, s30, v31
    v_sub_u32 v9, s30, v32
    v_min3_u32 v7, v7, v8, v9
    v_sub_u32 v8, s30, v33
    v_sub_u32 v9, s30, v34
    v_min3_u32 v7, v7, v8, v9
    v_sub_u32 v8, s30, v35
    v_sub_u32 v9, s30, v36
    v_min3_u32 v7, v7, v8, v9
    v_sub_u32 v8, s30, v37
    v_sub_u32 v9, s30, v38
    v_min3_u32 v7, v7, v8, v9
    v_sub_u32 v8, s30, v39
    v_sub_u32 v9, s30, v40
    v_min3_u32 v7, v7, v8, v9
    v_sub_u32 v8, s30, v41
    v_sub_u32 v9, s30, v42
    v_min3_u32 v7, v7, v8, v9
    v_sub_u32 v8, s30, v43
    v_sub_u32 v9, s30, v44
    v_min3_u32 v7, v7, v8, v9
    v_sub_u32 v8, s30, v45
    v_sub_u32 v9, s30, v46
    v_min3_u32 v7, v7, v8, v9
    v_sub_u32 v8, s30, v47
    v_min_u32 v7, v7, v8
    s_nop 1
    v_min_u32_dpp v7, v7, v7 row_ror:8 row_mask:0xf bank_mask:0xf
    s_nop 1
    v_min_u32_dpp v7, v7, v7 row_ror:4 row_mask:0xf bank_mask:0xf
    s_nop 1
    v_min_u32_dpp v7, v7, v7 row_ror:2 row_mask:0xf bank_mask:0xf
    s_nop 1
    v_min_u32_dpp v7, v7, v7 row_ror:1 row_mask:0xf bank_mask:0xf
    v_mov_b32 v8, v7
    s_nop 1
    v_permlane16_swap_b32 v7, v8
    v_min_u32 v7, v7, v8
    v_mov_b32 v8, v7
    s_nop 1
    v_permlane32_swap_b32 v7, v8
    v_min_u32 v7, v7, v8
    s_nop 0
    v_readfirstlane_b32 s67, v7
    s_nop 1
    s_sub_u32 s67, s30, s67
    s_sub_u32 s30, s67, 1
    v_sub_u32 v7, s30, v16
    v_sub_u32 v8, s30, v17
    v_sub_u32 v9, s30, v18
    v_min3_u32 v7, v7, v8, v9
    v_sub_u32 v8, s30, v19
    v_sub_u32 v9, s30, v20
    v_min3_u32 v7, v7, v8, v9
    v_sub_u32 v8, s30, v21
    v_sub_u32 v9, s30, v22
    v_min3_u32 v7, v7, v8, v9
    v_sub_u32 v8, s30, v23
    v_sub_u32 v9, s30, v24
    v_min3_u32 v7, v7, v8, v9
    v_sub_u32 v8, s30, v25
    v_sub_u32 v9, s30, v26
    v_min3_u32 v7, v7, v8, v9
    v_sub_u32 v8, s30, v27
    v_sub_u32 v9, s30, v28
    v_min3_u32 v7, v7, v8, v9
    v_sub_u32 v8, s30, v29
    v_sub_u32 v9, s30, v30
    v_min3_u32 v7, v7, v8, v9
    v_sub_u32 v8, s30, v31
    v_sub_u32 v9, s30, v32
    v_min3_u32 v7, v7, v8, v9
    v_sub_u32 v8, s30, v33
    v_sub_u32 v9, s30, v34
    v_min3_u32 v7, v7, v8, v9
    v_sub_u32 v8, s30, v35
    v_sub_u32 v9, s30, v36
    v_min3_u32 v7, v7, v8, v9
    v_sub_u32 v8, s30, v37
    v_sub_u32 v9, s30, v38
    v_min3_u32 v7, v7, v8, v9
    v_sub_u32 v8, s30, v39
    v_sub_u32 v9, s30, v40
    v_min3_u32 v7, v7, v8, v9
    v_sub_u32 v8, s30, v41
    v_sub_u32 v9, s30, v42
    v_min3_u32 v7, v7, v8, v9
    v_sub_u32 v8, s30, v43
    v_sub_u32 v9, s30, v44
    v_min3_u32 v7, v7, v8, v9
    v_sub_u32 v8, s30, v45
    v_sub_u32 v9, s30, v46
    v_min3_u32 v7, v7, v8, v9
    v_sub_u32 v8, s30, v47
    v_min_u32 v7, v7, v8
    s_nop 1
    v_min_u32_dpp v7, v7, v7 row_ror:8 row_mask:0xf bank_mask:0xf
    s_nop 1
    v_min_u32_dpp v7, v7, v7 row_ror:4 row_mask:0xf bank_mask:0xf
    s_nop 1
    v_min_u32_dpp v7, v7, v7 row_ror:2 row_mask:0xf bank_mask:0xf
    s_nop 1
    v_min_u32_dpp v7, v7, v7 row_ror:1 row_mask:0xf bank_mask:0xf
    v_mov_b32 v8, v7
    s_nop 1
    v_permlane16_swap_b32 v7, v8
    v_min_u32 v7, v7, v8
    v_mov_b32 v8, v7
    s_nop 1
    v_permlane32_swap_b32 v7, v8
    v_min_u32 v7, v7, v8
    s_nop 0
    v_readfirstlane_b32 s68, v7
    s_nop 1
    s_sub_u32 s68, s30, s68
    s_sub_u32 s30, s68, 1
    v_sub_u32 v7, s30, v16
    v_sub_u32 v8, s30, v17
    v_sub_u32 v9, s30, v18
    v_min3_u32 v7, v7, v8, v9
    v_sub_u32 v8, s30, v19
    v_sub_u32 v9, s30, v20
    v_min3_u32 v7, v7, v8, v9
    v_sub_u32 v8, s30, v21
    v_sub_u32 v9, s30, v22
    v_min3_u32 v7, v7, v8, v9
    v_sub_u32 v8, s30, v23
    v_sub_u32 v9, s30, v24
    v_min3_u32 v7, v7, v8, v9
    v_sub_u32 v8, s30, v25
    v_sub_u32 v9, s30, v26
    v_min3_u32 v7, v7, v8, v9
    v_sub_u32 v8, s30, v27
    v_sub_u32 v9, s30, v28
    v_min3_u32 v7, v7, v8, v9
    v_sub_u32 v8, s30, v29
    v_sub_u32 v9, s30, v30
    v_min3_u32 v7, v7, v8, v9
    v_sub_u32 v8, s30, v31
    v_sub_u32 v9, s30, v32
    v_min3_u32 v7, v7, v8, v9
    v_sub_u32 v8, s30, v33
    v_sub_u32 v9, s30, v34
    v_min3_u32 v7, v7, v8, v9
    v_sub_u32 v8, s30, v35
    v_sub_u32 v9, s30, v36
    v_min3_u32 v7, v7, v8, v9
    v_sub_u32 v8, s30, v37
    v_sub_u32 v9, s30, v38
    v_min3_u32 v7, v7, v8, v9
    v_sub_u32 v8, s30, v39
    v_sub_u32 v9, s30, v40
    v_min3_u32 v7, v7, v8, v9
    v_sub_u32 v8, s30, v41
    v_sub_u32 v9, s30, v42
    v_min3_u32 v7, v7, v8, v9
    v_sub_u32 v8, s30, v43
    v_sub_u32 v9, s30, v44
    v_min3_u32 v7, v7, v8, v9
    v_sub_u32 v8, s30, v45
    v_sub_u32 v9, s30, v46
    v_min3_u32 v7, v7, v8, v9
    v_sub_u32 v8, s30, v47
    v_min_u32 v7, v7, v8
    s_nop 1
    v_min_u32_dpp v7, v7, v7 row_ror:8 row_mask:0xf bank_mask:0xf
    s_nop 1
    v_min_u32_dpp v7, v7, v7 row_ror:4 row_mask:0xf bank_mask:0xf
    s_nop 1
    v_min_u32_dpp v7, v7, v7 row_ror:2 row_mask:0xf bank_mask:0xf
    s_nop 1
    v_min_u32_dpp v7, v7, v7 row_ror:1 row_mask:0xf bank_mask:0xf
    v_mov_b32 v8, v7
    s_nop 1
    v_permlane16_swap_b32 v7, v8
    v_min_u32 v7, v7, v8
    v_mov_b32 v8, v7
    s_nop 1
    v_permlane32_swap_b32 v7, v8
    v_min_u32 v7, v7, v8
    s_nop 0
    v_readfirstlane_b32 s69, v7
    s_nop 1
    s_sub_u32 s69, s30, s69
    s_sub_u32 s30, s69, 1
    v_sub_u32 v7, s30, v16
    v_sub_u32 v8, s30, v17
    v_sub_u32 v9, s30, v18
    v_min3_u32 v7, v7, v8, v9
    v_sub_u32 v8, s30, v19
    v_sub_u32 v9, s30, v20
    v_min3_u32 v7, v7, v8, v9
    v_sub_u32 v8, s30, v21
    v_sub_u32 v9, s30, v22
    v_min3_u32 v7, v7, v8, v9
    v_sub_u32 v8, s30, v23
    v_sub_u32 v9, s30, v24
    v_min3_u32 v7, v7, v8, v9
    v_sub_u32 v8, s30, v25
    v_sub_u32 v9, s30, v26
    v_min3_u32 v7, v7, v8, v9
    v_sub_u32 v8, s30, v27
    v_sub_u32 v9, s30, v28
    v_min3_u32 v7, v7, v8, v9
    v_sub_u32 v8, s30, v29
    v_sub_u32 v9, s30, v30
    v_min3_u32 v7, v7, v8, v9
    v_sub_u32 v8, s30, v31
    v_sub_u32 v9, s30, v32
    v_min3_u32 v7, v7, v8, v9
    v_sub_u32 v8, s30, v33
    v_sub_u32 v9, s30, v34
    v_min3_u32 v7, v7, v8, v9
    v_sub_u32 v8, s30, v35
    v_sub_u32 v9, s30, v36
    v_min3_u32 v7, v7, v8, v9
    v_sub_u32 v8, s30, v37
    v_sub_u32 v9, s30, v38
    v_min3_u32 v7, v7, v8, v9
    v_sub_u32 v8, s30, v39
    v_sub_u32 v9, s30, v40
    v_min3_u32 v7, v7, v8, v9
    v_sub_u32 v8, s30, v41
    v_sub_u32 v9, s30, v42
    v_min3_u32 v7, v7, v8, v9
    v_sub_u32 v8, s30, v43
    v_sub_u32 v9, s30, v44
    v_min3_u32 v7, v7, v8, v9
    v_sub_u32 v8, s30, v45
    v_sub_u32 v9, s30, v46
    v_min3_u32 v7, v7, v8, v9
    v_sub_u32 v8, s30, v47
    v_min_u32 v7, v7, v8
    s_nop 1
    v_min_u32_dpp v7, v7, v7 row_ror:8 row_mask:0xf bank_mask:0xf
    s_nop 1
    v_min_u32_dpp v7, v7, v7 row_ror:4 row_mask:0xf bank_mask:0xf
    s_nop 1
    v_min_u32_dpp v7, v7, v7 row_ror:2 row_mask:0xf bank_mask:0xf
    s_nop 1
    v_min_u32_dpp v7, v7, v7 row_ror:1 row_mask:0xf bank_mask:0xf
    v_mov_b32 v8, v7
    s_nop 1
    v_permlane16_swap_b32 v7, v8
    v_min_u32 v7, v7, v8
    v_mov_b32 v8, v7
    s_nop 1
    v_permlane32_swap_b32 v7, v8
    v_min_u32 v7, v7, v8
    s_nop 0
    v_readfirstlane_b32 s70, v7
    s_nop 1
    s_sub_u32 s70, s30, s70
    s_sub_u32 s30, s70, 1
    v_sub_u32 v7, s30, v16
    v_sub_u32 v8, s30, v17
    v_sub_u32 v9, s30, v18
    v_min3_u32 v7, v7, v8, v9
    v_sub_u32 v8, s30, v19
    v_sub_u32 v9, s30, v20
    v_min3_u32 v7, v7, v8, v9
    v_sub_u32 v8, s30, v21
    v_sub_u32 v9, s30, v22
    v_min3_u32 v7, v7, v8, v9
    v_sub_u32 v8, s30, v23
    v_sub_u32 v9, s30, v24
    v_min3_u32 v7, v7, v8, v9
    v_sub_u32 v8, s30, v25
    v_sub_u32 v9, s30, v26
    v_min3_u32 v7, v7, v8, v9
    v_sub_u32 v8, s30, v27
    v_sub_u32 v9, s30, v28
    v_min3_u32 v7, v7, v8, v9
    v_sub_u32 v8, s30, v29
    v_sub_u32 v9, s30, v30
    v_min3_u32 v7, v7, v8, v9
    v_sub_u32 v8, s30, v31
    v_sub_u32 v9, s30, v32
    v_min3_u32 v7, v7, v8, v9
    v_sub_u32 v8, s30, v33
    v_sub_u32 v9, s30, v34
    v_min3_u32 v7, v7, v8, v9
    v_sub_u32 v8, s30, v35
    v_sub_u32 v9, s30, v36
    v_min3_u32 v7, v7, v8, v9
    v_sub_u32 v8, s30, v37
    v_sub_u32 v9, s30, v38
    v_min3_u32 v7, v7, v8, v9
    v_sub_u32 v8, s30, v39
    v_sub_u32 v9, s30, v40
    v_min3_u32 v7, v7, v8, v9
    v_sub_u32 v8, s30, v41
    v_sub_u32 v9, s30, v42
    v_min3_u32 v7, v7, v8, v9
    v_sub_u32 v8, s30, v43
    v_sub_u32 v9, s30, v44
    v_min3_u32 v7, v7, v8, v9
    v_sub_u32 v8, s30, v45
    v_sub_u32 v9, s30, v46
    v_min3_u32 v7, v7, v8, v9
    v_sub_u32 v8, s30, v47
    v_min_u32 v7, v7, v8
    s_nop 1
    v_min_u32_dpp v7, v7, v7 row_ror:8 row_mask:0xf bank_mask:0xf
    s_nop 1
    v_min_u32_dpp v7, v7, v7 row_ror:4 row_mask:0xf bank_mask:0xf
    s_nop 1
    v_min_u32_dpp v7, v7, v7 row_ror:2 row_mask:0xf bank_mask:0xf
    s_nop 1
    v_min_u32_dpp v7, v7, v7 row_ror:1 row_mask:0xf bank_mask:0xf
    v_mov_b32 v8, v7
    s_nop 1
    v_permlane16_swap_b32 v7, v8
    v_min_u32 v7, v7, v8
    v_mov_b32 v8, v7
    s_nop 1
    v_permlane32_swap_b32 v7, v8
    v_min_u32 v7, v7, v8
    s_nop 0
    v_readfirstlane_b32 s71, v7
    s_nop 1
    s_sub_u32 s71, s30, s71
    s_and_b32 s64, s64, 0xffff
    s_sub_u32 s64, 2047, s64
    s_and_b32 s65, s65, 0xffff
    s_sub_u32 s65, 2047, s65
    s_and_b32 s66, s66, 0xffff
    s_sub_u32 s66, 2047, s66
    s_and_b32 s67, s67, 0xffff
    s_sub_u32 s67, 2047, s67
    s_and_b32 s68, s68, 0xffff
    s_sub_u32 s68, 2047, s68
    s_and_b32 s69, s69, 0xffff
    s_sub_u32 s69, 2047, s69
    s_and_b32 s70, s70, 0xffff
    s_sub_u32 s70, 2047, s70
    s_and_b32 s71, s71, 0xffff
    s_sub_u32 s71, 2047, s71
    v_and_b32 v7, 7, v2
    v_mov_b32 v8, 0
    v_mov_b32 v9, s64
    v_cmp_ne_u32 vcc, 0, v7
    s_nop 1
    v_cndmask_b32 v8, v9, v8, vcc
    v_mov_b32 v9, s65
    v_cmp_ne_u32 vcc, 1, v7
    s_nop 1
    v_cndmask_b32 v8, v9, v8, vcc
    v_mov_b32 v9, s66
    v_cmp_ne_u32 vcc, 2, v7
    s_nop 1
    v_cndmask_b32 v8, v9, v8, vcc
    v_mov_b32 v9, s67
    v_cmp_ne_u32 vcc, 3, v7
    s_nop 1
    v_cndmask_b32 v8, v9, v8, vcc
    v_mov_b32 v9, s68
    v_cmp_ne_u32 vcc, 4, v7
    s_nop 1
    v_cndmask_b32 v8, v9, v8, vcc
    v_mov_b32 v9, s69
    v_cmp_ne_u32 vcc, 5, v7
    s_nop 1
    v_cndmask_b32 v8, v9, v8, vcc
    v_mov_b32 v9, s70
    v_cmp_ne_u32 vcc, 6, v7
    s_nop 1
    v_cndmask_b32 v8, v9, v8, vcc
    v_mov_b32 v9, s71
    v_cmp_ne_u32 vcc, 7, v7
    s_nop 1
    v_cndmask_b32 v8, v9, v8, vcc
    v_lshrrev_b32 v9, 4, v8
    v_mul_u32_u24 v9, 14336, v9
    v_and_b32 v10, 15, v8
    v_lshl_add_u32 v9, v10, 4, v9
    v_lshl_add_u32 v9, v3, 8, v9
    s_mov_b32 s26, 0
    buffer_load_dwordx4 v[160:163], v9, s[40:43], s26 offen offset:0
    s_mov_b32 s26, 0
    buffer_load_dwordx4 v[164:167], v9, s[40:43], s26 offen offset:1024
    s_mov_b32 s26, 0
    buffer_load_dwordx4 v[168:171], v9, s[40:43], s26 offen offset:2048
    s_mov_b32 s26, 0
    buffer_load_dwordx4 v[172:175], v9, s[40:43], s26 offen offset:3072
    s_mov_b32 s26, 4096
    buffer_load_dwordx4 v[176:179], v9, s[40:43], s26 offen offset:0
    s_mov_b32 s26, 4096
    buffer_load_dwordx4 v[180:183], v9, s[40:43], s26 offen offset:1024
    s_mov_b32 s26, 4096
    buffer_load_dwordx4 v[184:187], v9, s[40:43], s26 offen offset:2048
    s_mov_b32 s26, 4096
    buffer_load_dwordx4 v[188:191], v9, s[40:43], s26 offen offset:3072
    s_mov_b32 s26, 8192
    buffer_load_dwordx4 v[192:195], v9, s[40:43], s26 offen offset:0
    s_mov_b32 s26, 8192
    buffer_load_dwordx4 v[196:199], v9, s[40:43], s26 offen offset:1024
    s_mov_b32 s26, 8192
    buffer_load_dwordx4 v[200:203], v9, s[40:43], s26 offen offset:2048
    s_mov_b32 s26, 8192
    buffer_load_dwordx4 v[204:207], v9, s[40:43], s26 offen offset:3072
    s_mov_b32 s26, 12288
    buffer_load_dwordx4 v[208:211], v9, s[40:43], s26 offen offset:0
    s_mov_b32 s26, 12288
    buffer_load_dwordx4 v[212:215], v9, s[40:43], s26 offen offset:1024
    s_or_b32 s26, s22, s3
    s_cmp_lg_u32 s26, 0
    s_cbranch_scc1 KE_noidx
    v_lshlrev_b32 v10, 2, v1
    s_mov_b64 exec, 0xff
    buffer_store_dword v8, v10, s[60:63], 0 offen sc1
    s_mov_b64 exec, -1
KE_noidx:
    s_waitcnt vmcnt(0)
    v_mfma_f32_16x16x32_bf16 v[16:19], v[48:51], v[160:163], 0
    v_mfma_f32_16x16x32_bf16 v[20:23], a[0:3], v[160:163], 0
    v_mfma_f32_16x16x32_bf16 v[16:19], v[52:55], v[160:163], v[16:19]
    v_mfma_f32_16x16x32_bf16 v[20:23], a[4:7], v[160:163], v[20:23]
    v_mfma_f32_16x16x32_bf16 v[16:19], v[56:59], v[164:167], v[16:19]
    v_mfma_f32_16x16x32_bf16 v[20:23], a[8:11], v[164:167], v[20:23]
    v_mfma_f32_16x16x32_bf16 v[16:19], v[60:63], v[164:167], v[16:19]
    v_mfma_f32_16x16x32_bf16 v[20:23], a[12:15], v[164:167], v[20:23]
    v_mfma_f32_16x16x32_bf16 v[16:19], v[64:67], v[168:171], v[16:19]
    v_mfma_f32_16x16x32_bf16 v[20:23], a[16:19], v[168:171], v[20:23]
    v_mfma_f32_16x16x32_bf16 v[16:19], v[68:71], v[168:171], v[16:19]
    v_mfma_f32_16x16x32_bf16 v[20:23], a[20:23], v[168:171], v[20:23]
    v_mfma_f32_16x16x32_bf16 v[16:19], v[72:75], v[172:175], v[16:19]
    v_mfma_f32_16x16x32_bf16 v[20:23], a[24:27], v[172:175], v[20:23]
    v_mfma_f32_16x16x32_bf16 v[16:19], v[76:79], v[172:175], v[16:19]
    v_mfma_f32_16x16x32_bf16 v[20:23], a[28:31], v[172:175], v[20:23]
    v_mfma_f32_16x16x32_bf16 v[16:19], v[80:83], v[176:179], v[16:19]
    v_mfma_f32_16x16x32_bf16 v[20:23], a[32:35], v[176:179], v[20:23]
    v_mfma_f32_16x16x32_bf16 v[16:19], v[84:87], v[176:179], v[16:19]
    v_mfma_f32_16x16x32_bf16 v[20:23], a[36:39], v[176:179], v[20:23]
    v_mfma_f32_16x16x32_bf16 v[16:19], v[88:91], v[180:183], v[16:19]
    v_mfma_f32_16x16x32_bf16 v[20:23], a[40:43], v[180:183], v[20:23]
    v_mfma_f32_16x16x32_bf16 v[16:19], v[92:95], v[180:183], v[16:19]
    v_mfma_f32_16x16x32_bf16 v[20:23], a[44:47], v[180:183], v[20:23]
    v_mfma_f32_16x16x32_bf16 v[16:19], v[96:99], v[184:187], v[16:19]
    v_mfma_f32_16x16x32_bf16 v[20:23], a[48:51], v[184:187], v[20:23]
    v_mfma_f32_16x16x32_bf16 v[16:19], v[100:103], v[184:187], v[16:19]
    v_mfma_f32_16x16x32_bf16 v[20:23], a[52:55], v[184:187], v[20:23]
    v_mfma_f32_16x16x32_bf16 v[16:19], v[104:107], v[188:191], v[16:19]
    v_mfma_f32_16x16x32_bf16 v[20:23], a[56:59], v[188:191], v[20:23]
    v_mfma_f32_16x16x32_bf16 v[16:19], v[108:111], v[188:191], v[16:19]
    v_mfma_f32_16x16x32_bf16 v[20:23], a[60:63], v[188:191], v[20:23]
    v_mfma_f32_16x16x32_bf16 v[16:19], v[112:115], v[192:195], v[16:19]
    v_mfma_f32_16x16x32_bf16 v[20:23], a[64:67], v[192:195], v[20:23]
    v_mfma_f32_16x16x32_bf16 v[16:19], v[116:119], v[192:195], v[16:19]
    v_mfma_f32_16x16x32_bf16 v[20:23], a[68:71], v[192:195], v[20:23]
    v_mfma_f32_16x16x32_bf16 v[16:19], v[120:123], v[196:199], v[16:19]
    v_mfma_f32_16x16x32_bf16 v[20:23], a[72:75], v[196:199], v[20:23]
    v_mfma_f32_16x16x32_bf16 v[16:19], v[124:127], v[196:199], v[16:19]
    v_mfma_f32_16x16x32_bf16 v[20:23], a[76:79], v[196:199], v[20:23]
    v_mfma_f32_16x16x32_bf16 v[16:19], v[128:131], v[200:203], v[16:19]
    v_mfma_f32_16x16x32_bf16 v[20:23], a[80:83], v[200:203], v[20:23]
    v_mfma_f32_16x16x32_bf16 v[16:19], v[132:135], v[200:203], v[16:19]
    v_mfma_f32_16x16x32_bf16 v[20:23], a[84:87], v[200:203], v[20:23]
    v_mfma_f32_16x16x32_bf16 v[16:19], v[136:139], v[204:207], v[16:19]
    v_mfma_f32_16x16x32_bf16 v[20:23], a[88:91], v[204:207], v[20:23]
    v_mfma_f32_16x16x32_bf16 v[16:19], v[140:143], v[204:207], v[16:19]
    v_mfma_f32_16x16x32_bf16 v[20:23], a[92:95], v[204:207], v[20:23]
    v_mfma_f32_16x16x32_bf16 v[16:19], v[144:147], v[208:211], v[16:19]
    v_mfma_f32_16x16x32_bf16 v[20:23], a[96:99], v[208:211], v[20:23]
    v_mfma_f32_16x16x32_bf16 v[16:19], v[148:151], v[208:211], v[16:19]
    v_mfma_f32_16x16x32_bf16 v[20:23], a[100:103], v[208:211], v[20:23]
    v_mfma_f32_16x16x32_bf16 v[16:19], v[152:155], v[212:215], v[16:19]
    v_mfma_f32_16x16x32_bf16 v[20:23], a[104:107], v[212:215], v[20:23]
    v_mfma_f32_16x16x32_bf16 v[16:19], v[156:159], v[212:215], v[16:19]
    v_mfma_f32_16x16x32_bf16 v[20:23], a[108:111], v[212:215], v[20:23]
    s_mov_b32 s26, 0x3fb8aa3b
    s_nop 5
    v_cvt_pk_bf16_f32 v24, v16, v17
    v_cvt_pk_bf16_f32 v25, v20, v21
    v_lshlrev_b32 v26, 16, v24
    v_and_b32 v27, s28, v24
    v_mul_f32 v28, s26, v26
    v_mul_f32 v29, s26, v27
    v_exp_f32 v28, -v28
    v_exp_f32 v29, -v29
    v_add_f32 v28, 1.0, v28
    v_add_f32 v29, 1.0, v29
    v_rcp_f32 v28, v28
    v_rcp_f32 v29, v29
    v_mul_f32 v26, v26, v28
    v_mul_f32 v27, v27, v29
    v_cvt_pk_bf16_f32 v24, v26, v27
    v_lshlrev_b32 v26, 16, v24
    v_and_b32 v27, s28, v24
    v_lshlrev_b32 v28, 16, v25
    v_and_b32 v29, s28, v25
    v_mul_f32 v26, v26, v28
    v_mul_f32 v27, v27, v29
    v_cvt_pk_bf16_f32 v30, v26, v27
    v_cvt_pk_bf16_f32 v24, v18, v19
    v_cvt_pk_bf16_f32 v25, v22, v23
    v_lshlrev_b32 v26, 16, v24
    v_and_b32 v27, s28, v24
    v_mul_f32 v28, s26, v26
    v_mul_f32 v29, s26, v27
    v_exp_f32 v28, -v28
    v_exp_f32 v29, -v29
    v_add_f32 v28, 1.0, v28
    v_add_f32 v29, 1.0, v29
    v_rcp_f32 v28, v28
    v_rcp_f32 v29, v29
    v_mul_f32 v26, v26, v28
    v_mul_f32 v27, v27, v29
    v_cvt_pk_bf16_f32 v24, v26, v27
    v_lshlrev_b32 v26, 16, v24
    v_and_b32 v27, s28, v24
    v_lshlrev_b32 v28, 16, v25
    v_and_b32 v29, s28, v25
    v_mul_f32 v26, v26, v28
    v_mul_f32 v27, v27, v29
    v_cvt_pk_bf16_f32 v31, v26, v27
    v_lshlrev_b32 v10, 3, v0
    v_lshlrev_b32 v11, 3, v1
    ds_write_b64 v10, v[30:31]
    s_waitcnt lgkmcnt(0)
    s_barrier
    ds_read_b64 v[32:33], v11 offset:0
    ds_read_b64 v[34:35], v11 offset:512
    ds_read_b64 v[36:37], v11 offset:1024
    ds_read_b64 v[38:39], v11 offset:1536
    s_waitcnt lgkmcnt(0)
    v_mul_u32_u24 v12, 1792, v2
    v_lshl_add_u32 v12, v3, 4, v12
    s_mul_i32 s26, s22, 14336
    s_mul_i32 s27, s3, 448
    s_add_u32 s26, s26, s27
    v_mfma_f32_16x16x16_bf16 v[48:51], a[112:113], v[32:33], 0
    v_mfma_f32_16x16x16_bf16 v[48:51], a[114:115], v[32:33], v[48:51]
    v_mfma_f32_16x16x16_bf16 v[48:51], a[116:117], v[34:35], v[48:51]
    v_mfma_f32_16x16x16_bf16 v[48:51], a[118:119], v[34:35], v[48:51]
    v_mfma_f32_16x16x16_bf16 v[48:51], a[120:121], v[36:37], v[48:51]
    v_mfma_f32_16x16x16_bf16 v[48:51], a[122:123], v[36:37], v[48:51]
    v_mfma_f32_16x16x16_bf16 v[48:51], a[124:125], v[38:39], v[48:51]
    v_mfma_f32_16x16x16_bf16 v[48:51], a[126:127], v[38:39], v[48:51]
    v_mfma_f32_16x16x16_bf16 v[52:55], a[128:129], v[32:33], 0
    v_mfma_f32_16x16x16_bf16 v[52:55], a[130:131], v[32:33], v[52:55]
    v_mfma_f32_16x16x16_bf16 v[52:55], a[132:133], v[34:35], v[52:55]
    v_mfma_f32_16x16x16_bf16 v[52:55], a[134:135], v[34:35], v[52:55]
    v_mfma_f32_16x16x16_bf16 v[52:55], a[136:137], v[36:37], v[52:55]
    v_mfma_f32_16x16x16_bf16 v[52:55], a[138:139], v[36:37], v[52:55]
    v_mfma_f32_16x16x16_bf16 v[52:55], a[140:141], v[38:39], v[52:55]
    v_mfma_f32_16x16x16_bf16 v[52:55], a[142:143], v[38:39], v[52:55]
    v_mfma_f32_16x16x16_bf16 v[56:59], a[144:145], v[32:33], 0
    v_mfma_f32_16x16x16_bf16 v[56:59], a[146:147], v[32:33], v[56:59]
    v_mfma_f32_16x16x16_bf16 v[56:59], a[148:149], v[34:35], v[56:59]
    v_mfma_f32_16x16x16_bf16 v[56:59], a[150:151], v[34:35], v[56:59]
    v_mfma_f32_16x16x16_bf16 v[56:59], a[152:153], v[36:37], v[56:59]
    v_mfma_f32_16x16x16_bf16 v[56:59], a[154:155], v[36:37], v[56:59]
    v_mfma_f32_16x16x16_bf16 v[56:59], a[156:157], v[38:39], v[56:59]
    v_mfma_f32_16x16x16_bf16 v[56:59], a[158:159], v[38:39], v[56:59]
    v_mfma_f32_16x16x16_bf16 v[60:63], a[160:161], v[32:33], 0
    v_mfma_f32_16x16x16_bf16 v[60:63], a[162:163], v[32:33], v[60:63]
    v_mfma_f32_16x16x16_bf16 v[60:63], a[164:165], v[34:35], v[60:63]
    v_mfma_f32_16x16x16_bf16 v[60:63], a[166:167], v[34:35], v[60:63]
    v_mfma_f32_16x16x16_bf16 v[60:63], a[168:169], v[36:37], v[60:63]
    v_mfma_f32_16x16x16_bf16 v[60:63], a[170:171], v[36:37], v[60:63]
    v_mfma_f32_16x16x16_bf16 v[60:63], a[172:173], v[38:39], v[60:63]
    v_mfma_f32_16x16x16_bf16 v[60:63], a[174:175], v[38:39], v[60:63]
    v_mfma_f32_16x16x16_bf16 v[64:67], a[176:177], v[32:33], 0
    v_mfma_f32_16x16x16_bf16 v[64:67], a[178:179], v[32:33], v[64:67]
    v_mfma_f32_16x16x16_bf16 v[64:67], a[180:181], v[34:35], v[64:67]
    v_mfma_f32_16x16x16_bf16 v[64:67], a[182:183], v[34:35], v[64:67]
    v_mfma_f32_16x16x16_bf16 v[64:67], a[184:185], v[36:37], v[64:67]
    v_mfma_f32_16x16x16_bf16 v[64:67], a[186:187], v[36:37], v[64:67]
    v_mfma_f32_16x16x16_bf16 v[64:67], a[188:189], v[38:39], v[64:67]
    v_mfma_f32_16x16x16_bf16 v[64:67], a[190:191], v[38:39], v[64:67]
    v_mfma_f32_16x16x16_bf16 v[68:71], a[192:193], v[32:33], 0
    v_mfma_f32_16x16x16_bf16 v[68:71], a[194:195], v[32:33], v[68:71]
    v_mfma_f32_16x16x16_bf16 v[68:71], a[196:197], v[34:35], v[68:71]
    v_mfma_f32_16x16x16_bf16 v[68:71], a[198:199], v[34:35], v[68:71]
    v_mfma_f32_16x16x16_bf16 v[68:71], a[200:201], v[36:37], v[68:71]
    v_mfma_f32_16x16x16_bf16 v[68:71], a[202:203], v[36:37], v[68:71]
    v_mfma_f32_16x16x16_bf16 v[68:71], a[204:205], v[38:39], v[68:71]
    v_mfma_f32_16x16x16_bf16 v[68:71], a[206:207], v[38:39], v[68:71]
    v_mfma_f32_16x16x16_bf16 v[72:75], a[208:209], v[32:33], 0
    v_mfma_f32_16x16x16_bf16 v[72:75], a[210:211], v[32:33], v[72:75]
    v_mfma_f32_16x16x16_bf16 v[72:75], a[212:213], v[34:35], v[72:75]
    v_mfma_f32_16x16x16_bf16 v[72:75], a[214:215], v[34:35], v[72:75]
    v_mfma_f32_16x16x16_bf16 v[72:75], a[216:217], v[36:37], v[72:75]
    v_mfma_f32_16x16x16_bf16 v[72:75], a[218:219], v[36:37], v[72:75]
    v_mfma_f32_16x16x16_bf16 v[72:75], a[220:221], v[38:39], v[72:75]
    v_mfma_f32_16x16x16_bf16 v[72:75], a[222:223], v[38:39], v[72:75]
    v_cmp_gt_u32 vcc, 8, v2
    s_and_saveexec_b64 s[30:31], vcc
    buffer_store_dwordx4 v[48:51], v12, s[56:59], s26 offen offset:0 sc1
    buffer_store_dwordx4 v[52:55], v12, s[56:59], s26 offen offset:64 sc1
    buffer_store_dwordx4 v[56:59], v12, s[56:59], s26 offen offset:128 sc1
    buffer_store_dwordx4 v[60:63], v12, s[56:59], s26 offen offset:192 sc1
    buffer_store_dwordx4 v[64:67], v12, s[56:59], s26 offen offset:256 sc1
    buffer_store_dwordx4 v[68:71], v12, s[56:59], s26 offen offset:320 sc1
    buffer_store_dwordx4 v[72:75], v12, s[56:59], s26 offen offset:384 sc1
    s_mov_b64 exec, s[30:31]
    s_add_u32 s36, s18, 0x5d00000
    s_addc_u32 s37, s19, 0
    s_mov_b32 s38, 0xb8000
    s_mov_b32 s39, 0x20000
    s_waitcnt vmcnt(0)
    s_barrier
    s_lshl_b32 s28, s22, 7
    s_add_u32 s28, s28, 524288
    s_cmp_lg_u32 s3, 0
    s_cbranch_scc1 KE_moed
    v_mov_b32 v6, s96
    v_mov_b32 v7, 0
    s_mov_b64 exec, 1
    buffer_store_dword v6, v7, s[36:39], s28 offen sc1
    s_mov_b64 exec, -1
KE_moed:
    s_branch KM_tasks
KM_nomoe:
    s_lshl_b32 s28, s22, 7
    s_add_u32 s28, s28, 51200
    v_mov_b32 v5, 0
    s_mov_b32 s27, 0
KM_df:
    buffer_load_dword v6, v5, s[48:51], s28 offen sc1
    s_add_u32 s27, s27, 1
    s_cmp_gt_u32 s27, 65536
    s_cbranch_scc1 K3_bail
    s_waitcnt vmcnt(0)
    v_cmp_ne_u32 vcc, s96, v6
    s_cbranch_vccz KM_df_ok
    s_sleep 16
    s_branch KM_df
KM_df_ok:
KM_g1:
    s_cmp_lt_u32 s22, 16
    s_cbranch_scc1 KM_ne0
    s_cmp_lt_u32 s23, 4
    s_cselect_b32 s28, 7, 0
    s_add_u32 s23, s23, s28
KM_ne0:
    s_barrier
    s_and_b32 s24, s3, 1
    s_and_b32 s25, s22, 15
    v_lshlrev_b32 v4, 4, v1
    s_mul_i32 s26, s22, 401408
    s_add_u32 s26, s26, 0x800000
    s_add_u32 s36, s18, s26
    s_addc_u32 s37, s19, 0
    s_mov_b32 s38, 0x62000
    s_mov_b32 s39, 0x20000
    s_add_u32 s40, s18, 0x200000
    s_addc_u32 s41, s19, 0
    s_mov_b32 s42, 0x1c0000
    s_mov_b32 s43, 0x20000
    s_add_u32 s48, s18, 0x5d00000
    s_addc_u32 s49, s19, 0
    s_mov_b32 s50, 0xb8000
    s_mov_b32 s51, 0x20000
    s_mov_b32 s30, 0
    v_min_u32 v5, 31, v1
    v_lshlrev_b32 v5, 7, v5
    s_mov_b32 s28, 565248
    s_mov_b32 s27, 0
KG_l:
    buffer_load_dword v6, v5, s[48:51], s28 offen sc1
    s_add_u32 s27, s27, 1
    s_cmp_gt_u32 s27, 65536
    s_cbranch_scc1 K3_bail
    s_waitcnt vmcnt(0)
    v_cmp_ne_u32 vcc, s96, v6
    s_cbranch_vccz KG_l_ok
    s_sleep 4
    s_branch KG_l
KG_l_ok:
    s_mul_i32 s28, s23, 28672
    s_mul_i32 s29, s3, 7168
    s_add_u32 s28, s28, s29
    s_add_u32 s29, s29, s30
    s_mov_b32 m0, s29
    s_nop 0
    buffer_load_dwordx4 v4, s[40:43], s28 offen offset:0 lds
    buffer_load_dwordx4 v4, s[40:43], s28 offen offset:1024 lds
    buffer_load_dwordx4 v4, s[40:43], s28 offen offset:2048 lds
    buffer_load_dwordx4 v4, s[40:43], s28 offen offset:3072 lds
    s_add_u32 s28, s28, 4096
    s_add_u32 s29, s29, 4096
    s_mov_b32 m0, s29
    s_nop 0
    buffer_load_dwordx4 v4, s[40:43], s28 offen offset:0 lds
    buffer_load_dwordx4 v4, s[40:43], s28 offen offset:1024 lds
    buffer_load_dwordx4 v4, s[40:43], s28 offen offset:2048 lds
    s_cmp_lt_u32 s22, 16
    s_cselect_b32 s34, 4, 7
    s_add_u32 s34, s34, s23
    s_mov_b32 s31, 28672
    s_mul_i32 s28, s34, 28672
    s_mul_i32 s29, s3, 7168
    s_add_u32 s28, s28, s29
    s_add_u32 s29, s29, s31
    s_mov_b32 m0, s29
    s_nop 0
    buffer_load_dwordx4 v4, s[40:43], s28 offen offset:0 lds
    buffer_load_dwordx4 v4, s[40:43], s28 offen offset:1024 lds
    buffer_load_dwordx4 v4, s[40:43], s28 offen offset:2048 lds
    buffer_load_dwordx4 v4, s[40:43], s28 offen offset:3072 lds
    s_add_u32 s28, s28, 4096
    s_add_u32 s29, s29, 4096
    s_mov_b32 m0, s29
    s_nop 0
    buffer_load_dwordx4 v4, s[40:43], s28 offen offset:0 lds
    buffer_load_dwordx4 v4, s[40:43], s28 offen offset:1024 lds
    buffer_load_dwordx4 v4, s[40:43], s28 offen offset:2048 lds
    v_min_u32 v5, 27, v1
    v_lshlrev_b32 v5, 7, v5
    s_mul_i32 s54, s22, 3584
    s_add_u32 s54, s54, 589824
    s_mul_i32 s28, s3, 7
    s_add_u32 s28, s28, s24
    s_add_u32 s28, s28, 0
    s_mul_i32 s68, s28, 14336
    s_mul_i32 s28, s3, 7
    s_add_u32 s28, s28, s24
    s_add_u32 s28, s28, 1
    s_mul_i32 s69, s28, 14336
    s_mul_i32 s28, s3, 7
    s_add_u32 s28, s28, s24
    s_add_u32 s28, s28, 2
    s_mul_i32 s70, s28, 14336
    s_mul_i32 s28, s3, 7
    s_add_u32 s28, s28, s24
    s_add_u32 s28, s28, 3
    s_mul_i32 s71, s28, 14336
    s_mul_i32 s28, s3, 7
    s_add_u32 s28, s28, s24
    s_add_u32 s28, s28, 4
    s_mul_i32 s72, s28, 14336
    s_mul_i32 s28, s3, 7
    s_add_u32 s28, s28, s24
    s_add_u32 s28, s28, 5
    s_mul_i32 s73, s28, 14336
    s_mul_i32 s28, s24, 6
    s_sub_u32 s28, 6, s28
    s_mul_i32 s29, s3, 7
    s_add_u32 s28, s28, s29
    s_mul_i32 s74, s28, 14336
    s_cmp_ge_u32 s22, 16
    s_cbranch_scc1 KG_vo
    s_mov_b32 s27, 0
KG_wpa0:
    buffer_load_dword v7, v5, s[48:51], s54 offen sc1
    s_add_u32 s27, s27, 1
    s_cmp_gt_u32 s27, 65536
    s_cbranch_scc1 K3_bail
KG_wpa0_chk:
    s_waitcnt vmcnt(0)
    v_subrev_u32 v7, s95, v7
    v_subrev_u32 v7, 1, v7
    v_cmp_lt_u32 vcc, 4, v7
    s_cbranch_vccz KG_wpa0_ok
    s_sleep 2
    s_branch KG_wpa0
KG_wpa0_ok:
    buffer_load_dwordx4 a[0:3], v4, s[36:39], s68 offen offset:0 sc1
    buffer_load_dwordx4 a[4:7], v4, s[36:39], s68 offen offset:1024 sc1
    buffer_load_dwordx4 a[8:11], v4, s[36:39], s68 offen offset:2048 sc1
    buffer_load_dwordx4 a[12:15], v4, s[36:39], s68 offen offset:3072 sc1
    s_add_u32 s68, s68, 4096
    buffer_load_dwordx4 a[56:59], v4, s[36:39], s69 offen offset:0 sc1
    buffer_load_dwordx4 a[60:63], v4, s[36:39], s69 offen offset:1024 sc1
    buffer_load_dwordx4 a[64:67], v4, s[36:39], s69 offen offset:2048 sc1
    buffer_load_dwordx4 a[68:71], v4, s[36:39], s69 offen offset:3072 sc1
    s_add_u32 s69, s69, 4096
    buffer_load_dwordx4 a[112:115], v4, s[36:39], s70 offen offset:0 sc1
    buffer_load_dwordx4 a[116:119], v4, s[36:39], s70 offen offset:1024 sc1
    buffer_load_dwordx4 a[120:123], v4, s[36:39], s70 offen offset:2048 sc1
    buffer_load_dwordx4 a[124:127], v4, s[36:39], s70 offen offset:3072 sc1
    s_add_u32 s70, s70, 4096
    buffer_load_dwordx4 a[168:171], v4, s[36:39], s71 offen offset:0 sc1
    buffer_load_dwordx4 a[172:175], v4, s[36:39], s71 offen offset:1024 sc1
    buffer_load_dwordx4 a[176:179], v4, s[36:39], s71 offen offset:2048 sc1
    buffer_load_dwordx4 a[180:183], v4, s[36:39], s71 offen offset:3072 sc1
    s_add_u32 s71, s71, 4096
    buffer_load_dwordx4 a[224:227], v4, s[36:39], s72 offen offset:0 sc1
    buffer_load_dwordx4 a[228:231], v4, s[36:39], s72 offen offset:1024 sc1
    buffer_load_dwordx4 a[232:235], v4, s[36:39], s72 offen offset:2048 sc1
    buffer_load_dwordx4 a[236:239], v4, s[36:39], s72 offen offset:3072 sc1
    s_add_u32 s72, s72, 4096
    buffer_load_dwordx4 v[144:147], v4, s[36:39], s73 offen offset:0 sc1
    buffer_load_dwordx4 v[148:151], v4, s[36:39], s73 offen offset:1024 sc1
    buffer_load_dwordx4 v[152:155], v4, s[36:39], s73 offen offset:2048 sc1
    buffer_load_dwordx4 v[156:159], v4, s[36:39], s73 offen offset:3072 sc1
    s_add_u32 s73, s73, 4096
    buffer_load_dwordx4 v[200:203], v4, s[36:39], s74 offen offset:0 sc1
    buffer_load_dwordx4 v[204:207], v4, s[36:39], s74 offen offset:1024 sc1
    buffer_load_dwordx4 v[208:211], v4, s[36:39], s74 offen offset:2048 sc1
    buffer_load_dwordx4 v[212:215], v4, s[36:39], s74 offen offset:3072 sc1
    s_add_u32 s74, s74, 4096
    buffer_load_dword v7, v5, s[48:51], s54 offen sc1
    s_mov_b32 s27, 0
    s_branch KG_wpa1_chk
KG_wpa1:
    buffer_load_dword v7, v5, s[48:51], s54 offen sc1
    s_add_u32 s27, s27, 1
    s_cmp_gt_u32 s27, 65536
    s_cbranch_scc1 K3_bail
KG_wpa1_chk:
    s_waitcnt vmcnt(0)
    v_subrev_u32 v7, s95, v7
    v_subrev_u32 v7, 2, v7
    v_cmp_lt_u32 vcc, 3, v7
    s_cbranch_vccz KG_wpa1_ok
    s_sleep 2
    s_branch KG_wpa1
KG_wpa1_ok:
    buffer_load_dwordx4 a[16:19], v4, s[36:39], s68 offen offset:0 sc1
    buffer_load_dwordx4 a[20:23], v4, s[36:39], s68 offen offset:1024 sc1
    buffer_load_dwordx4 a[24:27], v4, s[36:39], s68 offen offset:2048 sc1
    buffer_load_dwordx4 a[28:31], v4, s[36:39], s68 offen offset:3072 sc1
    s_add_u32 s68, s68, 4096
    buffer_load_dwordx4 a[72:75], v4, s[36:39], s69 offen offset:0 sc1
    buffer_load_dwordx4 a[76:79], v4, s[36:39], s69 offen offset:1024 sc1
    buffer_load_dwordx4 a[80:83], v4, s[36:39], s69 offen offset:2048 sc1
    buffer_load_dwordx4 a[84:87], v4, s[36:39], s69 offen offset:3072 sc1
    s_add_u32 s69, s69, 4096
    buffer_load_dwordx4 a[128:131], v4, s[36:39], s70 offen offset:0 sc1
    buffer_load_dwordx4 a[132:135], v4, s[36:39], s70 offen offset:1024 sc1
    buffer_load_dwordx4 a[136:139], v4, s[36:39], s70 offen offset:2048 sc1
    buffer_load_dwordx4 a[140:143], v4, s[36:39], s70 offen offset:3072 sc1
    s_add_u32 s70, s70, 4096
    buffer_load_dwordx4 a[184:187], v4, s[36:39], s71 offen offset:0 sc1
    buffer_load_dwordx4 a[188:191], v4, s[36:39], s71 offen offset:1024 sc1
    buffer_load_dwordx4 a[192:195], v4, s[36:39], s71 offen offset:2048 sc1
    buffer_load_dwordx4 a[196:199], v4, s[36:39], s71 offen offset:3072 sc1
    s_add_u32 s71, s71, 4096
    buffer_load_dwordx4 a[240:243], v4, s[36:39], s72 offen offset:0 sc1
    buffer_load_dwordx4 a[244:247], v4, s[36:39], s72 offen offset:1024 sc1
    buffer_load_dwordx4 a[248:251], v4, s[36:39], s72 offen offset:2048 sc1
    buffer_load_dwordx4 a[252:255], v4, s[36:39], s72 offen offset:3072 sc1
    s_add_u32 s72, s72, 4096
    buffer_load_dwordx4 v[160:163], v4, s[36:39], s73 offen offset:0 sc1
    buffer_load_dwordx4 v[164:167], v4, s[36:39], s73 offen offset:1024 sc1
    buffer_load_dwordx4 v[168:171], v4, s[36:39], s73 offen offset:2048 sc1
    buffer_load_dwordx4 v[172:175], v4, s[36:39], s73 offen offset:3072 sc1
    s_add_u32 s73, s73, 4096
    buffer_load_dwordx4 v[216:219], v4, s[36:39], s74 offen offset:0 sc1
    buffer_load_dwordx4 v[220:223], v4, s[36:39], s74 offen offset:1024 sc1
    buffer_load_dwordx4 v[224:227], v4, s[36:39], s74 offen offset:2048 sc1
    buffer_load_dwordx4 v[228:231], v4, s[36:39], s74 offen offset:3072 sc1
    s_add_u32 s74, s74, 4096
    buffer_load_dword v7, v5, s[48:51], s54 offen sc1
    s_mov_b32 s27, 0
    s_branch KG_wpa2_chk
KG_wpa2:
    buffer_load_dword v7, v5, s[48:51], s54 offen sc1
    s_add_u32 s27, s27, 1
    s_cmp_gt_u32 s27, 65536
    s_cbranch_scc1 K3_bail
KG_wpa2_chk:
    s_waitcnt vmcnt(0)
    v_subrev_u32 v7, s95, v7
    v_subrev_u32 v7, 3, v7
    v_cmp_lt_u32 vcc, 2, v7
    s_cbranch_vccz KG_wpa2_ok
    s_sleep 2
    s_branch KG_wpa2
KG_wpa2_ok:
    buffer_load_dwordx4 a[32:35], v4, s[36:39], s68 offen offset:0 sc1
    buffer_load_dwordx4 a[36:39], v4, s[36:39], s68 offen offset:1024 sc1
    buffer_load_dwordx4 a[40:43], v4, s[36:39], s68 offen offset:2048 sc1
    buffer_load_dwordx4 a[44:47], v4, s[36:39], s68 offen offset:3072 sc1
    s_add_u32 s68, s68, 4096
    buffer_load_dwordx4 a[88:91], v4, s[36:39], s69 offen offset:0 sc1
    buffer_load_dwordx4 a[92:95], v4, s[36:39], s69 offen offset:1024 sc1
    buffer_load_dwordx4 a[96:99], v4, s[36:39], s69 offen offset:2048 sc1
    buffer_load_dwordx4 a[100:103], v4, s[36:39], s69 offen offset:3072 sc1
    s_add_u32 s69, s69, 4096
    buffer_load_dwordx4 a[144:147], v4, s[36:39], s70 offen offset:0 sc1
    buffer_load_dwordx4 a[148:151], v4, s[36:39], s70 offen offset:1024 sc1
    buffer_load_dwordx4 a[152:155], v4, s[36:39], s70 offen offset:2048 sc1
    buffer_load_dwordx4 a[156:159], v4, s[36:39], s70 offen offset:3072 sc1
    s_add_u32 s70, s70, 4096
    buffer_load_dwordx4 a[200:203], v4, s[36:39], s71 offen offset:0 sc1
    buffer_load_dwordx4 a[204:207], v4, s[36:39], s71 offen offset:1024 sc1
    buffer_load_dwordx4 a[208:211], v4, s[36:39], s71 offen offset:2048 sc1
    buffer_load_dwordx4 a[212:215], v4, s[36:39], s71 offen offset:3072 sc1
    s_add_u32 s71, s71, 4096
    buffer_load_dwordx4 v[120:123], v4, s[36:39], s72 offen offset:0 sc1
    buffer_load_dwordx4 v[124:127], v4, s[36:39], s72 offen offset:1024 sc1
    buffer_load_dwordx4 v[128:131], v4, s[36:39], s72 offen offset:2048 sc1
    buffer_load_dwordx4 v[132:135], v4, s[36:39], s72 offen offset:3072 sc1
    s_add_u32 s72, s72, 4096
    buffer_load_dwordx4 v[176:179], v4, s[36:39], s73 offen offset:0 sc1
    buffer_load_dwordx4 v[180:183], v4, s[36:39], s73 offen offset:1024 sc1
    buffer_load_dwordx4 v[184:187], v4, s[36:39], s73 offen offset:2048 sc1
    buffer_load_dwordx4 v[188:191], v4, s[36:39], s73 offen offset:3072 sc1
    s_add_u32 s73, s73, 4096
    buffer_load_dwordx4 v[232:235], v4, s[36:39], s74 offen offset:0 sc1
    buffer_load_dwordx4 v[236:239], v4, s[36:39], s74 offen offset:1024 sc1
    buffer_load_dwordx4 v[240:243], v4, s[36:39], s74 offen offset:2048 sc1
    buffer_load_dwordx4 v[244:247], v4, s[36:39], s74 offen offset:3072 sc1
    s_add_u32 s74, s74, 4096
    buffer_load_dword v7, v5, s[48:51], s54 offen sc1
    s_mov_b32 s27, 0
    s_branch KG_wpa3_chk
KG_wpa3:
    buffer_load_dword v7, v5, s[48:51], s54 offen sc1
    s_add_u32 s27, s27, 1
    s_cmp_gt_u32 s27, 65536
    s_cbranch_scc1 K3_bail
KG_wpa3_chk:
    s_waitcnt vmcnt(0)
    v_subrev_u32 v7, s95, v7
    v_subrev_u32 v7, 4, v7
    v_cmp_lt_u32 vcc, 1, v7
    s_cbranch_vccz KG_wpa3_ok
    s_sleep 2
    s_branch KG_wpa3
KG_wpa3_ok:
    buffer_load_dwordx4 a[48:51], v4, s[36:39], s68 offen offset:0 sc1
    buffer_load_dwordx4 a[52:55], v4, s[36:39], s68 offen offset:1024 sc1
    buffer_load_dwordx4 a[104:107], v4, s[36:39], s69 offen offset:0 sc1
    buffer_load_dwordx4 a[108:111], v4, s[36:39], s69 offen offset:1024 sc1
    buffer_load_dwordx4 a[160:163], v4, s[36:39], s70 offen offset:0 sc1
    buffer_load_dwordx4 a[164:167], v4, s[36:39], s70 offen offset:1024 sc1
    buffer_load_dwordx4 a[216:219], v4, s[36:39], s71 offen offset:0 sc1
    buffer_load_dwordx4 a[220:223], v4, s[36:39], s71 offen offset:1024 sc1
    buffer_load_dwordx4 v[136:139], v4, s[36:39], s72 offen offset:0 sc1
    buffer_load_dwordx4 v[140:143], v4, s[36:39], s72 offen offset:1024 sc1
    buffer_load_dwordx4 v[192:195], v4, s[36:39], s73 offen offset:0 sc1
    buffer_load_dwordx4 v[196:199], v4, s[36:39], s73 offen offset:1024 sc1
    buffer_load_dwordx4 v[248:251], v4, s[36:39], s74 offen offset:0 sc1
    buffer_load_dwordx4 v[252:255], v4, s[36:39], s74 offen offset:1024 sc1
    s_mul_i32 s26, s25, 28672
    s_add_u32 s26, s26, 0x1800000
    s_add_u32 s44, s18, s26
    s_addc_u32 s45, s19, 0
    s_mov_b32 s46, 0x1b97000
    s_mov_b32 s47, 0x20000
    s_mul_i32 s31, s3, 7
    s_add_u32 s31, s31, s24
    s_lshr_b32 s31, s31, 1
    s_lshl_b32 s31, s31, 10
    s_mul_i32 s32, s24, 6
    s_sub_u32 s32, 6, s32
    s_mul_i32 s33, s3, 7
    s_add_u32 s32, s32, s33
    s_lshr_b32 s32, s32, 1
    s_lshl_b32 s32, s32, 10
    s_lshl_b32 s33, s24, 3
    v_add_u32 v5, s33, v4
    s_waitcnt vmcnt(0)
    s_barrier
KG_kq_loop:
    v_add_u32 v6, s30, v4
    s_add_u32 s52, s30, 57344
    s_sub_u32 s53, s52, 86016
    s_cmp_ge_u32 s52, 86016
    s_cselect_b32 s52, s53, s52
    s_add_u32 s30, s30, 28672
    s_cmp_ge_u32 s30, 86016
    s_cselect_b32 s30, 0, s30
    s_add_u32 s34, s23, 8
    s_mul_i32 s28, s34, 28672
    s_mul_i32 s29, s3, 7168
    s_add_u32 s28, s28, s29
    s_add_u32 s29, s29, s52
    s_mov_b32 m0, s29
    s_nop 0
    buffer_load_dwordx4 v4, s[40:43], s28 offen offset:0 lds
    buffer_load_dwordx4 v4, s[40:43], s28 offen offset:1024 lds
    buffer_load_dwordx4 v4, s[40:43], s28 offen offset:2048 lds
    buffer_load_dwordx4 v4, s[40:43], s28 offen offset:3072 lds
    s_add_u32 s28, s28, 4096
    s_add_u32 s29, s29, 4096
    s_mov_b32 m0, s29
    s_nop 0
    buffer_load_dwordx4 v4, s[40:43], s28 offen offset:0 lds
    buffer_load_dwordx4 v4, s[40:43], s28 offen offset:1024 lds
    buffer_load_dwordx4 v4, s[40:43], s28 offen offset:2048 lds
    ds_read_b128 v[48:51], v6 offset:0
    ds_read_b128 v[52:55], v6 offset:14336
    ds_read_b128 v[56:59], v6 offset:1024
    ds_read_b128 v[60:63], v6 offset:15360
    s_waitcnt lgkmcnt(2)
    v_mfma_f32_16x16x32_bf16 v[64:67], a[0:3], v[48:51], 0
    v_mfma_f32_16x16x32_bf16 v[68:71], a[56:59], v[48:51], 0
    v_mfma_f32_16x16x32_bf16 v[72:75], a[112:115], v[48:51], 0
    v_mfma_f32_16x16x32_bf16 v[76:79], a[168:171], v[48:51], 0
    v_mfma_f32_16x16x32_bf16 v[80:83], a[224:227], v[48:51], 0
    v_mfma_f32_16x16x32_bf16 v[84:87], v[144:147], v[48:51], 0
    v_mfma_f32_16x16x32_bf16 v[88:91], v[200:203], v[48:51], 0
    v_mfma_f32_16x16x32_bf16 v[92:95], a[0:3], v[52:55], 0
    v_mfma_f32_16x16x32_bf16 v[96:99], a[56:59], v[52:55], 0
    v_mfma_f32_16x16x32_bf16 v[100:103], a[112:115], v[52:55], 0
    v_mfma_f32_16x16x32_bf16 v[104:107], a[168:171], v[52:55], 0
    v_mfma_f32_16x16x32_bf16 v[108:111], a[224:227], v[52:55], 0
    v_mfma_f32_16x16x32_bf16 v[112:115], v[144:147], v[52:55], 0
    v_mfma_f32_16x16x32_bf16 v[116:119], v[200:203], v[52:55], 0
    ds_read_b128 v[48:51], v6 offset:2048
    ds_read_b128 v[52:55], v6 offset:16384
    s_waitcnt lgkmcnt(2)
    v_mfma_f32_16x16x32_bf16 v[64:67], a[4:7], v[56:59], v[64:67]
    v_mfma_f32_16x16x32_bf16 v[68:71], a[60:63], v[56:59], v[68:71]
    v_mfma_f32_16x16x32_bf16 v[72:75], a[116:119], v[56:59], v[72:75]
    v_mfma_f32_16x16x32_bf16 v[76:79], a[172:175], v[56:59], v[76:79]
    v_mfma_f32_16x16x32_bf16 v[80:83], a[228:231], v[56:59], v[80:83]
    v_mfma_f32_16x16x32_bf16 v[84:87], v[148:151], v[56:59], v[84:87]
    v_mfma_f32_16x16x32_bf16 v[88:91], v[204:207], v[56:59], v[88:91]
    v_mfma_f32_16x16x32_bf16 v[92:95], a[4:7], v[60:63], v[92:95]
    v_mfma_f32_16x16x32_bf16 v[96:99], a[60:63], v[60:63], v[96:99]
    v_mfma_f32_16x16x32_bf16 v[100:103], a[116:119], v[60:63], v[100:103]
    v_mfma_f32_16x16x32_bf16 v[104:107], a[172:175], v[60:63], v[104:107]
    v_mfma_f32_16x16x32_bf16 v[108:111], a[228:231], v[60:63], v[108:111]
    v_mfma_f32_16x16x32_bf16 v[112:115], v[148:151], v[60:63], v[112:115]
    v_mfma_f32_16x16x32_bf16 v[116:119], v[204:207], v[60:63], v[116:119]
    ds_read_b128 v[56:59], v6 offset:3072
    ds_read_b128 v[60:63], v6 offset:17408
    s_waitcnt lgkmcnt(2)
    v_mfma_f32_16x16x32_bf16 v[64:67], a[8:11], v[48:51], v[64:67]
    v_mfma_f32_16x16x32_bf16 v[68:71], a[64:67], v[48:51], v[68:71]
    v_mfma_f32_16x16x32_bf16 v[72:75], a[120:123], v[48:51], v[72:75]
    v_mfma_f32_16x16x32_bf16 v[76:79], a[176:179], v[48:51], v[76:79]
    v_mfma_f32_16x16x32_bf16 v[80:83], a[232:235], v[48:51], v[80:83]
    v_mfma_f32_16x16x32_bf16 v[84:87], v[152:155], v[48:51], v[84:87]
    v_mfma_f32_16x16x32_bf16 v[88:91], v[208:211], v[48:51], v[88:91]
    v_mfma_f32_16x16x32_bf16 v[92:95], a[8:11], v[52:55], v[92:95]
    v_mfma_f32_16x16x32_bf16 v[96:99], a[64:67], v[52:55], v[96:99]
    v_mfma_f32_16x16x32_bf16 v[100:103], a[120:123], v[52:55], v[100:103]
    v_mfma_f32_16x16x32_bf16 v[104:107], a[176:179], v[52:55], v[104:107]
    v_mfma_f32_16x16x32_bf16 v[108:111], a[232:235], v[52:55], v[108:111]
    v_mfma_f32_16x16x32_bf16 v[112:115], v[152:155], v[52:55], v[112:115]
    v_mfma_f32_16x16x32_bf16 v[116:119], v[208:211], v[52:55], v[116:119]
    ds_read_b128 v[48:51], v6 offset:4096
    ds_read_b128 v[52:55], v6 offset:18432
    s_waitcnt lgkmcnt(2)
    v_mfma_f32_16x16x32_bf16 v[64:67], a[12:15], v[56:59], v[64:67]
    v_mfma_f32_16x16x32_bf16 v[68:71], a[68:71], v[56:59], v[68:71]
    v_mfma_f32_16x16x32_bf16 v[72:75], a[124:127], v[56:59], v[72:75]
    v_mfma_f32_16x16x32_bf16 v[76:79], a[180:183], v[56:59], v[76:79]
    v_mfma_f32_16x16x32_bf16 v[80:83], a[236:239], v[56:59], v[80:83]
    v_mfma_f32_16x16x32_bf16 v[84:87], v[156:159], v[56:59], v[84:87]
    v_mfma_f32_16x16x32_bf16 v[88:91], v[212:215], v[56:59], v[88:91]
    v_mfma_f32_16x16x32_bf16 v[92:95], a[12:15], v[60:63], v[92:95]
    v_mfma_f32_16x16x32_bf16 v[96:99], a[68:71], v[60:63], v[96:99]
    v_mfma_f32_16x16x32_bf16 v[100:103], a[124:127], v[60:63], v[100:103]
    v_mfma_f32_16x16x32_bf16 v[104:107], a[180:183], v[60:63], v[104:107]
    v_mfma_f32_16x16x32_bf16 v[108:111], a[236:239], v[60:63], v[108:111]
    v_mfma_f32_16x16x32_bf16 v[112:115], v[156:159], v[60:63], v[112:115]
    v_mfma_f32_16x16x32_bf16 v[116:119], v[212:215], v[60:63], v[116:119]
    ds_read_b128 v[56:59], v6 offset:5120
    ds_read_b128 v[60:63], v6 offset:19456
    s_waitcnt lgkmcnt(2)
    v_mfma_f32_16x16x32_bf16 v[64:67], a[16:19], v[48:51], v[64:67]
    v_mfma_f32_16x16x32_bf16 v[68:71], a[72:75], v[48:51], v[68:71]
    v_mfma_f32_16x16x32_bf16 v[72:75], a[128:131], v[48:51], v[72:75]
    v_mfma_f32_16x16x32_bf16 v[76:79], a[184:187], v[48:51], v[76:79]
    v_mfma_f32_16x16x32_bf16 v[80:83], a[240:243], v[48:51], v[80:83]
    v_mfma_f32_16x16x32_bf16 v[84:87], v[160:163], v[48:51], v[84:87]
    v_mfma_f32_16x16x32_bf16 v[88:91], v[216:219], v[48:51], v[88:91]
    v_mfma_f32_16x16x32_bf16 v[92:95], a[16:19], v[52:55], v[92:95]
    v_mfma_f32_16x16x32_bf16 v[96:99], a[72:75], v[52:55], v[96:99]
    v_mfma_f32_16x16x32_bf16 v[100:103], a[128:131], v[52:55], v[100:103]
    v_mfma_f32_16x16x32_bf16 v[104:107], a[184:187], v[52:55], v[104:107]
    v_mfma_f32_16x16x32_bf16 v[108:111], a[240:243], v[52:55], v[108:111]
    v_mfma_f32_16x16x32_bf16 v[112:115], v[160:163], v[52:55], v[112:115]
    v_mfma_f32_16x16x32_bf16 v[116:119], v[216:219], v[52:55], v[116:119]
    ds_read_b128 v[48:51], v6 offset:6144
    ds_read_b128 v[52:55], v6 offset:20480
    s_waitcnt lgkmcnt(2)
    v_mfma_f32_16x16x32_bf16 v[64:67], a[20:23], v[56:59], v[64:67]
    v_mfma_f32_16x16x32_bf16 v[68:71], a[76:79], v[56:59], v[68:71]
    v_mfma_f32_16x16x32_bf16 v[72:75], a[132:135], v[56:59], v[72:75]
    v_mfma_f32_16x16x32_bf16 v[76:79], a[188:191], v[56:59], v[76:79]
    v_mfma_f32_16x16x32_bf16 v[80:83], a[244:247], v[56:59], v[80:83]
    v_mfma_f32_16x16x32_bf16 v[84:87], v[164:167], v[56:59], v[84:87]
    v_mfma_f32_16x16x32_bf16 v[88:91], v[220:223], v[56:59], v[88:91]
    v_mfma_f32_16x16x32_bf16 v[92:95], a[20:23], v[60:63], v[92:95]
    v_mfma_f32_16x16x32_bf16 v[96:99], a[76:79], v[60:63], v[96:99]
    v_mfma_f32_16x16x32_bf16 v[100:103], a[132:135], v[60:63], v[100:103]
    v_mfma_f32_16x16x32_bf16 v[104:107], a[188:191], v[60:63], v[104:107]
    v_mfma_f32_16x16x32_bf16 v[108:111], a[244:247], v[60:63], v[108:111]
    v_mfma_f32_16x16x32_bf16 v[112:115], v[164:167], v[60:63], v[112:115]
    v_mfma_f32_16x16x32_bf16 v[116:119], v[220:223], v[60:63], v[116:119]
    ds_read_b128 v[56:59], v6 offset:7168
    ds_read_b128 v[60:63], v6 offset:21504
    s_waitcnt lgkmcnt(2)
    v_mfma_f32_16x16x32_bf16 v[64:67], a[24:27], v[48:51], v[64:67]
    v_mfma_f32_16x16x32_bf16 v[68:71], a[80:83], v[48:51], v[68:71]
    v_mfma_f32_16x16x32_bf16 v[72:75], a[136:139], v[48:51], v[72:75]
    v_mfma_f32_16x16x32_bf16 v[76:79], a[192:195], v[48:51], v[76:79]
    v_mfma_f32_16x16x32_bf16 v[80:83], a[248:251], v[48:51], v[80:83]
    v_mfma_f32_16x16x32_bf16 v[84:87], v[168:171], v[48:51], v[84:87]
    v_mfma_f32_16x16x32_bf16 v[88:91], v[224:227], v[48:51], v[88:91]
    v_mfma_f32_16x16x32_bf16 v[92:95], a[24:27], v[52:55], v[92:95]
    v_mfma_f32_16x16x32_bf16 v[96:99], a[80:83], v[52:55], v[96:99]
    v_mfma_f32_16x16x32_bf16 v[100:103], a[136:139], v[52:55], v[100:103]
    v_mfma_f32_16x16x32_bf16 v[104:107], a[192:195], v[52:55], v[104:107]
    v_mfma_f32_16x16x32_bf16 v[108:111], a[248:251], v[52:55], v[108:111]
    v_mfma_f32_16x16x32_bf16 v[112:115], v[168:171], v[52:55], v[112:115]
    v_mfma_f32_16x16x32_bf16 v[116:119], v[224:227], v[52:55], v[116:119]
    ds_read_b128 v[48:51], v6 offset:8192
    ds_read_b128 v[52:55], v6 offset:22528
    s_waitcnt lgkmcnt(2)
    v_mfma_f32_16x16x32_bf16 v[64:67], a[28:31], v[56:59], v[64:67]
    v_mfma_f32_16x16x32_bf16 v[68:71], a[84:87], v[56:59], v[68:71]
    v_mfma_f32_16x16x32_bf16 v[72:75], a[140:143], v[56:59], v[72:75]
    v_mfma_f32_16x16x32_bf16 v[76:79], a[196:199], v[56:59], v[76:79]
    v_mfma_f32_16x16x32_bf16 v[80:83], a[252:255], v[56:59], v[80:83]
    v_mfma_f32_16x16x32_bf16 v[84:87], v[172:175], v[56:59], v[84:87]
    v_mfma_f32_16x16x32_bf16 v[88:91], v[228:231], v[56:59], v[88:91]
    v_mfma_f32_16x16x32_bf16 v[92:95], a[28:31], v[60:63], v[92:95]
    v_mfma_f32_16x16x32_bf16 v[96:99], a[84:87], v[60:63], v[96:99]
    v_mfma_f32_16x16x32_bf16 v[100:103], a[140:143], v[60:63], v[100:103]
    v_mfma_f32_16x16x32_bf16 v[104:107], a[196:199], v[60:63], v[104:107]
    v_mfma_f32_16x16x32_bf16 v[108:111], a[252:255], v[60:63], v[108:111]
    v_mfma_f32_16x16x32_bf16 v[112:115], v[172:175], v[60:63], v[112:115]
    v_mfma_f32_16x16x32_bf16 v[116:119], v[228:231], v[60:63], v[116:119]
    ds_read_b128 v[56:59], v6 offset:9216
    ds_read_b128 v[60:63], v6 offset:23552
    s_waitcnt lgkmcnt(2)
    v_mfma_f32_16x16x32_bf16 v[64:67], a[32:35], v[48:51], v[64:67]
    v_mfma_f32_16x16x32_bf16 v[68:71], a[88:91], v[48:51], v[68:71]
    v_mfma_f32_16x16x32_bf16 v[72:75], a[144:147], v[48:51], v[72:75]
    v_mfma_f32_16x16x32_bf16 v[76:79], a[200:203], v[48:51], v[76:79]
    v_mfma_f32_16x16x32_bf16 v[80:83], v[120:123], v[48:51], v[80:83]
    v_mfma_f32_16x16x32_bf16 v[84:87], v[176:179], v[48:51], v[84:87]
    v_mfma_f32_16x16x32_bf16 v[88:91], v[232:235], v[48:51], v[88:91]
    v_mfma_f32_16x16x32_bf16 v[92:95], a[32:35], v[52:55], v[92:95]
    v_mfma_f32_16x16x32_bf16 v[96:99], a[88:91], v[52:55], v[96:99]
    v_mfma_f32_16x16x32_bf16 v[100:103], a[144:147], v[52:55], v[100:103]
    v_mfma_f32_16x16x32_bf16 v[104:107], a[200:203], v[52:55], v[104:107]
    v_mfma_f32_16x16x32_bf16 v[108:111], v[120:123], v[52:55], v[108:111]
    v_mfma_f32_16x16x32_bf16 v[112:115], v[176:179], v[52:55], v[112:115]
    v_mfma_f32_16x16x32_bf16 v[116:119], v[232:235], v[52:55], v[116:119]
    ds_read_b128 v[48:51], v6 offset:10240
    ds_read_b128 v[52:55], v6 offset:24576
    s_waitcnt lgkmcnt(2)
    v_mfma_f32_16x16x32_bf16 v[64:67], a[36:39], v[56:59], v[64:67]
    v_mfma_f32_16x16x32_bf16 v[68:71], a[92:95], v[56:59], v[68:71]
    v_mfma_f32_16x16x32_bf16 v[72:75], a[148:151], v[56:59], v[72:75]
    v_mfma_f32_16x16x32_bf16 v[76:79], a[204:207], v[56:59], v[76:79]
    v_mfma_f32_16x16x32_bf16 v[80:83], v[124:127], v[56:59], v[80:83]
    v_mfma_f32_16x16x32_bf16 v[84:87], v[180:183], v[56:59], v[84:87]
    v_mfma_f32_16x16x32_bf16 v[88:91], v[236:239], v[56:59], v[88:91]
    v_mfma_f32_16x16x32_bf16 v[92:95], a[36:39], v[60:63], v[92:95]
    v_mfma_f32_16x16x32_bf16 v[96:99], a[92:95], v[60:63], v[96:99]
    v_mfma_f32_16x16x32_bf16 v[100:103], a[148:151], v[60:63], v[100:103]
    v_mfma_f32_16x16x32_bf16 v[104:107], a[204:207], v[60:63], v[104:107]
    v_mfma_f32_16x16x32_bf16 v[108:111], v[124:127], v[60:63], v[108:111]
    v_mfma_f32_16x16x32_bf16 v[112:115], v[180:183], v[60:63], v[112:115]
    v_mfma_f32_16x16x32_bf16 v[116:119], v[236:239], v[60:63], v[116:119]
    ds_read_b128 v[56:59], v6 offset:11264
    ds_read_b128 v[60:63], v6 offset:25600
    s_waitcnt lgkmcnt(2)
    v_mfma_f32_16x16x32_bf16 v[64:67], a[40:43], v[48:51], v[64:67]
    v_mfma_f32_16x16x32_bf16 v[68:71], a[96:99], v[48:51], v[68:71]
    v_mfma_f32_16x16x32_bf16 v[72:75], a[152:155], v[48:51], v[72:75]
    v_mfma_f32_16x16x32_bf16 v[76:79], a[208:211], v[48:51], v[76:79]
    v_mfma_f32_16x16x32_bf16 v[80:83], v[128:131], v[48:51], v[80:83]
    v_mfma_f32_16x16x32_bf16 v[84:87], v[184:187], v[48:51], v[84:87]
    v_mfma_f32_16x16x32_bf16 v[88:91], v[240:243], v[48:51], v[88:91]
    v_mfma_f32_16x16x32_bf16 v[92:95], a[40:43], v[52:55], v[92:95]
    v_mfma_f32_16x16x32_bf16 v[96:99], a[96:99], v[52:55], v[96:99]
    v_mfma_f32_16x16x32_bf16 v[100:103], a[152:155], v[52:55], v[100:103]
    v_mfma_f32_16x16x32_bf16 v[104:107], a[208:211], v[52:55], v[104:107]
    v_mfma_f32_16x16x32_bf16 v[108:111], v[128:131], v[52:55], v[108:111]
    v_mfma_f32_16x16x32_bf16 v[112:115], v[184:187], v[52:55], v[112:115]
    v_mfma_f32_16x16x32_bf16 v[116:119], v[240:243], v[52:55], v[116:119]
    ds_read_b128 v[48:51], v6 offset:12288
    ds_read_b128 v[52:55], v6 offset:26624
    s_waitcnt lgkmcnt(2)
    v_mfma_f32_16x16x32_bf16 v[64:67], a[44:47], v[56:59], v[64:67]
    v_mfma_f32_16x16x32_bf16 v[68:71], a[100:103], v[56:59], v[68:71]
    v_mfma_f32_16x16x32_bf16 v[72:75], a[156:159], v[56:59], v[72:75]
    v_mfma_f32_16x16x32_bf16 v[76:79], a[212:215], v[56:59], v[76:79]
    v_mfma_f32_16x16x32_bf16 v[80:83], v[132:135], v[56:59], v[80:83]
    v_mfma_f32_16x16x32_bf16 v[84:87], v[188:191], v[56:59], v[84:87]
    v_mfma_f32_16x16x32_bf16 v[88:91], v[244:247], v[56:59], v[88:91]
    v_mfma_f32_16x16x32_bf16 v[92:95], a[44:47], v[60:63], v[92:95]
    v_mfma_f32_16x16x32_bf16 v[96:99], a[100:103], v[60:63], v[96:99]
    v_mfma_f32_16x16x32_bf16 v[100:103], a[156:159], v[60:63], v[100:103]
    v_mfma_f32_16x16x32_bf16 v[104:107], a[212:215], v[60:63], v[104:107]
    v_mfma_f32_16x16x32_bf16 v[108:111], v[132:135], v[60:63], v[108:111]
    v_mfma_f32_16x16x32_bf16 v[112:115], v[188:191], v[60:63], v[112:115]
    v_mfma_f32_16x16x32_bf16 v[116:119], v[244:247], v[60:63], v[116:119]
    ds_read_b128 v[56:59], v6 offset:13312
    ds_read_b128 v[60:63], v6 offset:27648
    s_waitcnt lgkmcnt(2)
    v_mfma_f32_16x16x32_bf16 v[64:67], a[48:51], v[48:51], v[64:67]
    v_mfma_f32_16x16x32_bf16 v[68:71], a[104:107], v[48:51], v[68:71]
    v_mfma_f32_16x16x32_bf16 v[72:75], a[160:163], v[48:51], v[72:75]
    v_mfma_f32_16x16x32_bf16 v[76:79], a[216:219], v[48:51], v[76:79]
    v_mfma_f32_16x16x32_bf16 v[80:83], v[136:139], v[48:51], v[80:83]
    v_mfma_f32_16x16x32_bf16 v[84:87], v[192:195], v[48:51], v[84:87]
    v_mfma_f32_16x16x32_bf16 v[88:91], v[248:251], v[48:51], v[88:91]
    v_mfma_f32_16x16x32_bf16 v[92:95], a[48:51], v[52:55], v[92:95]
    v_mfma_f32_16x16x32_bf16 v[96:99], a[104:107], v[52:55], v[96:99]
    v_mfma_f32_16x16x32_bf16 v[100:103], a[160:163], v[52:55], v[100:103]
    v_mfma_f32_16x16x32_bf16 v[104:107], a[216:219], v[52:55], v[104:107]
    v_mfma_f32_16x16x32_bf16 v[108:111], v[136:139], v[52:55], v[108:111]
    v_mfma_f32_16x16x32_bf16 v[112:115], v[192:195], v[52:55], v[112:115]
    v_mfma_f32_16x16x32_bf16 v[116:119], v[248:251], v[52:55], v[116:119]
    s_waitcnt lgkmcnt(0)
    v_mfma_f32_16x16x32_bf16 v[64:67], a[52:55], v[56:59], v[64:67]
    v_mfma_f32_16x16x32_bf16 v[68:71], a[108:111], v[56:59], v[68:71]
    v_mfma_f32_16x16x32_bf16 v[72:75], a[164:167], v[56:59], v[72:75]
    v_mfma_f32_16x16x32_bf16 v[76:79], a[220:223], v[56:59], v[76:79]
    v_mfma_f32_16x16x32_bf16 v[80:83], v[140:143], v[56:59], v[80:83]
    v_mfma_f32_16x16x32_bf16 v[84:87], v[196:199], v[56:59], v[84:87]
    v_mfma_f32_16x16x32_bf16 v[88:91], v[252:255], v[56:59], v[88:91]
    v_mfma_f32_16x16x32_bf16 v[92:95], a[52:55], v[60:63], v[92:95]
    v_mfma_f32_16x16x32_bf16 v[96:99], a[108:111], v[60:63], v[96:99]
    v_mfma_f32_16x16x32_bf16 v[100:103], a[164:167], v[60:63], v[100:103]
    v_mfma_f32_16x16x32_bf16 v[104:107], a[220:223], v[60:63], v[104:107]
    v_mfma_f32_16x16x32_bf16 v[108:111], v[140:143], v[60:63], v[108:111]
    v_mfma_f32_16x16x32_bf16 v[112:115], v[196:199], v[60:63], v[112:115]
    v_mfma_f32_16x16x32_bf16 v[116:119], v[252:255], v[60:63], v[116:119]
    s_mul_i32 s35, s23, 458752
    s_add_u32 s28, s35, s31
    s_add_u32 s28, s28, 0
    s_add_u32 s29, s35, s32
    s_add_u32 s29, s29, 0
    v_cvt_pk_bf16_f32 v16, v64, v65
    v_cvt_pk_bf16_f32 v17, v66, v67
    v_cvt_pk_bf16_f32 v18, v68, v69
    v_cvt_pk_bf16_f32 v19, v70, v71
    buffer_store_dwordx4 v[16:19], v4, s[44:47], s28 offen offset:0 sc1
    v_cvt_pk_bf16_f32 v20, v72, v73
    v_cvt_pk_bf16_f32 v21, v74, v75
    v_cvt_pk_bf16_f32 v22, v76, v77
    v_cvt_pk_bf16_f32 v23, v78, v79
    buffer_store_dwordx4 v[20:23], v4, s[44:47], s28 offen offset:1024 sc1
    v_cvt_pk_bf16_f32 v24, v80, v81
    v_cvt_pk_bf16_f32 v25, v82, v83
    v_cvt_pk_bf16_f32 v26, v84, v85
    v_cvt_pk_bf16_f32 v27, v86, v87
    buffer_store_dwordx4 v[24:27], v4, s[44:47], s28 offen offset:2048 sc1
    v_cvt_pk_bf16_f32 v28, v88, v89
    v_cvt_pk_bf16_f32 v29, v90, v91
    buffer_store_dwordx2 v[28:29], v5, s[44:47], s29 offen sc1
    s_add_u32 s28, s35, s31
    s_add_u32 s28, s28, 14336
    s_add_u32 s29, s35, s32
    s_add_u32 s29, s29, 14336
    v_cvt_pk_bf16_f32 v32, v92, v93
    v_cvt_pk_bf16_f32 v33, v94, v95
    v_cvt_pk_bf16_f32 v34, v96, v97
    v_cvt_pk_bf16_f32 v35, v98, v99
    buffer_store_dwordx4 v[32:35], v4, s[44:47], s28 offen offset:0 sc1
    v_cvt_pk_bf16_f32 v36, v100, v101
    v_cvt_pk_bf16_f32 v37, v102, v103
    v_cvt_pk_bf16_f32 v38, v104, v105
    v_cvt_pk_bf16_f32 v39, v106, v107
    buffer_store_dwordx4 v[36:39], v4, s[44:47], s28 offen offset:1024 sc1
    v_cvt_pk_bf16_f32 v40, v108, v109
    v_cvt_pk_bf16_f32 v41, v110, v111
    v_cvt_pk_bf16_f32 v42, v112, v113
    v_cvt_pk_bf16_f32 v43, v114, v115
    buffer_store_dwordx4 v[40:43], v4, s[44:47], s28 offen offset:2048 sc1
    v_cvt_pk_bf16_f32 v44, v116, v117
    v_cvt_pk_bf16_f32 v45, v118, v119
    buffer_store_dwordx2 v[44:45], v5, s[44:47], s29 offen sc1
    s_waitcnt vmcnt(0)
    s_barrier
    s_lshl_b32 s28, s23, 13
    s_lshl_b32 s29, s22, 7
    s_add_u32 s28, s28, s29
    s_cmp_lg_u32 s3, 0
    s_cbranch_scc1 KG_kq_pf
    v_mov_b32 v6, s96
    v_mov_b32 v7, 0
    s_mov_b64 exec, 1
    buffer_store_dword v6, v7, s[48:51], s28 offen sc1
    s_mov_b64 exec, -1
KG_kq_pf:
    s_add_u32 s23, s23, 4
    s_cmp_ge_u32 s23, 64
    s_cbranch_scc1 K3_end
    s_sub_u32 s28, s23, 4
    s_max_i32 s28, s28, 0
    s_lshl_b32 s28, s28, 13
    v_mov_b32 v6, 6144
    s_mov_b32 s27, 0
KG_kq_pw:
    buffer_load_dword v7, v6, s[48:51], s28 offen sc1
    s_add_u32 s27, s27, 1
    s_cmp_gt_u32 s27, 65536
    s_cbranch_scc1 K3_bail
    s_waitcnt vmcnt(0)
    v_cmp_ne_u32 vcc, s96, v7
    s_cbranch_vccz KG_kq_pw_ok
    s_sleep 16
    s_branch KG_kq_pw
KG_kq_pw_ok:
    s_nop 1
    s_branch KG_kq_loop
KG_vo:
    s_lshl_b32 s26, s25, 10
    s_add_u32 s26, s26, 0x3400000
    s_add_u32 s44, s18, s26
    s_addc_u32 s45, s19, 0
    s_mov_b32 s46, 0x1bfc400
    s_mov_b32 s47, 0x20000
    s_mul_i32 s31, s3, 7
    s_add_u32 s31, s31, s24
    s_add_u32 s31, s31, 0
    s_lshl_b32 s31, s31, 14
    s_mul_i32 s32, s24, 6
    s_sub_u32 s32, 6, s32
    s_mul_i32 s33, s3, 7
    s_add_u32 s32, s32, s33
    s_lshl_b32 s32, s32, 14
    s_add_u32 s56, s18, 0x5c00000
    s_addc_u32 s57, s19, 0
    s_mov_b32 s58, 0x80000
    s_mov_b32 s59, 0x20000
    s_add_u32 s60, s18, 0x5400000
    s_addc_u32 s61, s19, 0
    s_mov_b32 s62, 0x700000
    s_mov_b32 s63, 0x20000
    s_mul_i32 s65, s3, 7
    s_add_u32 s65, s65, s24
    s_add_u32 s65, s65, 0
    s_mul_i32 s66, s24, 6
    s_sub_u32 s66, 6, s66
    s_mul_i32 s67, s3, 7
    s_add_u32 s66, s66, s67
    s_mov_b32 s64, s21
    s_lshl_b32 s65, s65, 12
    s_lshl_b32 s66, s66, 12
    s_lshl_b32 s28, s25, 8
    v_lshlrev_b32 v10, 2, v1
    v_add_u32 v10, s28, v10
    v_and_b32 v6, 1, v1
    v_cmp_eq_u32 vcc, 1, v6
    v_mov_b32 v8, 0x4444
    v_mov_b32 v6, 0xeeee
    v_cndmask_b32 v8, v8, v6, vcc
    v_mov_b32 v9, 6144
    v_add_u32 v6, s30, v4
    s_add_u32 s52, s30, 57344
    s_sub_u32 s53, s52, 86016
    s_cmp_ge_u32 s52, 86016
    s_cselect_b32 s52, s53, s52
    s_add_u32 s30, s30, 28672
    s_cmp_ge_u32 s30, 86016
    s_cselect_b32 s30, 0, s30
    s_add_u32 s34, s23, 14
    s_mul_i32 s28, s34, 28672
    s_mul_i32 s29, s3, 7168
    s_add_u32 s28, s28, s29
    s_add_u32 s29, s29, s52
    s_mov_b32 m0, s29
    s_nop 0
    buffer_load_dwordx4 v4, s[40:43], s28 offen offset:0 lds
    buffer_load_dwordx4 v4, s[40:43], s28 offen offset:1024 lds
    buffer_load_dwordx4 v4, s[40:43], s28 offen offset:2048 lds
    buffer_load_dwordx4 v4, s[40:43], s28 offen offset:3072 lds
    s_add_u32 s28, s28, 4096
    s_add_u32 s29, s29, 4096
    s_mov_b32 m0, s29
    s_nop 0
    buffer_load_dwordx4 v4, s[40:43], s28 offen offset:0 lds
    buffer_load_dwordx4 v4, s[40:43], s28 offen offset:1024 lds
    buffer_load_dwordx4 v4, s[40:43], s28 offen offset:2048 lds
    s_mov_b32 s27, 0
KG_wpb0:
    buffer_load_dword v7, v5, s[48:51], s54 offen sc1
    s_add_u32 s27, s27, 1
    s_cmp_gt_u32 s27, 65536
    s_cbranch_scc1 K3_bail
KG_wpb0_chk:
    s_waitcnt vmcnt(0)
    v_subrev_u32 v7, s95, v7
    v_subrev_u32 v7, 1, v7
    v_cmp_lt_u32 vcc, 4, v7
    s_cbranch_vccz KG_wpb0_ok
    s_sleep 2
    s_branch KG_wpb0
KG_wpb0_ok:
    buffer_load_dwordx4 a[0:3], v4, s[36:39], s68 offen offset:0 sc1
    buffer_load_dwordx4 a[4:7], v4, s[36:39], s68 offen offset:1024 sc1
    buffer_load_dwordx4 a[8:11], v4, s[36:39], s68 offen offset:2048 sc1
    buffer_load_dwordx4 a[12:15], v4, s[36:39], s68 offen offset:3072 sc1
    s_add_u32 s68, s68, 4096
    buffer_load_dwordx4 a[56:59], v4, s[36:39], s69 offen offset:0 sc1
    buffer_load_dwordx4 a[60:63], v4, s[36:39], s69 offen offset:1024 sc1
    buffer_load_dwordx4 a[64:67], v4, s[36:39], s69 offen offset:2048 sc1
    buffer_load_dwordx4 a[68:71], v4, s[36:39], s69 offen offset:3072 sc1
    s_add_u32 s69, s69, 4096
    buffer_load_dwordx4 a[112:115], v4, s[36:39], s70 offen offset:0 sc1
    buffer_load_dwordx4 a[116:119], v4, s[36:39], s70 offen offset:1024 sc1
    buffer_load_dwordx4 a[120:123], v4, s[36:39], s70 offen offset:2048 sc1
    buffer_load_dwordx4 a[124:127], v4, s[36:39], s70 offen offset:3072 sc1
    s_add_u32 s70, s70, 4096
    buffer_load_dwordx4 a[168:171], v4, s[36:39], s71 offen offset:0 sc1
    buffer_load_dwordx4 a[172:175], v4, s[36:39], s71 offen offset:1024 sc1
    buffer_load_dwordx4 a[176:179], v4, s[36:39], s71 offen offset:2048 sc1
    buffer_load_dwordx4 a[180:183], v4, s[36:39], s71 offen offset:3072 sc1
    s_add_u32 s71, s71, 4096
    buffer_load_dwordx4 a[224:227], v4, s[36:39], s72 offen offset:0 sc1
    buffer_load_dwordx4 a[228:231], v4, s[36:39], s72 offen offset:1024 sc1
    buffer_load_dwordx4 a[232:235], v4, s[36:39], s72 offen offset:2048 sc1
    buffer_load_dwordx4 a[236:239], v4, s[36:39], s72 offen offset:3072 sc1
    s_add_u32 s72, s72, 4096
    buffer_load_dwordx4 v[144:147], v4, s[36:39], s73 offen offset:0 sc1
    buffer_load_dwordx4 v[148:151], v4, s[36:39], s73 offen offset:1024 sc1
    buffer_load_dwordx4 v[152:155], v4, s[36:39], s73 offen offset:2048 sc1
    buffer_load_dwordx4 v[156:159], v4, s[36:39], s73 offen offset:3072 sc1
    s_add_u32 s73, s73, 4096
    buffer_load_dwordx4 v[200:203], v4, s[36:39], s74 offen offset:0 sc1
    buffer_load_dwordx4 v[204:207], v4, s[36:39], s74 offen offset:1024 sc1
    buffer_load_dwordx4 v[208:211], v4, s[36:39], s74 offen offset:2048 sc1
    buffer_load_dwordx4 v[212:215], v4, s[36:39], s74 offen offset:3072 sc1
    s_add_u32 s74, s74, 4096
    buffer_load_dword v7, v5, s[48:51], s54 offen sc1
    s_mov_b32 s27, 0
    s_branch KG_wpb1_chk
KG_wpb1:
    buffer_load_dword v7, v5, s[48:51], s54 offen sc1
    s_add_u32 s27, s27, 1
    s_cmp_gt_u32 s27, 65536
    s_cbranch_scc1 K3_bail
KG_wpb1_chk:
    s_waitcnt vmcnt(0)
    v_subrev_u32 v7, s95, v7
    v_subrev_u32 v7, 2, v7
    v_cmp_lt_u32 vcc, 3, v7
    s_cbranch_vccz KG_wpb1_ok
    s_sleep 2
    s_branch KG_wpb1
KG_wpb1_ok:
    s_barrier
    ds_read_b128 v[48:51], v6 offset:0
    ds_read_b128 v[52:55], v6 offset:14336
    ds_read_b128 v[56:59], v6 offset:1024
    ds_read_b128 v[60:63], v6 offset:15360
    s_waitcnt lgkmcnt(2)
    v_mfma_f32_16x16x32_bf16 v[64:67], v[48:51], a[0:3], 0
    buffer_load_dwordx4 a[16:19], v4, s[36:39], s68 offen offset:0 sc1
    v_mfma_f32_16x16x32_bf16 v[68:71], v[48:51], a[56:59], 0
    v_mfma_f32_16x16x32_bf16 v[72:75], v[48:51], a[112:115], 0
    buffer_load_dwordx4 a[20:23], v4, s[36:39], s68 offen offset:1024 sc1
    v_mfma_f32_16x16x32_bf16 v[76:79], v[48:51], a[168:171], 0
    v_mfma_f32_16x16x32_bf16 v[80:83], v[48:51], a[224:227], 0
    buffer_load_dwordx4 a[24:27], v4, s[36:39], s68 offen offset:2048 sc1
    v_mfma_f32_16x16x32_bf16 v[84:87], v[48:51], v[144:147], 0
    v_mfma_f32_16x16x32_bf16 v[88:91], v[48:51], v[200:203], 0
    buffer_load_dwordx4 a[28:31], v4, s[36:39], s68 offen offset:3072 sc1
    s_add_u32 s68, s68, 4096
    v_mfma_f32_16x16x32_bf16 v[92:95], v[52:55], a[0:3], 0
    buffer_load_dwordx4 a[72:75], v4, s[36:39], s69 offen offset:0 sc1
    v_mfma_f32_16x16x32_bf16 v[96:99], v[52:55], a[56:59], 0
    v_mfma_f32_16x16x32_bf16 v[100:103], v[52:55], a[112:115], 0
    buffer_load_dwordx4 a[76:79], v4, s[36:39], s69 offen offset:1024 sc1
    v_mfma_f32_16x16x32_bf16 v[104:107], v[52:55], a[168:171], 0
    v_mfma_f32_16x16x32_bf16 v[108:111], v[52:55], a[224:227], 0
    buffer_load_dwordx4 a[80:83], v4, s[36:39], s69 offen offset:2048 sc1
    v_mfma_f32_16x16x32_bf16 v[112:115], v[52:55], v[144:147], 0
    v_mfma_f32_16x16x32_bf16 v[116:119], v[52:55], v[200:203], 0
    buffer_load_dwordx4 a[84:87], v4, s[36:39], s69 offen offset:3072 sc1
    s_add_u32 s69, s69, 4096
    ds_read_b128 v[48:51], v6 offset:2048
    ds_read_b128 v[52:55], v6 offset:16384
    s_waitcnt lgkmcnt(2)
    v_mfma_f32_16x16x32_bf16 v[64:67], v[56:59], a[4:7], v[64:67]
    buffer_load_dwordx4 a[128:131], v4, s[36:39], s70 offen offset:0 sc1
    v_mfma_f32_16x16x32_bf16 v[68:71], v[56:59], a[60:63], v[68:71]
    v_mfma_f32_16x16x32_bf16 v[72:75], v[56:59], a[116:119], v[72:75]
    buffer_load_dwordx4 a[132:135], v4, s[36:39], s70 offen offset:1024 sc1
    v_mfma_f32_16x16x32_bf16 v[76:79], v[56:59], a[172:175], v[76:79]
    v_mfma_f32_16x16x32_bf16 v[80:83], v[56:59], a[228:231], v[80:83]
    buffer_load_dwordx4 a[136:139], v4, s[36:39], s70 offen offset:2048 sc1
    v_mfma_f32_16x16x32_bf16 v[84:87], v[56:59], v[148:151], v[84:87]
    v_mfma_f32_16x16x32_bf16 v[88:91], v[56:59], v[204:207], v[88:91]
    buffer_load_dwordx4 a[140:143], v4, s[36:39], s70 offen offset:3072 sc1
    s_add_u32 s70, s70, 4096
    v_mfma_f32_16x16x32_bf16 v[92:95], v[60:63], a[4:7], v[92:95]
    buffer_load_dwordx4 a[184:187], v4, s[36:39], s71 offen offset:0 sc1
    v_mfma_f32_16x16x32_bf16 v[96:99], v[60:63], a[60:63], v[96:99]
    v_mfma_f32_16x16x32_bf16 v[100:103], v[60:63], a[116:119], v[100:103]
    buffer_load_dwordx4 a[188:191], v4, s[36:39], s71 offen offset:1024 sc1
    v_mfma_f32_16x16x32_bf16 v[104:107], v[60:63], a[172:175], v[104:107]
    v_mfma_f32_16x16x32_bf16 v[108:111], v[60:63], a[228:231], v[108:111]
    buffer_load_dwordx4 a[192:195], v4, s[36:39], s71 offen offset:2048 sc1
    v_mfma_f32_16x16x32_bf16 v[112:115], v[60:63], v[148:151], v[112:115]
    v_mfma_f32_16x16x32_bf16 v[116:119], v[60:63], v[204:207], v[116:119]
    buffer_load_dwordx4 a[196:199], v4, s[36:39], s71 offen offset:3072 sc1
    s_add_u32 s71, s71, 4096
    ds_read_b128 v[56:59], v6 offset:3072
    ds_read_b128 v[60:63], v6 offset:17408
    s_waitcnt lgkmcnt(2)
    v_mfma_f32_16x16x32_bf16 v[64:67], v[48:51], a[8:11], v[64:67]
    buffer_load_dwordx4 a[240:243], v4, s[36:39], s72 offen offset:0 sc1
    v_mfma_f32_16x16x32_bf16 v[68:71], v[48:51], a[64:67], v[68:71]
    v_mfma_f32_16x16x32_bf16 v[72:75], v[48:51], a[120:123], v[72:75]
    buffer_load_dwordx4 a[244:247], v4, s[36:39], s72 offen offset:1024 sc1
    v_mfma_f32_16x16x32_bf16 v[76:79], v[48:51], a[176:179], v[76:79]
    v_mfma_f32_16x16x32_bf16 v[80:83], v[48:51], a[232:235], v[80:83]
    buffer_load_dwordx4 a[248:251], v4, s[36:39], s72 offen offset:2048 sc1
    v_mfma_f32_16x16x32_bf16 v[84:87], v[48:51], v[152:155], v[84:87]
    v_mfma_f32_16x16x32_bf16 v[88:91], v[48:51], v[208:211], v[88:91]
    buffer_load_dwordx4 a[252:255], v4, s[36:39], s72 offen offset:3072 sc1
    s_add_u32 s72, s72, 4096
    v_mfma_f32_16x16x32_bf16 v[92:95], v[52:55], a[8:11], v[92:95]
    buffer_load_dwordx4 v[160:163], v4, s[36:39], s73 offen offset:0 sc1
    v_mfma_f32_16x16x32_bf16 v[96:99], v[52:55], a[64:67], v[96:99]
    v_mfma_f32_16x16x32_bf16 v[100:103], v[52:55], a[120:123], v[100:103]
    buffer_load_dwordx4 v[164:167], v4, s[36:39], s73 offen offset:1024 sc1
    v_mfma_f32_16x16x32_bf16 v[104:107], v[52:55], a[176:179], v[104:107]
    v_mfma_f32_16x16x32_bf16 v[108:111], v[52:55], a[232:235], v[108:111]
    buffer_load_dwordx4 v[168:171], v4, s[36:39], s73 offen offset:2048 sc1
    v_mfma_f32_16x16x32_bf16 v[112:115], v[52:55], v[152:155], v[112:115]
    v_mfma_f32_16x16x32_bf16 v[116:119], v[52:55], v[208:211], v[116:119]
    buffer_load_dwordx4 v[172:175], v4, s[36:39], s73 offen offset:3072 sc1
    s_add_u32 s73, s73, 4096
    s_waitcnt lgkmcnt(0)
    v_mfma_f32_16x16x32_bf16 v[64:67], v[56:59], a[12:15], v[64:67]
    buffer_load_dwordx4 v[216:219], v4, s[36:39], s74 offen offset:0 sc1
    v_mfma_f32_16x16x32_bf16 v[68:71], v[56:59], a[68:71], v[68:71]
    v_mfma_f32_16x16x32_bf16 v[72:75], v[56:59], a[124:127], v[72:75]
    buffer_load_dwordx4 v[220:223], v4, s[36:39], s74 offen offset:1024 sc1
    v_mfma_f32_16x16x32_bf16 v[76:79], v[56:59], a[180:183], v[76:79]
    v_mfma_f32_16x16x32_bf16 v[80:83], v[56:59], a[236:239], v[80:83]
    buffer_load_dwordx4 v[224:227], v4, s[36:39], s74 offen offset:2048 sc1
    v_mfma_f32_16x16x32_bf16 v[84:87], v[56:59], v[156:159], v[84:87]
    v_mfma_f32_16x16x32_bf16 v[88:91], v[56:59], v[212:215], v[88:91]
    buffer_load_dwordx4 v[228:231], v4, s[36:39], s74 offen offset:3072 sc1
    s_add_u32 s74, s74, 4096
    v_mfma_f32_16x16x32_bf16 v[92:95], v[60:63], a[12:15], v[92:95]
    buffer_load_dword v7, v5, s[48:51], s54 offen sc1
    v_mfma_f32_16x16x32_bf16 v[96:99], v[60:63], a[68:71], v[96:99]
    v_mfma_f32_16x16x32_bf16 v[100:103], v[60:63], a[124:127], v[100:103]
    v_mfma_f32_16x16x32_bf16 v[104:107], v[60:63], a[180:183], v[104:107]
    v_mfma_f32_16x16x32_bf16 v[108:111], v[60:63], a[236:239], v[108:111]
    v_mfma_f32_16x16x32_bf16 v[112:115], v[60:63], v[156:159], v[112:115]
    v_mfma_f32_16x16x32_bf16 v[116:119], v[60:63], v[212:215], v[116:119]
    s_mov_b32 s27, 0
    s_branch KG_wpb2_chk
KG_wpb2:
    buffer_load_dword v7, v5, s[48:51], s54 offen sc1
    s_add_u32 s27, s27, 1
    s_cmp_gt_u32 s27, 65536
    s_cbranch_scc1 K3_bail
KG_wpb2_chk:
    s_waitcnt vmcnt(0)
    v_subrev_u32 v7, s95, v7
    v_subrev_u32 v7, 3, v7
    v_cmp_lt_u32 vcc, 2, v7
    s_cbranch_vccz KG_wpb2_ok
    s_sleep 2
    s_branch KG_wpb2
KG_wpb2_ok:
    ds_read_b128 v[48:51], v6 offset:4096
    ds_read_b128 v[52:55], v6 offset:18432
    ds_read_b128 v[56:59], v6 offset:5120
    ds_read_b128 v[60:63], v6 offset:19456
    s_waitcnt lgkmcnt(2)
    v_mfma_f32_16x16x32_bf16 v[64:67], v[48:51], a[16:19], v[64:67]
    buffer_load_dwordx4 a[32:35], v4, s[36:39], s68 offen offset:0 sc1
    v_mfma_f32_16x16x32_bf16 v[68:71], v[48:51], a[72:75], v[68:71]
    v_mfma_f32_16x16x32_bf16 v[72:75], v[48:51], a[128:131], v[72:75]
    buffer_load_dwordx4 a[36:39], v4, s[36:39], s68 offen offset:1024 sc1
    v_mfma_f32_16x16x32_bf16 v[76:79], v[48:51], a[184:187], v[76:79]
    v_mfma_f32_16x16x32_bf16 v[80:83], v[48:51], a[240:243], v[80:83]
    buffer_load_dwordx4 a[40:43], v4, s[36:39], s68 offen offset:2048 sc1
    v_mfma_f32_16x16x32_bf16 v[84:87], v[48:51], v[160:163], v[84:87]
    v_mfma_f32_16x16x32_bf16 v[88:91], v[48:51], v[216:219], v[88:91]
    buffer_load_dwordx4 a[44:47], v4, s[36:39], s68 offen offset:3072 sc1
    s_add_u32 s68, s68, 4096
    v_mfma_f32_16x16x32_bf16 v[92:95], v[52:55], a[16:19], v[92:95]
    buffer_load_dwordx4 a[88:91], v4, s[36:39], s69 offen offset:0 sc1
    v_mfma_f32_16x16x32_bf16 v[96:99], v[52:55], a[72:75], v[96:99]
    v_mfma_f32_16x16x32_bf16 v[100:103], v[52:55], a[128:131], v[100:103]
    buffer_load_dwordx4 a[92:95], v4, s[36:39], s69 offen offset:1024 sc1
    v_mfma_f32_16x16x32_bf16 v[104:107], v[52:55], a[184:187], v[104:107]
    v_mfma_f32_16x16x32_bf16 v[108:111], v[52:55], a[240:243], v[108:111]
    buffer_load_dwordx4 a[96:99], v4, s[36:39], s69 offen offset:2048 sc1
    v_mfma_f32_16x16x32_bf16 v[112:115], v[52:55], v[160:163], v[112:115]
    v_mfma_f32_16x16x32_bf16 v[116:119], v[52:55], v[216:219], v[116:119]
    buffer_load_dwordx4 a[100:103], v4, s[36:39], s69 offen offset:3072 sc1
    s_add_u32 s69, s69, 4096
    ds_read_b128 v[48:51], v6 offset:6144
    ds_read_b128 v[52:55], v6 offset:20480
    s_waitcnt lgkmcnt(2)
    v_mfma_f32_16x16x32_bf16 v[64:67], v[56:59], a[20:23], v[64:67]
    buffer_load_dwordx4 a[144:147], v4, s[36:39], s70 offen offset:0 sc1
    v_mfma_f32_16x16x32_bf16 v[68:71], v[56:59], a[76:79], v[68:71]
    v_mfma_f32_16x16x32_bf16 v[72:75], v[56:59], a[132:135], v[72:75]
    buffer_load_dwordx4 a[148:151], v4, s[36:39], s70 offen offset:1024 sc1
    v_mfma_f32_16x16x32_bf16 v[76:79], v[56:59], a[188:191], v[76:79]
    v_mfma_f32_16x16x32_bf16 v[80:83], v[56:59], a[244:247], v[80:83]
    buffer_load_dwordx4 a[152:155], v4, s[36:39], s70 offen offset:2048 sc1
    v_mfma_f32_16x16x32_bf16 v[84:87], v[56:59], v[164:167], v[84:87]
    v_mfma_f32_16x16x32_bf16 v[88:91], v[56:59], v[220:223], v[88:91]
    buffer_load_dwordx4 a[156:159], v4, s[36:39], s70 offen offset:3072 sc1
    s_add_u32 s70, s70, 4096
    v_mfma_f32_16x16x32_bf16 v[92:95], v[60:63], a[20:23], v[92:95]
    buffer_load_dwordx4 a[200:203], v4, s[36:39], s71 offen offset:0 sc1
    v_mfma_f32_16x16x32_bf16 v[96:99], v[60:63], a[76:79], v[96:99]
    v_mfma_f32_16x16x32_bf16 v[100:103], v[60:63], a[132:135], v[100:103]
    buffer_load_dwordx4 a[204:207], v4, s[36:39], s71 offen offset:1024 sc1
    v_mfma_f32_16x16x32_bf16 v[104:107], v[60:63], a[188:191], v[104:107]
    v_mfma_f32_16x16x32_bf16 v[108:111], v[60:63], a[244:247], v[108:111]
    buffer_load_dwordx4 a[208:211], v4, s[36:39], s71 offen offset:2048 sc1
    v_mfma_f32_16x16x32_bf16 v[112:115], v[60:63], v[164:167], v[112:115]
    v_mfma_f32_16x16x32_bf16 v[116:119], v[60:63], v[220:223], v[116:119]
    buffer_load_dwordx4 a[212:215], v4, s[36:39], s71 offen offset:3072 sc1
    s_add_u32 s71, s71, 4096
    ds_read_b128 v[56:59], v6 offset:7168
    ds_read_b128 v[60:63], v6 offset:21504
    s_waitcnt lgkmcnt(2)
    v_mfma_f32_16x16x32_bf16 v[64:67], v[48:51], a[24:27], v[64:67]
    buffer_load_dwordx4 v[120:123], v4, s[36:39], s72 offen offset:0 sc1
    v_mfma_f32_16x16x32_bf16 v[68:71], v[48:51], a[80:83], v[68:71]
    v_mfma_f32_16x16x32_bf16 v[72:75], v[48:51], a[136:139], v[72:75]
    buffer_load_dwordx4 v[124:127], v4, s[36:39], s72 offen offset:1024 sc1
    v_mfma_f32_16x16x32_bf16 v[76:79], v[48:51], a[192:195], v[76:79]
    v_mfma_f32_16x16x32_bf16 v[80:83], v[48:51], a[248:251], v[80:83]
    buffer_load_dwordx4 v[128:131], v4, s[36:39], s72 offen offset:2048 sc1
    v_mfma_f32_16x16x32_bf16 v[84:87], v[48:51], v[168:171], v[84:87]
    v_mfma_f32_16x16x32_bf16 v[88:91], v[48:51], v[224:227], v[88:91]
    buffer_load_dwordx4 v[132:135], v4, s[36:39], s72 offen offset:3072 sc1
    s_add_u32 s72, s72, 4096
    v_mfma_f32_16x16x32_bf16 v[92:95], v[52:55], a[24:27], v[92:95]
    buffer_load_dwordx4 v[176:179], v4, s[36:39], s73 offen offset:0 sc1
    v_mfma_f32_16x16x32_bf16 v[96:99], v[52:55], a[80:83], v[96:99]
    v_mfma_f32_16x16x32_bf16 v[100:103], v[52:55], a[136:139], v[100:103]
    buffer_load_dwordx4 v[180:183], v4, s[36:39], s73 offen offset:1024 sc1
    v_mfma_f32_16x16x32_bf16 v[104:107], v[52:55], a[192:195], v[104:107]
    v_mfma_f32_16x16x32_bf16 v[108:111], v[52:55], a[248:251], v[108:111]
    buffer_load_dwordx4 v[184:187], v4, s[36:39], s73 offen offset:2048 sc1
    v_mfma_f32_16x16x32_bf16 v[112:115], v[52:55], v[168:171], v[112:115]
    v_mfma_f32_16x16x32_bf16 v[116:119], v[52:55], v[224:227], v[116:119]
    buffer_load_dwordx4 v[188:191], v4, s[36:39], s73 offen offset:3072 sc1
    s_add_u32 s73, s73, 4096
    s_waitcnt lgkmcnt(0)
    v_mfma_f32_16x16x32_bf16 v[64:67], v[56:59], a[28:31], v[64:67]
    buffer_load_dwordx4 v[232:235], v4, s[36:39], s74 offen offset:0 sc1
    v_mfma_f32_16x16x32_bf16 v[68:71], v[56:59], a[84:87], v[68:71]
    v_mfma_f32_16x16x32_bf16 v[72:75], v[56:59], a[140:143], v[72:75]
    buffer_load_dwordx4 v[236:239], v4, s[36:39], s74 offen offset:1024 sc1
    v_mfma_f32_16x16x32_bf16 v[76:79], v[56:59], a[196:199], v[76:79]
    v_mfma_f32_16x16x32_bf16 v[80:83], v[56:59], a[252:255], v[80:83]
    buffer_load_dwordx4 v[240:243], v4, s[36:39], s74 offen offset:2048 sc1
    v_mfma_f32_16x16x32_bf16 v[84:87], v[56:59], v[172:175], v[84:87]
    v_mfma_f32_16x16x32_bf16 v[88:91], v[56:59], v[228:231], v[88:91]
    buffer_load_dwordx4 v[244:247], v4, s[36:39], s74 offen offset:3072 sc1
    s_add_u32 s74, s74, 4096
    v_mfma_f32_16x16x32_bf16 v[92:95], v[60:63], a[28:31], v[92:95]
    buffer_load_dword v7, v5, s[48:51], s54 offen sc1
    v_mfma_f32_16x16x32_bf16 v[96:99], v[60:63], a[84:87], v[96:99]
    v_mfma_f32_16x16x32_bf16 v[100:103], v[60:63], a[140:143], v[100:103]
    v_mfma_f32_16x16x32_bf16 v[104:107], v[60:63], a[196:199], v[104:107]
    v_mfma_f32_16x16x32_bf16 v[108:111], v[60:63], a[252:255], v[108:111]
    v_mfma_f32_16x16x32_bf16 v[112:115], v[60:63], v[172:175], v[112:115]
    v_mfma_f32_16x16x32_bf16 v[116:119], v[60:63], v[228:231], v[116:119]
    s_mov_b32 s27, 0
    s_branch KG_wpb3_chk
KG_wpb3:
    buffer_load_dword v7, v5, s[48:51], s54 offen sc1
    s_add_u32 s27, s27, 1
    s_cmp_gt_u32 s27, 65536
    s_cbranch_scc1 K3_bail
KG_wpb3_chk:
    s_waitcnt vmcnt(0)
    v_subrev_u32 v7, s95, v7
    v_subrev_u32 v7, 4, v7
    v_cmp_lt_u32 vcc, 1, v7
    s_cbranch_vccz KG_wpb3_ok
    s_sleep 2
    s_branch KG_wpb3
KG_wpb3_ok:
    ds_read_b128 v[48:51], v6 offset:8192
    ds_read_b128 v[52:55], v6 offset:22528
    ds_read_b128 v[56:59], v6 offset:9216
    ds_read_b128 v[60:63], v6 offset:23552
    s_waitcnt lgkmcnt(2)
    v_mfma_f32_16x16x32_bf16 v[64:67], v[48:51], a[32:35], v[64:67]
    buffer_load_dwordx4 a[48:51], v4, s[36:39], s68 offen offset:0 sc1
    v_mfma_f32_16x16x32_bf16 v[68:71], v[48:51], a[88:91], v[68:71]
    v_mfma_f32_16x16x32_bf16 v[72:75], v[48:51], a[144:147], v[72:75]
    buffer_load_dwordx4 a[52:55], v4, s[36:39], s68 offen offset:1024 sc1
    v_mfma_f32_16x16x32_bf16 v[76:79], v[48:51], a[200:203], v[76:79]
    v_mfma_f32_16x16x32_bf16 v[80:83], v[48:51], v[120:123], v[80:83]
    buffer_load_dwordx4 a[104:107], v4, s[36:39], s69 offen offset:0 sc1
    v_mfma_f32_16x16x32_bf16 v[84:87], v[48:51], v[176:179], v[84:87]
    v_mfma_f32_16x16x32_bf16 v[88:91], v[48:51], v[232:235], v[88:91]
    buffer_load_dwordx4 a[108:111], v4, s[36:39], s69 offen offset:1024 sc1
    v_mfma_f32_16x16x32_bf16 v[92:95], v[52:55], a[32:35], v[92:95]
    buffer_load_dwordx4 a[160:163], v4, s[36:39], s70 offen offset:0 sc1
    v_mfma_f32_16x16x32_bf16 v[96:99], v[52:55], a[88:91], v[96:99]
    v_mfma_f32_16x16x32_bf16 v[100:103], v[52:55], a[144:147], v[100:103]
    buffer_load_dwordx4 a[164:167], v4, s[36:39], s70 offen offset:1024 sc1
    v_mfma_f32_16x16x32_bf16 v[104:107], v[52:55], a[200:203], v[104:107]
    v_mfma_f32_16x16x32_bf16 v[108:111], v[52:55], v[120:123], v[108:111]
    buffer_load_dwordx4 a[216:219], v4, s[36:39], s71 offen offset:0 sc1
    v_mfma_f32_16x16x32_bf16 v[112:115], v[52:55], v[176:179], v[112:115]
    v_mfma_f32_16x16x32_bf16 v[116:119], v[52:55], v[232:235], v[116:119]
    buffer_load_dwordx4 a[220:223], v4, s[36:39], s71 offen offset:1024 sc1
    ds_read_b128 v[48:51], v6 offset:10240
    ds_read_b128 v[52:55], v6 offset:24576
    s_waitcnt lgkmcnt(2)
    v_mfma_f32_16x16x32_bf16 v[64:67], v[56:59], a[36:39], v[64:67]
    buffer_load_dwordx4 v[136:139], v4, s[36:39], s72 offen offset:0 sc1
    v_mfma_f32_16x16x32_bf16 v[68:71], v[56:59], a[92:95], v[68:71]
    v_mfma_f32_16x16x32_bf16 v[72:75], v[56:59], a[148:151], v[72:75]
    buffer_load_dwordx4 v[140:143], v4, s[36:39], s72 offen offset:1024 sc1
    v_mfma_f32_16x16x32_bf16 v[76:79], v[56:59], a[204:207], v[76:79]
    v_mfma_f32_16x16x32_bf16 v[80:83], v[56:59], v[124:127], v[80:83]
    buffer_load_dwordx4 v[192:195], v4, s[36:39], s73 offen offset:0 sc1
    v_mfma_f32_16x16x32_bf16 v[84:87], v[56:59], v[180:183], v[84:87]
    v_mfma_f32_16x16x32_bf16 v[88:91], v[56:59], v[236:239], v[88:91]
    buffer_load_dwordx4 v[196:199], v4, s[36:39], s73 offen offset:1024 sc1
    v_mfma_f32_16x16x32_bf16 v[92:95], v[60:63], a[36:39], v[92:95]
    buffer_load_dwordx4 v[248:251], v4, s[36:39], s74 offen offset:0 sc1
    v_mfma_f32_16x16x32_bf16 v[96:99], v[60:63], a[92:95], v[96:99]
    v_mfma_f32_16x16x32_bf16 v[100:103], v[60:63], a[148:151], v[100:103]
    buffer_load_dwordx4 v[252:255], v4, s[36:39], s74 offen offset:1024 sc1
    v_mfma_f32_16x16x32_bf16 v[104:107], v[60:63], a[204:207], v[104:107]
    v_mfma_f32_16x16x32_bf16 v[108:111], v[60:63], v[124:127], v[108:111]
    v_mfma_f32_16x16x32_bf16 v[112:115], v[60:63], v[180:183], v[112:115]
    v_mfma_f32_16x16x32_bf16 v[116:119], v[60:63], v[236:239], v[116:119]
    ds_read_b128 v[56:59], v6 offset:11264
    ds_read_b128 v[60:63], v6 offset:25600
    s_waitcnt lgkmcnt(2)
    v_mfma_f32_16x16x32_bf16 v[64:67], v[48:51], a[40:43], v[64:67]
    v_mfma_f32_16x16x32_bf16 v[68:71], v[48:51], a[96:99], v[68:71]
    v_mfma_f32_16x16x32_bf16 v[72:75], v[48:51], a[152:155], v[72:75]
    v_mfma_f32_16x16x32_bf16 v[76:79], v[48:51], a[208:211], v[76:79]
    v_mfma_f32_16x16x32_bf16 v[80:83], v[48:51], v[128:131], v[80:83]
    v_mfma_f32_16x16x32_bf16 v[84:87], v[48:51], v[184:187], v[84:87]
    v_mfma_f32_16x16x32_bf16 v[88:91], v[48:51], v[240:243], v[88:91]
    v_mfma_f32_16x16x32_bf16 v[92:95], v[52:55], a[40:43], v[92:95]
    v_mfma_f32_16x16x32_bf16 v[96:99], v[52:55], a[96:99], v[96:99]
    v_mfma_f32_16x16x32_bf16 v[100:103], v[52:55], a[152:155], v[100:103]
    v_mfma_f32_16x16x32_bf16 v[104:107], v[52:55], a[208:211], v[104:107]
    v_mfma_f32_16x16x32_bf16 v[108:111], v[52:55], v[128:131], v[108:111]
    v_mfma_f32_16x16x32_bf16 v[112:115], v[52:55], v[184:187], v[112:115]
    v_mfma_f32_16x16x32_bf16 v[116:119], v[52:55], v[240:243], v[116:119]
    s_waitcnt lgkmcnt(0)
    v_mfma_f32_16x16x32_bf16 v[64:67], v[56:59], a[44:47], v[64:67]
    v_mfma_f32_16x16x32_bf16 v[68:71], v[56:59], a[100:103], v[68:71]
    v_mfma_f32_16x16x32_bf16 v[72:75], v[56:59], a[156:159], v[72:75]
    v_mfma_f32_16x16x32_bf16 v[76:79], v[56:59], a[212:215], v[76:79]
    v_mfma_f32_16x16x32_bf16 v[80:83], v[56:59], v[132:135], v[80:83]
    v_mfma_f32_16x16x32_bf16 v[84:87], v[56:59], v[188:191], v[84:87]
    v_mfma_f32_16x16x32_bf16 v[88:91], v[56:59], v[244:247], v[88:91]
    v_mfma_f32_16x16x32_bf16 v[92:95], v[60:63], a[44:47], v[92:95]
    v_mfma_f32_16x16x32_bf16 v[96:99], v[60:63], a[100:103], v[96:99]
    v_mfma_f32_16x16x32_bf16 v[100:103], v[60:63], a[156:159], v[100:103]
    v_mfma_f32_16x16x32_bf16 v[104:107], v[60:63], a[212:215], v[104:107]
    v_mfma_f32_16x16x32_bf16 v[108:111], v[60:63], v[132:135], v[108:111]
    v_mfma_f32_16x16x32_bf16 v[112:115], v[60:63], v[188:191], v[112:115]
    v_mfma_f32_16x16x32_bf16 v[116:119], v[60:63], v[244:247], v[116:119]
    s_waitcnt vmcnt(0)
    ds_read_b128 v[48:51], v6 offset:12288
    ds_read_b128 v[52:55], v6 offset:26624
    ds_read_b128 v[56:59], v6 offset:13312
    ds_read_b128 v[60:63], v6 offset:27648
    s_waitcnt lgkmcnt(2)
    v_mfma_f32_16x16x32_bf16 v[64:67], v[48:51], a[48:51], v[64:67]
    v_mfma_f32_16x16x32_bf16 v[68:71], v[48:51], a[104:107], v[68:71]
    v_mfma_f32_16x16x32_bf16 v[72:75], v[48:51], a[160:163], v[72:75]
    v_mfma_f32_16x16x32_bf16 v[76:79], v[48:51], a[216:219], v[76:79]
    v_mfma_f32_16x16x32_bf16 v[80:83], v[48:51], v[136:139], v[80:83]
    v_mfma_f32_16x16x32_bf16 v[84:87], v[48:51], v[192:195], v[84:87]
    v_mfma_f32_16x16x32_bf16 v[88:91], v[48:51], v[248:251], v[88:91]
    v_mfma_f32_16x16x32_bf16 v[92:95], v[52:55], a[48:51], v[92:95]
    v_mfma_f32_16x16x32_bf16 v[96:99], v[52:55], a[104:107], v[96:99]
    v_mfma_f32_16x16x32_bf16 v[100:103], v[52:55], a[160:163], v[100:103]
    v_mfma_f32_16x16x32_bf16 v[104:107], v[52:55], a[216:219], v[104:107]
    v_mfma_f32_16x16x32_bf16 v[108:111], v[52:55], v[136:139], v[108:111]
    v_mfma_f32_16x16x32_bf16 v[112:115], v[52:55], v[192:195], v[112:115]
    v_mfma_f32_16x16x32_bf16 v[116:119], v[52:55], v[248:251], v[116:119]
    s_waitcnt lgkmcnt(0)
    v_mfma_f32_16x16x32_bf16 v[64:67], v[56:59], a[52:55], v[64:67]
    v_mfma_f32_16x16x32_bf16 v[68:71], v[56:59], a[108:111], v[68:71]
    v_mfma_f32_16x16x32_bf16 v[72:75], v[56:59], a[164:167], v[72:75]
    v_mfma_f32_16x16x32_bf16 v[76:79], v[56:59], a[220:223], v[76:79]
    v_mfma_f32_16x16x32_bf16 v[80:83], v[56:59], v[140:143], v[80:83]
    v_mfma_f32_16x16x32_bf16 v[84:87], v[56:59], v[196:199], v[84:87]
    v_mfma_f32_16x16x32_bf16 v[88:91], v[56:59], v[252:255], v[88:91]
    v_mfma_f32_16x16x32_bf16 v[92:95], v[60:63], a[52:55], v[92:95]
    v_mfma_f32_16x16x32_bf16 v[96:99], v[60:63], a[108:111], v[96:99]
    v_mfma_f32_16x16x32_bf16 v[100:103], v[60:63], a[164:167], v[100:103]
    v_mfma_f32_16x16x32_bf16 v[104:107], v[60:63], a[220:223], v[104:107]
    v_mfma_f32_16x16x32_bf16 v[108:111], v[60:63], v[140:143], v[108:111]
    v_mfma_f32_16x16x32_bf16 v[112:115], v[60:63], v[196:199], v[112:115]
    v_mfma_f32_16x16x32_bf16 v[116:119], v[60:63], v[252:255], v[116:119]
    s_branch KG_vo_epi
KG_vo_loop:
    v_add_u32 v6, s30, v4
    s_add_u32 s52, s30, 57344
    s_sub_u32 s53, s52, 86016
    s_cmp_ge_u32 s52, 86016
    s_cselect_b32 s52, s53, s52
    s_add_u32 s30, s30, 28672
    s_cmp_ge_u32 s30, 86016
    s_cselect_b32 s30, 0, s30
    s_add_u32 s34, s23, 14
    s_mul_i32 s28, s34, 28672
    s_mul_i32 s29, s3, 7168
    s_add_u32 s28, s28, s29
    s_add_u32 s29, s29, s52
    s_mov_b32 m0, s29
    s_nop 0
    buffer_load_dwordx4 v4, s[40:43], s28 offen offset:0 lds
    buffer_load_dwordx4 v4, s[40:43], s28 offen offset:1024 lds
    buffer_load_dwordx4 v4, s[40:43], s28 offen offset:2048 lds
    buffer_load_dwordx4 v4, s[40:43], s28 offen offset:3072 lds
    s_add_u32 s28, s28, 4096
    s_add_u32 s29, s29, 4096
    s_mov_b32 m0, s29
    s_nop 0
    buffer_load_dwordx4 v4, s[40:43], s28 offen offset:0 lds
    buffer_load_dwordx4 v4, s[40:43], s28 offen offset:1024 lds
    buffer_load_dwordx4 v4, s[40:43], s28 offen offset:2048 lds
    ds_read_b128 v[48:51], v6 offset:0
    ds_read_b128 v[52:55], v6 offset:14336
    ds_read_b128 v[56:59], v6 offset:1024
    ds_read_b128 v[60:63], v6 offset:15360
    s_waitcnt lgkmcnt(2)
    v_mfma_f32_16x16x32_bf16 v[64:67], v[48:51], a[0:3], 0
    v_mfma_f32_16x16x32_bf16 v[68:71], v[48:51], a[56:59], 0
    v_mfma_f32_16x16x32_bf16 v[72:75], v[48:51], a[112:115], 0
    v_mfma_f32_16x16x32_bf16 v[76:79], v[48:51], a[168:171], 0
    v_mfma_f32_16x16x32_bf16 v[80:83], v[48:51], a[224:227], 0
    v_mfma_f32_16x16x32_bf16 v[84:87], v[48:51], v[144:147], 0
    v_mfma_f32_16x16x32_bf16 v[88:91], v[48:51], v[200:203], 0
    v_mfma_f32_16x16x32_bf16 v[92:95], v[52:55], a[0:3], 0
    v_mfma_f32_16x16x32_bf16 v[96:99], v[52:55], a[56:59], 0
    v_mfma_f32_16x16x32_bf16 v[100:103], v[52:55], a[112:115], 0
    v_mfma_f32_16x16x32_bf16 v[104:107], v[52:55], a[168:171], 0
    v_mfma_f32_16x16x32_bf16 v[108:111], v[52:55], a[224:227], 0
    v_mfma_f32_16x16x32_bf16 v[112:115], v[52:55], v[144:147], 0
    v_mfma_f32_16x16x32_bf16 v[116:119], v[52:55], v[200:203], 0
    ds_read_b128 v[48:51], v6 offset:2048
    ds_read_b128 v[52:55], v6 offset:16384
    s_waitcnt lgkmcnt(2)
    v_mfma_f32_16x16x32_bf16 v[64:67], v[56:59], a[4:7], v[64:67]
    v_mfma_f32_16x16x32_bf16 v[68:71], v[56:59], a[60:63], v[68:71]
    v_mfma_f32_16x16x32_bf16 v[72:75], v[56:59], a[116:119], v[72:75]
    v_mfma_f32_16x16x32_bf16 v[76:79], v[56:59], a[172:175], v[76:79]
    v_mfma_f32_16x16x32_bf16 v[80:83], v[56:59], a[228:231], v[80:83]
    v_mfma_f32_16x16x32_bf16 v[84:87], v[56:59], v[148:151], v[84:87]
    v_mfma_f32_16x16x32_bf16 v[88:91], v[56:59], v[204:207], v[88:91]
    v_mfma_f32_16x16x32_bf16 v[92:95], v[60:63], a[4:7], v[92:95]
    v_mfma_f32_16x16x32_bf16 v[96:99], v[60:63], a[60:63], v[96:99]
    v_mfma_f32_16x16x32_bf16 v[100:103], v[60:63], a[116:119], v[100:103]
    v_mfma_f32_16x16x32_bf16 v[104:107], v[60:63], a[172:175], v[104:107]
    v_mfma_f32_16x16x32_bf16 v[108:111], v[60:63], a[228:231], v[108:111]
    v_mfma_f32_16x16x32_bf16 v[112:115], v[60:63], v[148:151], v[112:115]
    v_mfma_f32_16x16x32_bf16 v[116:119], v[60:63], v[204:207], v[116:119]
    ds_read_b128 v[56:59], v6 offset:3072
    ds_read_b128 v[60:63], v6 offset:17408
    s_waitcnt lgkmcnt(2)
    v_mfma_f32_16x16x32_bf16 v[64:67], v[48:51], a[8:11], v[64:67]
    v_mfma_f32_16x16x32_bf16 v[68:71], v[48:51], a[64:67], v[68:71]
    v_mfma_f32_16x16x32_bf16 v[72:75], v[48:51], a[120:123], v[72:75]
    v_mfma_f32_16x16x32_bf16 v[76:79], v[48:51], a[176:179], v[76:79]
    v_mfma_f32_16x16x32_bf16 v[80:83], v[48:51], a[232:235], v[80:83]
    v_mfma_f32_16x16x32_bf16 v[84:87], v[48:51], v[152:155], v[84:87]
    v_mfma_f32_16x16x32_bf16 v[88:91], v[48:51], v[208:211], v[88:91]
    v_mfma_f32_16x16x32_bf16 v[92:95], v[52:55], a[8:11], v[92:95]
    v_mfma_f32_16x16x32_bf16 v[96:99], v[52:55], a[64:67], v[96:99]
    v_mfma_f32_16x16x32_bf16 v[100:103], v[52:55], a[120:123], v[100:103]
    v_mfma_f32_16x16x32_bf16 v[104:107], v[52:55], a[176:179], v[104:107]
    v_mfma_f32_16x16x32_bf16 v[108:111], v[52:55], a[232:235], v[108:111]
    v_mfma_f32_16x16x32_bf16 v[112:115], v[52:55], v[152:155], v[112:115]
    v_mfma_f32_16x16x32_bf16 v[116:119], v[52:55], v[208:211], v[116:119]
    ds_read_b128 v[48:51], v6 offset:4096
    ds_read_b128 v[52:55], v6 offset:18432
    s_waitcnt lgkmcnt(2)
    v_mfma_f32_16x16x32_bf16 v[64:67], v[56:59], a[12:15], v[64:67]
    v_mfma_f32_16x16x32_bf16 v[68:71], v[56:59], a[68:71], v[68:71]
    v_mfma_f32_16x16x32_bf16 v[72:75], v[56:59], a[124:127], v[72:75]
    v_mfma_f32_16x16x32_bf16 v[76:79], v[56:59], a[180:183], v[76:79]
    v_mfma_f32_16x16x32_bf16 v[80:83], v[56:59], a[236:239], v[80:83]
    v_mfma_f32_16x16x32_bf16 v[84:87], v[56:59], v[156:159], v[84:87]
    v_mfma_f32_16x16x32_bf16 v[88:91], v[56:59], v[212:215], v[88:91]
    v_mfma_f32_16x16x32_bf16 v[92:95], v[60:63], a[12:15], v[92:95]
    v_mfma_f32_16x16x32_bf16 v[96:99], v[60:63], a[68:71], v[96:99]
    v_mfma_f32_16x16x32_bf16 v[100:103], v[60:63], a[124:127], v[100:103]
    v_mfma_f32_16x16x32_bf16 v[104:107], v[60:63], a[180:183], v[104:107]
    v_mfma_f32_16x16x32_bf16 v[108:111], v[60:63], a[236:239], v[108:111]
    v_mfma_f32_16x16x32_bf16 v[112:115], v[60:63], v[156:159], v[112:115]
    v_mfma_f32_16x16x32_bf16 v[116:119], v[60:63], v[212:215], v[116:119]
    ds_read_b128 v[56:59], v6 offset:5120
    ds_read_b128 v[60:63], v6 offset:19456
    s_waitcnt lgkmcnt(2)
    v_mfma_f32_16x16x32_bf16 v[64:67], v[48:51], a[16:19], v[64:67]
    v_mfma_f32_16x16x32_bf16 v[68:71], v[48:51], a[72:75], v[68:71]
    v_mfma_f32_16x16x32_bf16 v[72:75], v[48:51], a[128:131], v[72:75]
    v_mfma_f32_16x16x32_bf16 v[76:79], v[48:51], a[184:187], v[76:79]
    v_mfma_f32_16x16x32_bf16 v[80:83], v[48:51], a[240:243], v[80:83]
    v_mfma_f32_16x16x32_bf16 v[84:87], v[48:51], v[160:163], v[84:87]
    v_mfma_f32_16x16x32_bf16 v[88:91], v[48:51], v[216:219], v[88:91]
    v_mfma_f32_16x16x32_bf16 v[92:95], v[52:55], a[16:19], v[92:95]
    v_mfma_f32_16x16x32_bf16 v[96:99], v[52:55], a[72:75], v[96:99]
    v_mfma_f32_16x16x32_bf16 v[100:103], v[52:55], a[128:131], v[100:103]
    v_mfma_f32_16x16x32_bf16 v[104:107], v[52:55], a[184:187], v[104:107]
    v_mfma_f32_16x16x32_bf16 v[108:111], v[52:55], a[240:243], v[108:111]
    v_mfma_f32_16x16x32_bf16 v[112:115], v[52:55], v[160:163], v[112:115]
    v_mfma_f32_16x16x32_bf16 v[116:119], v[52:55], v[216:219], v[116:119]
    ds_read_b128 v[48:51], v6 offset:6144
    ds_read_b128 v[52:55], v6 offset:20480
    s_waitcnt lgkmcnt(2)
    v_mfma_f32_16x16x32_bf16 v[64:67], v[56:59], a[20:23], v[64:67]
    v_mfma_f32_16x16x32_bf16 v[68:71], v[56:59], a[76:79], v[68:71]
    v_mfma_f32_16x16x32_bf16 v[72:75], v[56:59], a[132:135], v[72:75]
    v_mfma_f32_16x16x32_bf16 v[76:79], v[56:59], a[188:191], v[76:79]
    v_mfma_f32_16x16x32_bf16 v[80:83], v[56:59], a[244:247], v[80:83]
    v_mfma_f32_16x16x32_bf16 v[84:87], v[56:59], v[164:167], v[84:87]
    v_mfma_f32_16x16x32_bf16 v[88:91], v[56:59], v[220:223], v[88:91]
    v_mfma_f32_16x16x32_bf16 v[92:95], v[60:63], a[20:23], v[92:95]
    v_mfma_f32_16x16x32_bf16 v[96:99], v[60:63], a[76:79], v[96:99]
    v_mfma_f32_16x16x32_bf16 v[100:103], v[60:63], a[132:135], v[100:103]
    v_mfma_f32_16x16x32_bf16 v[104:107], v[60:63], a[188:191], v[104:107]
    v_mfma_f32_16x16x32_bf16 v[108:111], v[60:63], a[244:247], v[108:111]
    v_mfma_f32_16x16x32_bf16 v[112:115], v[60:63], v[164:167], v[112:115]
    v_mfma_f32_16x16x32_bf16 v[116:119], v[60:63], v[220:223], v[116:119]
    ds_read_b128 v[56:59], v6 offset:7168
    ds_read_b128 v[60:63], v6 offset:21504
    s_waitcnt lgkmcnt(2)
    v_mfma_f32_16x16x32_bf16 v[64:67], v[48:51], a[24:27], v[64:67]
    v_mfma_f32_16x16x32_bf16 v[68:71], v[48:51], a[80:83], v[68:71]
    v_mfma_f32_16x16x32_bf16 v[72:75], v[48:51], a[136:139], v[72:75]
    v_mfma_f32_16x16x32_bf16 v[76:79], v[48:51], a[192:195], v[76:79]
    v_mfma_f32_16x16x32_bf16 v[80:83], v[48:51], a[248:251], v[80:83]
    v_mfma_f32_16x16x32_bf16 v[84:87], v[48:51], v[168:171], v[84:87]
    v_mfma_f32_16x16x32_bf16 v[88:91], v[48:51], v[224:227], v[88:91]
    v_mfma_f32_16x16x32_bf16 v[92:95], v[52:55], a[24:27], v[92:95]
    v_mfma_f32_16x16x32_bf16 v[96:99], v[52:55], a[80:83], v[96:99]
    v_mfma_f32_16x16x32_bf16 v[100:103], v[52:55], a[136:139], v[100:103]
    v_mfma_f32_16x16x32_bf16 v[104:107], v[52:55], a[192:195], v[104:107]
    v_mfma_f32_16x16x32_bf16 v[108:111], v[52:55], a[248:251], v[108:111]
    v_mfma_f32_16x16x32_bf16 v[112:115], v[52:55], v[168:171], v[112:115]
    v_mfma_f32_16x16x32_bf16 v[116:119], v[52:55], v[224:227], v[116:119]
    ds_read_b128 v[48:51], v6 offset:8192
    ds_read_b128 v[52:55], v6 offset:22528
    s_waitcnt lgkmcnt(2)
    v_mfma_f32_16x16x32_bf16 v[64:67], v[56:59], a[28:31], v[64:67]
    v_mfma_f32_16x16x32_bf16 v[68:71], v[56:59], a[84:87], v[68:71]
    v_mfma_f32_16x16x32_bf16 v[72:75], v[56:59], a[140:143], v[72:75]
    v_mfma_f32_16x16x32_bf16 v[76:79], v[56:59], a[196:199], v[76:79]
    v_mfma_f32_16x16x32_bf16 v[80:83], v[56:59], a[252:255], v[80:83]
    v_mfma_f32_16x16x32_bf16 v[84:87], v[56:59], v[172:175], v[84:87]
    v_mfma_f32_16x16x32_bf16 v[88:91], v[56:59], v[228:231], v[88:91]
    v_mfma_f32_16x16x32_bf16 v[92:95], v[60:63], a[28:31], v[92:95]
    v_mfma_f32_16x16x32_bf16 v[96:99], v[60:63], a[84:87], v[96:99]
    v_mfma_f32_16x16x32_bf16 v[100:103], v[60:63], a[140:143], v[100:103]
    v_mfma_f32_16x16x32_bf16 v[104:107], v[60:63], a[196:199], v[104:107]
    v_mfma_f32_16x16x32_bf16 v[108:111], v[60:63], a[252:255], v[108:111]
    v_mfma_f32_16x16x32_bf16 v[112:115], v[60:63], v[172:175], v[112:115]
    v_mfma_f32_16x16x32_bf16 v[116:119], v[60:63], v[228:231], v[116:119]
    ds_read_b128 v[56:59], v6 offset:9216
    ds_read_b128 v[60:63], v6 offset:23552
    s_waitcnt lgkmcnt(2)
    v_mfma_f32_16x16x32_bf16 v[64:67], v[48:51], a[32:35], v[64:67]
    v_mfma_f32_16x16x32_bf16 v[68:71], v[48:51], a[88:91], v[68:71]
    v_mfma_f32_16x16x32_bf16 v[72:75], v[48:51], a[144:147], v[72:75]
    v_mfma_f32_16x16x32_bf16 v[76:79], v[48:51], a[200:203], v[76:79]
    v_mfma_f32_16x16x32_bf16 v[80:83], v[48:51], v[120:123], v[80:83]
    v_mfma_f32_16x16x32_bf16 v[84:87], v[48:51], v[176:179], v[84:87]
    v_mfma_f32_16x16x32_bf16 v[88:91], v[48:51], v[232:235], v[88:91]
    v_mfma_f32_16x16x32_bf16 v[92:95], v[52:55], a[32:35], v[92:95]
    v_mfma_f32_16x16x32_bf16 v[96:99], v[52:55], a[88:91], v[96:99]
    v_mfma_f32_16x16x32_bf16 v[100:103], v[52:55], a[144:147], v[100:103]
    v_mfma_f32_16x16x32_bf16 v[104:107], v[52:55], a[200:203], v[104:107]
    v_mfma_f32_16x16x32_bf16 v[108:111], v[52:55], v[120:123], v[108:111]
    v_mfma_f32_16x16x32_bf16 v[112:115], v[52:55], v[176:179], v[112:115]
    v_mfma_f32_16x16x32_bf16 v[116:119], v[52:55], v[232:235], v[116:119]
    ds_read_b128 v[48:51], v6 offset:10240
    ds_read_b128 v[52:55], v6 offset:24576
    s_waitcnt lgkmcnt(2)
    v_mfma_f32_16x16x32_bf16 v[64:67], v[56:59], a[36:39], v[64:67]
    v_mfma_f32_16x16x32_bf16 v[68:71], v[56:59], a[92:95], v[68:71]
    v_mfma_f32_16x16x32_bf16 v[72:75], v[56:59], a[148:151], v[72:75]
    v_mfma_f32_16x16x32_bf16 v[76:79], v[56:59], a[204:207], v[76:79]
    v_mfma_f32_16x16x32_bf16 v[80:83], v[56:59], v[124:127], v[80:83]
    v_mfma_f32_16x16x32_bf16 v[84:87], v[56:59], v[180:183], v[84:87]
    v_mfma_f32_16x16x32_bf16 v[88:91], v[56:59], v[236:239], v[88:91]
    v_mfma_f32_16x16x32_bf16 v[92:95], v[60:63], a[36:39], v[92:95]
    v_mfma_f32_16x16x32_bf16 v[96:99], v[60:63], a[92:95], v[96:99]
    v_mfma_f32_16x16x32_bf16 v[100:103], v[60:63], a[148:151], v[100:103]
    v_mfma_f32_16x16x32_bf16 v[104:107], v[60:63], a[204:207], v[104:107]
    v_mfma_f32_16x16x32_bf16 v[108:111], v[60:63], v[124:127], v[108:111]
    v_mfma_f32_16x16x32_bf16 v[112:115], v[60:63], v[180:183], v[112:115]
    v_mfma_f32_16x16x32_bf16 v[116:119], v[60:63], v[236:239], v[116:119]
    ds_read_b128 v[56:59], v6 offset:11264
    ds_read_b128 v[60:63], v6 offset:25600
    s_waitcnt lgkmcnt(2)
    v_mfma_f32_16x16x32_bf16 v[64:67], v[48:51], a[40:43], v[64:67]
    v_mfma_f32_16x16x32_bf16 v[68:71], v[48:51], a[96:99], v[68:71]
    v_mfma_f32_16x16x32_bf16 v[72:75], v[48:51], a[152:155], v[72:75]
    v_mfma_f32_16x16x32_bf16 v[76:79], v[48:51], a[208:211], v[76:79]
    v_mfma_f32_16x16x32_bf16 v[80:83], v[48:51], v[128:131], v[80:83]
    v_mfma_f32_16x16x32_bf16 v[84:87], v[48:51], v[184:187], v[84:87]
    v_mfma_f32_16x16x32_bf16 v[88:91], v[48:51], v[240:243], v[88:91]
    v_mfma_f32_16x16x32_bf16 v[92:95], v[52:55], a[40:43], v[92:95]
    v_mfma_f32_16x16x32_bf16 v[96:99], v[52:55], a[96:99], v[96:99]
    v_mfma_f32_16x16x32_bf16 v[100:103], v[52:55], a[152:155], v[100:103]
    v_mfma_f32_16x16x32_bf16 v[104:107], v[52:55], a[208:211], v[104:107]
    v_mfma_f32_16x16x32_bf16 v[108:111], v[52:55], v[128:131], v[108:111]
    v_mfma_f32_16x16x32_bf16 v[112:115], v[52:55], v[184:187], v[112:115]
    v_mfma_f32_16x16x32_bf16 v[116:119], v[52:55], v[240:243], v[116:119]
    ds_read_b128 v[48:51], v6 offset:12288
    ds_read_b128 v[52:55], v6 offset:26624
    s_waitcnt lgkmcnt(2)
    v_mfma_f32_16x16x32_bf16 v[64:67], v[56:59], a[44:47], v[64:67]
    v_mfma_f32_16x16x32_bf16 v[68:71], v[56:59], a[100:103], v[68:71]
    v_mfma_f32_16x16x32_bf16 v[72:75], v[56:59], a[156:159], v[72:75]
    v_mfma_f32_16x16x32_bf16 v[76:79], v[56:59], a[212:215], v[76:79]
    v_mfma_f32_16x16x32_bf16 v[80:83], v[56:59], v[132:135], v[80:83]
    v_mfma_f32_16x16x32_bf16 v[84:87], v[56:59], v[188:191], v[84:87]
    v_mfma_f32_16x16x32_bf16 v[88:91], v[56:59], v[244:247], v[88:91]
    v_mfma_f32_16x16x32_bf16 v[92:95], v[60:63], a[44:47], v[92:95]
    v_mfma_f32_16x16x32_bf16 v[96:99], v[60:63], a[100:103], v[96:99]
    v_mfma_f32_16x16x32_bf16 v[100:103], v[60:63], a[156:159], v[100:103]
    v_mfma_f32_16x16x32_bf16 v[104:107], v[60:63], a[212:215], v[104:107]
    v_mfma_f32_16x16x32_bf16 v[108:111], v[60:63], v[132:135], v[108:111]
    v_mfma_f32_16x16x32_bf16 v[112:115], v[60:63], v[188:191], v[112:115]
    v_mfma_f32_16x16x32_bf16 v[116:119], v[60:63], v[244:247], v[116:119]
    ds_read_b128 v[56:59], v6 offset:13312
    ds_read_b128 v[60:63], v6 offset:27648
    s_waitcnt lgkmcnt(2)
    v_mfma_f32_16x16x32_bf16 v[64:67], v[48:51], a[48:51], v[64:67]
    v_mfma_f32_16x16x32_bf16 v[68:71], v[48:51], a[104:107], v[68:71]
    v_mfma_f32_16x16x32_bf16 v[72:75], v[48:51], a[160:163], v[72:75]
    v_mfma_f32_16x16x32_bf16 v[76:79], v[48:51], a[216:219], v[76:79]
    v_mfma_f32_16x16x32_bf16 v[80:83], v[48:51], v[136:139], v[80:83]
    v_mfma_f32_16x16x32_bf16 v[84:87], v[48:51], v[192:195], v[84:87]
    v_mfma_f32_16x16x32_bf16 v[88:91], v[48:51], v[248:251], v[88:91]
    v_mfma_f32_16x16x32_bf16 v[92:95], v[52:55], a[48:51], v[92:95]
    v_mfma_f32_16x16x32_bf16 v[96:99], v[52:55], a[104:107], v[96:99]
    v_mfma_f32_16x16x32_bf16 v[100:103], v[52:55], a[160:163], v[100:103]
    v_mfma_f32_16x16x32_bf16 v[104:107], v[52:55], a[216:219], v[104:107]
    v_mfma_f32_16x16x32_bf16 v[108:111], v[52:55], v[136:139], v[108:111]
    v_mfma_f32_16x16x32_bf16 v[112:115], v[52:55], v[192:195], v[112:115]
    v_mfma_f32_16x16x32_bf16 v[116:119], v[52:55], v[248:251], v[116:119]
    s_waitcnt lgkmcnt(0)
    v_mfma_f32_16x16x32_bf16 v[64:67], v[56:59], a[52:55], v[64:67]
    v_mfma_f32_16x16x32_bf16 v[68:71], v[56:59], a[108:111], v[68:71]
    v_mfma_f32_16x16x32_bf16 v[72:75], v[56:59], a[164:167], v[72:75]
    v_mfma_f32_16x16x32_bf16 v[76:79], v[56:59], a[220:223], v[76:79]
    v_mfma_f32_16x16x32_bf16 v[80:83], v[56:59], v[140:143], v[80:83]
    v_mfma_f32_16x16x32_bf16 v[84:87], v[56:59], v[196:199], v[84:87]
    v_mfma_f32_16x16x32_bf16 v[88:91], v[56:59], v[252:255], v[88:91]
    v_mfma_f32_16x16x32_bf16 v[92:95], v[60:63], a[52:55], v[92:95]
    v_mfma_f32_16x16x32_bf16 v[96:99], v[60:63], a[108:111], v[96:99]
    v_mfma_f32_16x16x32_bf16 v[100:103], v[60:63], a[164:167], v[100:103]
    v_mfma_f32_16x16x32_bf16 v[104:107], v[60:63], a[220:223], v[104:107]
    v_mfma_f32_16x16x32_bf16 v[108:111], v[60:63], v[140:143], v[108:111]
    v_mfma_f32_16x16x32_bf16 v[112:115], v[60:63], v[196:199], v[112:115]
    v_mfma_f32_16x16x32_bf16 v[116:119], v[60:63], v[252:255], v[116:119]
KG_vo_epi:
    s_nop 7
    s_mul_i32 s35, s23, 458752
    s_add_u32 s28, s35, s31
    v_cvt_pk_bf16_f32 v16, v64, v65
    v_cvt_pk_bf16_f32 v17, v66, v67
    v_cvt_pk_bf16_f32 v18, v92, v93
    v_cvt_pk_bf16_f32 v19, v94, v95
    buffer_store_dwordx4 v[16:19], v4, s[44:47], s28 offen sc1
    s_add_u32 s28, s28, 16384
    v_cvt_pk_bf16_f32 v20, v68, v69
    v_cvt_pk_bf16_f32 v21, v70, v71
    v_cvt_pk_bf16_f32 v22, v96, v97
    v_cvt_pk_bf16_f32 v23, v98, v99
    buffer_store_dwordx4 v[20:23], v4, s[44:47], s28 offen sc1
    s_add_u32 s28, s28, 16384
    v_cvt_pk_bf16_f32 v24, v72, v73
    v_cvt_pk_bf16_f32 v25, v74, v75
    v_cvt_pk_bf16_f32 v26, v100, v101
    v_cvt_pk_bf16_f32 v27, v102, v103
    buffer_store_dwordx4 v[24:27], v4, s[44:47], s28 offen sc1
    s_add_u32 s28, s28, 16384
    v_cvt_pk_bf16_f32 v28, v76, v77
    v_cvt_pk_bf16_f32 v29, v78, v79
    v_cvt_pk_bf16_f32 v30, v104, v105
    v_cvt_pk_bf16_f32 v31, v106, v107
    buffer_store_dwordx4 v[28:31], v4, s[44:47], s28 offen sc1
    s_add_u32 s28, s28, 16384
    v_cvt_pk_bf16_f32 v32, v80, v81
    v_cvt_pk_bf16_f32 v33, v82, v83
    v_cvt_pk_bf16_f32 v34, v108, v109
    v_cvt_pk_bf16_f32 v35, v110, v111
    buffer_store_dwordx4 v[32:35], v4, s[44:47], s28 offen sc1
    s_add_u32 s28, s28, 16384
    v_cvt_pk_bf16_f32 v36, v84, v85
    v_cvt_pk_bf16_f32 v37, v86, v87
    v_cvt_pk_bf16_f32 v38, v112, v113
    v_cvt_pk_bf16_f32 v39, v114, v115
    buffer_store_dwordx4 v[36:39], v4, s[44:47], s28 offen sc1
    v_cvt_pk_bf16_f32 v40, v88, v89
    v_cvt_pk_bf16_f32 v41, v90, v91
    v_cvt_pk_bf16_f32 v42, v116, v117
    v_cvt_pk_bf16_f32 v43, v118, v119
    s_add_u32 s28, s35, s32
    buffer_store_dwordx4 v[40:43], v4, s[44:47], s28 offen sc1
    s_waitcnt vmcnt(0)
    s_barrier
    s_lshl_b32 s28, s23, 13
    s_lshl_b32 s29, s22, 7
    s_add_u32 s28, s28, s29
    s_cmp_lg_u32 s3, 0
    s_cbranch_scc1 KG_vo_pf
    v_mov_b32 v6, s96
    v_mov_b32 v7, 0
    s_mov_b64 exec, 1
    buffer_store_dword v6, v7, s[48:51], s28 offen sc1
    s_mov_b64 exec, -1
KG_vo_pf:
    s_add_u32 s23, s23, 7
    s_cmp_ge_u32 s23, 64
    s_cbranch_scc1 KG_done
    s_cmp_lt_u32 s23, 14
    s_cbranch_scc1 KG_vo_loop
    v_mov_b32 v64, 0
    v_mov_b32 v65, 0
    v_mov_b32 v66, 0
    v_mov_b32 v67, 0
    v_mov_b32 v68, 0
    v_mov_b32 v69, 0
    v_mov_b32 v70, 0
    v_mov_b32 v71, 0
    v_mov_b32 v72, 0
    v_mov_b32 v73, 0
    v_mov_b32 v74, 0
    v_mov_b32 v75, 0
    v_mov_b32 v76, 0
    v_mov_b32 v77, 0
    v_mov_b32 v78, 0
    v_mov_b32 v79, 0
    v_mov_b32 v80, 0
    v_mov_b32 v81, 0
    v_mov_b32 v82, 0
    v_mov_b32 v83, 0
    v_mov_b32 v84, 0
    v_mov_b32 v85, 0
    v_mov_b32 v86, 0
    v_mov_b32 v87, 0
    v_mov_b32 v88, 0
    v_mov_b32 v89, 0
    v_mov_b32 v90, 0
    v_mov_b32 v91, 0
    s_lshl_b32 s67, s64, 13
    s_mov_b32 s27, 0
KG_vo_ws_w:
    buffer_load_dword v7, v9, s[48:51], s67 offen sc1
    s_add_u32 s27, s27, 1
    s_cmp_gt_u32 s27, 65536
    s_cbranch_scc1 K3_bail
    s_waitcnt vmcnt(0)
    v_cmp_ne_u32 vcc, s96, v7
    s_cbranch_vccz KG_vo_ws_w_ok
    s_sleep 1
    s_branch KG_vo_ws_w
KG_vo_ws_w_ok:
    s_lshl_b32 s28, s64, 13
    s_add_u32 s29, s28, 4096
    s_mov_b32 s27, 0
    s_mov_b32 s26, 0xffff0000
KG_vo_ws_mp:
    buffer_load_dwordx4 v[16:19], v4, s[56:59], s28 offen offset:0 sc1
    buffer_load_dwordx4 v[20:23], v4, s[56:59], s28 offen offset:1024 sc1
    buffer_load_dwordx4 v[24:27], v4, s[56:59], s28 offen offset:2048 sc1
    buffer_load_dwordx4 v[28:31], v4, s[56:59], s28 offen offset:3072 sc1
    buffer_load_dwordx4 v[32:35], v4, s[56:59], s29 offen offset:0 sc1
    buffer_load_dwordx4 v[36:39], v4, s[56:59], s29 offen offset:1024 sc1
    buffer_load_dwordx4 v[40:43], v4, s[56:59], s29 offen offset:2048 sc1
    s_add_u32 s27, s27, 1
    s_cmp_gt_u32 s27, 65536
    s_cbranch_scc1 K3_bail
    s_waitcnt vmcnt(6)
    v_pk_max_u16 v6, v16, v17
    v_pk_max_u16 v6, v6, v18
    v_pk_max_u16 v6, v6, v19
    s_waitcnt vmcnt(5)
    v_pk_max_u16 v6, v6, v20
    v_pk_max_u16 v6, v6, v21
    v_pk_max_u16 v6, v6, v22
    v_pk_max_u16 v6, v6, v23
    s_waitcnt vmcnt(4)
    v_pk_max_u16 v6, v6, v24
    v_pk_max_u16 v6, v6, v25
    v_pk_max_u16 v6, v6, v26
    v_pk_max_u16 v6, v6, v27
    s_waitcnt vmcnt(3)
    v_pk_max_u16 v6, v6, v28
    v_pk_max_u16 v6, v6, v29
    v_pk_max_u16 v6, v6, v30
    v_pk_max_u16 v6, v6, v31
    s_waitcnt vmcnt(2)
    v_pk_max_u16 v6, v6, v32
    v_pk_max_u16 v6, v6, v33
    v_pk_max_u16 v6, v6, v34
    v_pk_max_u16 v6, v6, v35
    s_waitcnt vmcnt(1)
    v_pk_max_u16 v6, v6, v36
    v_pk_max_u16 v6, v6, v37
    v_pk_max_u16 v6, v6, v38
    v_pk_max_u16 v6, v6, v39
    s_waitcnt vmcnt(0)
    v_pk_max_u16 v6, v6, v40
    v_pk_max_u16 v6, v6, v41
    v_pk_max_u16 v6, v6, v42
    v_pk_max_u16 v6, v6, v43
    v_lshlrev_b32 v7, 16, v6
    v_max_u32 v6, v6, v7
    v_cmp_le_u32 vcc, s26, v6
    s_cbranch_vccnz KG_vo_ws_mp
    v_smfmac_f32_16x16x64_bf16 v[64:67], v[16:19], a[0:7], v8
    v_smfmac_f32_16x16x64_bf16 v[64:67], v[20:23], a[8:15], v8
    v_smfmac_f32_16x16x64_bf16 v[64:67], v[24:27], a[16:23], v8
    v_smfmac_f32_16x16x64_bf16 v[64:67], v[28:31], a[24:31], v8
    v_smfmac_f32_16x16x64_bf16 v[64:67], v[32:35], a[32:39], v8
    v_smfmac_f32_16x16x64_bf16 v[64:67], v[36:39], a[40:47], v8
    v_smfmac_f32_16x16x64_bf16 v[64:67], v[40:43], a[48:55], v8
    v_smfmac_f32_16x16x64_bf16 v[68:71], v[16:19], a[56:63], v8
    v_smfmac_f32_16x16x64_bf16 v[68:71], v[20:23], a[64:71], v8
    v_smfmac_f32_16x16x64_bf16 v[68:71], v[24:27], a[72:79], v8
    v_smfmac_f32_16x16x64_bf16 v[68:71], v[28:31], a[80:87], v8
    v_smfmac_f32_16x16x64_bf16 v[68:71], v[32:35], a[88:95], v8
    v_smfmac_f32_16x16x64_bf16 v[68:71], v[36:39], a[96:103], v8
    v_smfmac_f32_16x16x64_bf16 v[68:71], v[40:43], a[104:111], v8
    v_smfmac_f32_16x16x64_bf16 v[72:75], v[16:19], a[112:119], v8
    v_smfmac_f32_16x16x64_bf16 v[72:75], v[20:23], a[120:127], v8
    v_smfmac_f32_16x16x64_bf16 v[72:75], v[24:27], a[128:135], v8
    v_smfmac_f32_16x16x64_bf16 v[72:75], v[28:31], a[136:143], v8
    v_smfmac_f32_16x16x64_bf16 v[72:75], v[32:35], a[144:151], v8
    v_smfmac_f32_16x16x64_bf16 v[72:75], v[36:39], a[152:159], v8
    v_smfmac_f32_16x16x64_bf16 v[72:75], v[40:43], a[160:167], v8
    v_smfmac_f32_16x16x64_bf16 v[76:79], v[16:19], a[168:175], v8
    v_smfmac_f32_16x16x64_bf16 v[76:79], v[20:23], a[176:183], v8
    v_smfmac_f32_16x16x64_bf16 v[76:79], v[24:27], a[184:191], v8
    v_smfmac_f32_16x16x64_bf16 v[76:79], v[28:31], a[192:199], v8
    v_smfmac_f32_16x16x64_bf16 v[76:79], v[32:35], a[200:207], v8
    v_smfmac_f32_16x16x64_bf16 v[76:79], v[36:39], a[208:215], v8
    v_smfmac_f32_16x16x64_bf16 v[76:79], v[40:43], a[216:223], v8
    v_smfmac_f32_16x16x64_bf16 v[80:83], v[16:19], a[224:231], v8
    v_smfmac_f32_16x16x64_bf16 v[80:83], v[20:23], a[232:239], v8
    v_smfmac_f32_16x16x64_bf16 v[80:83], v[24:27], a[240:247], v8
    v_smfmac_f32_16x16x64_bf16 v[80:83], v[28:31], a[248:255], v8
    v_smfmac_f32_16x16x64_bf16 v[80:83], v[32:35], v[120:127], v8
    v_smfmac_f32_16x16x64_bf16 v[80:83], v[36:39], v[128:135], v8
    v_smfmac_f32_16x16x64_bf16 v[80:83], v[40:43], v[136:143], v8
    v_smfmac_f32_16x16x64_bf16 v[84:87], v[16:19], v[144:151], v8
    v_smfmac_f32_16x16x64_bf16 v[84:87], v[20:23], v[152:159], v8
    v_smfmac_f32_16x16x64_bf16 v[84:87], v[24:27], v[160:167], v8
    v_smfmac_f32_16x16x64_bf16 v[84:87], v[28:31], v[168:175], v8
    v_smfmac_f32_16x16x64_bf16 v[84:87], v[32:35], v[176:183], v8
    v_smfmac_f32_16x16x64_bf16 v[84:87], v[36:39], v[184:191], v8
    v_smfmac_f32_16x16x64_bf16 v[84:87], v[40:43], v[192:199], v8
    v_smfmac_f32_16x16x64_bf16 v[88:91], v[16:19], v[200:207], v8
    v_smfmac_f32_16x16x64_bf16 v[88:91], v[20:23], v[208:215], v8
    v_smfmac_f32_16x16x64_bf16 v[88:91], v[24:27], v[216:223], v8
    v_smfmac_f32_16x16x64_bf16 v[88:91], v[28:31], v[224:231], v8
    v_smfmac_f32_16x16x64_bf16 v[88:91], v[32:35], v[232:239], v8
    v_smfmac_f32_16x16x64_bf16 v[88:91], v[36:39], v[240:247], v8
    v_smfmac_f32_16x16x64_bf16 v[88:91], v[40:43], v[248:255], v8
    s_mul_i32 s28, s64, 114688
    s_add_u32 s29, s28, s66
    s_add_u32 s28, s28, s65
    v_add_f32 v64, v64, v65
    v_add_f32 v66, v66, v67
    v_cvt_pk_bf16_f32 v64, v64, v66
    buffer_store_dword v64, v10, s[60:63], s28 offen sc1
    s_add_u32 s28, s28, 4096
    v_add_f32 v68, v68, v69
    v_add_f32 v70, v70, v71
    v_cvt_pk_bf16_f32 v68, v68, v70
    buffer_store_dword v68, v10, s[60:63], s28 offen sc1
    s_add_u32 s28, s28, 4096
    v_add_f32 v72, v72, v73
    v_add_f32 v74, v74, v75
    v_cvt_pk_bf16_f32 v72, v72, v74
    buffer_store_dword v72, v10, s[60:63], s28 offen sc1
    s_add_u32 s28, s28, 4096
    v_add_f32 v76, v76, v77
    v_add_f32 v78, v78, v79
    v_cvt_pk_bf16_f32 v76, v76, v78
    buffer_store_dword v76, v10, s[60:63], s28 offen sc1
    s_add_u32 s28, s28, 4096
    v_add_f32 v80, v80, v81
    v_add_f32 v82, v82, v83
    v_cvt_pk_bf16_f32 v80, v80, v82
    buffer_store_dword v80, v10, s[60:63], s28 offen sc1
    s_add_u32 s28, s28, 4096
    v_add_f32 v84, v84, v85
    v_add_f32 v86, v86, v87
    v_cvt_pk_bf16_f32 v84, v84, v86
    buffer_store_dword v84, v10, s[60:63], s28 offen sc1
    v_add_f32 v88, v88, v89
    v_add_f32 v90, v90, v91
    v_cvt_pk_bf16_f32 v88, v88, v90
    buffer_store_dword v88, v10, s[60:63], s29 offen sc1
    s_lshl_b32 s28, s25, 7
    s_add_u32 s28, s28, s67
    s_add_u32 s28, s28, 4096
    s_waitcnt vmcnt(0)
    s_barrier
    s_cmp_lg_u32 s3, 0
    s_cbranch_scc1 KG_vo_ws_nf
    v_mov_b32 v6, s96
    v_mov_b32 v7, 0
    s_mov_b64 exec, 1
    buffer_store_dword v6, v7, s[48:51], s28 offen sc1
    s_mov_b64 exec, -1
KG_vo_ws_nf:
    s_add_u32 s64, s64, 7
    s_branch KG_vo_loop
KG_done:
    s_cmp_lt_u32 s22, 16
    s_cbranch_scc1 KM_tasks
KW_loop:
    v_mov_b32 v64, 0
    v_mov_b32 v65, 0
    v_mov_b32 v66, 0
    v_mov_b32 v67, 0
    v_mov_b32 v68, 0
    v_mov_b32 v69, 0
    v_mov_b32 v70, 0
    v_mov_b32 v71, 0
    v_mov_b32 v72, 0
    v_mov_b32 v73, 0
    v_mov_b32 v74, 0
    v_mov_b32 v75, 0
    v_mov_b32 v76, 0
    v_mov_b32 v77, 0
    v_mov_b32 v78, 0
    v_mov_b32 v79, 0
    v_mov_b32 v80, 0
    v_mov_b32 v81, 0
    v_mov_b32 v82, 0
    v_mov_b32 v83, 0
    v_mov_b32 v84, 0
    v_mov_b32 v85, 0
    v_mov_b32 v86, 0
    v_mov_b32 v87, 0
    v_mov_b32 v88, 0
    v_mov_b32 v89, 0
    v_mov_b32 v90, 0
    v_mov_b32 v91, 0
    s_lshl_b32 s67, s64, 13
    s_mov_b32 s27, 0
KW_w:
    buffer_load_dword v7, v9, s[48:51], s67 offen sc1
    s_add_u32 s27, s27, 1
    s_cmp_gt_u32 s27, 65536
    s_cbranch_scc1 K3_bail
    s_waitcnt vmcnt(0)
    v_cmp_ne_u32 vcc, s96, v7
    s_cbranch_vccz KW_w_ok
    s_sleep 1
    s_branch KW_w
KW_w_ok:
    s_lshl_b32 s28, s64, 13
    s_add_u32 s29, s28, 4096
    s_mov_b32 s27, 0
    s_mov_b32 s26, 0xffff0000
KW_mp:
    buffer_load_dwordx4 v[16:19], v4, s[56:59], s28 offen offset:0 sc1
    buffer_load_dwordx4 v[20:23], v4, s[56:59], s28 offen offset:1024 sc1
    buffer_load_dwordx4 v[24:27], v4, s[56:59], s28 offen offset:2048 sc1
    buffer_load_dwordx4 v[28:31], v4, s[56:59], s28 offen offset:3072 sc1
    buffer_load_dwordx4 v[32:35], v4, s[56:59], s29 offen offset:0 sc1
    buffer_load_dwordx4 v[36:39], v4, s[56:59], s29 offen offset:1024 sc1
    buffer_load_dwordx4 v[40:43], v4, s[56:59], s29 offen offset:2048 sc1
    s_add_u32 s27, s27, 1
    s_cmp_gt_u32 s27, 65536
    s_cbranch_scc1 K3_bail
    s_waitcnt vmcnt(6)
    v_pk_max_u16 v6, v16, v17
    v_pk_max_u16 v6, v6, v18
    v_pk_max_u16 v6, v6, v19
    s_waitcnt vmcnt(5)
    v_pk_max_u16 v6, v6, v20
    v_pk_max_u16 v6, v6, v21
    v_pk_max_u16 v6, v6, v22
    v_pk_max_u16 v6, v6, v23
    s_waitcnt vmcnt(4)
    v_pk_max_u16 v6, v6, v24
    v_pk_max_u16 v6, v6, v25
    v_pk_max_u16 v6, v6, v26
    v_pk_max_u16 v6, v6, v27
    s_waitcnt vmcnt(3)
    v_pk_max_u16 v6, v6, v28
    v_pk_max_u16 v6, v6, v29
    v_pk_max_u16 v6, v6, v30
    v_pk_max_u16 v6, v6, v31
    s_waitcnt vmcnt(2)
    v_pk_max_u16 v6, v6, v32
    v_pk_max_u16 v6, v6, v33
    v_pk_max_u16 v6, v6, v34
    v_pk_max_u16 v6, v6, v35
    s_waitcnt vmcnt(1)
    v_pk_max_u16 v6, v6, v36
    v_pk_max_u16 v6, v6, v37
    v_pk_max_u16 v6, v6, v38
    v_pk_max_u16 v6, v6, v39
    s_waitcnt vmcnt(0)
    v_pk_max_u16 v6, v6, v40
    v_pk_max_u16 v6, v6, v41
    v_pk_max_u16 v6, v6, v42
    v_pk_max_u16 v6, v6, v43
    v_lshlrev_b32 v7, 16, v6
    v_max_u32 v6, v6, v7
    v_cmp_le_u32 vcc, s26, v6
    s_cbranch_vccnz KW_mp
    v_smfmac_f32_16x16x64_bf16 v[64:67], v[16:19], a[0:7], v8
    v_smfmac_f32_16x16x64_bf16 v[64:67], v[20:23], a[8:15], v8
    v_smfmac_f32_16x16x64_bf16 v[64:67], v[24:27], a[16:23], v8
    v_smfmac_f32_16x16x64_bf16 v[64:67], v[28:31], a[24:31], v8
    v_smfmac_f32_16x16x64_bf16 v[64:67], v[32:35], a[32:39], v8
    v_smfmac_f32_16x16x64_bf16 v[64:67], v[36:39], a[40:47], v8
    v_smfmac_f32_16x16x64_bf16 v[64:67], v[40:43], a[48:55], v8
    v_smfmac_f32_16x16x64_bf16 v[68:71], v[16:19], a[56:63], v8
    v_smfmac_f32_16x16x64_bf16 v[68:71], v[20:23], a[64:71], v8
    v_smfmac_f32_16x16x64_bf16 v[68:71], v[24:27], a[72:79], v8
    v_smfmac_f32_16x16x64_bf16 v[68:71], v[28:31], a[80:87], v8
    v_smfmac_f32_16x16x64_bf16 v[68:71], v[32:35], a[88:95], v8
    v_smfmac_f32_16x16x64_bf16 v[68:71], v[36:39], a[96:103], v8
    v_smfmac_f32_16x16x64_bf16 v[68:71], v[40:43], a[104:111], v8
    v_smfmac_f32_16x16x64_bf16 v[72:75], v[16:19], a[112:119], v8
    v_smfmac_f32_16x16x64_bf16 v[72:75], v[20:23], a[120:127], v8
    v_smfmac_f32_16x16x64_bf16 v[72:75], v[24:27], a[128:135], v8
    v_smfmac_f32_16x16x64_bf16 v[72:75], v[28:31], a[136:143], v8
    v_smfmac_f32_16x16x64_bf16 v[72:75], v[32:35], a[144:151], v8
    v_smfmac_f32_16x16x64_bf16 v[72:75], v[36:39], a[152:159], v8
    v_smfmac_f32_16x16x64_bf16 v[72:75], v[40:43], a[160:167], v8
    v_smfmac_f32_16x16x64_bf16 v[76:79], v[16:19], a[168:175], v8
    v_smfmac_f32_16x16x64_bf16 v[76:79], v[20:23], a[176:183], v8
    v_smfmac_f32_16x16x64_bf16 v[76:79], v[24:27], a[184:191], v8
    v_smfmac_f32_16x16x64_bf16 v[76:79], v[28:31], a[192:199], v8
    v_smfmac_f32_16x16x64_bf16 v[76:79], v[32:35], a[200:207], v8
    v_smfmac_f32_16x16x64_bf16 v[76:79], v[36:39], a[208:215], v8
    v_smfmac_f32_16x16x64_bf16 v[76:79], v[40:43], a[216:223], v8
    v_smfmac_f32_16x16x64_bf16 v[80:83], v[16:19], a[224:231], v8
    v_smfmac_f32_16x16x64_bf16 v[80:83], v[20:23], a[232:239], v8
    v_smfmac_f32_16x16x64_bf16 v[80:83], v[24:27], a[240:247], v8
    v_smfmac_f32_16x16x64_bf16 v[80:83], v[28:31], a[248:255], v8
    v_smfmac_f32_16x16x64_bf16 v[80:83], v[32:35], v[120:127], v8
    v_smfmac_f32_16x16x64_bf16 v[80:83], v[36:39], v[128:135], v8
    v_smfmac_f32_16x16x64_bf16 v[80:83], v[40:43], v[136:143], v8
    v_smfmac_f32_16x16x64_bf16 v[84:87], v[16:19], v[144:151], v8
    v_smfmac_f32_16x16x64_bf16 v[84:87], v[20:23], v[152:159], v8
    v_smfmac_f32_16x16x64_bf16 v[84:87], v[24:27], v[160:167], v8
    v_smfmac_f32_16x16x64_bf16 v[84:87], v[28:31], v[168:175], v8
    v_smfmac_f32_16x16x64_bf16 v[84:87], v[32:35], v[176:183], v8
    v_smfmac_f32_16x16x64_bf16 v[84:87], v[36:39], v[184:191], v8
    v_smfmac_f32_16x16x64_bf16 v[84:87], v[40:43], v[192:199], v8
    v_smfmac_f32_16x16x64_bf16 v[88:91], v[16:19], v[200:207], v8
    v_smfmac_f32_16x16x64_bf16 v[88:91], v[20:23], v[208:215], v8
    v_smfmac_f32_16x16x64_bf16 v[88:91], v[24:27], v[216:223], v8
    v_smfmac_f32_16x16x64_bf16 v[88:91], v[28:31], v[224:231], v8
    v_smfmac_f32_16x16x64_bf16 v[88:91], v[32:35], v[232:239], v8
    v_smfmac_f32_16x16x64_bf16 v[88:91], v[36:39], v[240:247], v8
    v_smfmac_f32_16x16x64_bf16 v[88:91], v[40:43], v[248:255], v8
    s_mul_i32 s28, s64, 114688
    s_add_u32 s29, s28, s66
    s_add_u32 s28, s28, s65
    v_add_f32 v64, v64, v65
    v_add_f32 v66, v66, v67
    v_cvt_pk_bf16_f32 v64, v64, v66
    buffer_store_dword v64, v10, s[60:63], s28 offen sc1
    s_add_u32 s28, s28, 4096
    v_add_f32 v68, v68, v69
    v_add_f32 v70, v70, v71
    v_cvt_pk_bf16_f32 v68, v68, v70
    buffer_store_dword v68, v10, s[60:63], s28 offen sc1
    s_add_u32 s28, s28, 4096
    v_add_f32 v72, v72, v73
    v_add_f32 v74, v74, v75
    v_cvt_pk_bf16_f32 v72, v72, v74
    buffer_store_dword v72, v10, s[60:63], s28 offen sc1
    s_add_u32 s28, s28, 4096
    v_add_f32 v76, v76, v77
    v_add_f32 v78, v78, v79
    v_cvt_pk_bf16_f32 v76, v76, v78
    buffer_store_dword v76, v10, s[60:63], s28 offen sc1
    s_add_u32 s28, s28, 4096
    v_add_f32 v80, v80, v81
    v_add_f32 v82, v82, v83
    v_cvt_pk_bf16_f32 v80, v80, v82
    buffer_store_dword v80, v10, s[60:63], s28 offen sc1
    s_add_u32 s28, s28, 4096
    v_add_f32 v84, v84, v85
    v_add_f32 v86, v86, v87
    v_cvt_pk_bf16_f32 v84, v84, v86
    buffer_store_dword v84, v10, s[60:63], s28 offen sc1
    v_add_f32 v88, v88, v89
    v_add_f32 v90, v90, v91
    v_cvt_pk_bf16_f32 v88, v88, v90
    buffer_store_dword v88, v10, s[60:63], s29 offen sc1
    s_lshl_b32 s28, s25, 7
    s_add_u32 s28, s28, s67
    s_add_u32 s28, s28, 4096
    s_waitcnt vmcnt(0)
    s_barrier
    s_cmp_lg_u32 s3, 0
    s_cbranch_scc1 KW_nf
    v_mov_b32 v6, s96
    v_mov_b32 v7, 0
    s_mov_b64 exec, 1
    buffer_store_dword v6, v7, s[48:51], s28 offen sc1
    s_mov_b64 exec, -1
KW_nf:
    s_add_u32 s64, s64, 7
    s_cmp_lt_u32 s64, 64
    s_cbranch_scc1 KW_loop
    s_branch KM_end
KM_tasks:
    s_add_u32 s36, s18, 0x5000000
    s_addc_u32 s37, s19, 0
    s_mov_b32 s38, 0x280000
    s_mov_b32 s39, 0x20000
    s_add_u32 s40, s18, 0x3400000
    s_addc_u32 s41, s19, 0
    s_mov_b32 s42, 0x1c00000
    s_mov_b32 s43, 0x20000
    s_add_u32 s44, s18, 0x5400000
    s_addc_u32 s45, s19, 0
    s_mov_b32 s46, 0x700000
    s_mov_b32 s47, 0x20000
    s_mov_b32 s48, s4
    s_mov_b32 s49, s5
    s_mov_b32 s50, 0x1c0000
    s_mov_b32 s51, 0x20000
    s_add_u32 s52, s18, 0x200000
    s_addc_u32 s53, s19, 0
    s_mov_b32 s54, 0x1c0000
    s_mov_b32 s55, 0x20000
    s_add_u32 s56, s18, 0x410000
    s_addc_u32 s57, s19, 0
    s_mov_b32 s58, 0x62000
    s_mov_b32 s59, 0x20000
    s_add_u32 s60, s18, 0x480000
    s_addc_u32 s61, s19, 0
    s_mov_b32 s62, 0x20
    s_mov_b32 s63, 0x20000
    s_add_u32 s64, s18, 0x400000
    s_addc_u32 s65, s19, 0
    s_mov_b32 s66, 0x2000
    s_mov_b32 s67, 0x20000
    s_mov_b32 s68, s6
    s_mov_b32 s69, s7
    s_mov_b32 s70, 0x1c0000
    s_mov_b32 s71, 0x20000
    s_add_u32 s36, s18, 0x5000000
    s_addc_u32 s37, s19, 0
    s_mov_b32 s38, 0x280000
    s_mov_b32 s39, 0x20000
    s_add_u32 s72, s18, 0x1800000
    s_addc_u32 s73, s19, 0
    s_mov_b32 s74, 0x1c00000
    s_mov_b32 s75, 0x20000
    s_add_u32 s76, s18, 0x200000
    s_addc_u32 s77, s19, 0
    s_mov_b32 s78, 0x1c0000
    s_mov_b32 s79, 0x20000
    s_add_u32 s80, s18, 0x5c00000
    s_addc_u32 s81, s19, 0
    s_mov_b32 s82, 0x80000
    s_mov_b32 s83, 0x20000
    s_add_u32 s92, s18, 0x5d00000
    s_addc_u32 s93, s19, 0
    s_mov_b32 s94, 0xb8000
    s_mov_b32 s95, 0x20000
    v_lshlrev_b32 v4, 4, v1
KM_next:
    s_mul_i32 s22, s20, 5958
    s_lshr_b32 s22, s22, 16
    s_mul_i32 s23, s22, 11
    s_sub_u32 s23, s20, s23
    s_barrier
    s_cmp_ge_u32 s23, 4
    s_cbranch_scc1 KM_g
    s_mul_i32 s28, s22, 28672
    s_mul_i32 s29, s3, 7168
    s_add_u32 s28, s28, s29
    s_mov_b32 m0, s29
    s_nop 0
    buffer_load_dwordx4 v4, s[76:79], s28 offen offset:0 lds
    buffer_load_dwordx4 v4, s[76:79], s28 offen offset:1024 lds
    buffer_load_dwordx4 v4, s[76:79], s28 offen offset:2048 lds
    buffer_load_dwordx4 v4, s[76:79], s28 offen offset:3072 lds
    s_add_u32 s28, s28, 4096
    s_add_u32 m0, m0, 4096
    s_nop 0
    buffer_load_dwordx4 v4, s[76:79], s28 offen offset:0 lds
    buffer_load_dwordx4 v4, s[76:79], s28 offen offset:1024 lds
    buffer_load_dwordx4 v4, s[76:79], s28 offen offset:2048 lds
    s_lshl_b32 s24, s23, 2
    s_add_u32 s24, s24, s3
    s_mul_i32 s28, s22, 458752
    s_mul_i32 s29, s24, 28672
    s_add_u32 s28, s28, s29
    s_lshl_b32 s33, s22, 13
    s_lshl_b32 s29, s24, 7
    v_mov_b32 v6, s29
    s_mov_b32 s27, 0
KX_wt:
    buffer_load_dword v7, v6, s[92:95], s33 offen sc1
    s_add_u32 s27, s27, 1
    s_cmp_gt_u32 s27, 65536
    s_cbranch_scc1 K3_bail
    s_waitcnt vmcnt(0)
    v_cmp_ne_u32 vcc, s96, v7
    s_cbranch_vccz KX_wt_ok
    s_sleep 6
    s_branch KX_wt
KX_wt_ok:
    s_add_u32 s29, s28, 0
    buffer_load_dwordx4 v[16:19], v4, s[72:75], s29 offen offset:0 sc1
    s_add_u32 s29, s28, 14336
    buffer_load_dwordx4 v[72:75], v4, s[72:75], s29 offen offset:0 sc1
    s_add_u32 s29, s28, 0
    buffer_load_dwordx4 v[20:23], v4, s[72:75], s29 offen offset:1024 sc1
    s_add_u32 s29, s28, 14336
    buffer_load_dwordx4 v[76:79], v4, s[72:75], s29 offen offset:1024 sc1
    s_add_u32 s29, s28, 0
    buffer_load_dwordx4 v[24:27], v4, s[72:75], s29 offen offset:2048 sc1
    s_add_u32 s29, s28, 14336
    buffer_load_dwordx4 v[80:83], v4, s[72:75], s29 offen offset:2048 sc1
    s_add_u32 s29, s28, 0
    buffer_load_dwordx4 v[28:31], v4, s[72:75], s29 offen offset:3072 sc1
    s_add_u32 s29, s28, 14336
    buffer_load_dwordx4 v[84:87], v4, s[72:75], s29 offen offset:3072 sc1
    s_add_u32 s29, s28, 4096
    buffer_load_dwordx4 v[32:35], v4, s[72:75], s29 offen offset:0 sc1
    s_add_u32 s29, s28, 18432
    buffer_load_dwordx4 v[88:91], v4, s[72:75], s29 offen offset:0 sc1
    s_add_u32 s29, s28, 4096
    buffer_load_dwordx4 v[36:39], v4, s[72:75], s29 offen offset:1024 sc1
    s_add_u32 s29, s28, 18432
    buffer_load_dwordx4 v[92:95], v4, s[72:75], s29 offen offset:1024 sc1
    s_add_u32 s29, s28, 4096
    buffer_load_dwordx4 v[40:43], v4, s[72:75], s29 offen offset:2048 sc1
    s_add_u32 s29, s28, 18432
    buffer_load_dwordx4 v[96:99], v4, s[72:75], s29 offen offset:2048 sc1
    s_add_u32 s29, s28, 4096
    buffer_load_dwordx4 v[44:47], v4, s[72:75], s29 offen offset:3072 sc1
    s_add_u32 s29, s28, 18432
    buffer_load_dwordx4 v[100:103], v4, s[72:75], s29 offen offset:3072 sc1
    s_add_u32 s29, s28, 8192
    buffer_load_dwordx4 v[48:51], v4, s[72:75], s29 offen offset:0 sc1
    s_add_u32 s29, s28, 22528
    buffer_load_dwordx4 v[104:107], v4, s[72:75], s29 offen offset:0 sc1
    s_add_u32 s29, s28, 8192
    buffer_load_dwordx4 v[52:55], v4, s[72:75], s29 offen offset:1024 sc1
    s_add_u32 s29, s28, 22528
    buffer_load_dwordx4 v[108:111], v4, s[72:75], s29 offen offset:1024 sc1
    s_add_u32 s29, s28, 8192
    buffer_load_dwordx4 v[56:59], v4, s[72:75], s29 offen offset:2048 sc1
    s_add_u32 s29, s28, 22528
    buffer_load_dwordx4 v[112:115], v4, s[72:75], s29 offen offset:2048 sc1
    s_add_u32 s29, s28, 8192
    buffer_load_dwordx4 v[60:63], v4, s[72:75], s29 offen offset:3072 sc1
    s_add_u32 s29, s28, 22528
    buffer_load_dwordx4 v[116:119], v4, s[72:75], s29 offen offset:3072 sc1
    s_add_u32 s29, s28, 12288
    buffer_load_dwordx4 v[64:67], v4, s[72:75], s29 offen offset:0 sc1
    s_add_u32 s29, s28, 26624
    buffer_load_dwordx4 v[120:123], v4, s[72:75], s29 offen offset:0 sc1
    s_add_u32 s29, s28, 12288
    buffer_load_dwordx4 v[68:71], v4, s[72:75], s29 offen offset:1024 sc1
    s_add_u32 s29, s28, 26624
    buffer_load_dwordx4 v[124:127], v4, s[72:75], s29 offen offset:1024 sc1
    v_lshlrev_b32 v5, 2, v3
    v_add_u32 v6, 0, v5
    v_cmp_le_u32 s[84:85], v6, v2
    v_add_u32 v6, 1, v5
    v_cmp_le_u32 s[86:87], v6, v2
    v_add_u32 v6, 2, v5
    v_cmp_le_u32 s[88:89], v6, v2
    v_add_u32 v6, 3, v5
    v_cmp_le_u32 s[90:91], v6, v2
    v_and_b32 v6, 1, v2
    v_cmp_eq_u32 vcc, 1, v6
    v_mov_b32 v7, 0x4444
    v_mov_b32 v6, 0xeeee
    v_cndmask_b32 v7, v7, v6, vcc
    s_waitcnt vmcnt(28)
    s_barrier
    ds_read_b128 v[128:131], v4 offset:0
    ds_read_b128 v[132:135], v4 offset:14336
    ds_read_b128 v[136:139], v4 offset:1024
    ds_read_b128 v[140:143], v4 offset:15360
    ds_read_b128 v[144:147], v4 offset:2048
    ds_read_b128 v[148:151], v4 offset:16384
    ds_read_b128 v[152:155], v4 offset:3072
    ds_read_b128 v[156:159], v4 offset:17408
    s_waitcnt vmcnt(26) lgkmcnt(6)
    v_mfma_f32_16x16x32_bf16 v[160:163], v[128:131], v[16:19], 0
    v_mfma_f32_16x16x32_bf16 v[168:171], v[128:131], v[72:75], 0
    v_mfma_f32_16x16x32_bf16 v[164:167], v[132:135], v[72:75], 0
    ds_read_b128 v[128:131], v4 offset:4096
    ds_read_b128 v[132:135], v4 offset:18432
    s_waitcnt vmcnt(24) lgkmcnt(6)
    v_mfma_f32_16x16x32_bf16 v[160:163], v[136:139], v[20:23], v[160:163]
    v_mfma_f32_16x16x32_bf16 v[168:171], v[136:139], v[76:79], v[168:171]
    v_mfma_f32_16x16x32_bf16 v[164:167], v[140:143], v[76:79], v[164:167]
    ds_read_b128 v[136:139], v4 offset:5120
    ds_read_b128 v[140:143], v4 offset:19456
    s_waitcnt vmcnt(22) lgkmcnt(6)
    v_mfma_f32_16x16x32_bf16 v[160:163], v[144:147], v[24:27], v[160:163]
    v_mfma_f32_16x16x32_bf16 v[168:171], v[144:147], v[80:83], v[168:171]
    v_mfma_f32_16x16x32_bf16 v[164:167], v[148:151], v[80:83], v[164:167]
    ds_read_b128 v[144:147], v4 offset:6144
    ds_read_b128 v[148:151], v4 offset:20480
    s_waitcnt vmcnt(20) lgkmcnt(6)
    v_mfma_f32_16x16x32_bf16 v[160:163], v[152:155], v[28:31], v[160:163]
    v_mfma_f32_16x16x32_bf16 v[168:171], v[152:155], v[84:87], v[168:171]
    v_mfma_f32_16x16x32_bf16 v[164:167], v[156:159], v[84:87], v[164:167]
    ds_read_b128 v[152:155], v4 offset:7168
    ds_read_b128 v[156:159], v4 offset:21504
    s_waitcnt vmcnt(18) lgkmcnt(6)
    v_mfma_f32_16x16x32_bf16 v[160:163], v[128:131], v[32:35], v[160:163]
    v_mfma_f32_16x16x32_bf16 v[168:171], v[128:131], v[88:91], v[168:171]
    v_mfma_f32_16x16x32_bf16 v[164:167], v[132:135], v[88:91], v[164:167]
    ds_read_b128 v[128:131], v4 offset:8192
    ds_read_b128 v[132:135], v4 offset:22528
    s_waitcnt vmcnt(16) lgkmcnt(6)
    v_mfma_f32_16x16x32_bf16 v[160:163], v[136:139], v[36:39], v[160:163]
    v_mfma_f32_16x16x32_bf16 v[168:171], v[136:139], v[92:95], v[168:171]
    v_mfma_f32_16x16x32_bf16 v[164:167], v[140:143], v[92:95], v[164:167]
    ds_read_b128 v[136:139], v4 offset:9216
    ds_read_b128 v[140:143], v4 offset:23552
    s_waitcnt vmcnt(14) lgkmcnt(6)
    v_mfma_f32_16x16x32_bf16 v[160:163], v[144:147], v[40:43], v[160:163]
    v_mfma_f32_16x16x32_bf16 v[168:171], v[144:147], v[96:99], v[168:171]
    v_mfma_f32_16x16x32_bf16 v[164:167], v[148:151], v[96:99], v[164:167]
    ds_read_b128 v[144:147], v4 offset:10240
    ds_read_b128 v[148:151], v4 offset:24576
    s_waitcnt vmcnt(12) lgkmcnt(6)
    v_mfma_f32_16x16x32_bf16 v[160:163], v[152:155], v[44:47], v[160:163]
    v_mfma_f32_16x16x32_bf16 v[168:171], v[152:155], v[100:103], v[168:171]
    v_mfma_f32_16x16x32_bf16 v[164:167], v[156:159], v[100:103], v[164:167]
    ds_read_b128 v[152:155], v4 offset:11264
    ds_read_b128 v[156:159], v4 offset:25600
    s_waitcnt vmcnt(10) lgkmcnt(6)
    v_mfma_f32_16x16x32_bf16 v[160:163], v[128:131], v[48:51], v[160:163]
    v_mfma_f32_16x16x32_bf16 v[168:171], v[128:131], v[104:107], v[168:171]
    v_mfma_f32_16x16x32_bf16 v[164:167], v[132:135], v[104:107], v[164:167]
    ds_read_b128 v[128:131], v4 offset:12288
    ds_read_b128 v[132:135], v4 offset:26624
    s_waitcnt vmcnt(8) lgkmcnt(6)
    v_mfma_f32_16x16x32_bf16 v[160:163], v[136:139], v[52:55], v[160:163]
    v_mfma_f32_16x16x32_bf16 v[168:171], v[136:139], v[108:111], v[168:171]
    v_mfma_f32_16x16x32_bf16 v[164:167], v[140:143], v[108:111], v[164:167]
    ds_read_b128 v[136:139], v4 offset:13312
    ds_read_b128 v[140:143], v4 offset:27648
    s_waitcnt vmcnt(6) lgkmcnt(6)
    v_mfma_f32_16x16x32_bf16 v[160:163], v[144:147], v[56:59], v[160:163]
    v_mfma_f32_16x16x32_bf16 v[168:171], v[144:147], v[112:115], v[168:171]
    v_mfma_f32_16x16x32_bf16 v[164:167], v[148:151], v[112:115], v[164:167]
    s_waitcnt vmcnt(4) lgkmcnt(4)
    v_mfma_f32_16x16x32_bf16 v[160:163], v[152:155], v[60:63], v[160:163]
    v_mfma_f32_16x16x32_bf16 v[168:171], v[152:155], v[116:119], v[168:171]
    v_mfma_f32_16x16x32_bf16 v[164:167], v[156:159], v[116:119], v[164:167]
    s_waitcnt vmcnt(2) lgkmcnt(2)
    v_mfma_f32_16x16x32_bf16 v[160:163], v[128:131], v[64:67], v[160:163]
    v_mfma_f32_16x16x32_bf16 v[168:171], v[128:131], v[120:123], v[168:171]
    v_mfma_f32_16x16x32_bf16 v[164:167], v[132:135], v[120:123], v[164:167]
    s_waitcnt vmcnt(0) lgkmcnt(0)
    v_mfma_f32_16x16x32_bf16 v[160:163], v[136:139], v[68:71], v[160:163]
    v_mfma_f32_16x16x32_bf16 v[168:171], v[136:139], v[124:127], v[168:171]
    v_mfma_f32_16x16x32_bf16 v[164:167], v[140:143], v[124:127], v[164:167]
    v_mov_b32 v172, 0
    v_mov_b32 v173, 0
    v_mov_b32 v174, 0
    v_mov_b32 v175, 0
    v_mov_b32 v176, 0
    v_mov_b32 v177, 0
    v_mov_b32 v178, 0
    v_mov_b32 v179, 0
    v_mov_b32 v6, 0xff800000
    v_cndmask_b32 v160, v6, v160, s[84:85]
    v_cndmask_b32 v161, v6, v161, s[86:87]
    v_cndmask_b32 v162, v6, v162, s[88:89]
    v_cndmask_b32 v163, v6, v163, s[90:91]
    v_cndmask_b32 v164, v6, v164, s[84:85]
    v_cndmask_b32 v165, v6, v165, s[86:87]
    v_cndmask_b32 v166, v6, v166, s[88:89]
    v_cndmask_b32 v167, v6, v167, s[90:91]
    v_mov_b32 v6, 6144
    s_mov_b32 s27, 0
KX_wm:
    buffer_load_dword v9, v6, s[92:95], s33 offen sc1
    s_add_u32 s27, s27, 1
    s_cmp_gt_u32 s27, 65536
    s_cbranch_scc1 K3_bail
    s_waitcnt vmcnt(0)
    v_cmp_ne_u32 vcc, s96, v9
    s_cbranch_vccz KX_wm_ok
    s_sleep 1
    s_branch KX_wm
KX_wm_ok:
    s_lshl_b32 s28, s22, 13
    s_add_u32 s29, s28, 4096
    s_mov_b32 s27, 0
    s_mov_b32 s26, 0xffff0000
KX_mp:
    buffer_load_dwordx4 v[128:131], v4, s[80:83], s28 offen offset:0 sc1
    buffer_load_dwordx4 v[132:135], v4, s[80:83], s28 offen offset:1024 sc1
    buffer_load_dwordx4 v[136:139], v4, s[80:83], s28 offen offset:2048 sc1
    buffer_load_dwordx4 v[140:143], v4, s[80:83], s28 offen offset:3072 sc1
    buffer_load_dwordx4 v[144:147], v4, s[80:83], s29 offen offset:0 sc1
    buffer_load_dwordx4 v[148:151], v4, s[80:83], s29 offen offset:1024 sc1
    buffer_load_dwordx4 v[152:155], v4, s[80:83], s29 offen offset:2048 sc1
    s_add_u32 s27, s27, 1
    s_cmp_gt_u32 s27, 65536
    s_cbranch_scc1 K3_bail
    s_waitcnt vmcnt(6)
    v_pk_max_u16 v9, v128, v129
    v_pk_max_u16 v9, v9, v130
    v_pk_max_u16 v9, v9, v131
    s_waitcnt vmcnt(5)
    v_pk_max_u16 v9, v9, v132
    v_pk_max_u16 v9, v9, v133
    v_pk_max_u16 v9, v9, v134
    v_pk_max_u16 v9, v9, v135
    s_waitcnt vmcnt(4)
    v_pk_max_u16 v9, v9, v136
    v_pk_max_u16 v9, v9, v137
    v_pk_max_u16 v9, v9, v138
    v_pk_max_u16 v9, v9, v139
    s_waitcnt vmcnt(3)
    v_pk_max_u16 v9, v9, v140
    v_pk_max_u16 v9, v9, v141
    v_pk_max_u16 v9, v9, v142
    v_pk_max_u16 v9, v9, v143
    s_waitcnt vmcnt(2)
    v_pk_max_u16 v9, v9, v144
    v_pk_max_u16 v9, v9, v145
    v_pk_max_u16 v9, v9, v146
    v_pk_max_u16 v9, v9, v147
    s_waitcnt vmcnt(1)
    v_pk_max_u16 v9, v9, v148
    v_pk_max_u16 v9, v9, v149
    v_pk_max_u16 v9, v9, v150
    v_pk_max_u16 v9, v9, v151
    s_waitcnt vmcnt(0)
    v_pk_max_u16 v9, v9, v152
    v_pk_max_u16 v9, v9, v153
    v_pk_max_u16 v9, v9, v154
    v_pk_max_u16 v9, v9, v155
    v_lshlrev_b32 v10, 16, v9
    v_max_u32 v9, v9, v10
    v_cmp_le_u32 vcc, s26, v9
    s_cbranch_vccnz KX_mp
    v_smfmac_f32_16x16x64_bf16 v[172:175], v[128:131], v[16:23], v7
    v_smfmac_f32_16x16x64_bf16 v[176:179], v[128:131], v[72:79], v7
    v_smfmac_f32_16x16x64_bf16 v[172:175], v[132:135], v[24:31], v7
    v_smfmac_f32_16x16x64_bf16 v[176:179], v[132:135], v[80:87], v7
    v_smfmac_f32_16x16x64_bf16 v[172:175], v[136:139], v[32:39], v7
    v_smfmac_f32_16x16x64_bf16 v[176:179], v[136:139], v[88:95], v7
    v_smfmac_f32_16x16x64_bf16 v[172:175], v[140:143], v[40:47], v7
    v_smfmac_f32_16x16x64_bf16 v[176:179], v[140:143], v[96:103], v7
    v_smfmac_f32_16x16x64_bf16 v[172:175], v[144:147], v[48:55], v7
    v_smfmac_f32_16x16x64_bf16 v[176:179], v[144:147], v[104:111], v7
    v_smfmac_f32_16x16x64_bf16 v[172:175], v[148:151], v[56:63], v7
    v_smfmac_f32_16x16x64_bf16 v[176:179], v[148:151], v[112:119], v7
    v_smfmac_f32_16x16x64_bf16 v[172:175], v[152:155], v[64:71], v7
    v_smfmac_f32_16x16x64_bf16 v[176:179], v[152:155], v[120:127], v7
    s_mul_i32 s28, s22, 40960
    s_lshl_b32 s29, s24, 10
    s_add_u32 s29, s29, s28
    s_add_u32 s30, s23, 16
    s_lshl_b32 s30, s30, 10
    s_add_u32 s30, s30, s28
    s_lshl_b32 s31, s3, 2
    v_add_u32 v8, s31, v4
    v_add_f32 v172, v172, v173
    v_add_f32 v173, v174, v175
    v_max3_f32 v180, v172, v173, v160
    v_max3_f32 v180, v180, v161, v162
    v_max_f32 v180, v180, v163
    v_mov_b32 v182, v180
    s_nop 1
    v_permlane16_swap_b32 v180, v182
    v_max_f32 v180, v180, v182
    v_mov_b32 v182, v180
    s_nop 1
    v_permlane32_swap_b32 v180, v182
    v_max_f32 v180, v180, v182
    v_pk_add_f32 v[172:173], v[172:173], v[180:181] op_sel_hi:[1,0] neg_lo:[0,1] neg_hi:[0,1]
    v_pk_add_f32 v[160:161], v[160:161], v[180:181] op_sel_hi:[1,0] neg_lo:[0,1] neg_hi:[0,1]
    v_pk_add_f32 v[162:163], v[162:163], v[180:181] op_sel_hi:[1,0] neg_lo:[0,1] neg_hi:[0,1]
    v_exp_f32 v172, v172
    v_exp_f32 v173, v173
    v_exp_f32 v160, v160
    v_exp_f32 v161, v161
    v_exp_f32 v162, v162
    v_exp_f32 v163, v163
    v_pk_add_f32 v[184:185], v[172:173], v[160:161]
    v_pk_add_f32 v[184:185], v[184:185], v[162:163]
    v_add_f32 v184, v184, v185
    v_mov_b32 v182, v184
    s_nop 1
    v_permlane16_swap_b32 v184, v182
    v_add_f32 v184, v184, v182
    v_mov_b32 v182, v184
    s_nop 1
    v_permlane32_swap_b32 v184, v182
    v_add_f32 v184, v184, v182
    v_rcp_f32 v184, v184
    s_nop 0
    v_pk_mul_f32 v[172:173], v[172:173], v[184:185] op_sel_hi:[1,0]
    v_pk_mul_f32 v[160:161], v[160:161], v[184:185] op_sel_hi:[1,0]
    v_pk_mul_f32 v[162:163], v[162:163], v[184:185] op_sel_hi:[1,0]
    v_cvt_pk_bf16_f32 v188, v160, v161
    v_cvt_pk_bf16_f32 v189, v162, v163
    v_mov_b32 v190, 0
    v_mov_b32 v191, 0
    v_cvt_pk_bf16_f32 v192, v172, v173
    buffer_store_dwordx4 v[188:191], v4, s[36:39], s29 offen sc1
    buffer_store_dword v192, v8, s[36:39], s30 offen sc1
    s_add_u32 s29, s29, 20480
    s_add_u32 s30, s30, 20480
    v_add_f32 v176, v176, v177
    v_add_f32 v177, v178, v179
    v_max3_f32 v180, v176, v177, v164
    v_max3_f32 v180, v180, v165, v166
    v_max_f32 v180, v180, v167
    v_max3_f32 v180, v180, v168, v169
    v_max3_f32 v180, v180, v170, v171
    v_mov_b32 v182, v180
    s_nop 1
    v_permlane16_swap_b32 v180, v182
    v_max_f32 v180, v180, v182
    v_mov_b32 v182, v180
    s_nop 1
    v_permlane32_swap_b32 v180, v182
    v_max_f32 v180, v180, v182
    v_pk_add_f32 v[176:177], v[176:177], v[180:181] op_sel_hi:[1,0] neg_lo:[0,1] neg_hi:[0,1]
    v_pk_add_f32 v[164:165], v[164:165], v[180:181] op_sel_hi:[1,0] neg_lo:[0,1] neg_hi:[0,1]
    v_pk_add_f32 v[166:167], v[166:167], v[180:181] op_sel_hi:[1,0] neg_lo:[0,1] neg_hi:[0,1]
    v_pk_add_f32 v[168:169], v[168:169], v[180:181] op_sel_hi:[1,0] neg_lo:[0,1] neg_hi:[0,1]
    v_pk_add_f32 v[170:171], v[170:171], v[180:181] op_sel_hi:[1,0] neg_lo:[0,1] neg_hi:[0,1]
    v_exp_f32 v176, v176
    v_exp_f32 v177, v177
    v_exp_f32 v164, v164
    v_exp_f32 v165, v165
    v_exp_f32 v166, v166
    v_exp_f32 v167, v167
    v_exp_f32 v168, v168
    v_exp_f32 v169, v169
    v_exp_f32 v170, v170
    v_exp_f32 v171, v171
    v_pk_add_f32 v[184:185], v[176:177], v[164:165]
    v_pk_add_f32 v[184:185], v[184:185], v[166:167]
    v_pk_add_f32 v[184:185], v[184:185], v[168:169]
    v_pk_add_f32 v[184:185], v[184:185], v[170:171]
    v_add_f32 v184, v184, v185
    v_mov_b32 v182, v184
    s_nop 1
    v_permlane16_swap_b32 v184, v182
    v_add_f32 v184, v184, v182
    v_mov_b32 v182, v184
    s_nop 1
    v_permlane32_swap_b32 v184, v182
    v_add_f32 v184, v184, v182
    v_rcp_f32 v184, v184
    s_nop 0
    v_pk_mul_f32 v[176:177], v[176:177], v[184:185] op_sel_hi:[1,0]
    v_pk_mul_f32 v[164:165], v[164:165], v[184:185] op_sel_hi:[1,0]
    v_pk_mul_f32 v[166:167], v[166:167], v[184:185] op_sel_hi:[1,0]
    v_pk_mul_f32 v[168:169], v[168:169], v[184:185] op_sel_hi:[1,0]
    v_pk_mul_f32 v[170:171], v[170:171], v[184:185] op_sel_hi:[1,0]
    v_cvt_pk_bf16_f32 v196, v168, v169
    v_cvt_pk_bf16_f32 v197, v170, v171
    v_cvt_pk_bf16_f32 v198, v164, v165
    v_cvt_pk_bf16_f32 v199, v166, v167
    v_cvt_pk_bf16_f32 v200, v176, v177
    buffer_store_dwordx4 v[196:199], v4, s[36:39], s29 offen sc1
    buffer_store_dword v200, v8, s[36:39], s30 offen sc1
    s_waitcnt vmcnt(0)
    s_barrier
    s_lshl_b32 s28, s23, 7
    s_add_u32 s28, s28, s33
    s_add_u32 s28, s28, 7680
    s_cmp_lg_u32 s3, 0
    s_cbranch_scc1 KX_nofl
    v_mov_b32 v6, s96
    v_mov_b32 v7, 0
    s_mov_b64 exec, 1
    buffer_store_dword v6, v7, s[92:95], s28 offen sc1
    s_mov_b64 exec, -1
KX_nofl:
    s_branch KM_adv
KM_g:
    s_sub_u32 s23, s23, 4
    s_lshl_b32 s24, s23, 2
    s_add_u32 s24, s24, s3
    s_lshl_b32 s33, s22, 13
    v_min_u32 v6, 15, v1
    v_lshlrev_b32 v6, 7, v6
    v_add_u32 v6, 2048, v6
    s_mov_b32 s27, 0
K4_wv:
    buffer_load_dword v7, v6, s[92:95], s33 offen sc1
    s_add_u32 s27, s27, 1
    s_cmp_gt_u32 s27, 65536
    s_cbranch_scc1 K3_bail
    s_waitcnt vmcnt(0)
    v_cmp_ne_u32 vcc, s96, v7
    s_cbranch_vccz K4_wv_ok
    s_sleep 6
    s_branch K4_wv
K4_wv_ok:
    s_mul_i32 s28, s22, 458752
    s_lshl_b32 s29, s24, 14
    s_add_u32 s28, s28, s29
    buffer_load_dwordx4 v[16:19], v4, s[40:43], s28 offen offset:0 sc1
    buffer_load_dwordx4 v[20:23], v4, s[40:43], s28 offen offset:1024 sc1
    buffer_load_dwordx4 v[24:27], v4, s[40:43], s28 offen offset:2048 sc1
    buffer_load_dwordx4 v[28:31], v4, s[40:43], s28 offen offset:3072 sc1
    s_add_u32 s28, s28, 4096
    buffer_load_dwordx4 v[32:35], v4, s[40:43], s28 offen offset:0 sc1
    buffer_load_dwordx4 v[36:39], v4, s[40:43], s28 offen offset:1024 sc1
    buffer_load_dwordx4 v[40:43], v4, s[40:43], s28 offen offset:2048 sc1
    buffer_load_dwordx4 v[44:47], v4, s[40:43], s28 offen offset:3072 sc1
    s_add_u32 s28, s28, 4096
    buffer_load_dwordx4 v[48:51], v4, s[40:43], s28 offen offset:0 sc1
    buffer_load_dwordx4 v[52:55], v4, s[40:43], s28 offen offset:1024 sc1
    buffer_load_dwordx4 v[56:59], v4, s[40:43], s28 offen offset:2048 sc1
    buffer_load_dwordx4 v[60:63], v4, s[40:43], s28 offen offset:3072 sc1
    s_add_u32 s28, s28, 4096
    buffer_load_dwordx4 v[64:67], v4, s[40:43], s28 offen offset:0 sc1
    buffer_load_dwordx4 v[68:71], v4, s[40:43], s28 offen offset:1024 sc1
    buffer_load_dwordx4 v[72:75], v4, s[40:43], s28 offen offset:2048 sc1
    buffer_load_dwordx4 v[76:79], v4, s[40:43], s28 offen offset:3072 sc1
    v_mul_u32_u24 v5, 896, v2
    v_lshl_add_u32 v5, v3, 3, v5
    s_mul_i32 s30, s22, 28672
    s_lshl_b32 s29, s24, 5
    s_add_u32 s30, s30, s29
    s_add_u32 s31, s30, 14336
    v_lshrrev_b32 v6, 1, v3
    v_lshlrev_b32 v6, 8, v6
    v_lshl_add_u32 v6, v2, 4, v6
    v_and_b32 v7, 1, v3
    v_lshl_add_u32 v6, v7, 3, v6
    s_mul_i32 s28, s22, 28672
    s_lshl_b32 s29, s24, 9
    s_add_u32 s28, s28, s29
    s_add_u32 s29, s28, 14336
    buffer_load_dwordx2 v[96:97], v5, s[48:51], s30 offen
    buffer_load_dwordx2 v[100:101], v6, s[52:55], s28 offen
    buffer_load_dwordx2 v[98:99], v5, s[48:51], s31 offen
    buffer_load_dwordx2 v[102:103], v6, s[52:55], s29 offen
    v_mov_b32 v104, 0
    v_mov_b32 v105, 0
    v_mov_b32 v106, 0
    v_mov_b32 v107, 0
    v_mov_b32 v108, 0
    v_mov_b32 v109, 0
    v_mov_b32 v110, 0
    v_mov_b32 v111, 0
    v_min_u32 v6, 27, v1
    v_lshlrev_b32 v6, 7, v6
    s_mov_b32 s28, 524288
    s_mov_b32 s27, 0
K4_wm:
    buffer_load_dword v7, v6, s[92:95], s28 offen sc1
    s_add_u32 s27, s27, 1
    s_cmp_gt_u32 s27, 65536
    s_cbranch_scc1 K3_bail
    s_waitcnt vmcnt(0)
    v_cmp_ne_u32 vcc, s96, v7
    s_cbranch_vccz K4_wm_ok
    s_sleep 6
    s_branch K4_wm
K4_wm_ok:
    v_lshlrev_b32 v6, 2, v1
    buffer_load_dword v13, v6, s[60:63], 0 offen sc1
    v_min_u32 v6, 19, v1
    v_lshlrev_b32 v6, 7, v6
    v_add_u32 v7, 5632, v6
    v_add_u32 v6, 4096, v6
    v_cmp_lt_u32 vcc, 15, v1
    s_nop 1
    v_cndmask_b32 v6, v6, v7, vcc
    s_waitcnt vmcnt(0)
    s_mov_b32 s26, 0xffff0000
    s_mov_b32 s32, 0
    s_lshl_b32 s28, s22, 5
    v_add_u32 v8, s28, v2
    v_add_u32 v9, 16, v8
    v_lshlrev_b32 v10, 4, v3
    s_nop 1
K4_moe:
    s_nop 3
    v_readlane_b32 s34, v13, s32
    s_nop 3
    s_lshr_b32 s35, s34, 5
    s_cmp_lg_u32 s35, s22
    s_cbranch_scc1 K4_moen
    s_mul_i32 s28, s32, 1792
    s_lshl_b32 s29, s24, 6
    s_add_u32 s28, s28, s29
    s_lshl_b32 s29, s34, 2
    v_mov_b32 v11, s29
    buffer_load_dword v12, v11, s[64:67], 0 offen
    buffer_load_dwordx4 v[112:115], v10, s[56:59], s28 offen sc1
    s_add_u32 s28, s28, 14336
    buffer_load_dwordx4 v[116:119], v10, s[56:59], s28 offen sc1
    s_add_u32 s28, s28, 14336
    buffer_load_dwordx4 v[120:123], v10, s[56:59], s28 offen sc1
    s_add_u32 s28, s28, 14336
    buffer_load_dwordx4 v[124:127], v10, s[56:59], s28 offen sc1
    s_add_u32 s28, s28, 14336
    buffer_load_dwordx4 v[128:131], v10, s[56:59], s28 offen sc1
    s_add_u32 s28, s28, 14336
    buffer_load_dwordx4 v[132:135], v10, s[56:59], s28 offen sc1
    s_add_u32 s28, s28, 14336
    buffer_load_dwordx4 v[136:139], v10, s[56:59], s28 offen sc1
    s_add_u32 s28, s28, 14336
    buffer_load_dwordx4 v[140:143], v10, s[56:59], s28 offen sc1
    s_add_u32 s28, s28, 14336
    buffer_load_dwordx4 v[144:147], v10, s[56:59], s28 offen sc1
    s_add_u32 s28, s28, 14336
    buffer_load_dwordx4 v[148:151], v10, s[56:59], s28 offen sc1
    s_add_u32 s28, s28, 14336
    buffer_load_dwordx4 v[152:155], v10, s[56:59], s28 offen sc1
    s_add_u32 s28, s28, 14336
    buffer_load_dwordx4 v[156:159], v10, s[56:59], s28 offen sc1
    s_add_u32 s28, s28, 14336
    buffer_load_dwordx4 v[160:163], v10, s[56:59], s28 offen sc1
    s_add_u32 s28, s28, 14336
    buffer_load_dwordx4 v[164:167], v10, s[56:59], s28 offen sc1
    s_add_u32 s28, s28, 14336
    buffer_load_dwordx4 v[168:171], v10, s[56:59], s28 offen sc1
    s_add_u32 s28, s28, 14336
    buffer_load_dwordx4 v[172:175], v10, s[56:59], s28 offen sc1
    s_add_u32 s28, s28, 14336
    buffer_load_dwordx4 v[176:179], v10, s[56:59], s28 offen sc1
    s_add_u32 s28, s28, 14336
    buffer_load_dwordx4 v[180:183], v10, s[56:59], s28 offen sc1
    s_add_u32 s28, s28, 14336
    buffer_load_dwordx4 v[184:187], v10, s[56:59], s28 offen sc1
    s_add_u32 s28, s28, 14336
    buffer_load_dwordx4 v[188:191], v10, s[56:59], s28 offen sc1
    s_add_u32 s28, s28, 14336
    buffer_load_dwordx4 v[192:195], v10, s[56:59], s28 offen sc1
    s_add_u32 s28, s28, 14336
    buffer_load_dwordx4 v[196:199], v10, s[56:59], s28 offen sc1
    s_add_u32 s28, s28, 14336
    buffer_load_dwordx4 v[200:203], v10, s[56:59], s28 offen sc1
    s_add_u32 s28, s28, 14336
    buffer_load_dwordx4 v[204:207], v10, s[56:59], s28 offen sc1
    s_add_u32 s28, s28, 14336
    buffer_load_dwordx4 v[208:211], v10, s[56:59], s28 offen sc1
    s_add_u32 s28, s28, 14336
    buffer_load_dwordx4 v[212:215], v10, s[56:59], s28 offen sc1
    s_add_u32 s28, s28, 14336
    buffer_load_dwordx4 v[216:219], v10, s[56:59], s28 offen sc1
    s_add_u32 s28, s28, 14336
    buffer_load_dwordx4 v[220:223], v10, s[56:59], s28 offen sc1
    s_add_u32 s28, s28, 14336
    s_waitcnt vmcnt(0)
    v_pk_add_f32 v[112:113], v[112:113], v[116:117]
    v_pk_add_f32 v[114:115], v[114:115], v[118:119]
    v_pk_add_f32 v[112:113], v[112:113], v[120:121]
    v_pk_add_f32 v[114:115], v[114:115], v[122:123]
    v_pk_add_f32 v[112:113], v[112:113], v[124:125]
    v_pk_add_f32 v[114:115], v[114:115], v[126:127]
    v_pk_add_f32 v[112:113], v[112:113], v[128:129]
    v_pk_add_f32 v[114:115], v[114:115], v[130:131]
    v_pk_add_f32 v[112:113], v[112:113], v[132:133]
    v_pk_add_f32 v[114:115], v[114:115], v[134:135]
    v_pk_add_f32 v[112:113], v[112:113], v[136:137]
    v_pk_add_f32 v[114:115], v[114:115], v[138:139]
    v_pk_add_f32 v[112:113], v[112:113], v[140:141]
    v_pk_add_f32 v[114:115], v[114:115], v[142:143]
    v_pk_add_f32 v[112:113], v[112:113], v[144:145]
    v_pk_add_f32 v[114:115], v[114:115], v[146:147]
    v_pk_add_f32 v[112:113], v[112:113], v[148:149]
    v_pk_add_f32 v[114:115], v[114:115], v[150:151]
    v_pk_add_f32 v[112:113], v[112:113], v[152:153]
    v_pk_add_f32 v[114:115], v[114:115], v[154:155]
    v_pk_add_f32 v[112:113], v[112:113], v[156:157]
    v_pk_add_f32 v[114:115], v[114:115], v[158:159]
    v_pk_add_f32 v[112:113], v[112:113], v[160:161]
    v_pk_add_f32 v[114:115], v[114:115], v[162:163]
    v_pk_add_f32 v[112:113], v[112:113], v[164:165]
    v_pk_add_f32 v[114:115], v[114:115], v[166:167]
    v_pk_add_f32 v[112:113], v[112:113], v[168:169]
    v_pk_add_f32 v[114:115], v[114:115], v[170:171]
    v_pk_add_f32 v[112:113], v[112:113], v[172:173]
    v_pk_add_f32 v[114:115], v[114:115], v[174:175]
    v_pk_add_f32 v[112:113], v[112:113], v[176:177]
    v_pk_add_f32 v[114:115], v[114:115], v[178:179]
    v_pk_add_f32 v[112:113], v[112:113], v[180:181]
    v_pk_add_f32 v[114:115], v[114:115], v[182:183]
    v_pk_add_f32 v[112:113], v[112:113], v[184:185]
    v_pk_add_f32 v[114:115], v[114:115], v[186:187]
    v_pk_add_f32 v[112:113], v[112:113], v[188:189]
    v_pk_add_f32 v[114:115], v[114:115], v[190:191]
    v_pk_add_f32 v[112:113], v[112:113], v[192:193]
    v_pk_add_f32 v[114:115], v[114:115], v[194:195]
    v_pk_add_f32 v[112:113], v[112:113], v[196:197]
    v_pk_add_f32 v[114:115], v[114:115], v[198:199]
    v_pk_add_f32 v[112:113], v[112:113], v[200:201]
    v_pk_add_f32 v[114:115], v[114:115], v[202:203]
    v_pk_add_f32 v[112:113], v[112:113], v[204:205]
    v_pk_add_f32 v[114:115], v[114:115], v[206:207]
    v_pk_add_f32 v[112:113], v[112:113], v[208:209]
    v_pk_add_f32 v[114:115], v[114:115], v[210:211]
    v_pk_add_f32 v[112:113], v[112:113], v[212:213]
    v_pk_add_f32 v[114:115], v[114:115], v[214:215]
    v_pk_add_f32 v[112:113], v[112:113], v[216:217]
    v_pk_add_f32 v[114:115], v[114:115], v[218:219]
    v_pk_add_f32 v[112:113], v[112:113], v[220:221]
    v_pk_add_f32 v[114:115], v[114:115], v[222:223]
    v_mul_f32 v12, 0x3fb8aa3b, v12
    v_exp_f32 v12, -v12
    v_cvt_pk_bf16_f32 v112, v112, v113
    v_add_f32 v12, 1.0, v12
    v_rcp_f32 v12, v12
    v_cvt_pk_bf16_f32 v114, v114, v115
    v_cvt_pk_bf16_f32 v12, v12, v12
    v_and_b32 v12, s26, v12
    v_and_b32 v113, s26, v112
    v_lshlrev_b32 v112, 16, v112
    v_and_b32 v115, s26, v114
    v_lshlrev_b32 v114, 16, v114
    v_mul_f32 v112, v112, v12
    v_mul_f32 v113, v113, v12
    v_mul_f32 v114, v114, v12
    v_mul_f32 v115, v115, v12
    v_cvt_pk_bf16_f32 v112, v112, v113
    v_cvt_pk_bf16_f32 v114, v114, v115
    v_and_b32 v113, s26, v112
    v_lshlrev_b32 v112, 16, v112
    v_and_b32 v115, s26, v114
    v_lshlrev_b32 v114, 16, v114
    v_cmp_eq_u32 vcc, s34, v8
    s_nop 1
    v_cndmask_b32 v104, v104, v112, vcc
    v_cndmask_b32 v105, v105, v113, vcc
    v_cndmask_b32 v106, v106, v114, vcc
    v_cndmask_b32 v107, v107, v115, vcc
    v_cmp_eq_u32 vcc, s34, v9
    s_nop 1
    v_cndmask_b32 v108, v108, v112, vcc
    v_cndmask_b32 v109, v109, v113, vcc
    v_cndmask_b32 v110, v110, v114, vcc
    v_cndmask_b32 v111, v111, v115, vcc
    s_nop 1
K4_moen:
    s_add_u32 s32, s32, 1
    s_cmp_lt_u32 s32, 8
    s_cbranch_scc1 K4_moe
    s_mov_b32 s27, 0
K4_wp:
    buffer_load_dword v7, v6, s[92:95], s33 offen sc1
    s_add_u32 s27, s27, 1
    s_cmp_gt_u32 s27, 65536
    s_cbranch_scc1 K3_bail
    s_waitcnt vmcnt(0)
    v_cmp_ne_u32 vcc, s96, v7
    s_cbranch_vccz K4_wp_ok
    s_sleep 1
    s_branch K4_wp
K4_wp_ok:
    s_mul_i32 s28, s22, 40960
    s_mul_i32 s29, s3, 10240
    s_add_u32 s28, s28, s29
    s_mov_b32 m0, s29
    s_nop 0
    buffer_load_dwordx4 v4, s[36:39], s28 offen offset:0 sc1 lds
    buffer_load_dwordx4 v4, s[36:39], s28 offen offset:1024 sc1 lds
    buffer_load_dwordx4 v4, s[36:39], s28 offen offset:2048 sc1 lds
    buffer_load_dwordx4 v4, s[36:39], s28 offen offset:3072 sc1 lds
    s_add_u32 s28, s28, 4096
    s_add_u32 m0, m0, 4096
    s_nop 0
    buffer_load_dwordx4 v4, s[36:39], s28 offen offset:0 sc1 lds
    buffer_load_dwordx4 v4, s[36:39], s28 offen offset:1024 sc1 lds
    buffer_load_dwordx4 v4, s[36:39], s28 offen offset:2048 sc1 lds
    buffer_load_dwordx4 v4, s[36:39], s28 offen offset:3072 sc1 lds
    s_add_u32 s28, s28, 4096
    s_add_u32 m0, m0, 4096
    s_nop 0
    buffer_load_dwordx4 v4, s[36:39], s28 offen offset:0 sc1 lds
    buffer_load_dwordx4 v4, s[36:39], s28 offen offset:1024 sc1 lds
    s_mul_i32 s28, s22, 114688
    s_lshl_b32 s29, s24, 12
    s_add_u32 s28, s28, s29
    v_lshlrev_b32 v6, 2, v1
    buffer_load_dword v80, v6, s[44:47], s28 offen offset:0 sc1
    buffer_load_dword v81, v6, s[44:47], s28 offen offset:256 sc1
    buffer_load_dword v82, v6, s[44:47], s28 offen offset:512 sc1
    buffer_load_dword v83, v6, s[44:47], s28 offen offset:768 sc1
    buffer_load_dword v84, v6, s[44:47], s28 offen offset:1024 sc1
    buffer_load_dword v85, v6, s[44:47], s28 offen offset:1280 sc1
    buffer_load_dword v86, v6, s[44:47], s28 offen offset:1536 sc1
    buffer_load_dword v87, v6, s[44:47], s28 offen offset:1792 sc1
    buffer_load_dword v88, v6, s[44:47], s28 offen offset:2048 sc1
    buffer_load_dword v89, v6, s[44:47], s28 offen offset:2304 sc1
    buffer_load_dword v90, v6, s[44:47], s28 offen offset:2560 sc1
    buffer_load_dword v91, v6, s[44:47], s28 offen offset:2816 sc1
    buffer_load_dword v92, v6, s[44:47], s28 offen offset:3072 sc1
    buffer_load_dword v93, v6, s[44:47], s28 offen offset:3328 sc1
    buffer_load_dword v94, v6, s[44:47], s28 offen offset:3584 sc1
    buffer_load_dword v95, v6, s[44:47], s28 offen offset:3840 sc1
    s_waitcnt vmcnt(16)
    s_barrier
    ds_read_b128 v[232:235], v4 offset:0
    ds_read_b128 v[236:239], v4 offset:20480
    ds_read_b128 v[240:243], v4 offset:1024
    ds_read_b128 v[244:247], v4 offset:21504
    ds_read_b128 v[248:251], v4 offset:2048
    ds_read_b128 v[252:255], v4 offset:22528
    s_waitcnt vmcnt(16) lgkmcnt(4)
    v_mfma_f32_16x16x32_bf16 v[224:227], v[16:19], v[232:235], 0
    v_mfma_f32_16x16x32_bf16 v[228:231], v[16:19], v[236:239], 0
    ds_read_b128 v[232:235], v4 offset:3072
    ds_read_b128 v[236:239], v4 offset:23552
    s_waitcnt vmcnt(16) lgkmcnt(4)
    v_mfma_f32_16x16x32_bf16 v[224:227], v[20:23], v[240:243], v[224:227]
    v_mfma_f32_16x16x32_bf16 v[228:231], v[20:23], v[244:247], v[228:231]
    ds_read_b128 v[240:243], v4 offset:4096
    ds_read_b128 v[244:247], v4 offset:24576
    s_waitcnt vmcnt(16) lgkmcnt(4)
    v_mfma_f32_16x16x32_bf16 v[224:227], v[24:27], v[248:251], v[224:227]
    v_mfma_f32_16x16x32_bf16 v[228:231], v[24:27], v[252:255], v[228:231]
    ds_read_b128 v[248:251], v4 offset:5120
    ds_read_b128 v[252:255], v4 offset:25600
    s_waitcnt vmcnt(16) lgkmcnt(4)
    v_mfma_f32_16x16x32_bf16 v[224:227], v[28:31], v[232:235], v[224:227]
    v_mfma_f32_16x16x32_bf16 v[228:231], v[28:31], v[236:239], v[228:231]
    ds_read_b128 v[232:235], v4 offset:6144
    ds_read_b128 v[236:239], v4 offset:26624
    s_waitcnt vmcnt(16) lgkmcnt(4)
    v_mfma_f32_16x16x32_bf16 v[224:227], v[32:35], v[240:243], v[224:227]
    v_mfma_f32_16x16x32_bf16 v[228:231], v[32:35], v[244:247], v[228:231]
    ds_read_b128 v[240:243], v4 offset:7168
    ds_read_b128 v[244:247], v4 offset:27648
    s_waitcnt vmcnt(16) lgkmcnt(4)
    v_mfma_f32_16x16x32_bf16 v[224:227], v[36:39], v[248:251], v[224:227]
    v_mfma_f32_16x16x32_bf16 v[228:231], v[36:39], v[252:255], v[228:231]
    ds_read_b128 v[248:251], v4 offset:8192
    ds_read_b128 v[252:255], v4 offset:28672
    s_waitcnt vmcnt(16) lgkmcnt(4)
    v_mfma_f32_16x16x32_bf16 v[224:227], v[40:43], v[232:235], v[224:227]
    v_mfma_f32_16x16x32_bf16 v[228:231], v[40:43], v[236:239], v[228:231]
    ds_read_b128 v[232:235], v4 offset:9216
    ds_read_b128 v[236:239], v4 offset:29696
    s_waitcnt vmcnt(16) lgkmcnt(4)
    v_mfma_f32_16x16x32_bf16 v[224:227], v[44:47], v[240:243], v[224:227]
    v_mfma_f32_16x16x32_bf16 v[228:231], v[44:47], v[244:247], v[228:231]
    ds_read_b128 v[240:243], v4 offset:10240
    ds_read_b128 v[244:247], v4 offset:30720
    s_waitcnt vmcnt(16) lgkmcnt(4)
    v_mfma_f32_16x16x32_bf16 v[224:227], v[48:51], v[248:251], v[224:227]
    v_mfma_f32_16x16x32_bf16 v[228:231], v[48:51], v[252:255], v[228:231]
    ds_read_b128 v[248:251], v4 offset:11264
    ds_read_b128 v[252:255], v4 offset:31744
    s_waitcnt vmcnt(16) lgkmcnt(4)
    v_mfma_f32_16x16x32_bf16 v[224:227], v[52:55], v[232:235], v[224:227]
    v_mfma_f32_16x16x32_bf16 v[228:231], v[52:55], v[236:239], v[228:231]
    ds_read_b128 v[232:235], v4 offset:12288
    ds_read_b128 v[236:239], v4 offset:32768
    s_waitcnt vmcnt(16) lgkmcnt(4)
    v_mfma_f32_16x16x32_bf16 v[224:227], v[56:59], v[240:243], v[224:227]
    v_mfma_f32_16x16x32_bf16 v[228:231], v[56:59], v[244:247], v[228:231]
    ds_read_b128 v[240:243], v4 offset:13312
    ds_read_b128 v[244:247], v4 offset:33792
    s_waitcnt vmcnt(16) lgkmcnt(4)
    v_mfma_f32_16x16x32_bf16 v[224:227], v[60:63], v[248:251], v[224:227]
    v_mfma_f32_16x16x32_bf16 v[228:231], v[60:63], v[252:255], v[228:231]
    ds_read_b128 v[248:251], v4 offset:14336
    ds_read_b128 v[252:255], v4 offset:34816
    s_waitcnt vmcnt(16) lgkmcnt(4)
    v_mfma_f32_16x16x32_bf16 v[224:227], v[64:67], v[232:235], v[224:227]
    v_mfma_f32_16x16x32_bf16 v[228:231], v[64:67], v[236:239], v[228:231]
    ds_read_b128 v[232:235], v4 offset:15360
    ds_read_b128 v[236:239], v4 offset:35840
    s_waitcnt vmcnt(16) lgkmcnt(4)
    v_mfma_f32_16x16x32_bf16 v[224:227], v[68:71], v[240:243], v[224:227]
    v_mfma_f32_16x16x32_bf16 v[228:231], v[68:71], v[244:247], v[228:231]
    ds_read_b128 v[240:243], v4 offset:16384
    ds_read_b128 v[244:247], v4 offset:36864
    s_waitcnt vmcnt(16) lgkmcnt(4)
    v_mfma_f32_16x16x32_bf16 v[224:227], v[72:75], v[248:251], v[224:227]
    v_mfma_f32_16x16x32_bf16 v[228:231], v[72:75], v[252:255], v[228:231]
    ds_read_b128 v[248:251], v4 offset:17408
    ds_read_b128 v[252:255], v4 offset:37888
    s_waitcnt vmcnt(16) lgkmcnt(4)
    v_mfma_f32_16x16x32_bf16 v[224:227], v[76:79], v[232:235], v[224:227]
    v_mfma_f32_16x16x32_bf16 v[228:231], v[76:79], v[236:239], v[228:231]
    ds_read_b128 v[232:235], v4 offset:18432
    ds_read_b128 v[236:239], v4 offset:38912
    s_waitcnt vmcnt(12) lgkmcnt(4)
    v_mfma_f32_16x16x32_bf16 v[224:227], v[80:83], v[240:243], v[224:227]
    v_mfma_f32_16x16x32_bf16 v[228:231], v[80:83], v[244:247], v[228:231]
    ds_read_b128 v[240:243], v4 offset:19456
    ds_read_b128 v[244:247], v4 offset:39936
    s_waitcnt vmcnt(8) lgkmcnt(4)
    v_mfma_f32_16x16x32_bf16 v[224:227], v[84:87], v[248:251], v[224:227]
    v_mfma_f32_16x16x32_bf16 v[228:231], v[84:87], v[252:255], v[228:231]
    s_waitcnt vmcnt(4) lgkmcnt(2)
    v_mfma_f32_16x16x32_bf16 v[224:227], v[88:91], v[232:235], v[224:227]
    v_mfma_f32_16x16x32_bf16 v[228:231], v[88:91], v[236:239], v[228:231]
    s_waitcnt vmcnt(0) lgkmcnt(0)
    v_mfma_f32_16x16x32_bf16 v[224:227], v[92:95], v[240:243], v[224:227]
    v_mfma_f32_16x16x32_bf16 v[228:231], v[92:95], v[244:247], v[228:231]
    s_nop 6
    v_cvt_pk_bf16_f32 v112, v224, v225
    v_lshlrev_b32 v114, 16, v96
    v_and_b32 v115, s26, v96
    v_and_b32 v113, s26, v112
    v_lshlrev_b32 v112, 16, v112
    v_lshlrev_b32 v116, 16, v100
    v_and_b32 v117, s26, v100
    v_pk_add_f32 v[112:113], v[112:113], v[114:115]
    v_pk_add_f32 v[116:117], v[116:117], v[104:105]
    v_cvt_pk_bf16_f32 v112, v112, v113
    v_cvt_pk_bf16_f32 v116, v116, v117
    v_and_b32 v113, s26, v112
    v_lshlrev_b32 v112, 16, v112
    v_and_b32 v117, s26, v116
    v_lshlrev_b32 v116, 16, v116
    v_pk_add_f32 v[112:113], v[112:113], v[116:117]
    v_cvt_pk_bf16_f32 v120, v112, v113
    v_cvt_pk_bf16_f32 v112, v226, v227
    v_lshlrev_b32 v114, 16, v97
    v_and_b32 v115, s26, v97
    v_and_b32 v113, s26, v112
    v_lshlrev_b32 v112, 16, v112
    v_lshlrev_b32 v116, 16, v101
    v_and_b32 v117, s26, v101
    v_pk_add_f32 v[112:113], v[112:113], v[114:115]
    v_pk_add_f32 v[116:117], v[116:117], v[106:107]
    v_cvt_pk_bf16_f32 v112, v112, v113
    v_cvt_pk_bf16_f32 v116, v116, v117
    v_and_b32 v113, s26, v112
    v_lshlrev_b32 v112, 16, v112
    v_and_b32 v117, s26, v116
    v_lshlrev_b32 v116, 16, v116
    v_pk_add_f32 v[112:113], v[112:113], v[116:117]
    v_cvt_pk_bf16_f32 v121, v112, v113
    buffer_store_dwordx2 v[120:121], v5, s[68:71], s30 offen
    v_cvt_pk_bf16_f32 v112, v228, v229
    v_lshlrev_b32 v114, 16, v98
    v_and_b32 v115, s26, v98
    v_and_b32 v113, s26, v112
    v_lshlrev_b32 v112, 16, v112
    v_lshlrev_b32 v116, 16, v102
    v_and_b32 v117, s26, v102
    v_pk_add_f32 v[112:113], v[112:113], v[114:115]
    v_pk_add_f32 v[116:117], v[116:117], v[108:109]
    v_cvt_pk_bf16_f32 v112, v112, v113
    v_cvt_pk_bf16_f32 v116, v116, v117
    v_and_b32 v113, s26, v112
    v_lshlrev_b32 v112, 16, v112
    v_and_b32 v117, s26, v116
    v_lshlrev_b32 v116, 16, v116
    v_pk_add_f32 v[112:113], v[112:113], v[116:117]
    v_cvt_pk_bf16_f32 v122, v112, v113
    v_cvt_pk_bf16_f32 v112, v230, v231
    v_lshlrev_b32 v114, 16, v99
    v_and_b32 v115, s26, v99
    v_and_b32 v113, s26, v112
    v_lshlrev_b32 v112, 16, v112
    v_lshlrev_b32 v116, 16, v103
    v_and_b32 v117, s26, v103
    v_pk_add_f32 v[112:113], v[112:113], v[114:115]
    v_pk_add_f32 v[116:117], v[116:117], v[110:111]
    v_cvt_pk_bf16_f32 v112, v112, v113
    v_cvt_pk_bf16_f32 v116, v116, v117
    v_and_b32 v113, s26, v112
    v_lshlrev_b32 v112, 16, v112
    v_and_b32 v117, s26, v116
    v_lshlrev_b32 v116, 16, v116
    v_pk_add_f32 v[112:113], v[112:113], v[116:117]
    v_cvt_pk_bf16_f32 v123, v112, v113
    buffer_store_dwordx2 v[122:123], v5, s[68:71], s31 offen
KM_adv:
    s_cmp_lg_u32 s20, 703
    s_cbranch_scc1 KM_ne
    s_cmp_lg_u32 s3, 0
    s_cbranch_scc1 KM_ne
    s_mov_b32 s28, 573440
    v_mov_b32 v6, s96
    v_mov_b32 v7, 0
    s_mov_b64 exec, 1
    buffer_store_dword v6, v7, s[92:95], s28 offen sc1
    s_mov_b64 exec, -1
KM_ne:
    s_add_u32 s20, s20, 48
    s_cmp_lt_u32 s20, 704
    s_cbranch_scc1 KM_next
KM_end:
K3_end:
    s_endpgm
K3_bail:
    s_mov_b64 exec, -1
    s_add_u32 s36, s18, 0x5d00000
    s_addc_u32 s37, s19, 0
    s_mov_b32 s38, 0xb8000
    s_mov_b32 s39, 0x20000
    s_mov_b32 s28, 573440
    v_mov_b32 v6, s96
    v_mov_b32 v7, 0
    s_mov_b64 exec, 1
    buffer_store_dword v6, v7, s[36:39], s28 offen sc1
    s_mov_b64 exec, -1
    s_endpgm

.section .rodata,"a"
.p2align 6
.amdhsa_kernel parallel_sum__memory_aug_recurrent_mem_tr__moe_arch_mod__prompt_kernel
  .amdhsa_next_free_vgpr 512
  .amdhsa_next_free_sgpr 102
  .amdhsa_accum_offset 256
  .amdhsa_group_segment_fixed_size 0
  .amdhsa_kernarg_size 120
  .amdhsa_user_sgpr_count 2
  .amdhsa_user_sgpr_kernarg_segment_ptr 1
  .amdhsa_system_sgpr_workgroup_id_x 1
.end_amdhsa_kernel
```
